```python
import torch

def _softmax(x, axis=-1):
    return torch.softmax(x, dim=axis)
def _gelu(x):
    return torch.nn.functional.gelu(x, approximate="tanh")
def _silu(x):
    return torch.nn.functional.silu(x)
def _sigmoid(x):
    return torch.sigmoid(x)
def _layernorm(x, axis=-1, eps=1e-5):
    m = x.mean(dim=axis, keepdim=True)
    v = x.var(dim=axis, keepdim=True, unbiased=False)
    return (x - m) / torch.sqrt(v + eps)
def _scatter_add(tgt, idx, src, axis=0):
    return tgt.clone().index_add_(axis, idx, src)
def _segment_sum(src, seg, n):
    out = torch.zeros((n,) + src.shape[1:], dtype=src.dtype)
    return out.index_add_(0, seg, src)
def _pad(x, pw):
    flat = tuple(v for pair in reversed(pw) for v in pair)
    return torch.nn.functional.pad(x, flat)

kernel_name = 'recurrent_scan__gqa_block_cached__mixer_s_mlp__prompt'

def setup_inputs():

    _w = (lambda a: (lambda t: t.to(torch.bfloat16) if t.is_floating_point() else t)(torch.as_tensor(a)))
    def _A_setup():
        B, Sq, D = 1, 2048, 512
        Hq, Hkv, Sk, Dh = 32, 8, 2048, 128
        assert Hq % Hkv == 0, (Hq, Hkv)
        return {
            "x": _w((lambda *s: torch.randn(*s, dtype=torch.bfloat16) * 0.05)(B, Sq, D)),
            "k_cache": _w((lambda *s: torch.randn(*s, dtype=torch.bfloat16) * 0.8)(B, Hkv, Sk, Dh)),
            "v_cache": _w((lambda *s: torch.randn(*s, dtype=torch.bfloat16) * 0.8)(B, Hkv, Sk, Dh)),
            "wq": _w((lambda *s: torch.randn(*s, dtype=torch.bfloat16) * 0.8)(D, Hq * Dh) * (D ** -0.5)),
            "wo": _w((lambda *s: torch.randn(*s, dtype=torch.bfloat16) * 0.8)(Hq * Dh, D) * ((Hq * Dh) ** -0.5)),
        }
    _A_in = _A_setup()

    def _B_setup():
        B, S, D, F = 1, 2048, 512, 1792
        return {
            "x":  _w((lambda *s: torch.randn(*s, dtype=torch.bfloat16) * 0.05)(B, S, D)),
            "w1": _w((lambda *s: torch.randn(*s, dtype=torch.bfloat16) * 3.2)(D, D) * (D ** -0.5)),
            "w2": _w((lambda *s: torch.randn(*s, dtype=torch.bfloat16) * 3.2)(D, D) * (D ** -0.5)),
            "w3": _w((lambda *s: torch.randn(*s, dtype=torch.bfloat16) * 3.2)(D, F) * (D ** -0.5)),
            "w4": _w((lambda *s: torch.randn(*s, dtype=torch.bfloat16) * 1.6)(F, D) * (F ** -0.5)),
        }
    _B_in = _B_setup()

    return {
        "A_x": _A_in["x"],
        "A_k_cache": _A_in["k_cache"],
        "A_v_cache": _A_in["v_cache"],
        "A_wq": _A_in["wq"],
        "A_wo": _A_in["wo"],
        "B_x": _B_in["x"],
        "B_w1": _B_in["w1"],
        "B_w2": _B_in["w2"],
        "B_w3": _B_in["w3"],
        "B_w4": _B_in["w4"],
    }

def reference(A_x, A_k_cache, A_v_cache, A_wq, A_wo, B_x, B_w1, B_w2, B_w3, B_w4):
    def _A_ref(x, k_cache, v_cache, wq, wo):
        B, Sq, D = x.shape
        Hq, Dh = 32, 128
        Hkv = k_cache.shape[1]
        rep = Hq // Hkv
        q = (lambda x, *d: x.permute(*d))((x @ wq).reshape(B, Sq, Hq, Dh), 0, 2, 1, 3)
        k = (lambda x, n, axis: torch.repeat_interleave(x, n, dim=axis))(k_cache, rep, axis=1)
        v = (lambda x, n, axis: torch.repeat_interleave(x, n, dim=axis))(v_cache, rep, axis=1)
        scores = torch.einsum("bhqd,bhkd->bhqk", q, k) * (Dh ** -0.5)
        p = _softmax(scores, axis=-1)
        o = torch.einsum("bhqk,bhkd->bhqd", p, v)
        return (lambda x, *d: x.permute(*d))(o, 0, 2, 1, 3).reshape(B, Sq, Hq * Dh) @ wo

    def _B_ref(x, w1, w2, w3, w4):
        B, S, D = x.shape
        h = _gelu(_layernorm(x, axis=-1) @ w1)
        c = D // 4
        g0 = _pad(h[:, :, 0*c:1*c], ((0, 0), (1, 0), (0, 0)))[:, :S, :]
        g1 = _pad(h[:, :, 1*c:2*c], ((0, 0), (0, 1), (0, 0)))[:, 1:, :]
        g2 = _pad(h[:, :, 2*c:3*c], ((0, 0), (2, 0), (0, 0)))[:, :S, :]
        g3 = _pad(h[:, :, 3*c:   ], ((0, 0), (0, 2), (0, 0)))[:, 2:, :]
        hs = torch.concatenate([g0, g1, g2, g3], axis=-1) @ w2
        x1 = x + hs
        h2 = _gelu(_layernorm(x1, axis=-1) @ w3) @ w4
        return x1 + h2

    x = A_x
    xn = _layernorm(x, axis=-1)
    s = _A_ref(xn, A_k_cache, A_v_cache, A_wq, A_wo)
    g = _silu(_B_ref(xn, B_w1, B_w2, B_w3, B_w4))
    return x + s * g
```

```asm
; @launch grid=(256,1,1) block=(256,1,1) lds=163840
.amdgcn_target "amdgcn-amd-amdhsa--gfx950"
.macro mf x:vararg
 v_mfma_f32_16x16x32_bf16 \x
.endm
.macro rt x:vararg
 ds_read_b64_tr_b16 \x
.endm
.macro pk x:vararg
 v_cvt_pk_bf16_f32 \x
.endm
.macro bl x:vararg
 buffer_load_dwordx4 \x
.endm
.macro rq x:vararg
 ds_read_b128 \x
.endm
.text
.globl recurrent_scan__gqa_block_cached__mixer_s_mlp__prompt_kernel
.p2align 8
.type recurrent_scan__gqa_block_cached__mixer_s_mlp__prompt_kernel,@function
recurrent_scan__gqa_block_cached__mixer_s_mlp__prompt_kernel:
 s_cmp_lt_u32 s2,256
 s_cbranch_scc1 L_go
 s_endpgm
L_go:
 s_load_dwordx16 s[64:79],s[0:1],0
 s_load_dwordx8 s[80:87],s[0:1],64
 s_load_dwordx2 s[88:89],s[0:1],96
 s_and_b32 s52,s2,7
 s_lshr_b32 s53,s2,3
 s_lshr_b32 s90,s2,3
 v_lshrrev_b32 v1,6,v0
 v_and_b32 v0,63,v0
 v_readfirstlane_b32 s54,v1
 v_lshlrev_b32 v255,4,v0
 v_lshlrev_b32 v251,7,v0
 s_getpc_b64 s[56:57]
L_pc:
 s_lshr_b32 s58,s2,3
 s_lshl_b32 s55,s58,9
 s_lshl_b32 s59,s54,7
 s_add_u32 s55,s55,s59
 v_min_u32 v6,9,v0
 v_lshl_add_u32 v6,v6,14,s55
 v_min_u32 v6,L_end-L_pc,v6
 v_mov_b32 v249,s57
 v_add_co_u32 v248,vcc,s56,v6
 s_nop 1
 v_addc_co_u32 v249,vcc,0,v249,vcc
 s_mov_b64 exec,15
 global_load_dword a255,v[248:249],off
 s_mov_b64 exec,-1
 s_lshl_b32 s91,s90,2
 s_lshl_b32 s59,s54,0
 s_add_u32 s91,s91,s59
 v_lshrrev_b32 v6,10,v251
 v_min_u32 v6,0,v6
 s_mul_i32 s55,s91,1
 v_add_u32 v6,s55,v6
 v_mul_u32_u24 v6,8192,v6
 s_lshl_b32 s55,s52,10
 v_and_b32 v7,896,v251
 v_add3_u32 v6,v6,v7,s55
 v_lshrrev_b32 v239,7,v251
 v_min_u32 v239,3,v239
 s_mul_i32 s55,s91,4
 v_add_u32 v239,s55,v239
 v_mul_u32_u24 v239,1024,v239
 s_lshl_b32 s55,s52,7
 v_add_u32 v239,s55,v239
 v_and_b32 v2,3,v0
 v_lshrrev_b32 v1,2,v0
 s_lshl_b32 s55,s53,6
 s_lshl_b32 s59,s54,4
 s_add_u32 s55,s55,s59
 v_add_u32 v3,s55,v1
 v_lshlrev_b32 v3,10,v3
 v_lshl_add_u32 v3,v2,4,v3
 s_bfe_u32 s56,s52,65536
 s_lshl_b32 s57,s56,9
 v_add_u32 v3,s57,v3
 v_xor_b32 v205,0x200,v3
 s_waitcnt lgkmcnt(0)
 global_load_dword a255,v239,s[76:77]
 global_load_dword a255,v6,s[70:71]
 global_load_dwordx4 v[128:131],v3,s[64:65] offset:0
 global_load_dwordx4 v[132:135],v3,s[64:65] offset:64
 global_load_dwordx4 v[136:139],v3,s[64:65] offset:128
 global_load_dwordx4 v[140:143],v3,s[64:65] offset:192
 global_load_dwordx4 v[144:147],v3,s[64:65] offset:256
 global_load_dwordx4 v[148:151],v3,s[64:65] offset:320
 global_load_dwordx4 v[152:155],v3,s[64:65] offset:384
 global_load_dwordx4 v[156:159],v3,s[64:65] offset:448
 s_branch L_main
.p2align 12
L_main:
 v_lshlrev_b32 v4,1,v2
 v_xor_b32 v4,v4,v1
 v_lshlrev_b32 v4,4,v4
 v_lshl_add_u32 v4,v2,8,v4
 s_lshl_b32 s57,s56,15
 s_lshl_b32 s59,s54,10
 s_add_u32 s57,s57,s59
 v_add_u32 v235,s57,v4
 v_xor_b32 v236,0x8000,v235
 v_and_b32 v1,15,v0
 v_lshrrev_b32 v2,4,v0
 v_lshlrev_b32 v4,1,v2
 v_xor_b32 v4,v4,v1
 v_lshlrev_b32 v4,4,v4
 v_lshl_add_u32 v234,v2,8,v4
 v_add_u32 v3,s55,v1
 v_lshlrev_b32 v4,15,v2
 v_lshl_add_u32 v254,v3,4,v4
 s_lshl_b32 s55,s52,19
 s_add_u32 s8,s66,s55
 s_addc_u32 s9,s67,0
 s_mov_b32 s10,0x80000
 s_mov_b32 s11,0x20000
 s_lshl_b32 s55,s52,19
 s_add_u32 s12,s68,s55
 s_addc_u32 s13,s69,0
 s_mov_b32 s14,0x80000
 s_mov_b32 s15,0x20000
 s_mov_b32 s4,s64
 s_mov_b32 s5,s65
 s_mov_b32 s6,2097152
 s_mov_b32 s7,0x20000
 s_mov_b32 s20,s70
 s_mov_b32 s21,s71
 s_mov_b32 s22,4194304
 s_mov_b32 s23,0x20000
 s_mov_b32 s28,s76
 s_mov_b32 s29,s77
 s_mov_b32 s30,524288
 s_mov_b32 s31,0x20000
 s_mov_b32 s16,s88
 s_mov_b32 s17,s89
 s_mov_b32 s18,268435456
 s_mov_b32 s19,0x20000
 s_mov_b32 s24,s72
 s_mov_b32 s25,s73
 s_mov_b32 s26,4194304
 s_mov_b32 s27,0x20000
 s_mov_b32 s32,s78
 s_mov_b32 s33,s79
 s_mov_b32 s34,524288
 s_mov_b32 s35,0x20000
 s_mov_b32 s36,s80
 s_mov_b32 s37,s81
 s_mov_b32 s38,1835008
 s_mov_b32 s39,0x20000
 s_mov_b32 s40,s82
 s_mov_b32 s41,s83
 s_mov_b32 s42,1835008
 s_mov_b32 s43,0x20000
 s_mov_b32 s44,s84
 s_mov_b32 s45,s85
 s_mov_b32 s46,2097152
 s_mov_b32 s47,0x20000
 s_mov_b32 s48,s86
 s_mov_b32 s49,s87
 s_mov_b32 s50,256
 s_mov_b32 s51,0x20000
 s_lshl_b32 s62,s54,13
 s_add_u32 s62,s62,65536
 s_lshl_b32 s60,s54,10
 s_lshl_b32 s61,s54,12
 s_lshl_b32 s55,s52,10
 s_lshl_b32 s59,s54,8
 s_add_u32 s55,s55,s59
 v_lshrrev_b32 v10,10,v251
 v_bfe_u32 v11,v255,4,3
 v_and_b32 v240,6,v10
 v_xor_b32 v11,v11,v240
 v_and_b32 v240,4,v10
 v_add_u32 v10,v10,v240
 v_mul_u32_u24 v10,8192,v10
 v_lshl_add_u32 v10,v11,4,v10
 v_add_u32 v240,s55,v10
 s_lshl_b32 s55,s54,16
 s_lshl_b32 s59,s52,7
 s_add_u32 s55,s55,s59
 v_lshrrev_b32 v10,10,v251
 v_bfe_u32 v11,v255,4,3
 v_and_b32 v241,6,v10
 v_xor_b32 v11,v11,v241
 v_and_b32 v241,4,v10
 v_add_u32 v10,v10,v241
 v_mul_u32_u24 v10,1024,v10
 v_lshl_add_u32 v10,v11,4,v10
 v_add_u32 v241,s55,v10
 v_lshrrev_b32 v10,10,v251
 v_bfe_u32 v11,v255,4,3
 v_and_b32 v243,6,v10
 v_xor_b32 v11,v11,v243
 v_mul_u32_u24 v10,1024,v10
 v_lshl_add_u32 v10,v11,4,v10
 v_add_u32 v243,s55,v10
 s_mov_b32 s75,0x00003f80
 s_mov_b32 s76,0x3f800000
 s_mov_b32 s77,0x3f803f80
 s_mov_b32 s78,0x409d30fc
 s_mov_b32 s79,0x3eeff558
 s_mov_b32 s80,0xc0450298
 s_mov_b32 s66,0
 s_mov_b32 s82,0xffff0000
 s_lshl_b32 s71,s53,12
 s_lshl_b32 s59,s54,8
 s_add_u32 s71,s71,s59
 s_add_u32 s71,s71,37748736
 s_lshl_b32 s70,s52,2
 s_lshl_b32 s59,s71,0
 s_add_u32 s70,s70,s59
 s_lshl_b32 s72,s53,12
 s_lshl_b32 s59,s52,7
 s_add_u32 s72,s72,s59
 s_add_u32 s72,s72,37749760
 s_add_u32 s81,s72,1024
 s_add_u32 s84,s72,2048
 s_lshl_b32 s74,s53,12
 s_lshl_b32 s59,s54,10
 s_add_u32 s74,s74,s59
 s_add_u32 s74,s74,38797312
 s_lshl_b32 s73,s52,7
 s_lshl_b32 s59,s74,0
 s_add_u32 s73,s73,s59
 s_lshl_b32 s68,s53,19
 s_lshl_b32 s59,s54,17
 s_add_u32 s68,s68,s59
 s_lshl_b32 s59,s52,13
 s_add_u32 s68,s68,s59
 s_lshl_b32 s69,s53,19
 s_lshl_b32 s59,s52,16
 s_add_u32 s69,s69,s59
 s_lshl_b32 s59,s54,11
 s_add_u32 s69,s69,s59
 s_lshl_b32 s67,s52,18
 s_and_b32 s83,s52,6
 s_lshl_b32 s83,s83,1
 s_lshr_b32 s55,s54,1
 s_add_u32 s83,s83,s55
 s_and_b32 s85,s52,1
 s_lshl_b32 s85,s85,1
 s_and_b32 s55,s54,1
 s_add_u32 s85,s85,s55
 s_lshl_b32 s86,s53,12
 s_lshl_b32 s59,s85,10
 s_add_u32 s86,s86,s59
 s_add_u32 s86,s86,38797312
 s_lshl_b32 s87,s53,16
 s_lshl_b32 s59,s85,14
 s_add_u32 s87,s87,s59
 s_lshl_b32 s59,s83,6
 s_add_u32 s87,s87,s59
 s_and_b32 s55,s52,1
 s_mul_i32 s89,s52,448
 s_lshl_b32 s59,s55,6
 s_add_u32 s89,s89,s59
 s_lshl_b32 s88,s54,11
 s_add_u32 s88,s88,65536
 v_lshrrev_b32 v6,2,v0
 v_and_b32 v7,3,v0
 v_lshlrev_b32 v7,3,v7
 v_lshl_add_u32 v7,v6,7,v7
 v_bfe_u32 v6,v0,3,2
 v_xor_b32 v10,0,v6
 v_lshl_add_u32 v10,v10,5,v7
 v_add_u32 v244,98304,v10
 v_lshrrev_b32 v8,2,v0
 v_and_b32 v9,6,v8
 v_and_b32 v10,3,v0
 v_xor_b32 v9,v9,v10
 v_xor_b32 v9,0,v9
 v_lshlrev_b32 v9,4,v9
 v_lshl_add_u32 v10,v8,7,v9
 v_add_u32 v226,s62,v10
 v_add_u32 v230,0x10000,v226
 v_xor_b32 v10,1,v6
 v_lshl_add_u32 v10,v10,5,v7
 v_add_u32 v245,98304,v10
 v_lshrrev_b32 v8,2,v0
 v_and_b32 v9,6,v8
 v_and_b32 v10,3,v0
 v_xor_b32 v9,v9,v10
 v_xor_b32 v9,0,v9
 v_lshlrev_b32 v9,4,v9
 v_lshl_add_u32 v10,v8,7,v9
 v_add_u32 v10,8,v10
 v_add_u32 v227,s62,v10
 v_add_u32 v231,0x10000,v227
 v_xor_b32 v10,2,v6
 v_lshl_add_u32 v10,v10,5,v7
 v_add_u32 v246,98304,v10
 v_lshrrev_b32 v8,2,v0
 v_and_b32 v9,6,v8
 v_and_b32 v10,3,v0
 v_xor_b32 v9,v9,v10
 v_xor_b32 v9,4,v9
 v_lshlrev_b32 v9,4,v9
 v_lshl_add_u32 v10,v8,7,v9
 v_add_u32 v228,s62,v10
 v_add_u32 v232,0x10000,v228
 v_xor_b32 v10,3,v6
 v_lshl_add_u32 v10,v10,5,v7
 v_add_u32 v247,98304,v10
 v_lshrrev_b32 v8,2,v0
 v_and_b32 v9,6,v8
 v_and_b32 v10,3,v0
 v_xor_b32 v9,v9,v10
 v_xor_b32 v9,4,v9
 v_lshlrev_b32 v9,4,v9
 v_lshl_add_u32 v10,v8,7,v9
 v_add_u32 v10,8,v10
 v_add_u32 v229,s62,v10
 v_add_u32 v233,0x10000,v229
 v_xor_b32 v9,v2,v1
 v_xor_b32 v10,0,v9
 v_lshlrev_b32 v10,4,v10
 v_lshl_add_u32 v208,v1,8,v10
 v_xor_b32 v10,4,v9
 v_lshlrev_b32 v10,4,v10
 v_lshl_add_u32 v209,v1,8,v10
 v_xor_b32 v10,8,v9
 v_lshlrev_b32 v10,4,v10
 v_lshl_add_u32 v210,v1,8,v10
 v_xor_b32 v10,12,v9
 v_lshlrev_b32 v10,4,v10
 v_lshl_add_u32 v211,v1,8,v10
 v_lshrrev_b32 v9,2,v0
 v_lshlrev_b32 v10,8,v9
 v_and_b32 v11,3,v0
 v_lshl_add_u32 v10,v11,3,v10
 v_add_u32 v10,65536,v10
 v_and_b32 v9,7,v9
 v_xor_b32 v11,0,v9
 v_lshl_add_u32 v212,v11,5,v10
 v_xor_b32 v11,1,v9
 v_lshl_add_u32 v213,v11,5,v10
 v_xor_b32 v11,2,v9
 v_lshl_add_u32 v214,v11,5,v10
 v_xor_b32 v11,3,v9
 v_lshl_add_u32 v215,v11,5,v10
 v_xor_b32 v11,4,v9
 v_lshl_add_u32 v216,v11,5,v10
 v_xor_b32 v11,5,v9
 v_lshl_add_u32 v217,v11,5,v10
 v_xor_b32 v11,6,v9
 v_lshl_add_u32 v218,v11,5,v10
 v_xor_b32 v11,7,v9
 v_lshl_add_u32 v219,v11,5,v10
 v_lshl_add_u32 v10,v2,8,s61
 v_add_u32 v9,0,v2
 v_xor_b32 v11,v9,v1
 v_lshl_add_u32 v220,v11,4,v10
 v_lshlrev_b32 v9,1,v9
 v_xor_b32 v11,v9,v1
 v_lshl_add_u32 v224,v11,4,v10
 v_add_u32 v9,4,v2
 v_xor_b32 v11,v9,v1
 v_lshl_add_u32 v221,v11,4,v10
 v_lshlrev_b32 v9,1,v9
 v_xor_b32 v11,v9,v1
 v_lshl_add_u32 v225,v11,4,v10
 v_add_u32 v9,8,v2
 v_xor_b32 v11,v9,v1
 v_lshl_add_u32 v222,v11,4,v10
 v_add_u32 v9,12,v2
 v_xor_b32 v11,v9,v1
 v_lshl_add_u32 v223,v11,4,v10
 v_lshlrev_b32 v200,4,v1
 v_lshrrev_b32 v237,10,v251
 v_min_u32 v237,2,v237
 s_mul_i32 s55,s91,3
 v_add_u32 v237,s55,v237
 v_mul_u32_u24 v237,8192,v237
 s_lshl_b32 s55,s52,10
 s_add_u32 s55,s55,1048576
 v_and_b32 v7,896,v251
 v_add3_u32 v237,v237,v7,s55
 v_lshrrev_b32 v242,7,v251
 v_min_u32 v242,2,v242
 s_mul_i32 s55,s91,3
 v_add_u32 v242,s55,v242
 v_mul_u32_u24 v242,128,v242
 s_mov_b32 s55,0
 v_add_u32 v242,s55,v242
 s_mov_b64 exec,0
 s_cmp_eq_u32 s54,0
 s_cbranch_scc1 L_pad_pg1
 s_cmp_eq_u32 s54,1
 s_cbranch_scc1 L_pad_pg2
 s_cmp_eq_u32 s54,2
 s_cbranch_scc1 L_pad_pg3
 s_branch L_pad_pg4
L_hop0:
 s_mov_b64 exec,-1
 bl v[160:163],v205,s[4:7],0 offen offset:0
 bl v[164:167],v205,s[4:7],0 offen offset:64
 bl v[168:171],v205,s[4:7],0 offen offset:128
 bl v[172:175],v205,s[4:7],0 offen offset:192
 bl v[176:179],v205,s[4:7],0 offen offset:256
 bl v[180:183],v205,s[4:7],0 offen offset:320
 bl v[184:187],v205,s[4:7],0 offen offset:384
 bl v[188:191],v205,s[4:7],0 offen offset:448
 s_mov_b64 exec,0
 s_cmp_eq_u32 s54,0
 s_cbranch_scc1 L_pad_pg5
 s_cmp_eq_u32 s54,1
 s_cbranch_scc1 L_pad_pg6
 s_cmp_eq_u32 s54,2
 s_cbranch_scc1 L_pad_pg7
 s_branch L_pad_pg8
L_hop1:
 s_mov_b64 exec,-1
 s_waitcnt vmcnt(15)
 v_dot2_f32_bf16 v192,v128,s77,0
 v_dot2_f32_bf16 v194,v128,v128,0
 v_dot2_f32_bf16 v193,v129,s77,0
 v_dot2_f32_bf16 v195,v129,v129,0
 v_dot2_f32_bf16 v192,v130,s77,v192
 v_dot2_f32_bf16 v194,v130,v130,v194
 v_dot2_f32_bf16 v193,v131,s77,v193
 v_dot2_f32_bf16 v195,v131,v131,v195
 v_lshlrev_b32 v0,16,v128
 v_and_b32 v1,s82,v128
 v_lshlrev_b32 v2,16,v129
 v_and_b32 v3,s82,v129
 v_lshlrev_b32 v4,16,v130
 v_and_b32 v5,s82,v130
 v_lshlrev_b32 v6,16,v131
 v_and_b32 v7,s82,v131
 s_waitcnt vmcnt(14)
 v_dot2_f32_bf16 v192,v132,s77,v192
 v_dot2_f32_bf16 v194,v132,v132,v194
 v_dot2_f32_bf16 v193,v133,s77,v193
 v_dot2_f32_bf16 v195,v133,v133,v195
 v_dot2_f32_bf16 v192,v134,s77,v192
 v_dot2_f32_bf16 v194,v134,v134,v194
 v_dot2_f32_bf16 v193,v135,s77,v193
 v_dot2_f32_bf16 v195,v135,v135,v195
 v_lshlrev_b32 v8,16,v132
 v_and_b32 v9,s82,v132
 v_lshlrev_b32 v10,16,v133
 v_and_b32 v11,s82,v133
 v_lshlrev_b32 v12,16,v134
 v_and_b32 v13,s82,v134
 v_lshlrev_b32 v14,16,v135
 v_and_b32 v15,s82,v135
 s_waitcnt vmcnt(13)
 v_dot2_f32_bf16 v192,v136,s77,v192
 v_dot2_f32_bf16 v194,v136,v136,v194
 v_dot2_f32_bf16 v193,v137,s77,v193
 v_dot2_f32_bf16 v195,v137,v137,v195
 v_dot2_f32_bf16 v192,v138,s77,v192
 v_dot2_f32_bf16 v194,v138,v138,v194
 v_dot2_f32_bf16 v193,v139,s77,v193
 v_dot2_f32_bf16 v195,v139,v139,v195
 v_lshlrev_b32 v16,16,v136
 v_and_b32 v17,s82,v136
 v_lshlrev_b32 v18,16,v137
 v_and_b32 v19,s82,v137
 v_lshlrev_b32 v20,16,v138
 v_and_b32 v21,s82,v138
 v_lshlrev_b32 v22,16,v139
 v_and_b32 v23,s82,v139
 s_waitcnt vmcnt(12)
 v_dot2_f32_bf16 v192,v140,s77,v192
 v_dot2_f32_bf16 v194,v140,v140,v194
 v_dot2_f32_bf16 v193,v141,s77,v193
 v_dot2_f32_bf16 v195,v141,v141,v195
 v_dot2_f32_bf16 v192,v142,s77,v192
 v_dot2_f32_bf16 v194,v142,v142,v194
 v_dot2_f32_bf16 v193,v143,s77,v193
 v_dot2_f32_bf16 v195,v143,v143,v195
 v_lshlrev_b32 v24,16,v140
 v_and_b32 v25,s82,v140
 v_lshlrev_b32 v26,16,v141
 v_and_b32 v27,s82,v141
 v_lshlrev_b32 v28,16,v142
 v_and_b32 v29,s82,v142
 v_lshlrev_b32 v30,16,v143
 v_and_b32 v31,s82,v143
 s_waitcnt vmcnt(11)
 v_dot2_f32_bf16 v192,v144,s77,v192
 v_dot2_f32_bf16 v194,v144,v144,v194
 v_dot2_f32_bf16 v193,v145,s77,v193
 v_dot2_f32_bf16 v195,v145,v145,v195
 v_dot2_f32_bf16 v192,v146,s77,v192
 v_dot2_f32_bf16 v194,v146,v146,v194
 v_dot2_f32_bf16 v193,v147,s77,v193
 v_dot2_f32_bf16 v195,v147,v147,v195
 v_lshlrev_b32 v32,16,v144
 v_and_b32 v33,s82,v144
 v_lshlrev_b32 v34,16,v145
 v_and_b32 v35,s82,v145
 v_lshlrev_b32 v36,16,v146
 v_and_b32 v37,s82,v146
 v_lshlrev_b32 v38,16,v147
 v_and_b32 v39,s82,v147
 s_waitcnt vmcnt(10)
 v_dot2_f32_bf16 v192,v148,s77,v192
 v_dot2_f32_bf16 v194,v148,v148,v194
 v_dot2_f32_bf16 v193,v149,s77,v193
 v_dot2_f32_bf16 v195,v149,v149,v195
 v_dot2_f32_bf16 v192,v150,s77,v192
 v_dot2_f32_bf16 v194,v150,v150,v194
 v_dot2_f32_bf16 v193,v151,s77,v193
 v_dot2_f32_bf16 v195,v151,v151,v195
 v_lshlrev_b32 v40,16,v148
 v_and_b32 v41,s82,v148
 v_lshlrev_b32 v42,16,v149
 v_and_b32 v43,s82,v149
 v_lshlrev_b32 v44,16,v150
 v_and_b32 v45,s82,v150
 v_lshlrev_b32 v46,16,v151
 v_and_b32 v47,s82,v151
 s_waitcnt vmcnt(9)
 v_dot2_f32_bf16 v192,v152,s77,v192
 v_dot2_f32_bf16 v194,v152,v152,v194
 v_dot2_f32_bf16 v193,v153,s77,v193
 v_dot2_f32_bf16 v195,v153,v153,v195
 v_dot2_f32_bf16 v192,v154,s77,v192
 v_dot2_f32_bf16 v194,v154,v154,v194
 v_dot2_f32_bf16 v193,v155,s77,v193
 v_dot2_f32_bf16 v195,v155,v155,v195
 v_lshlrev_b32 v48,16,v152
 v_and_b32 v49,s82,v152
 v_lshlrev_b32 v50,16,v153
 v_and_b32 v51,s82,v153
 v_lshlrev_b32 v52,16,v154
 v_and_b32 v53,s82,v154
 v_lshlrev_b32 v54,16,v155
 v_and_b32 v55,s82,v155
 s_waitcnt vmcnt(8)
 v_dot2_f32_bf16 v192,v156,s77,v192
 v_dot2_f32_bf16 v194,v156,v156,v194
 v_dot2_f32_bf16 v193,v157,s77,v193
 v_dot2_f32_bf16 v195,v157,v157,v195
 v_dot2_f32_bf16 v192,v158,s77,v192
 v_dot2_f32_bf16 v194,v158,v158,v194
 v_dot2_f32_bf16 v193,v159,s77,v193
 v_dot2_f32_bf16 v195,v159,v159,v195
 v_lshlrev_b32 v56,16,v156
 v_and_b32 v57,s82,v156
 v_lshlrev_b32 v58,16,v157
 v_and_b32 v59,s82,v157
 v_lshlrev_b32 v60,16,v158
 v_and_b32 v61,s82,v158
 v_lshlrev_b32 v62,16,v159
 v_and_b32 v63,s82,v159
 s_mov_b64 exec,0
 s_cmp_eq_u32 s54,0
 s_cbranch_scc1 L_pad_pg9
 s_cmp_eq_u32 s54,1
 s_cbranch_scc1 L_pad_pg10
 s_cmp_eq_u32 s54,2
 s_cbranch_scc1 L_pad_pg11
 s_branch L_pad_pg12
L_hop2:
 s_mov_b64 exec,-1
 s_waitcnt vmcnt(7)
 v_dot2_f32_bf16 v192,v160,s77,v192
 v_dot2_f32_bf16 v194,v160,v160,v194
 v_dot2_f32_bf16 v193,v161,s77,v193
 v_dot2_f32_bf16 v195,v161,v161,v195
 v_dot2_f32_bf16 v192,v162,s77,v192
 v_dot2_f32_bf16 v194,v162,v162,v194
 v_dot2_f32_bf16 v193,v163,s77,v193
 v_dot2_f32_bf16 v195,v163,v163,v195
 s_waitcnt vmcnt(6)
 v_dot2_f32_bf16 v192,v164,s77,v192
 v_dot2_f32_bf16 v194,v164,v164,v194
 v_dot2_f32_bf16 v193,v165,s77,v193
 v_dot2_f32_bf16 v195,v165,v165,v195
 v_dot2_f32_bf16 v192,v166,s77,v192
 v_dot2_f32_bf16 v194,v166,v166,v194
 v_dot2_f32_bf16 v193,v167,s77,v193
 v_dot2_f32_bf16 v195,v167,v167,v195
 s_waitcnt vmcnt(5)
 v_dot2_f32_bf16 v192,v168,s77,v192
 v_dot2_f32_bf16 v194,v168,v168,v194
 v_dot2_f32_bf16 v193,v169,s77,v193
 v_dot2_f32_bf16 v195,v169,v169,v195
 v_dot2_f32_bf16 v192,v170,s77,v192
 v_dot2_f32_bf16 v194,v170,v170,v194
 v_dot2_f32_bf16 v193,v171,s77,v193
 v_dot2_f32_bf16 v195,v171,v171,v195
 s_waitcnt vmcnt(4)
 v_dot2_f32_bf16 v192,v172,s77,v192
 v_dot2_f32_bf16 v194,v172,v172,v194
 v_dot2_f32_bf16 v193,v173,s77,v193
 v_dot2_f32_bf16 v195,v173,v173,v195
 v_dot2_f32_bf16 v192,v174,s77,v192
 v_dot2_f32_bf16 v194,v174,v174,v194
 v_dot2_f32_bf16 v193,v175,s77,v193
 v_dot2_f32_bf16 v195,v175,v175,v195
 s_waitcnt vmcnt(3)
 v_dot2_f32_bf16 v192,v176,s77,v192
 v_dot2_f32_bf16 v194,v176,v176,v194
 v_dot2_f32_bf16 v193,v177,s77,v193
 v_dot2_f32_bf16 v195,v177,v177,v195
 v_dot2_f32_bf16 v192,v178,s77,v192
 v_dot2_f32_bf16 v194,v178,v178,v194
 v_dot2_f32_bf16 v193,v179,s77,v193
 v_dot2_f32_bf16 v195,v179,v179,v195
 s_add_u32 m0,s62,32768
 s_mov_b32 s63,0
 bl v241,s[28:31],s63 offen offset:0 lds
 s_waitcnt vmcnt(3)
 v_dot2_f32_bf16 v192,v180,s77,v192
 v_dot2_f32_bf16 v194,v180,v180,v194
 v_dot2_f32_bf16 v193,v181,s77,v193
 v_dot2_f32_bf16 v195,v181,v181,v195
 v_dot2_f32_bf16 v192,v182,s77,v192
 v_dot2_f32_bf16 v194,v182,v182,v194
 v_dot2_f32_bf16 v193,v183,s77,v193
 v_dot2_f32_bf16 v195,v183,v183,v195
 s_waitcnt vmcnt(2)
 v_dot2_f32_bf16 v192,v184,s77,v192
 s_mov_b32 s63,15360
 bl v241,s[28:31],s63 offen offset:1024 lds
 v_dot2_f32_bf16 v194,v184,v184,v194
 v_dot2_f32_bf16 v193,v185,s77,v193
 v_dot2_f32_bf16 v195,v185,v185,v195
 v_dot2_f32_bf16 v192,v186,s77,v192
 v_dot2_f32_bf16 v194,v186,v186,v194
 v_dot2_f32_bf16 v193,v187,s77,v193
 v_dot2_f32_bf16 v195,v187,v187,v195
 s_waitcnt vmcnt(2)
 v_dot2_f32_bf16 v192,v188,s77,v192
 v_dot2_f32_bf16 v194,v188,v188,v194
 s_mov_b32 s63,2048
 bl v241,s[28:31],s63 offen offset:2048 lds
 v_dot2_f32_bf16 v193,v189,s77,v193
 v_dot2_f32_bf16 v195,v189,v189,v195
 v_dot2_f32_bf16 v192,v190,s77,v192
 v_dot2_f32_bf16 v194,v190,v190,v194
 v_dot2_f32_bf16 v193,v191,s77,v193
 v_dot2_f32_bf16 v195,v191,v191,v195
 s_nop 1
 v_add_f32 v192,v192,v193
 v_add_f32 v194,v194,v195
 s_nop 0
 v_add_f32_dpp v192,v192,v192 quad_perm:[1,0,3,2] row_mask:0xf bank_mask:0xf
 s_mov_b32 s63,17408
 bl v241,s[28:31],s63 offen offset:3072 lds
 v_add_f32_dpp v194,v194,v194 quad_perm:[1,0,3,2] row_mask:0xf bank_mask:0xf
 v_add_f32_dpp v192,v192,v192 quad_perm:[2,3,0,1] row_mask:0xf bank_mask:0xf
 s_nop 0
 v_add_f32_dpp v194,v194,v194 quad_perm:[2,3,0,1] row_mask:0xf bank_mask:0xf
 v_mul_f32 v196,0xbb000000,v192
 v_mul_f32 v194,0x3b000000,v194
 v_fma_f32 v192,-v196,v196,v194
 v_max_f32 v192,0,v192
 v_add_f32 v193,0x3727c5ac,v192
 v_rsq_f32 v252,v193
 s_add_u32 m0,s62,36864
 s_mov_b32 s63,32768
 bl v241,s[28:31],s63 offen offset:0 lds
 v_lshlrev_b32 v64,16,v160
 v_and_b32 v65,s82,v160
 v_lshlrev_b32 v66,16,v161
 v_and_b32 v67,s82,v161
 v_lshlrev_b32 v68,16,v162
 v_and_b32 v69,s82,v162
 v_lshlrev_b32 v70,16,v163
 v_and_b32 v71,s82,v163
 v_mul_f32 v194,0x3e0293ee,v252
 s_mov_b32 s63,48128
 bl v241,s[28:31],s63 offen offset:1024 lds
 v_mul_f32 v195,v196,v194
 v_pk_fma_f32 v[0:1],v[0:1],v[194:195],v[194:195] op_sel:[0,0,1] op_sel_hi:[1,0,1]
 v_pk_fma_f32 v[2:3],v[2:3],v[194:195],v[194:195] op_sel:[0,0,1] op_sel_hi:[1,0,1]
 v_pk_fma_f32 v[4:5],v[4:5],v[194:195],v[194:195] op_sel:[0,0,1] op_sel_hi:[1,0,1]
 v_pk_fma_f32 v[6:7],v[6:7],v[194:195],v[194:195] op_sel:[0,0,1] op_sel_hi:[1,0,1]
 v_lshlrev_b32 v72,16,v164
 v_and_b32 v73,s82,v164
 v_lshlrev_b32 v74,16,v165
 v_and_b32 v75,s82,v165
 s_mov_b32 s63,34816
 bl v241,s[28:31],s63 offen offset:2048 lds
 v_lshlrev_b32 v76,16,v166
 v_and_b32 v77,s82,v166
 v_lshlrev_b32 v78,16,v167
 v_and_b32 v79,s82,v167
 pk v128,v0,v1
 pk v129,v2,v3
 pk v130,v4,v5
 pk v131,v6,v7
 v_pk_fma_f32 v[8:9],v[8:9],v[194:195],v[194:195] op_sel:[0,0,1] op_sel_hi:[1,0,1]
 s_mov_b32 s63,50176
 bl v241,s[28:31],s63 offen offset:3072 lds
 v_pk_fma_f32 v[10:11],v[10:11],v[194:195],v[194:195] op_sel:[0,0,1] op_sel_hi:[1,0,1]
 v_pk_fma_f32 v[12:13],v[12:13],v[194:195],v[194:195] op_sel:[0,0,1] op_sel_hi:[1,0,1]
 v_pk_fma_f32 v[14:15],v[14:15],v[194:195],v[194:195] op_sel:[0,0,1] op_sel_hi:[1,0,1]
 ds_write_b128 v235,v[128:131] offset:0
 pk v132,v8,v9
 pk v133,v10,v11
 pk v134,v12,v13
 pk v135,v14,v15
 v_pk_fma_f32 v[16:17],v[16:17],v[194:195],v[194:195] op_sel:[0,0,1] op_sel_hi:[1,0,1]
 s_add_u32 m0,s62,65536
 s_mov_b32 s63,262144
 bl v241,s[28:31],s63 offen offset:0 lds
 v_pk_fma_f32 v[18:19],v[18:19],v[194:195],v[194:195] op_sel:[0,0,1] op_sel_hi:[1,0,1]
 v_pk_fma_f32 v[20:21],v[20:21],v[194:195],v[194:195] op_sel:[0,0,1] op_sel_hi:[1,0,1]
 v_pk_fma_f32 v[22:23],v[22:23],v[194:195],v[194:195] op_sel:[0,0,1] op_sel_hi:[1,0,1]
 ds_write_b128 v235,v[132:135] offset:4096
 v_lshlrev_b32 v80,16,v168
 v_and_b32 v81,s82,v168
 v_lshlrev_b32 v82,16,v169
 v_and_b32 v83,s82,v169
 v_lshlrev_b32 v84,16,v170
 s_mov_b32 s63,277504
 bl v241,s[28:31],s63 offen offset:1024 lds
 v_and_b32 v85,s82,v170
 v_lshlrev_b32 v86,16,v171
 v_and_b32 v87,s82,v171
 pk v136,v16,v17
 pk v137,v18,v19
 pk v138,v20,v21
 pk v139,v22,v23
 v_pk_fma_f32 v[24:25],v[24:25],v[194:195],v[194:195] op_sel:[0,0,1] op_sel_hi:[1,0,1]
 v_pk_fma_f32 v[26:27],v[26:27],v[194:195],v[194:195] op_sel:[0,0,1] op_sel_hi:[1,0,1]
 s_mov_b32 s63,264192
 bl v241,s[28:31],s63 offen offset:2048 lds
 v_pk_fma_f32 v[28:29],v[28:29],v[194:195],v[194:195] op_sel:[0,0,1] op_sel_hi:[1,0,1]
 v_pk_fma_f32 v[30:31],v[30:31],v[194:195],v[194:195] op_sel:[0,0,1] op_sel_hi:[1,0,1]
 ds_write_b128 v235,v[136:139] offset:8192
 pk v140,v24,v25
 pk v141,v26,v27
 pk v142,v28,v29
 pk v143,v30,v31
 v_pk_fma_f32 v[32:33],v[32:33],v[194:195],v[194:195] op_sel:[0,0,1] op_sel_hi:[1,0,1]
 v_pk_fma_f32 v[34:35],v[34:35],v[194:195],v[194:195] op_sel:[0,0,1] op_sel_hi:[1,0,1]
 s_mov_b32 s63,279552
 bl v241,s[28:31],s63 offen offset:3072 lds
 v_pk_fma_f32 v[36:37],v[36:37],v[194:195],v[194:195] op_sel:[0,0,1] op_sel_hi:[1,0,1]
 v_pk_fma_f32 v[38:39],v[38:39],v[194:195],v[194:195] op_sel:[0,0,1] op_sel_hi:[1,0,1]
 ds_write_b128 v235,v[140:143] offset:12288
 v_lshlrev_b32 v88,16,v172
 v_and_b32 v89,s82,v172
 v_lshlrev_b32 v90,16,v173
 v_and_b32 v91,s82,v173
 v_lshlrev_b32 v92,16,v174
 v_and_b32 v93,s82,v174
 s_add_u32 m0,s62,69632
 s_mov_b32 s63,294912
 bl v241,s[28:31],s63 offen offset:0 lds
 v_lshlrev_b32 v94,16,v175
 v_and_b32 v95,s82,v175
 pk v144,v32,v33
 pk v145,v34,v35
 pk v146,v36,v37
 pk v147,v38,v39
 v_pk_fma_f32 v[40:41],v[40:41],v[194:195],v[194:195] op_sel:[0,0,1] op_sel_hi:[1,0,1]
 v_pk_fma_f32 v[42:43],v[42:43],v[194:195],v[194:195] op_sel:[0,0,1] op_sel_hi:[1,0,1]
 v_pk_fma_f32 v[44:45],v[44:45],v[194:195],v[194:195] op_sel:[0,0,1] op_sel_hi:[1,0,1]
 s_mov_b32 s63,310272
 bl v241,s[28:31],s63 offen offset:1024 lds
 v_pk_fma_f32 v[46:47],v[46:47],v[194:195],v[194:195] op_sel:[0,0,1] op_sel_hi:[1,0,1]
 ds_write_b128 v235,v[144:147] offset:16384
 pk v148,v40,v41
 pk v149,v42,v43
 pk v150,v44,v45
 pk v151,v46,v47
 v_pk_fma_f32 v[48:49],v[48:49],v[194:195],v[194:195] op_sel:[0,0,1] op_sel_hi:[1,0,1]
 v_pk_fma_f32 v[50:51],v[50:51],v[194:195],v[194:195] op_sel:[0,0,1] op_sel_hi:[1,0,1]
 v_pk_fma_f32 v[52:53],v[52:53],v[194:195],v[194:195] op_sel:[0,0,1] op_sel_hi:[1,0,1]
 s_mov_b32 s63,296960
 bl v241,s[28:31],s63 offen offset:2048 lds
 v_pk_fma_f32 v[54:55],v[54:55],v[194:195],v[194:195] op_sel:[0,0,1] op_sel_hi:[1,0,1]
 ds_write_b128 v235,v[148:151] offset:20480
 v_lshlrev_b32 v96,16,v176
 v_and_b32 v97,s82,v176
 v_lshlrev_b32 v98,16,v177
 v_and_b32 v99,s82,v177
 v_lshlrev_b32 v100,16,v178
 v_and_b32 v101,s82,v178
 v_lshlrev_b32 v102,16,v179
 s_mov_b32 s63,312320
 bl v241,s[28:31],s63 offen offset:3072 lds
 v_and_b32 v103,s82,v179
 pk v152,v48,v49
 pk v153,v50,v51
 pk v154,v52,v53
 pk v155,v54,v55
 v_pk_fma_f32 v[56:57],v[56:57],v[194:195],v[194:195] op_sel:[0,0,1] op_sel_hi:[1,0,1]
 v_pk_fma_f32 v[58:59],v[58:59],v[194:195],v[194:195] op_sel:[0,0,1] op_sel_hi:[1,0,1]
 v_pk_fma_f32 v[60:61],v[60:61],v[194:195],v[194:195] op_sel:[0,0,1] op_sel_hi:[1,0,1]
 v_pk_fma_f32 v[62:63],v[62:63],v[194:195],v[194:195] op_sel:[0,0,1] op_sel_hi:[1,0,1]
 s_add_u32 m0,s62,0
 s_mov_b32 s63,0
L_pad_pg1:
 s_cbranch_execz L_hop0
 bl v240,s[20:23],s63 offen offset:0 lds
 ds_write_b128 v235,v[152:155] offset:24576
 pk v156,v56,v57
 pk v157,v58,v59
 pk v158,v60,v61
 pk v159,v62,v63
 v_pk_fma_f32 v[64:65],v[64:65],v[194:195],v[194:195] op_sel:[0,0,1] op_sel_hi:[1,0,1]
 v_pk_fma_f32 v[66:67],v[66:67],v[194:195],v[194:195] op_sel:[0,0,1] op_sel_hi:[1,0,1]
 v_pk_fma_f32 v[68:69],v[68:69],v[194:195],v[194:195] op_sel:[0,0,1] op_sel_hi:[1,0,1]
 v_pk_fma_f32 v[70:71],v[70:71],v[194:195],v[194:195] op_sel:[0,0,1] op_sel_hi:[1,0,1]
 s_mov_b32 s63,130048
 bl v240,s[20:23],s63 offen offset:1024 lds
 ds_write_b128 v235,v[156:159] offset:28672
 v_lshlrev_b32 v104,16,v180
 v_and_b32 v105,s82,v180
 v_lshlrev_b32 v106,16,v181
 v_and_b32 v107,s82,v181
 v_lshlrev_b32 v108,16,v182
 v_and_b32 v109,s82,v182
 v_lshlrev_b32 v110,16,v183
 v_and_b32 v111,s82,v183
 s_mov_b32 s63,30720
 bl v240,s[20:23],s63 offen offset:2048 lds
 pk v160,v64,v65
 pk v161,v66,v67
 pk v162,v68,v69
 pk v163,v70,v71
 v_pk_fma_f32 v[72:73],v[72:73],v[194:195],v[194:195] op_sel:[0,0,1] op_sel_hi:[1,0,1]
 v_pk_fma_f32 v[74:75],v[74:75],v[194:195],v[194:195] op_sel:[0,0,1] op_sel_hi:[1,0,1]
 v_pk_fma_f32 v[76:77],v[76:77],v[194:195],v[194:195] op_sel:[0,0,1] op_sel_hi:[1,0,1]
 v_pk_fma_f32 v[78:79],v[78:79],v[194:195],v[194:195] op_sel:[0,0,1] op_sel_hi:[1,0,1]
 ds_write_b128 v236,v[160:163] offset:0
 s_mov_b32 s63,160768
 bl v240,s[20:23],s63 offen offset:3072 lds
 pk v164,v72,v73
 pk v165,v74,v75
 pk v166,v76,v77
 pk v167,v78,v79
 v_pk_fma_f32 v[80:81],v[80:81],v[194:195],v[194:195] op_sel:[0,0,1] op_sel_hi:[1,0,1]
 v_pk_fma_f32 v[82:83],v[82:83],v[194:195],v[194:195] op_sel:[0,0,1] op_sel_hi:[1,0,1]
 v_pk_fma_f32 v[84:85],v[84:85],v[194:195],v[194:195] op_sel:[0,0,1] op_sel_hi:[1,0,1]
 v_pk_fma_f32 v[86:87],v[86:87],v[194:195],v[194:195] op_sel:[0,0,1] op_sel_hi:[1,0,1]
 ds_write_b128 v236,v[164:167] offset:4096
 s_add_u32 m0,s62,4096
 s_mov_b32 s63,262144
 bl v240,s[20:23],s63 offen offset:0 lds
 v_lshlrev_b32 v112,16,v184
 v_and_b32 v113,s82,v184
 v_lshlrev_b32 v114,16,v185
 v_and_b32 v115,s82,v185
 v_lshlrev_b32 v116,16,v186
 v_and_b32 v117,s82,v186
 v_lshlrev_b32 v118,16,v187
 v_and_b32 v119,s82,v187
 pk v168,v80,v81
 s_mov_b32 s63,392192
 bl v240,s[20:23],s63 offen offset:1024 lds
 pk v169,v82,v83
 pk v170,v84,v85
 pk v171,v86,v87
 v_pk_fma_f32 v[88:89],v[88:89],v[194:195],v[194:195] op_sel:[0,0,1] op_sel_hi:[1,0,1]
 v_pk_fma_f32 v[90:91],v[90:91],v[194:195],v[194:195] op_sel:[0,0,1] op_sel_hi:[1,0,1]
 v_pk_fma_f32 v[92:93],v[92:93],v[194:195],v[194:195] op_sel:[0,0,1] op_sel_hi:[1,0,1]
 v_pk_fma_f32 v[94:95],v[94:95],v[194:195],v[194:195] op_sel:[0,0,1] op_sel_hi:[1,0,1]
 ds_write_b128 v236,v[168:171] offset:8192
 pk v172,v88,v89
 s_mov_b32 s63,292864
 bl v240,s[20:23],s63 offen offset:2048 lds
 pk v173,v90,v91
 pk v174,v92,v93
 pk v175,v94,v95
 v_pk_fma_f32 v[96:97],v[96:97],v[194:195],v[194:195] op_sel:[0,0,1] op_sel_hi:[1,0,1]
 v_pk_fma_f32 v[98:99],v[98:99],v[194:195],v[194:195] op_sel:[0,0,1] op_sel_hi:[1,0,1]
 v_pk_fma_f32 v[100:101],v[100:101],v[194:195],v[194:195] op_sel:[0,0,1] op_sel_hi:[1,0,1]
 v_pk_fma_f32 v[102:103],v[102:103],v[194:195],v[194:195] op_sel:[0,0,1] op_sel_hi:[1,0,1]
 ds_write_b128 v236,v[172:175] offset:12288
 v_lshlrev_b32 v120,16,v188
 s_mov_b32 s63,422912
 bl v240,s[20:23],s63 offen offset:3072 lds
 v_and_b32 v121,s82,v188
 v_lshlrev_b32 v122,16,v189
 v_and_b32 v123,s82,v189
 v_lshlrev_b32 v124,16,v190
 v_and_b32 v125,s82,v190
 v_lshlrev_b32 v126,16,v191
 v_and_b32 v127,s82,v191
 pk v176,v96,v97
 pk v177,v98,v99
 buffer_load_dword a255,v237,s[20:23],0 offen
 pk v178,v100,v101
 pk v179,v102,v103
 v_pk_fma_f32 v[104:105],v[104:105],v[194:195],v[194:195] op_sel:[0,0,1] op_sel_hi:[1,0,1]
 v_pk_fma_f32 v[106:107],v[106:107],v[194:195],v[194:195] op_sel:[0,0,1] op_sel_hi:[1,0,1]
 v_pk_fma_f32 v[108:109],v[108:109],v[194:195],v[194:195] op_sel:[0,0,1] op_sel_hi:[1,0,1]
 v_pk_fma_f32 v[110:111],v[110:111],v[194:195],v[194:195] op_sel:[0,0,1] op_sel_hi:[1,0,1]
 ds_write_b128 v236,v[176:179] offset:16384
 pk v180,v104,v105
 pk v181,v106,v107
 buffer_load_dword a255,v242,s[8:11],0 offen
 pk v182,v108,v109
 pk v183,v110,v111
 v_pk_fma_f32 v[112:113],v[112:113],v[194:195],v[194:195] op_sel:[0,0,1] op_sel_hi:[1,0,1]
 v_pk_fma_f32 v[114:115],v[114:115],v[194:195],v[194:195] op_sel:[0,0,1] op_sel_hi:[1,0,1]
 v_pk_fma_f32 v[116:117],v[116:117],v[194:195],v[194:195] op_sel:[0,0,1] op_sel_hi:[1,0,1]
 v_pk_fma_f32 v[118:119],v[118:119],v[194:195],v[194:195] op_sel:[0,0,1] op_sel_hi:[1,0,1]
 ds_write_b128 v236,v[180:183] offset:20480
 pk v184,v112,v113
 pk v185,v114,v115
 buffer_load_dword a255,v242,s[12:15],0 offen
 pk v186,v116,v117
 pk v187,v118,v119
 v_pk_fma_f32 v[120:121],v[120:121],v[194:195],v[194:195] op_sel:[0,0,1] op_sel_hi:[1,0,1]
 v_pk_fma_f32 v[122:123],v[122:123],v[194:195],v[194:195] op_sel:[0,0,1] op_sel_hi:[1,0,1]
 v_pk_fma_f32 v[124:125],v[124:125],v[194:195],v[194:195] op_sel:[0,0,1] op_sel_hi:[1,0,1]
 v_pk_fma_f32 v[126:127],v[126:127],v[194:195],v[194:195] op_sel:[0,0,1] op_sel_hi:[1,0,1]
 ds_write_b128 v236,v[184:187] offset:24576
 pk v188,v120,v121
 pk v189,v122,v123
 pk v190,v124,v125
 pk v191,v126,v127
 ds_write_b128 v236,v[188:191] offset:28672
 v_mul_f32 v192,v192,v252
 v_mul_f32 v192,v192,v252
 v_add_f32 v192,0x3727c5ac,v192
 v_rsq_f32 v238,v192
 v_mul_f32 v252,s79,v252
 v_mul_f32 v238,0x406b389d,v238
 v_mul_f32 v253,v196,v252
 v_add_u32 v235,s60,v234
 ds_bpermute_b32 v253,v200,v253
 ds_bpermute_b32 v252,v200,v252
 ds_bpermute_b32 v238,v200,v238
 rq a[0:3],v235 offset:0
 rq a[4:7],v235 offset:4096
 rq a[8:11],v235 offset:8192
 rq a[12:15],v235 offset:12288
 rq a[16:19],v235 offset:16384
 rq a[20:23],v235 offset:20480
 rq a[24:27],v235 offset:24576
 rq a[28:31],v235 offset:28672
 s_waitcnt vmcnt(11) lgkmcnt(11)
 s_barrier
 rt a[160:161],v244 offset:0
 rt a[162:163],v244 offset:2048
 rt a[164:165],v244 offset:4096
 rt a[166:167],v244 offset:6144
 rt a[168:169],v244 offset:8192
 rt a[170:171],v244 offset:10240
 rt a[172:173],v244 offset:12288
 rt a[174:175],v244 offset:14336
 rt a[176:177],v244 offset:16384
 rt a[178:179],v244 offset:18432
 rt a[180:181],v244 offset:20480
 rt a[182:183],v244 offset:22528
 s_waitcnt lgkmcnt(10)
 mf v[192:195],a[160:163],a[0:3],0
 s_waitcnt lgkmcnt(8)
 rt a[184:185],v244 offset:24576
 rt a[186:187],v244 offset:26624
 mf v[192:195],a[164:167],a[4:7],v[192:195]
 s_waitcnt lgkmcnt(8)
 rt a[188:189],v244 offset:28672
 rt a[190:191],v244 offset:30720
 mf v[192:195],a[168:171],a[8:11],v[192:195]
 s_waitcnt lgkmcnt(8)
 rt a[192:193],v245 offset:0
 rt a[194:195],v245 offset:2048
 rq a[32:35],v235 offset:32768
 mf v[192:195],a[172:175],a[12:15],v[192:195]
 s_waitcnt lgkmcnt(9)
 rt a[196:197],v245 offset:4096
 rt a[198:199],v245 offset:6144
 mf v[192:195],a[176:179],a[16:19],v[192:195]
 s_waitcnt lgkmcnt(9)
 rt a[200:201],v245 offset:8192
 rt a[202:203],v245 offset:10240
 mf v[192:195],a[180:183],a[20:23],v[192:195]
 s_waitcnt lgkmcnt(9)
 rt a[204:205],v245 offset:12288
 rt a[206:207],v245 offset:14336
 rq a[36:39],v235 offset:36864
 mf v[192:195],a[184:187],a[24:27],v[192:195]
 s_waitcnt lgkmcnt(10)
 rt a[208:209],v245 offset:16384
 rt a[210:211],v245 offset:18432
 mf v[192:195],a[188:191],a[28:31],v[192:195]
 s_waitcnt lgkmcnt(10)
 rt a[212:213],v245 offset:20480
 rt a[214:215],v245 offset:22528
 mf v[196:199],a[192:195],a[0:3],0
 s_waitcnt lgkmcnt(9)
 rt a[216:217],v245 offset:24576
 rt a[218:219],v245 offset:26624
 rq a[40:43],v235 offset:40960
 mf v[196:199],a[196:199],a[4:7],v[196:199]
 s_waitcnt lgkmcnt(10)
 rt a[220:221],v245 offset:28672
 rt a[222:223],v245 offset:30720
 mf v[196:199],a[200:203],a[8:11],v[196:199]
 s_waitcnt lgkmcnt(10)
 rt a[160:161],v246 offset:0
 rt a[162:163],v246 offset:2048
 mf v[196:199],a[204:207],a[12:15],v[196:199]
 s_waitcnt lgkmcnt(9)
 rt a[164:165],v246 offset:4096
 rt a[166:167],v246 offset:6144
 rq a[44:47],v235 offset:45056
 mf v[196:199],a[208:211],a[16:19],v[196:199]
 s_waitcnt lgkmcnt(10)
 rt a[168:169],v246 offset:8192
 rt a[170:171],v246 offset:10240
 mf v[196:199],a[212:215],a[20:23],v[196:199]
 s_waitcnt lgkmcnt(10)
 rt a[172:173],v246 offset:12288
 rt a[174:175],v246 offset:14336
 mf v[196:199],a[216:219],a[24:27],v[196:199]
 s_waitcnt lgkmcnt(9)
 rt a[176:177],v246 offset:16384
 rt a[178:179],v246 offset:18432
 rq a[48:51],v235 offset:49152
 mf v[196:199],a[220:223],a[28:31],v[196:199]
 s_waitcnt lgkmcnt(10)
 rt a[180:181],v246 offset:20480
 rt a[182:183],v246 offset:22528
 mf v[200:203],a[160:163],a[0:3],0
 s_waitcnt lgkmcnt(10)
 rt a[184:185],v246 offset:24576
 rt a[186:187],v246 offset:26624
 mf v[200:203],a[164:167],a[4:7],v[200:203]
 s_waitcnt lgkmcnt(9)
 rt a[188:189],v246 offset:28672
 rt a[190:191],v246 offset:30720
 rq a[52:55],v235 offset:53248
 mf v[200:203],a[168:171],a[8:11],v[200:203]
 s_waitcnt lgkmcnt(10)
 rt a[192:193],v247 offset:0
 rt a[194:195],v247 offset:2048
 mf v[200:203],a[172:175],a[12:15],v[200:203]
 s_waitcnt lgkmcnt(10)
 rt a[196:197],v247 offset:4096
 rt a[198:199],v247 offset:6144
 mf v[200:203],a[176:179],a[16:19],v[200:203]
 s_waitcnt lgkmcnt(9)
 rt a[200:201],v247 offset:8192
 rt a[202:203],v247 offset:10240
 rq a[56:59],v235 offset:57344
 mf v[200:203],a[180:183],a[20:23],v[200:203]
 s_waitcnt lgkmcnt(10)
 rt a[204:205],v247 offset:12288
 rt a[206:207],v247 offset:14336
 mf v[200:203],a[184:187],a[24:27],v[200:203]
 s_waitcnt lgkmcnt(10)
 rt a[208:209],v247 offset:16384
 rt a[210:211],v247 offset:18432
 mf v[200:203],a[188:191],a[28:31],v[200:203]
 s_waitcnt lgkmcnt(9)
 rt a[212:213],v247 offset:20480
 rt a[214:215],v247 offset:22528
 rq a[60:63],v235 offset:61440
 mf v[204:207],a[192:195],a[0:3],0
 s_waitcnt lgkmcnt(10)
 rt a[216:217],v247 offset:24576
 rt a[218:219],v247 offset:26624
 mf v[204:207],a[196:199],a[4:7],v[204:207]
 s_waitcnt lgkmcnt(10)
 rt a[220:221],v247 offset:28672
 rt a[222:223],v247 offset:30720
 mf v[204:207],a[200:203],a[8:11],v[204:207]
 s_waitcnt lgkmcnt(9)
 rt a[160:161],v244 offset:32768
 rt a[162:163],v244 offset:34816
 mf v[204:207],a[204:207],a[12:15],v[204:207]
 s_waitcnt lgkmcnt(9)
 rt a[164:165],v244 offset:36864
 rt a[166:167],v244 offset:38912
 mf v[204:207],a[208:211],a[16:19],v[204:207]
 s_waitcnt lgkmcnt(9)
 rt a[168:169],v244 offset:40960
 rt a[170:171],v244 offset:43008
 mf v[204:207],a[212:215],a[20:23],v[204:207]
 s_waitcnt lgkmcnt(8)
 rt a[172:173],v244 offset:45056
 rt a[174:175],v244 offset:47104
 mf v[204:207],a[216:219],a[24:27],v[204:207]
 s_waitcnt lgkmcnt(8)
 rt a[176:177],v244 offset:49152
 rt a[178:179],v244 offset:51200
 mf v[204:207],a[220:223],a[28:31],v[204:207]
 s_waitcnt lgkmcnt(8)
 s_barrier
 rt a[180:181],v244 offset:53248
 rt a[182:183],v244 offset:55296
 mf v[192:195],a[160:163],a[32:35],v[192:195]
 s_waitcnt lgkmcnt(8)
 s_add_u32 m0,s62,32768
 rt a[184:185],v244 offset:57344
 rt a[186:187],v244 offset:59392
 mf v[192:195],a[164:167],a[36:39],v[192:195]
 s_waitcnt lgkmcnt(8)
 s_mov_b32 s63,128
 rt a[188:189],v244 offset:61440
 rt a[190:191],v244 offset:63488
 mf v[192:195],a[168:171],a[40:43],v[192:195]
 s_waitcnt lgkmcnt(8)
 rt a[192:193],v245 offset:32768
 rt a[194:195],v245 offset:34816
 bl v240,s[20:23],s63 offen offset:0 lds
 mf v[192:195],a[172:175],a[44:47],v[192:195]
 s_waitcnt lgkmcnt(8)
 rt a[196:197],v245 offset:36864
 rt a[198:199],v245 offset:38912
 mf v[192:195],a[176:179],a[48:51],v[192:195]
 s_waitcnt lgkmcnt(8)
 s_mov_b32 s63,130176
 rt a[200:201],v245 offset:40960
 rt a[202:203],v245 offset:43008
 mf v[192:195],a[180:183],a[52:55],v[192:195]
 s_waitcnt lgkmcnt(8)
 rt a[204:205],v245 offset:45056
 rt a[206:207],v245 offset:47104
 bl v240,s[20:23],s63 offen offset:1024 lds
 mf v[192:195],a[184:187],a[56:59],v[192:195]
 s_waitcnt lgkmcnt(8)
 rt a[208:209],v245 offset:49152
 rt a[210:211],v245 offset:51200
 mf v[192:195],a[188:191],a[60:63],v[192:195]
 s_waitcnt lgkmcnt(8)
 s_mov_b32 s63,30848
 rt a[212:213],v245 offset:53248
 rt a[214:215],v245 offset:55296
 mf v[196:199],a[192:195],a[32:35],v[196:199]
 s_waitcnt lgkmcnt(8)
 rt a[216:217],v245 offset:57344
 rt a[218:219],v245 offset:59392
 bl v240,s[20:23],s63 offen offset:2048 lds
 rq a[64:67],v234 offset:0
 mf v[196:199],a[196:199],a[36:39],v[196:199]
 s_waitcnt lgkmcnt(9)
 rt a[220:221],v245 offset:61440
 rt a[222:223],v245 offset:63488
 mf v[196:199],a[200:203],a[40:43],v[196:199]
 s_waitcnt lgkmcnt(9)
 s_mov_b32 s63,160896
 rt a[160:161],v246 offset:32768
 rt a[162:163],v246 offset:34816
 rq a[80:83],v234 offset:4096
 mf v[196:199],a[204:207],a[44:47],v[196:199]
 s_waitcnt lgkmcnt(10)
 rt a[164:165],v246 offset:36864
 rt a[166:167],v246 offset:38912
 bl v240,s[20:23],s63 offen offset:3072 lds
 mf v[196:199],a[208:211],a[48:51],v[196:199]
 s_waitcnt lgkmcnt(10)
 s_add_u32 m0,s62,36864
 rt a[168:169],v246 offset:40960
 rt a[170:171],v246 offset:43008
 rq a[68:71],v234 offset:1024
 mf v[196:199],a[212:215],a[52:55],v[196:199]
 s_waitcnt lgkmcnt(11)
 s_mov_b32 s63,262272
 rt a[172:173],v246 offset:45056
 rt a[174:175],v246 offset:47104
 mf v[196:199],a[216:219],a[56:59],v[196:199]
 s_waitcnt lgkmcnt(10)
 rt a[176:177],v246 offset:49152
 rt a[178:179],v246 offset:51200
 bl v240,s[20:23],s63 offen offset:0 lds
 rq a[84:87],v234 offset:5120
 mf v[196:199],a[220:223],a[60:63],v[196:199]
 s_waitcnt lgkmcnt(11)
 rt a[180:181],v246 offset:53248
 rt a[182:183],v246 offset:55296
 mf v[200:203],a[160:163],a[32:35],v[200:203]
 s_waitcnt lgkmcnt(10)
 s_mov_b32 s63,392320
 rt a[184:185],v246 offset:57344
 rt a[186:187],v246 offset:59392
 rq a[72:75],v234 offset:2048
 mf v[200:203],a[164:167],a[36:39],v[200:203]
 s_waitcnt lgkmcnt(11)
 rt a[188:189],v246 offset:61440
 rt a[190:191],v246 offset:63488
 bl v240,s[20:23],s63 offen offset:1024 lds
 mf v[200:203],a[168:171],a[40:43],v[200:203]
 s_waitcnt lgkmcnt(10)
 rt a[192:193],v247 offset:32768
 rt a[194:195],v247 offset:34816
 rq a[88:91],v234 offset:6144
 mf v[200:203],a[172:175],a[44:47],v[200:203]
 s_waitcnt lgkmcnt(11)
 s_mov_b32 s63,292992
 rt a[196:197],v247 offset:36864
 rt a[198:199],v247 offset:38912
 mf v[200:203],a[176:179],a[48:51],v[200:203]
 s_waitcnt lgkmcnt(10)
 rt a[200:201],v247 offset:40960
 rt a[202:203],v247 offset:43008
 bl v240,s[20:23],s63 offen offset:2048 lds
 rq a[76:79],v234 offset:3072
 mf v[200:203],a[180:183],a[52:55],v[200:203]
 s_waitcnt lgkmcnt(11)
 rt a[204:205],v247 offset:45056
 rt a[206:207],v247 offset:47104
 mf v[200:203],a[184:187],a[56:59],v[200:203]
 s_waitcnt lgkmcnt(10)
 s_mov_b32 s63,423040
 rt a[208:209],v247 offset:49152
 rt a[210:211],v247 offset:51200
 rq a[92:95],v234 offset:7168
 mf v[200:203],a[188:191],a[60:63],v[200:203]
 s_waitcnt lgkmcnt(11)
 rt a[212:213],v247 offset:53248
 rt a[214:215],v247 offset:55296
 bl v240,s[20:23],s63 offen offset:3072 lds
 mf v[204:207],a[192:195],a[32:35],v[204:207]
 s_waitcnt lgkmcnt(10)
 rt a[216:217],v247 offset:57344
 rt a[218:219],v247 offset:59392
 mf v[204:207],a[196:199],a[36:39],v[204:207]
 s_waitcnt lgkmcnt(10)
 rt a[220:221],v247 offset:61440
 rt a[222:223],v247 offset:63488
 mf v[204:207],a[200:203],a[40:43],v[204:207]
 s_waitcnt lgkmcnt(9)
 s_waitcnt vmcnt(11)
 rt a[128:129],v226 offset:0
 rt a[130:131],v226 offset:2048
 mf v[204:207],a[204:207],a[44:47],v[204:207]
 s_waitcnt lgkmcnt(9)
 rt a[132:133],v226 offset:4096
 rt a[134:135],v226 offset:6144
 mf v[204:207],a[208:211],a[48:51],v[204:207]
 s_waitcnt lgkmcnt(8)
 rt a[136:137],v227 offset:0
 rt a[138:139],v227 offset:2048
 mf v[204:207],a[212:215],a[52:55],v[204:207]
 s_waitcnt lgkmcnt(8)
 mf v[204:207],a[216:219],a[56:59],v[204:207]
 s_waitcnt lgkmcnt(6)
 mf v[204:207],a[220:223],a[60:63],v[204:207]
 s_waitcnt lgkmcnt(2)
 mf v[0:3],a[128:131],a[64:67],0
 rt a[140:141],v227 offset:4096
 mf v[0:3],a[132:135],a[80:83],v[0:3]
 s_barrier
 mf v[16:19],a[132:135],a[84:87],0
 s_add_u32 m0,s62,65536
 s_mov_b32 s63,524288
 rt a[142:143],v227 offset:6144
 mf v[16:19],a[128:131],a[68:71],v[16:19]
 rq a[96:99],v234 offset:8192
 bl v240,s[20:23],s63 offen offset:0 lds
 mf v[32:35],a[128:131],a[72:75],0
 s_mov_b32 s63,654336
 rt a[144:145],v228 offset:0
 mf v[32:35],a[132:135],a[88:91],v[32:35]
 bl v240,s[20:23],s63 offen offset:1024 lds
 mf v[48:51],a[132:135],a[92:95],0
 s_mov_b32 s63,555008
 rt a[146:147],v228 offset:2048
 mf v[48:51],a[128:131],a[76:79],v[48:51]
 s_waitcnt lgkmcnt(3)
 rq a[112:115],v234 offset:12288
 bl v240,s[20:23],s63 offen offset:2048 lds
 mf v[52:55],a[136:139],a[76:79],0
 s_mov_b32 s63,685056
 rt a[148:149],v228 offset:4096
 v_mul_f32 v192,v192,v238
 mf v[52:55],a[140:143],a[92:95],v[52:55]
 bl v240,s[20:23],s63 offen offset:3072 lds
 mf v[36:39],a[140:143],a[88:91],0
 s_add_u32 m0,s62,69632
 s_mov_b32 s63,786432
 rt a[150:151],v228 offset:6144
 mf v[36:39],a[136:139],a[72:75],v[36:39]
 bl v240,s[20:23],s63 offen offset:0 lds
 mf v[20:23],a[136:139],a[68:71],0
 s_mov_b32 s63,916480
 rt a[152:153],v229 offset:0
 v_mul_f32 v193,v193,v238
 mf v[20:23],a[140:143],a[84:87],v[20:23]
 bl v240,s[20:23],s63 offen offset:1024 lds
 mf v[4:7],a[140:143],a[80:83],0
 rt a[154:155],v229 offset:2048
 v_mul_f32 v194,v194,v238
 mf v[4:7],a[136:139],a[64:67],v[4:7]
 s_waitcnt lgkmcnt(2)
 rq a[100:103],v234 offset:9216
 v_mul_f32 v195,v195,v238
 mf v[8:11],a[144:147],a[64:67],0
 s_mov_b32 s63,817152
 rt a[156:157],v229 offset:4096
 v_mul_f32 v196,v196,v238
 mf v[8:11],a[148:151],a[80:83],v[8:11]
 bl v240,s[20:23],s63 offen offset:2048 lds
 mf v[24:27],a[148:151],a[84:87],0
 rt a[158:159],v229 offset:6144
 v_mul_f32 v197,v197,v238
 mf v[24:27],a[144:147],a[68:71],v[24:27]
 v_mul_f32 v198,v198,v238
 v_mul_f32 v199,v199,v238
 mf v[40:43],a[144:147],a[72:75],0
 s_mov_b32 s63,947200
 s_waitcnt vmcnt(7)
 rt a[128:129],v226 offset:32768
 v_mul_f32 v200,v200,v238
 mf v[40:43],a[148:151],a[88:91],v[40:43]
 bl v240,s[20:23],s63 offen offset:3072 lds
 mf v[56:59],a[148:151],a[92:95],0
 rt a[130:131],v226 offset:34816
 v_mul_f32 v201,v201,v238
 mf v[56:59],a[144:147],a[76:79],v[56:59]
 s_waitcnt lgkmcnt(2)
 s_add_u32 m0,s62,0
 rq a[116:119],v234 offset:13312
 mf v[60:63],a[152:155],a[76:79],0
 s_mov_b32 s63,524416
 rt a[132:133],v226 offset:36864
 v_mul_f32 v202,v202,v238
 mf v[60:63],a[156:159],a[92:95],v[60:63]
 bl v240,s[20:23],s63 offen offset:0 lds
 mf v[44:47],a[156:159],a[88:91],0
 rt a[134:135],v226 offset:38912
 v_mul_f32 v203,v203,v238
 mf v[44:47],a[152:155],a[72:75],v[44:47]
 v_mul_f32 v204,v204,v238
 v_mul_f32 v205,v205,v238
 mf v[28:31],a[152:155],a[68:71],0
 s_mov_b32 s63,654464
 rt a[136:137],v227 offset:32768
 v_mul_f32 v206,v206,v238
 mf v[28:31],a[156:159],a[84:87],v[28:31]
 bl v240,s[20:23],s63 offen offset:1024 lds
 mf v[12:15],a[156:159],a[80:83],0
 rt a[138:139],v227 offset:34816
 v_mul_f32 v207,v207,v238
 mf v[12:15],a[152:155],a[64:67],v[12:15]
 s_waitcnt lgkmcnt(2)
 rq a[104:107],v234 offset:10240
 v_fma_f32 v128,-v192,v192,-s78
 mf v[64:67],a[128:131],a[64:67],0
 s_mov_b32 s63,555136
 rt a[140:141],v227 offset:36864
 v_fma_f32 v129,-v193,v193,-s78
 mf v[64:67],a[132:135],a[80:83],v[64:67]
 bl v240,s[20:23],s63 offen offset:2048 lds
 mf v[80:83],a[132:135],a[84:87],0
 rt a[142:143],v227 offset:38912
 v_fma_f32 v130,-v194,v194,-s78
 mf v[80:83],a[128:131],a[68:71],v[80:83]
 rq a[120:123],v234 offset:14336
 v_fma_f32 v131,-v195,v195,-s78
 mf v[96:99],a[128:131],a[72:75],0
 s_mov_b32 s63,685184
 rt a[144:145],v228 offset:32768
 v_fma_f32 v132,-v196,v196,-s78
 mf v[96:99],a[132:135],a[88:91],v[96:99]
 bl v240,s[20:23],s63 offen offset:3072 lds
 mf v[112:115],a[132:135],a[92:95],0
 rt a[146:147],v228 offset:34816
 v_fma_f32 v133,-v197,v197,-s78
 mf v[112:115],a[128:131],a[76:79],v[112:115]
 s_waitcnt lgkmcnt(3)
 s_add_u32 m0,s62,4096
 v_fma_f32 v134,-v198,v198,-s78
 mf v[116:119],a[136:139],a[76:79],0
 s_mov_b32 s63,786560
 rt a[148:149],v228 offset:36864
 v_fma_f32 v135,-v199,v199,-s78
 mf v[116:119],a[140:143],a[92:95],v[116:119]
L_pad_pg2:
 s_cbranch_execz L_hop0
 bl v240,s[20:23],s63 offen offset:0 lds
 mf v[100:103],a[140:143],a[88:91],0
 rt a[150:151],v228 offset:38912
 v_fma_f32 v136,-v200,v200,-s78
 mf v[100:103],a[136:139],a[72:75],v[100:103]
 rq a[108:111],v234 offset:11264
 v_fma_f32 v137,-v201,v201,-s78
 mf v[84:87],a[136:139],a[68:71],0
 s_mov_b32 s63,916608
 rt a[152:153],v229 offset:32768
 v_fma_f32 v138,-v202,v202,-s78
 mf v[84:87],a[140:143],a[84:87],v[84:87]
 bl v240,s[20:23],s63 offen offset:1024 lds
 mf v[68:71],a[140:143],a[80:83],0
 rt a[154:155],v229 offset:34816
 v_fma_f32 v139,-v203,v203,-s78
 mf v[68:71],a[136:139],a[64:67],v[68:71]
 s_waitcnt lgkmcnt(3)
 v_fma_f32 v140,-v204,v204,-s78
 v_fma_f32 v141,-v205,v205,-s78
 mf v[72:75],a[144:147],a[64:67],0
 s_mov_b32 s63,817280
 rt a[156:157],v229 offset:36864
 v_fma_f32 v142,-v206,v206,-s78
 mf v[72:75],a[148:151],a[80:83],v[72:75]
 bl v240,s[20:23],s63 offen offset:2048 lds
 mf v[88:91],a[148:151],a[84:87],0
 rt a[158:159],v229 offset:38912
 v_fma_f32 v143,-v207,v207,-s78
 mf v[88:91],a[144:147],a[68:71],v[88:91]
 rq a[124:127],v234 offset:15360
 v_mul_f32 v128,v128,v192
 mf v[104:107],a[144:147],a[72:75],0
 s_mov_b32 s63,947328
 s_waitcnt vmcnt(7)
 rt a[128:129],v230 offset:0
 v_mul_f32 v129,v129,v193
 mf v[104:107],a[148:151],a[88:91],v[104:107]
 bl v240,s[20:23],s63 offen offset:3072 lds
 mf v[120:123],a[148:151],a[92:95],0
 rt a[130:131],v230 offset:2048
 v_mul_f32 v130,v130,v194
 mf v[120:123],a[144:147],a[76:79],v[120:123]
 s_waitcnt lgkmcnt(3)
 s_add_u32 m0,s62,32768
 v_mul_f32 v131,v131,v195
 mf v[124:127],a[152:155],a[76:79],0
 s_mov_b32 s63,1048576
 rt a[132:133],v230 offset:4096
 v_mul_f32 v132,v132,v196
 mf v[124:127],a[156:159],a[92:95],v[124:127]
 bl v240,s[20:23],s63 offen offset:0 lds
 mf v[108:111],a[156:159],a[88:91],0
 rt a[134:135],v230 offset:6144
 v_mul_f32 v133,v133,v197
 mf v[108:111],a[152:155],a[72:75],v[108:111]
 v_mul_f32 v134,v134,v198
 v_mul_f32 v135,v135,v199
 mf v[92:95],a[152:155],a[68:71],0
 s_mov_b32 s63,1178624
 rt a[136:137],v231 offset:0
 v_mul_f32 v136,v136,v200
 mf v[92:95],a[156:159],a[84:87],v[92:95]
 bl v240,s[20:23],s63 offen offset:1024 lds
 mf v[76:79],a[156:159],a[80:83],0
 rt a[138:139],v231 offset:2048
 v_mul_f32 v137,v137,v201
 mf v[76:79],a[152:155],a[64:67],v[76:79]
 s_waitcnt lgkmcnt(2)
 v_mul_f32 v138,v138,v202
 v_mul_f32 v139,v139,v203
 mf v[0:3],a[128:131],a[96:99],v[0:3]
 s_mov_b32 s63,1079296
 rt a[140:141],v231 offset:4096
 v_mul_f32 v140,v140,v204
 mf v[0:3],a[132:135],a[112:115],v[0:3]
 bl v240,s[20:23],s63 offen offset:2048 lds
 mf v[16:19],a[132:135],a[116:119],v[16:19]
 rt a[142:143],v231 offset:6144
 v_mul_f32 v141,v141,v205
 mf v[16:19],a[128:131],a[100:103],v[16:19]
 rq a[64:67],v234 offset:16384
 v_mul_f32 v142,v142,v206
 mf v[32:35],a[128:131],a[104:107],v[32:35]
 s_mov_b32 s63,1209344
 rt a[144:145],v232 offset:0
 v_mul_f32 v143,v143,v207
 mf v[32:35],a[132:135],a[120:123],v[32:35]
 bl v240,s[20:23],s63 offen offset:3072 lds
 mf v[48:51],a[132:135],a[124:127],v[48:51]
 rt a[146:147],v232 offset:2048
 v_exp_f32 v128,v128
 mf v[48:51],a[128:131],a[108:111],v[48:51]
 s_waitcnt lgkmcnt(3)
 s_add_u32 m0,s62,36864
 rq a[80:83],v234 offset:20480
 mf v[52:55],a[136:139],a[108:111],v[52:55]
 s_mov_b32 s63,1310720
 rt a[148:149],v232 offset:4096
 v_exp_f32 v129,v129
 mf v[52:55],a[140:143],a[124:127],v[52:55]
 bl v240,s[20:23],s63 offen offset:0 lds
 mf v[36:39],a[140:143],a[120:123],v[36:39]
 rt a[150:151],v232 offset:6144
 v_exp_f32 v130,v130
 mf v[36:39],a[136:139],a[104:107],v[36:39]
 v_exp_f32 v131,v131
 v_exp_f32 v132,v132
 mf v[20:23],a[136:139],a[100:103],v[20:23]
 s_mov_b32 s63,1440768
 rt a[152:153],v233 offset:0
 v_exp_f32 v133,v133
 mf v[20:23],a[140:143],a[116:119],v[20:23]
 bl v240,s[20:23],s63 offen offset:1024 lds
 mf v[4:7],a[140:143],a[112:115],v[4:7]
 rt a[154:155],v233 offset:2048
 v_exp_f32 v134,v134
 mf v[4:7],a[136:139],a[96:99],v[4:7]
 s_waitcnt lgkmcnt(2)
 rq a[68:71],v234 offset:17408
 v_exp_f32 v135,v135
 mf v[8:11],a[144:147],a[96:99],v[8:11]
 s_mov_b32 s63,1341440
 rt a[156:157],v233 offset:4096
 v_exp_f32 v136,v136
 mf v[8:11],a[148:151],a[112:115],v[8:11]
 bl v240,s[20:23],s63 offen offset:2048 lds
 mf v[24:27],a[148:151],a[116:119],v[24:27]
 rt a[158:159],v233 offset:6144
 v_exp_f32 v137,v137
 mf v[24:27],a[144:147],a[100:103],v[24:27]
 v_exp_f32 v138,v138
 v_exp_f32 v139,v139
 mf v[40:43],a[144:147],a[104:107],v[40:43]
 s_mov_b32 s63,1471488
 s_waitcnt vmcnt(7)
 rt a[128:129],v226 offset:0
 v_exp_f32 v140,v140
 mf v[40:43],a[148:151],a[120:123],v[40:43]
 bl v240,s[20:23],s63 offen offset:3072 lds
 mf v[56:59],a[148:151],a[124:127],v[56:59]
 rt a[130:131],v226 offset:2048
 v_exp_f32 v141,v141
 mf v[56:59],a[144:147],a[108:111],v[56:59]
 s_waitcnt lgkmcnt(2)
 s_add_u32 m0,s62,65536
 rq a[84:87],v234 offset:21504
 mf v[60:63],a[152:155],a[108:111],v[60:63]
 s_mov_b32 s63,1048704
 rt a[132:133],v226 offset:4096
 v_exp_f32 v142,v142
 mf v[60:63],a[156:159],a[124:127],v[60:63]
 bl v240,s[20:23],s63 offen offset:0 lds
 mf v[44:47],a[156:159],a[120:123],v[44:47]
 rt a[134:135],v226 offset:6144
 v_exp_f32 v143,v143
 mf v[44:47],a[152:155],a[104:107],v[44:47]
 v_add_f32 v128,1.0,v128
 v_add_f32 v129,1.0,v129
 mf v[28:31],a[152:155],a[100:103],v[28:31]
 s_mov_b32 s63,1178752
 rt a[136:137],v227 offset:0
 v_add_f32 v130,1.0,v130
 mf v[28:31],a[156:159],a[116:119],v[28:31]
 bl v240,s[20:23],s63 offen offset:1024 lds
 mf v[12:15],a[156:159],a[112:115],v[12:15]
 rt a[138:139],v227 offset:2048
 v_add_f32 v131,1.0,v131
 mf v[12:15],a[152:155],a[96:99],v[12:15]
 s_waitcnt lgkmcnt(2)
 rq a[72:75],v234 offset:18432
 v_add_f32 v132,1.0,v132
 mf v[64:67],a[128:131],a[96:99],v[64:67]
 s_mov_b32 s63,1079424
 rt a[140:141],v227 offset:4096
 v_add_f32 v133,1.0,v133
 mf v[64:67],a[132:135],a[112:115],v[64:67]
 bl v240,s[20:23],s63 offen offset:2048 lds
 mf v[80:83],a[132:135],a[116:119],v[80:83]
 rt a[142:143],v227 offset:6144
 v_add_f32 v134,1.0,v134
 mf v[80:83],a[128:131],a[100:103],v[80:83]
 rq a[88:91],v234 offset:22528
 v_add_f32 v135,1.0,v135
 mf v[96:99],a[128:131],a[104:107],v[96:99]
 s_mov_b32 s63,1209472
 rt a[144:145],v228 offset:0
 v_add_f32 v136,1.0,v136
 mf v[96:99],a[132:135],a[120:123],v[96:99]
 bl v240,s[20:23],s63 offen offset:3072 lds
 mf v[112:115],a[132:135],a[124:127],v[112:115]
 rt a[146:147],v228 offset:2048
 v_add_f32 v137,1.0,v137
 mf v[112:115],a[128:131],a[108:111],v[112:115]
 s_waitcnt lgkmcnt(3)
 s_add_u32 m0,s62,69632
 v_add_f32 v138,1.0,v138
 mf v[116:119],a[136:139],a[108:111],v[116:119]
 s_mov_b32 s63,1310848
 rt a[148:149],v228 offset:4096
 v_add_f32 v139,1.0,v139
 mf v[116:119],a[140:143],a[124:127],v[116:119]
 bl v240,s[20:23],s63 offen offset:0 lds
 mf v[100:103],a[140:143],a[120:123],v[100:103]
 rt a[150:151],v228 offset:6144
 v_add_f32 v140,1.0,v140
 mf v[100:103],a[136:139],a[104:107],v[100:103]
 rq a[76:79],v234 offset:19456
 v_add_f32 v141,1.0,v141
 mf v[84:87],a[136:139],a[100:103],v[84:87]
 s_mov_b32 s63,1440896
 rt a[152:153],v229 offset:0
 v_add_f32 v142,1.0,v142
 mf v[84:87],a[140:143],a[116:119],v[84:87]
 bl v240,s[20:23],s63 offen offset:1024 lds
 mf v[68:71],a[140:143],a[112:115],v[68:71]
 rt a[154:155],v229 offset:2048
 v_add_f32 v143,1.0,v143
 mf v[68:71],a[136:139],a[96:99],v[68:71]
 s_waitcnt lgkmcnt(3)
 v_rcp_f32 v128,v128
 v_rcp_f32 v129,v129
 mf v[72:75],a[144:147],a[96:99],v[72:75]
 s_mov_b32 s63,1341568
 rt a[156:157],v229 offset:4096
 v_rcp_f32 v130,v130
 mf v[72:75],a[148:151],a[112:115],v[72:75]
 bl v240,s[20:23],s63 offen offset:2048 lds
 mf v[88:91],a[148:151],a[116:119],v[88:91]
 rt a[158:159],v229 offset:6144
 v_rcp_f32 v131,v131
 mf v[88:91],a[144:147],a[100:103],v[88:91]
 rq a[92:95],v234 offset:23552
 v_rcp_f32 v132,v132
 mf v[104:107],a[144:147],a[104:107],v[104:107]
 s_mov_b32 s63,1471616
 s_waitcnt vmcnt(7)
 rt a[128:129],v226 offset:32768
 v_rcp_f32 v133,v133
 mf v[104:107],a[148:151],a[120:123],v[104:107]
 bl v240,s[20:23],s63 offen offset:3072 lds
 mf v[120:123],a[148:151],a[124:127],v[120:123]
 rt a[130:131],v226 offset:34816
 v_rcp_f32 v134,v134
 mf v[120:123],a[144:147],a[108:111],v[120:123]
 s_waitcnt lgkmcnt(3)
 s_add_u32 m0,s62,0
 v_rcp_f32 v135,v135
 mf v[124:127],a[152:155],a[108:111],v[124:127]
 s_mov_b32 s63,1572864
 rt a[132:133],v226 offset:36864
 v_rcp_f32 v136,v136
 mf v[124:127],a[156:159],a[124:127],v[124:127]
 bl v240,s[20:23],s63 offen offset:0 lds
 mf v[108:111],a[156:159],a[120:123],v[108:111]
 rt a[134:135],v226 offset:38912
 v_rcp_f32 v137,v137
 mf v[108:111],a[152:155],a[104:107],v[108:111]
 v_rcp_f32 v138,v138
 v_rcp_f32 v139,v139
 mf v[92:95],a[152:155],a[100:103],v[92:95]
 s_mov_b32 s63,1702912
 rt a[136:137],v227 offset:32768
 v_rcp_f32 v140,v140
 mf v[92:95],a[156:159],a[116:119],v[92:95]
 bl v240,s[20:23],s63 offen offset:1024 lds
 mf v[76:79],a[156:159],a[112:115],v[76:79]
 rt a[138:139],v227 offset:34816
 v_rcp_f32 v141,v141
 mf v[76:79],a[152:155],a[96:99],v[76:79]
 s_waitcnt lgkmcnt(2)
 v_rcp_f32 v142,v142
 v_rcp_f32 v143,v143
 mf v[0:3],a[128:131],a[64:67],v[0:3]
 s_mov_b32 s63,1603584
 rt a[140:141],v227 offset:36864
 v_mul_f32 v128,v128,v192
 mf v[0:3],a[132:135],a[80:83],v[0:3]
 bl v240,s[20:23],s63 offen offset:2048 lds
 mf v[16:19],a[132:135],a[84:87],v[16:19]
 rt a[142:143],v227 offset:38912
 v_mul_f32 v129,v129,v193
 mf v[16:19],a[128:131],a[68:71],v[16:19]
 rq a[96:99],v234 offset:24576
 v_mul_f32 v130,v130,v194
 mf v[32:35],a[128:131],a[72:75],v[32:35]
 s_mov_b32 s63,1733632
 rt a[144:145],v228 offset:32768
 v_mul_f32 v131,v131,v195
 mf v[32:35],a[132:135],a[88:91],v[32:35]
 bl v240,s[20:23],s63 offen offset:3072 lds
 mf v[48:51],a[132:135],a[92:95],v[48:51]
 rt a[146:147],v228 offset:34816
 v_mul_f32 v132,v132,v196
 mf v[48:51],a[128:131],a[76:79],v[48:51]
 s_waitcnt lgkmcnt(3)
 s_add_u32 m0,s62,4096
 rq a[112:115],v234 offset:28672
 mf v[52:55],a[136:139],a[76:79],v[52:55]
 s_mov_b32 s63,1835008
 rt a[148:149],v228 offset:36864
 v_mul_f32 v133,v133,v197
 mf v[52:55],a[140:143],a[92:95],v[52:55]
 bl v240,s[20:23],s63 offen offset:0 lds
 mf v[36:39],a[140:143],a[88:91],v[36:39]
 rt a[150:151],v228 offset:38912
 v_mul_f32 v134,v134,v198
 mf v[36:39],a[136:139],a[72:75],v[36:39]
 v_mul_f32 v135,v135,v199
 v_mul_f32 v136,v136,v200
 mf v[20:23],a[136:139],a[68:71],v[20:23]
 s_mov_b32 s63,1965056
 rt a[152:153],v229 offset:32768
 v_mul_f32 v137,v137,v201
 mf v[20:23],a[140:143],a[84:87],v[20:23]
 bl v240,s[20:23],s63 offen offset:1024 lds
 mf v[4:7],a[140:143],a[80:83],v[4:7]
 rt a[154:155],v229 offset:34816
 v_mul_f32 v138,v138,v202
 mf v[4:7],a[136:139],a[64:67],v[4:7]
 s_waitcnt lgkmcnt(2)
 rq a[100:103],v234 offset:25600
 v_mul_f32 v139,v139,v203
 mf v[8:11],a[144:147],a[64:67],v[8:11]
 s_mov_b32 s63,1865728
 rt a[156:157],v229 offset:36864
 v_mul_f32 v140,v140,v204
 mf v[8:11],a[148:151],a[80:83],v[8:11]
 bl v240,s[20:23],s63 offen offset:2048 lds
 mf v[24:27],a[148:151],a[84:87],v[24:27]
 rt a[158:159],v229 offset:38912
 v_mul_f32 v141,v141,v205
 mf v[24:27],a[144:147],a[68:71],v[24:27]
 v_mul_f32 v142,v142,v206
 v_mul_f32 v143,v143,v207
 mf v[40:43],a[144:147],a[72:75],v[40:43]
 s_mov_b32 s63,1995776
 s_waitcnt vmcnt(7)
 rt a[128:129],v230 offset:0
 pk v144,v128,v129
 mf v[40:43],a[148:151],a[88:91],v[40:43]
 bl v240,s[20:23],s63 offen offset:3072 lds
 mf v[56:59],a[148:151],a[92:95],v[56:59]
 rt a[130:131],v230 offset:2048
 pk v145,v130,v131
 mf v[56:59],a[144:147],a[76:79],v[56:59]
 s_waitcnt lgkmcnt(2)
 s_add_u32 m0,s62,32768
 rq a[116:119],v234 offset:29696
 mf v[60:63],a[152:155],a[76:79],v[60:63]
 s_mov_b32 s63,1572992
 rt a[132:133],v230 offset:4096
 pk v146,v132,v133
 mf v[60:63],a[156:159],a[92:95],v[60:63]
 bl v240,s[20:23],s63 offen offset:0 lds
 mf v[44:47],a[156:159],a[88:91],v[44:47]
 rt a[134:135],v230 offset:6144
 pk v147,v134,v135
 mf v[44:47],a[152:155],a[72:75],v[44:47]
 pk v148,v136,v137
 pk v149,v138,v139
 mf v[28:31],a[152:155],a[68:71],v[28:31]
 s_mov_b32 s63,1703040
 rt a[136:137],v231 offset:0
 pk v150,v140,v141
 mf v[28:31],a[156:159],a[84:87],v[28:31]
 bl v240,s[20:23],s63 offen offset:1024 lds
 mf v[12:15],a[156:159],a[80:83],v[12:15]
 rt a[138:139],v231 offset:2048
 pk v151,v142,v143
 mf v[12:15],a[152:155],a[64:67],v[12:15]
 s_waitcnt lgkmcnt(2)
 rq a[104:107],v234 offset:26624
 v_lshrrev_b32 v128,5,v255
 mf v[64:67],a[128:131],a[64:67],v[64:67]
 s_mov_b32 s63,1603712
 rt a[140:141],v231 offset:4096
 v_and_b32 v129,128,v251
 mf v[64:67],a[132:135],a[80:83],v[64:67]
 bl v240,s[20:23],s63 offen offset:2048 lds
 mf v[80:83],a[132:135],a[84:87],v[80:83]
 rt a[142:143],v231 offset:6144
 v_lshl_add_u32 v128,v128,10,v129
 mf v[80:83],a[128:131],a[68:71],v[80:83]
 rq a[120:123],v234 offset:30720
 v_mov_b32 v129,0
 mf v[96:99],a[128:131],a[72:75],v[96:99]
 s_mov_b32 s63,1733760
 rt a[144:145],v232 offset:0
 v_mov_b32 v130,-1
 mf v[96:99],a[132:135],a[88:91],v[96:99]
 bl v240,s[20:23],s63 offen offset:3072 lds
 mf v[112:115],a[132:135],a[92:95],v[112:115]
 rt a[146:147],v232 offset:2048
 v_mov_b32 v131,-1
 mf v[112:115],a[128:131],a[76:79],v[112:115]
 s_waitcnt lgkmcnt(3)
 s_add_u32 m0,s62,36864
 v_lshrrev_b32 v132,1,v255
 mf v[116:119],a[136:139],a[76:79],v[116:119]
 s_mov_b32 s63,1835136
 rt a[148:149],v232 offset:4096
 v_add_u32 v244,32768,v244
 mf v[116:119],a[140:143],a[92:95],v[116:119]
 bl v240,s[20:23],s63 offen offset:0 lds
 mf v[100:103],a[140:143],a[88:91],v[100:103]
 rt a[150:151],v232 offset:6144
 v_add_u32 v245,32768,v245
 mf v[100:103],a[136:139],a[72:75],v[100:103]
 rq a[108:111],v234 offset:27648
 v_add_u32 v246,32768,v246
 mf v[84:87],a[136:139],a[68:71],v[84:87]
 s_mov_b32 s63,1965184
 rt a[152:153],v233 offset:0
 v_add_u32 v247,32768,v247
 mf v[84:87],a[140:143],a[84:87],v[84:87]
 bl v240,s[20:23],s63 offen offset:1024 lds
 mf v[68:71],a[140:143],a[80:83],v[68:71]
 rt a[154:155],v233 offset:2048
 v_mov_b32 v133,0x3f803f80
 mf v[68:71],a[136:139],a[64:67],v[68:71]
 s_waitcnt lgkmcnt(3)
 v_and_b32 v134,0xe0,v255
 v_cmp_eq_u32 vcc,0,v134
 mf v[72:75],a[144:147],a[64:67],v[72:75]
 s_mov_b32 s63,1865856
 rt a[156:157],v233 offset:4096
 v_cndmask_b32 v133,0,v133,vcc
 mf v[72:75],a[148:151],a[80:83],v[72:75]
 bl v240,s[20:23],s63 offen offset:2048 lds
 mf v[88:91],a[148:151],a[84:87],v[88:91]
 rt a[158:159],v233 offset:6144
 v_bfe_i32 v134,v255,4,1
 mf v[88:91],a[144:147],a[68:71],v[88:91]
 rq a[124:127],v234 offset:31744
 v_and_b32 v134,0xaaaaaaaa,v134
 mf v[104:107],a[144:147],a[72:75],v[104:107]
 s_mov_b32 s63,1995904
 s_waitcnt vmcnt(7)
 rt a[128:129],v226 offset:0
 v_or_b32 v134,0x44444444,v134
 mf v[104:107],a[148:151],a[88:91],v[104:107]
 bl v240,s[20:23],s63 offen offset:3072 lds
 mf v[120:123],a[148:151],a[92:95],v[120:123]
 rt a[130:131],v226 offset:2048
 v_mov_b32 v250,v134
 mf v[120:123],a[144:147],a[76:79],v[120:123]
 s_waitcnt lgkmcnt(3)
 s_add_u32 m0,s62,65536
 v_accvgpr_write_b32 a192,0
 mf v[124:127],a[152:155],a[76:79],v[124:127]
 s_mov_b32 s63,2097152
 rt a[132:133],v226 offset:4096
 v_accvgpr_write_b32 a193,0
 mf v[124:127],a[156:159],a[92:95],v[124:127]
 bl v240,s[20:23],s63 offen offset:0 lds
 mf v[108:111],a[156:159],a[88:91],v[108:111]
 rt a[134:135],v226 offset:6144
 v_accvgpr_write_b32 a194,0
 mf v[108:111],a[152:155],a[72:75],v[108:111]
 v_accvgpr_write_b32 a195,0
 v_accvgpr_write_b32 a196,0
 mf v[92:95],a[152:155],a[68:71],v[92:95]
 s_mov_b32 s63,2227200
 rt a[136:137],v227 offset:0
 v_accvgpr_write_b32 a197,0
 mf v[92:95],a[156:159],a[84:87],v[92:95]
 bl v240,s[20:23],s63 offen offset:1024 lds
 mf v[76:79],a[156:159],a[80:83],v[76:79]
 rt a[138:139],v227 offset:2048
 v_accvgpr_write_b32 a198,0
 mf v[76:79],a[152:155],a[64:67],v[76:79]
 s_waitcnt lgkmcnt(2)
 v_accvgpr_write_b32 a199,0
 v_accvgpr_write_b32 a200,0
 mf v[0:3],a[128:131],a[96:99],v[0:3]
 s_mov_b32 s63,2127872
 rt a[140:141],v227 offset:4096
 v_accvgpr_write_b32 a201,0
 mf v[0:3],a[132:135],a[112:115],v[0:3]
 bl v240,s[20:23],s63 offen offset:2048 lds
 mf v[16:19],a[132:135],a[116:119],v[16:19]
 rt a[142:143],v227 offset:6144
 v_accvgpr_write_b32 a202,0
 mf v[16:19],a[128:131],a[100:103],v[16:19]
 rq a[64:67],v234 offset:32768
 v_accvgpr_write_b32 a203,0
 mf v[32:35],a[128:131],a[104:107],v[32:35]
 s_mov_b32 s63,2257920
 rt a[144:145],v228 offset:0
 v_accvgpr_write_b32 a204,0
 mf v[32:35],a[132:135],a[120:123],v[32:35]
 bl v240,s[20:23],s63 offen offset:3072 lds
 mf v[48:51],a[132:135],a[124:127],v[48:51]
 rt a[146:147],v228 offset:2048
 v_accvgpr_write_b32 a205,0
 mf v[48:51],a[128:131],a[108:111],v[48:51]
 s_waitcnt lgkmcnt(3)
 s_add_u32 m0,s62,69632
 rq a[80:83],v234 offset:36864
 mf v[52:55],a[136:139],a[108:111],v[52:55]
 s_mov_b32 s63,2359296
 rt a[148:149],v228 offset:4096
 v_accvgpr_write_b32 a206,0
 mf v[52:55],a[140:143],a[124:127],v[52:55]
 bl v240,s[20:23],s63 offen offset:0 lds
 mf v[36:39],a[140:143],a[120:123],v[36:39]
 rt a[150:151],v228 offset:6144
 v_accvgpr_write_b32 a207,0
 mf v[36:39],a[136:139],a[104:107],v[36:39]
 v_accvgpr_write_b32 a208,v133
 v_accvgpr_write_b32 a209,v133
 mf v[20:23],a[136:139],a[100:103],v[20:23]
 s_mov_b32 s63,2489344
 rt a[152:153],v229 offset:0
 v_accvgpr_write_b32 a210,v133
 mf v[20:23],a[140:143],a[116:119],v[20:23]
 bl v240,s[20:23],s63 offen offset:1024 lds
 mf v[4:7],a[140:143],a[112:115],v[4:7]
 rt a[154:155],v229 offset:2048
 v_accvgpr_write_b32 a211,v133
 mf v[4:7],a[136:139],a[96:99],v[4:7]
 s_waitcnt lgkmcnt(2)
 rq a[68:71],v234 offset:33792
 mf v[8:11],a[144:147],a[96:99],v[8:11]
 s_mov_b32 s63,2390016
 rt a[156:157],v229 offset:4096
 mf v[8:11],a[148:151],a[112:115],v[8:11]
 bl v240,s[20:23],s63 offen offset:2048 lds
 mf v[24:27],a[148:151],a[116:119],v[24:27]
 rt a[158:159],v229 offset:6144
 mf v[24:27],a[144:147],a[100:103],v[24:27]
 mf v[40:43],a[144:147],a[104:107],v[40:43]
 s_mov_b32 s63,2520064
 s_waitcnt vmcnt(7)
 rt a[128:129],v226 offset:32768
 mf v[40:43],a[148:151],a[120:123],v[40:43]
 bl v240,s[20:23],s63 offen offset:3072 lds
 mf v[56:59],a[148:151],a[124:127],v[56:59]
 rt a[130:131],v226 offset:34816
 mf v[56:59],a[144:147],a[108:111],v[56:59]
 s_waitcnt lgkmcnt(2)
 s_add_u32 m0,s62,0
 rq a[84:87],v234 offset:37888
 mf v[60:63],a[152:155],a[108:111],v[60:63]
 s_mov_b32 s63,2097280
 rt a[132:133],v226 offset:36864
 mf v[60:63],a[156:159],a[124:127],v[60:63]
 bl v240,s[20:23],s63 offen offset:0 lds
 mf v[44:47],a[156:159],a[120:123],v[44:47]
 rt a[134:135],v226 offset:38912
 mf v[44:47],a[152:155],a[104:107],v[44:47]
 mf v[28:31],a[152:155],a[100:103],v[28:31]
 s_mov_b32 s63,2227328
 rt a[136:137],v227 offset:32768
 mf v[28:31],a[156:159],a[116:119],v[28:31]
 bl v240,s[20:23],s63 offen offset:1024 lds
 mf v[12:15],a[156:159],a[112:115],v[12:15]
 rt a[138:139],v227 offset:34816
 mf v[12:15],a[152:155],a[96:99],v[12:15]
 s_waitcnt lgkmcnt(2)
 rq a[72:75],v234 offset:34816
 mf v[64:67],a[128:131],a[96:99],v[64:67]
 s_mov_b32 s63,2128000
 rt a[140:141],v227 offset:36864
 mf v[64:67],a[132:135],a[112:115],v[64:67]
 bl v240,s[20:23],s63 offen offset:2048 lds
 mf v[80:83],a[132:135],a[116:119],v[80:83]
L_pad_pg3:
 s_cbranch_execz L_hop0
 rt a[142:143],v227 offset:38912
 mf v[80:83],a[128:131],a[100:103],v[80:83]
 rq a[88:91],v234 offset:38912
 mf v[96:99],a[128:131],a[104:107],v[96:99]
 s_mov_b32 s63,2258048
 rt a[144:145],v228 offset:32768
 mf v[96:99],a[132:135],a[120:123],v[96:99]
 bl v240,s[20:23],s63 offen offset:3072 lds
 mf v[112:115],a[132:135],a[124:127],v[112:115]
 rt a[146:147],v228 offset:34816
 mf v[112:115],a[128:131],a[108:111],v[112:115]
 s_waitcnt lgkmcnt(3)
 s_add_u32 m0,s62,4096
 mf v[116:119],a[136:139],a[108:111],v[116:119]
 s_mov_b32 s63,2359424
 rt a[148:149],v228 offset:36864
 mf v[116:119],a[140:143],a[124:127],v[116:119]
 bl v240,s[20:23],s63 offen offset:0 lds
 mf v[100:103],a[140:143],a[120:123],v[100:103]
 rt a[150:151],v228 offset:38912
 mf v[100:103],a[136:139],a[104:107],v[100:103]
 rq a[76:79],v234 offset:35840
 mf v[84:87],a[136:139],a[100:103],v[84:87]
 s_mov_b32 s63,2489472
 rt a[152:153],v229 offset:32768
 mf v[84:87],a[140:143],a[116:119],v[84:87]
 bl v240,s[20:23],s63 offen offset:1024 lds
 mf v[68:71],a[140:143],a[112:115],v[68:71]
 rt a[154:155],v229 offset:34816
 mf v[68:71],a[136:139],a[96:99],v[68:71]
 s_waitcnt lgkmcnt(3)
 mf v[72:75],a[144:147],a[96:99],v[72:75]
 s_mov_b32 s63,2390144
 rt a[156:157],v229 offset:36864
 mf v[72:75],a[148:151],a[112:115],v[72:75]
 bl v240,s[20:23],s63 offen offset:2048 lds
 mf v[88:91],a[148:151],a[116:119],v[88:91]
 rt a[158:159],v229 offset:38912
 mf v[88:91],a[144:147],a[100:103],v[88:91]
 rq a[92:95],v234 offset:39936
 mf v[104:107],a[144:147],a[104:107],v[104:107]
 s_mov_b32 s63,2520192
 s_waitcnt vmcnt(7)
 rt a[128:129],v230 offset:0
 mf v[104:107],a[148:151],a[120:123],v[104:107]
 bl v240,s[20:23],s63 offen offset:3072 lds
 mf v[120:123],a[148:151],a[124:127],v[120:123]
 rt a[130:131],v230 offset:2048
 mf v[120:123],a[144:147],a[108:111],v[120:123]
 s_waitcnt lgkmcnt(3)
 s_add_u32 m0,s62,32768
 mf v[124:127],a[152:155],a[108:111],v[124:127]
 s_mov_b32 s63,2621440
 rt a[132:133],v230 offset:4096
 mf v[124:127],a[156:159],a[124:127],v[124:127]
 bl v240,s[20:23],s63 offen offset:0 lds
 mf v[108:111],a[156:159],a[120:123],v[108:111]
 rt a[134:135],v230 offset:6144
 mf v[108:111],a[152:155],a[104:107],v[108:111]
 mf v[92:95],a[152:155],a[100:103],v[92:95]
 s_mov_b32 s63,2751488
 rt a[136:137],v231 offset:0
 mf v[92:95],a[156:159],a[116:119],v[92:95]
 bl v240,s[20:23],s63 offen offset:1024 lds
 mf v[76:79],a[156:159],a[112:115],v[76:79]
 rt a[138:139],v231 offset:2048
 mf v[76:79],a[152:155],a[96:99],v[76:79]
 s_waitcnt lgkmcnt(2)
 mf v[0:3],a[128:131],a[64:67],v[0:3]
 s_mov_b32 s63,2652160
 rt a[140:141],v231 offset:4096
 mf v[0:3],a[132:135],a[80:83],v[0:3]
 bl v240,s[20:23],s63 offen offset:2048 lds
 mf v[16:19],a[132:135],a[84:87],v[16:19]
 rt a[142:143],v231 offset:6144
 mf v[16:19],a[128:131],a[68:71],v[16:19]
 rq a[96:99],v234 offset:40960
 mf v[32:35],a[128:131],a[72:75],v[32:35]
 s_mov_b32 s63,2782208
 rt a[144:145],v232 offset:0
 mf v[32:35],a[132:135],a[88:91],v[32:35]
 bl v240,s[20:23],s63 offen offset:3072 lds
 mf v[48:51],a[132:135],a[92:95],v[48:51]
 rt a[146:147],v232 offset:2048
 mf v[48:51],a[128:131],a[76:79],v[48:51]
 s_waitcnt lgkmcnt(3)
 s_add_u32 m0,s62,36864
 rq a[112:115],v234 offset:45056
 mf v[52:55],a[136:139],a[76:79],v[52:55]
 s_mov_b32 s63,2883584
 rt a[148:149],v232 offset:4096
 mf v[52:55],a[140:143],a[92:95],v[52:55]
 bl v240,s[20:23],s63 offen offset:0 lds
 mf v[36:39],a[140:143],a[88:91],v[36:39]
 rt a[150:151],v232 offset:6144
 mf v[36:39],a[136:139],a[72:75],v[36:39]
 mf v[20:23],a[136:139],a[68:71],v[20:23]
 s_mov_b32 s63,3013632
 rt a[152:153],v233 offset:0
 mf v[20:23],a[140:143],a[84:87],v[20:23]
 bl v240,s[20:23],s63 offen offset:1024 lds
 mf v[4:7],a[140:143],a[80:83],v[4:7]
 rt a[154:155],v233 offset:2048
 mf v[4:7],a[136:139],a[64:67],v[4:7]
 s_waitcnt lgkmcnt(2)
 rq a[100:103],v234 offset:41984
 mf v[8:11],a[144:147],a[64:67],v[8:11]
 s_mov_b32 s63,2914304
 rt a[156:157],v233 offset:4096
 mf v[8:11],a[148:151],a[80:83],v[8:11]
 bl v240,s[20:23],s63 offen offset:2048 lds
 mf v[24:27],a[148:151],a[84:87],v[24:27]
 rt a[158:159],v233 offset:6144
 mf v[24:27],a[144:147],a[68:71],v[24:27]
 mf v[40:43],a[144:147],a[72:75],v[40:43]
 s_mov_b32 s63,3044352
 s_waitcnt vmcnt(7)
 rt a[128:129],v226 offset:0
 mf v[40:43],a[148:151],a[88:91],v[40:43]
 bl v240,s[20:23],s63 offen offset:3072 lds
 mf v[56:59],a[148:151],a[92:95],v[56:59]
 rt a[130:131],v226 offset:2048
 mf v[56:59],a[144:147],a[76:79],v[56:59]
 s_waitcnt lgkmcnt(2)
 s_add_u32 m0,s62,65536
 rq a[116:119],v234 offset:46080
 mf v[60:63],a[152:155],a[76:79],v[60:63]
 s_mov_b32 s63,2621568
 rt a[132:133],v226 offset:4096
 mf v[60:63],a[156:159],a[92:95],v[60:63]
 bl v240,s[20:23],s63 offen offset:0 lds
 mf v[44:47],a[156:159],a[88:91],v[44:47]
 rt a[134:135],v226 offset:6144
 mf v[44:47],a[152:155],a[72:75],v[44:47]
 mf v[28:31],a[152:155],a[68:71],v[28:31]
 s_mov_b32 s63,2751616
 rt a[136:137],v227 offset:0
 mf v[28:31],a[156:159],a[84:87],v[28:31]
 bl v240,s[20:23],s63 offen offset:1024 lds
 mf v[12:15],a[156:159],a[80:83],v[12:15]
 rt a[138:139],v227 offset:2048
 mf v[12:15],a[152:155],a[64:67],v[12:15]
 s_waitcnt lgkmcnt(2)
 rq a[104:107],v234 offset:43008
 mf v[64:67],a[128:131],a[64:67],v[64:67]
 s_mov_b32 s63,2652288
 rt a[140:141],v227 offset:4096
 mf v[64:67],a[132:135],a[80:83],v[64:67]
 bl v240,s[20:23],s63 offen offset:2048 lds
 mf v[80:83],a[132:135],a[84:87],v[80:83]
 rt a[142:143],v227 offset:6144
 mf v[80:83],a[128:131],a[68:71],v[80:83]
 rq a[120:123],v234 offset:47104
 mf v[96:99],a[128:131],a[72:75],v[96:99]
 s_mov_b32 s63,2782336
 rt a[144:145],v228 offset:0
 mf v[96:99],a[132:135],a[88:91],v[96:99]
 bl v240,s[20:23],s63 offen offset:3072 lds
 mf v[112:115],a[132:135],a[92:95],v[112:115]
 rt a[146:147],v228 offset:2048
 mf v[112:115],a[128:131],a[76:79],v[112:115]
 s_waitcnt lgkmcnt(3)
 s_add_u32 m0,s62,69632
 mf v[116:119],a[136:139],a[76:79],v[116:119]
 s_mov_b32 s63,2883712
 rt a[148:149],v228 offset:4096
 mf v[116:119],a[140:143],a[92:95],v[116:119]
 bl v240,s[20:23],s63 offen offset:0 lds
 mf v[100:103],a[140:143],a[88:91],v[100:103]
 rt a[150:151],v228 offset:6144
 mf v[100:103],a[136:139],a[72:75],v[100:103]
 rq a[108:111],v234 offset:44032
 mf v[84:87],a[136:139],a[68:71],v[84:87]
 s_mov_b32 s63,3013760
 rt a[152:153],v229 offset:0
 mf v[84:87],a[140:143],a[84:87],v[84:87]
 bl v240,s[20:23],s63 offen offset:1024 lds
 mf v[68:71],a[140:143],a[80:83],v[68:71]
 rt a[154:155],v229 offset:2048
 mf v[68:71],a[136:139],a[64:67],v[68:71]
 s_waitcnt lgkmcnt(3)
 mf v[72:75],a[144:147],a[64:67],v[72:75]
 s_mov_b32 s63,2914432
 rt a[156:157],v229 offset:4096
 mf v[72:75],a[148:151],a[80:83],v[72:75]
 bl v240,s[20:23],s63 offen offset:2048 lds
 mf v[88:91],a[148:151],a[84:87],v[88:91]
 rt a[158:159],v229 offset:6144
 mf v[88:91],a[144:147],a[68:71],v[88:91]
 rq a[124:127],v234 offset:48128
 mf v[104:107],a[144:147],a[72:75],v[104:107]
 s_mov_b32 s63,3044480
 s_waitcnt vmcnt(7)
 rt a[128:129],v226 offset:32768
 mf v[104:107],a[148:151],a[88:91],v[104:107]
 bl v240,s[20:23],s63 offen offset:3072 lds
 mf v[120:123],a[148:151],a[92:95],v[120:123]
 rt a[130:131],v226 offset:34816
 mf v[120:123],a[144:147],a[76:79],v[120:123]
 s_waitcnt lgkmcnt(3)
 s_add_u32 m0,s62,0
 mf v[124:127],a[152:155],a[76:79],v[124:127]
 s_mov_b32 s63,3145728
 rt a[132:133],v226 offset:36864
 mf v[124:127],a[156:159],a[92:95],v[124:127]
 bl v240,s[20:23],s63 offen offset:0 lds
 mf v[108:111],a[156:159],a[88:91],v[108:111]
 rt a[134:135],v226 offset:38912
 mf v[108:111],a[152:155],a[72:75],v[108:111]
 mf v[92:95],a[152:155],a[68:71],v[92:95]
 s_mov_b32 s63,3275776
 rt a[136:137],v227 offset:32768
 mf v[92:95],a[156:159],a[84:87],v[92:95]
 bl v240,s[20:23],s63 offen offset:1024 lds
 mf v[76:79],a[156:159],a[80:83],v[76:79]
 rt a[138:139],v227 offset:34816
 mf v[76:79],a[152:155],a[64:67],v[76:79]
 s_waitcnt lgkmcnt(2)
 mf v[0:3],a[128:131],a[96:99],v[0:3]
 s_mov_b32 s63,3176448
 rt a[140:141],v227 offset:36864
 mf v[0:3],a[132:135],a[112:115],v[0:3]
 bl v240,s[20:23],s63 offen offset:2048 lds
 mf v[16:19],a[132:135],a[116:119],v[16:19]
 rt a[142:143],v227 offset:38912
 mf v[16:19],a[128:131],a[100:103],v[16:19]
 rq a[64:67],v234 offset:49152
 mf v[32:35],a[128:131],a[104:107],v[32:35]
 s_mov_b32 s63,3306496
 rt a[144:145],v228 offset:32768
 mf v[32:35],a[132:135],a[120:123],v[32:35]
 bl v240,s[20:23],s63 offen offset:3072 lds
 mf v[48:51],a[132:135],a[124:127],v[48:51]
 rt a[146:147],v228 offset:34816
 mf v[48:51],a[128:131],a[108:111],v[48:51]
 s_waitcnt lgkmcnt(3)
 s_add_u32 m0,s62,4096
 rq a[80:83],v234 offset:53248
 mf v[52:55],a[136:139],a[108:111],v[52:55]
 s_mov_b32 s63,3407872
 rt a[148:149],v228 offset:36864
 mf v[52:55],a[140:143],a[124:127],v[52:55]
 bl v240,s[20:23],s63 offen offset:0 lds
 mf v[36:39],a[140:143],a[120:123],v[36:39]
 rt a[150:151],v228 offset:38912
 mf v[36:39],a[136:139],a[104:107],v[36:39]
 mf v[20:23],a[136:139],a[100:103],v[20:23]
 s_mov_b32 s63,3537920
 rt a[152:153],v229 offset:32768
 mf v[20:23],a[140:143],a[116:119],v[20:23]
 bl v240,s[20:23],s63 offen offset:1024 lds
 mf v[4:7],a[140:143],a[112:115],v[4:7]
 rt a[154:155],v229 offset:34816
 mf v[4:7],a[136:139],a[96:99],v[4:7]
 s_waitcnt lgkmcnt(2)
 rq a[68:71],v234 offset:50176
 mf v[8:11],a[144:147],a[96:99],v[8:11]
 s_mov_b32 s63,3438592
 rt a[156:157],v229 offset:36864
 mf v[8:11],a[148:151],a[112:115],v[8:11]
 bl v240,s[20:23],s63 offen offset:2048 lds
 mf v[24:27],a[148:151],a[116:119],v[24:27]
 rt a[158:159],v229 offset:38912
 mf v[24:27],a[144:147],a[100:103],v[24:27]
 mf v[40:43],a[144:147],a[104:107],v[40:43]
 s_mov_b32 s63,3568640
 s_waitcnt vmcnt(7)
 rt a[128:129],v230 offset:0
 mf v[40:43],a[148:151],a[120:123],v[40:43]
 bl v240,s[20:23],s63 offen offset:3072 lds
 mf v[56:59],a[148:151],a[124:127],v[56:59]
 rt a[130:131],v230 offset:2048
 mf v[56:59],a[144:147],a[108:111],v[56:59]
 s_waitcnt lgkmcnt(2)
 s_add_u32 m0,s62,32768
 rq a[84:87],v234 offset:54272
 mf v[60:63],a[152:155],a[108:111],v[60:63]
 s_mov_b32 s63,3145856
 rt a[132:133],v230 offset:4096
 mf v[60:63],a[156:159],a[124:127],v[60:63]
 bl v240,s[20:23],s63 offen offset:0 lds
 mf v[44:47],a[156:159],a[120:123],v[44:47]
 rt a[134:135],v230 offset:6144
 mf v[44:47],a[152:155],a[104:107],v[44:47]
 mf v[28:31],a[152:155],a[100:103],v[28:31]
 s_mov_b32 s63,3275904
 rt a[136:137],v231 offset:0
 mf v[28:31],a[156:159],a[116:119],v[28:31]
 bl v240,s[20:23],s63 offen offset:1024 lds
 mf v[12:15],a[156:159],a[112:115],v[12:15]
 rt a[138:139],v231 offset:2048
 mf v[12:15],a[152:155],a[96:99],v[12:15]
 s_waitcnt lgkmcnt(2)
 rq a[72:75],v234 offset:51200
 mf v[64:67],a[128:131],a[96:99],v[64:67]
 s_mov_b32 s63,3176576
 rt a[140:141],v231 offset:4096
 mf v[64:67],a[132:135],a[112:115],v[64:67]
 bl v240,s[20:23],s63 offen offset:2048 lds
 mf v[80:83],a[132:135],a[116:119],v[80:83]
 rt a[142:143],v231 offset:6144
 mf v[80:83],a[128:131],a[100:103],v[80:83]
 rq a[88:91],v234 offset:55296
 mf v[96:99],a[128:131],a[104:107],v[96:99]
 s_mov_b32 s63,3306624
 rt a[144:145],v232 offset:0
 mf v[96:99],a[132:135],a[120:123],v[96:99]
 bl v240,s[20:23],s63 offen offset:3072 lds
 mf v[112:115],a[132:135],a[124:127],v[112:115]
 rt a[146:147],v232 offset:2048
 mf v[112:115],a[128:131],a[108:111],v[112:115]
 s_waitcnt lgkmcnt(3)
 s_add_u32 m0,s62,36864
 mf v[116:119],a[136:139],a[108:111],v[116:119]
 s_mov_b32 s63,3408000
 rt a[148:149],v232 offset:4096
 mf v[116:119],a[140:143],a[124:127],v[116:119]
 bl v240,s[20:23],s63 offen offset:0 lds
 mf v[100:103],a[140:143],a[120:123],v[100:103]
 rt a[150:151],v232 offset:6144
 mf v[100:103],a[136:139],a[104:107],v[100:103]
 rq a[76:79],v234 offset:52224
 mf v[84:87],a[136:139],a[100:103],v[84:87]
 s_mov_b32 s63,3538048
 rt a[152:153],v233 offset:0
 mf v[84:87],a[140:143],a[116:119],v[84:87]
 bl v240,s[20:23],s63 offen offset:1024 lds
 mf v[68:71],a[140:143],a[112:115],v[68:71]
 rt a[154:155],v233 offset:2048
 mf v[68:71],a[136:139],a[96:99],v[68:71]
 s_waitcnt lgkmcnt(3)
 mf v[72:75],a[144:147],a[96:99],v[72:75]
 s_mov_b32 s63,3438720
 rt a[156:157],v233 offset:4096
 mf v[72:75],a[148:151],a[112:115],v[72:75]
 bl v240,s[20:23],s63 offen offset:2048 lds
 mf v[88:91],a[148:151],a[116:119],v[88:91]
 rt a[158:159],v233 offset:6144
 mf v[88:91],a[144:147],a[100:103],v[88:91]
 rq a[92:95],v234 offset:56320
 mf v[104:107],a[144:147],a[104:107],v[104:107]
 s_mov_b32 s63,3568768
 s_waitcnt vmcnt(7)
 rt a[128:129],v226 offset:0
 mf v[104:107],a[148:151],a[120:123],v[104:107]
 bl v240,s[20:23],s63 offen offset:3072 lds
 mf v[120:123],a[148:151],a[124:127],v[120:123]
 rt a[130:131],v226 offset:2048
 mf v[120:123],a[144:147],a[108:111],v[120:123]
 s_waitcnt lgkmcnt(3)
 s_add_u32 m0,s62,65536
 mf v[124:127],a[152:155],a[108:111],v[124:127]
 s_mov_b32 s63,3670016
 rt a[132:133],v226 offset:4096
 mf v[124:127],a[156:159],a[124:127],v[124:127]
 bl v240,s[20:23],s63 offen offset:0 lds
 mf v[108:111],a[156:159],a[120:123],v[108:111]
 rt a[134:135],v226 offset:6144
 mf v[108:111],a[152:155],a[104:107],v[108:111]
 mf v[92:95],a[152:155],a[100:103],v[92:95]
 s_mov_b32 s63,3800064
 rt a[136:137],v227 offset:0
 mf v[92:95],a[156:159],a[116:119],v[92:95]
 bl v240,s[20:23],s63 offen offset:1024 lds
 mf v[76:79],a[156:159],a[112:115],v[76:79]
 rt a[138:139],v227 offset:2048
 mf v[76:79],a[152:155],a[96:99],v[76:79]
 s_waitcnt lgkmcnt(2)
 mf v[0:3],a[128:131],a[64:67],v[0:3]
 s_mov_b32 s63,3700736
 rt a[140:141],v227 offset:4096
 mf v[0:3],a[132:135],a[80:83],v[0:3]
 bl v240,s[20:23],s63 offen offset:2048 lds
 mf v[16:19],a[132:135],a[84:87],v[16:19]
 rt a[142:143],v227 offset:6144
 mf v[16:19],a[128:131],a[68:71],v[16:19]
 rq a[96:99],v234 offset:57344
 mf v[32:35],a[128:131],a[72:75],v[32:35]
 s_mov_b32 s63,3830784
 rt a[144:145],v228 offset:0
 mf v[32:35],a[132:135],a[88:91],v[32:35]
 bl v240,s[20:23],s63 offen offset:3072 lds
 mf v[48:51],a[132:135],a[92:95],v[48:51]
 rt a[146:147],v228 offset:2048
 mf v[48:51],a[128:131],a[76:79],v[48:51]
 s_waitcnt lgkmcnt(3)
 s_add_u32 m0,s62,69632
 rq a[112:115],v234 offset:61440
 mf v[52:55],a[136:139],a[76:79],v[52:55]
 s_mov_b32 s63,3932160
 rt a[148:149],v228 offset:4096
 mf v[52:55],a[140:143],a[92:95],v[52:55]
 bl v240,s[20:23],s63 offen offset:0 lds
 mf v[36:39],a[140:143],a[88:91],v[36:39]
 rt a[150:151],v228 offset:6144
 mf v[36:39],a[136:139],a[72:75],v[36:39]
 mf v[20:23],a[136:139],a[68:71],v[20:23]
 s_mov_b32 s63,4062208
 rt a[152:153],v229 offset:0
 mf v[20:23],a[140:143],a[84:87],v[20:23]
 bl v240,s[20:23],s63 offen offset:1024 lds
 mf v[4:7],a[140:143],a[80:83],v[4:7]
 rt a[154:155],v229 offset:2048
 mf v[4:7],a[136:139],a[64:67],v[4:7]
 s_waitcnt lgkmcnt(2)
 rq a[100:103],v234 offset:58368
 mf v[8:11],a[144:147],a[64:67],v[8:11]
 s_mov_b32 s63,3962880
 rt a[156:157],v229 offset:4096
 mf v[8:11],a[148:151],a[80:83],v[8:11]
 bl v240,s[20:23],s63 offen offset:2048 lds
 mf v[24:27],a[148:151],a[84:87],v[24:27]
 rt a[158:159],v229 offset:6144
 mf v[24:27],a[144:147],a[68:71],v[24:27]
 mf v[40:43],a[144:147],a[72:75],v[40:43]
 s_mov_b32 s63,4092928
 s_waitcnt vmcnt(7)
 rt a[128:129],v226 offset:32768
 mf v[40:43],a[148:151],a[88:91],v[40:43]
 bl v240,s[20:23],s63 offen offset:3072 lds
 mf v[56:59],a[148:151],a[92:95],v[56:59]
 rt a[130:131],v226 offset:34816
 mf v[56:59],a[144:147],a[76:79],v[56:59]
 s_waitcnt lgkmcnt(2)
 s_add_u32 m0,s62,0
 rq a[116:119],v234 offset:62464
 mf v[60:63],a[152:155],a[76:79],v[60:63]
 s_mov_b32 s63,3670144
 rt a[132:133],v226 offset:36864
 mf v[60:63],a[156:159],a[92:95],v[60:63]
 bl v240,s[20:23],s63 offen offset:0 lds
 mf v[44:47],a[156:159],a[88:91],v[44:47]
 rt a[134:135],v226 offset:38912
 mf v[44:47],a[152:155],a[72:75],v[44:47]
 mf v[28:31],a[152:155],a[68:71],v[28:31]
 s_mov_b32 s63,3800192
 rt a[136:137],v227 offset:32768
 mf v[28:31],a[156:159],a[84:87],v[28:31]
 bl v240,s[20:23],s63 offen offset:1024 lds
 mf v[12:15],a[156:159],a[80:83],v[12:15]
 rt a[138:139],v227 offset:34816
 mf v[12:15],a[152:155],a[64:67],v[12:15]
 s_waitcnt lgkmcnt(2)
 rq a[104:107],v234 offset:59392
 mf v[64:67],a[128:131],a[64:67],v[64:67]
 s_mov_b32 s63,3700864
 rt a[140:141],v227 offset:36864
 mf v[64:67],a[132:135],a[80:83],v[64:67]
 bl v240,s[20:23],s63 offen offset:2048 lds
 mf v[80:83],a[132:135],a[84:87],v[80:83]
 rt a[142:143],v227 offset:38912
 mf v[80:83],a[128:131],a[68:71],v[80:83]
 rq a[120:123],v234 offset:63488
 mf v[96:99],a[128:131],a[72:75],v[96:99]
 s_mov_b32 s63,3830912
 rt a[144:145],v228 offset:32768
 mf v[96:99],a[132:135],a[88:91],v[96:99]
 bl v240,s[20:23],s63 offen offset:3072 lds
 mf v[112:115],a[132:135],a[92:95],v[112:115]
 rt a[146:147],v228 offset:34816
 mf v[112:115],a[128:131],a[76:79],v[112:115]
 s_waitcnt lgkmcnt(3)
 s_add_u32 m0,s62,4096
 mf v[116:119],a[136:139],a[76:79],v[116:119]
 s_mov_b32 s63,3932288
 rt a[148:149],v228 offset:36864
 mf v[116:119],a[140:143],a[92:95],v[116:119]
 bl v240,s[20:23],s63 offen offset:0 lds
 mf v[100:103],a[140:143],a[88:91],v[100:103]
 rt a[150:151],v228 offset:38912
 mf v[100:103],a[136:139],a[72:75],v[100:103]
 rq a[108:111],v234 offset:60416
 mf v[84:87],a[136:139],a[68:71],v[84:87]
 s_mov_b32 s63,4062336
 rt a[152:153],v229 offset:32768
 mf v[84:87],a[140:143],a[84:87],v[84:87]
 bl v240,s[20:23],s63 offen offset:1024 lds
 mf v[68:71],a[140:143],a[80:83],v[68:71]
 rt a[154:155],v229 offset:34816
 mf v[68:71],a[136:139],a[64:67],v[68:71]
 s_waitcnt lgkmcnt(3)
 mf v[72:75],a[144:147],a[64:67],v[72:75]
 s_mov_b32 s63,3963008
 rt a[156:157],v229 offset:36864
 mf v[72:75],a[148:151],a[80:83],v[72:75]
 bl v240,s[20:23],s63 offen offset:2048 lds
 mf v[88:91],a[148:151],a[84:87],v[88:91]
 rt a[158:159],v229 offset:38912
 mf v[88:91],a[144:147],a[68:71],v[88:91]
 rq a[124:127],v234 offset:64512
 mf v[104:107],a[144:147],a[72:75],v[104:107]
 s_mov_b32 s63,4093056
 s_waitcnt vmcnt(7)
 rt a[128:129],v230 offset:0
 mf v[104:107],a[148:151],a[88:91],v[104:107]
 bl v240,s[20:23],s63 offen offset:3072 lds
 mf v[120:123],a[148:151],a[92:95],v[120:123]
 s_barrier
 rt a[130:131],v230 offset:2048
 mf v[120:123],a[144:147],a[76:79],v[120:123]
 s_waitcnt lgkmcnt(3)
 s_add_u32 m0,s61,0
 mf v[124:127],a[152:155],a[76:79],v[124:127]
 s_mov_b32 s63,0
 rt a[132:133],v230 offset:4096
 mf v[124:127],a[156:159],a[92:95],v[124:127]
 bl v220,s[8:11],s63 offen offset:0 lds
 mf v[108:111],a[156:159],a[88:91],v[108:111]
 rt a[134:135],v230 offset:6144
 mf v[108:111],a[152:155],a[72:75],v[108:111]
 mf v[92:95],a[152:155],a[68:71],v[92:95]
 rt a[136:137],v231 offset:0
 mf v[92:95],a[156:159],a[84:87],v[92:95]
 bl v221,s[8:11],s63 offen offset:1024 lds
 mf v[76:79],a[156:159],a[80:83],v[76:79]
 rt a[138:139],v231 offset:2048
 mf v[76:79],a[152:155],a[64:67],v[76:79]
 s_waitcnt lgkmcnt(2)
 mf v[0:3],a[128:131],a[96:99],v[0:3]
 rt a[140:141],v231 offset:4096
 mf v[0:3],a[132:135],a[112:115],v[0:3]
 bl v222,s[8:11],s63 offen offset:2048 lds
 mf v[16:19],a[132:135],a[116:119],v[16:19]
 rt a[142:143],v231 offset:6144
 mf v[16:19],a[128:131],a[100:103],v[16:19]
 mf v[32:35],a[128:131],a[104:107],v[32:35]
 rt a[144:145],v232 offset:0
 mf v[32:35],a[132:135],a[120:123],v[32:35]
 bl v223,s[8:11],s63 offen offset:3072 lds
 mf v[48:51],a[132:135],a[124:127],v[48:51]
 rt a[146:147],v232 offset:2048
 mf v[48:51],a[128:131],a[108:111],v[48:51]
 s_waitcnt lgkmcnt(2)
 s_add_u32 m0,s61,16384
 mf v[52:55],a[136:139],a[108:111],v[52:55]
 s_mov_b32 s63,16384
 rt a[148:149],v232 offset:4096
 mf v[52:55],a[140:143],a[124:127],v[52:55]
L_pad_pg4:
 s_cbranch_execz L_hop0
 bl v220,s[8:11],s63 offen offset:0 lds
 mf v[36:39],a[140:143],a[120:123],v[36:39]
 rt a[150:151],v232 offset:6144
 mf v[36:39],a[136:139],a[104:107],v[36:39]
 mf v[20:23],a[136:139],a[100:103],v[20:23]
 rt a[152:153],v233 offset:0
 mf v[20:23],a[140:143],a[116:119],v[20:23]
 bl v221,s[8:11],s63 offen offset:1024 lds
 mf v[4:7],a[140:143],a[112:115],v[4:7]
 rt a[154:155],v233 offset:2048
 mf v[4:7],a[136:139],a[96:99],v[4:7]
 s_waitcnt lgkmcnt(2)
 mf v[8:11],a[144:147],a[96:99],v[8:11]
 rt a[156:157],v233 offset:4096
 mf v[8:11],a[148:151],a[112:115],v[8:11]
 bl v222,s[8:11],s63 offen offset:2048 lds
 mf v[24:27],a[148:151],a[116:119],v[24:27]
 rt a[158:159],v233 offset:6144
 mf v[24:27],a[144:147],a[100:103],v[24:27]
 mf v[40:43],a[144:147],a[104:107],v[40:43]
 s_waitcnt vmcnt(7)
 rt a[128:129],v226 offset:0
 mf v[40:43],a[148:151],a[120:123],v[40:43]
 bl v223,s[8:11],s63 offen offset:3072 lds
 mf v[56:59],a[148:151],a[124:127],v[56:59]
 s_add_u32 s64,s67,0
 rt a[130:131],v226 offset:2048
 mf v[56:59],a[144:147],a[108:111],v[56:59]
 s_waitcnt lgkmcnt(2)
 s_add_u32 m0,s61,32768
 buffer_store_dwordx4 v[144:147],v254,s[16:19],s64 offen sc1
 mf v[60:63],a[152:155],a[108:111],v[60:63]
 s_mov_b32 s63,32768
 rt a[132:133],v226 offset:4096
 s_add_u32 s64,s67,131072
 mf v[60:63],a[156:159],a[124:127],v[60:63]
 bl v220,s[8:11],s63 offen offset:0 lds
 mf v[44:47],a[156:159],a[120:123],v[44:47]
 rt a[134:135],v226 offset:6144
 buffer_store_dwordx4 v[148:151],v254,s[16:19],s64 offen sc1
 mf v[44:47],a[152:155],a[104:107],v[44:47]
 s_mov_b64 exec,255
 buffer_store_dword v129,v128,s[16:19],s70 offen sc1
 s_mov_b64 exec,-1
 mf v[28:31],a[152:155],a[100:103],v[28:31]
 rt a[136:137],v227 offset:0
 s_mov_b64 exec,65535
 buffer_store_dwordx2 v[130:131],v132,s[16:19],s73 offen sc1
 s_mov_b64 exec,-1
 mf v[28:31],a[156:159],a[116:119],v[28:31]
 bl v221,s[8:11],s63 offen offset:1024 lds
 mf v[12:15],a[156:159],a[112:115],v[12:15]
 rt a[138:139],v227 offset:2048
 mf v[12:15],a[152:155],a[96:99],v[12:15]
 s_waitcnt lgkmcnt(2)
 mf v[64:67],a[128:131],a[96:99],v[64:67]
 rt a[140:141],v227 offset:4096
 mf v[64:67],a[132:135],a[112:115],v[64:67]
 bl v222,s[8:11],s63 offen offset:2048 lds
 mf v[80:83],a[132:135],a[116:119],v[80:83]
 rt a[142:143],v227 offset:6144
 mf v[80:83],a[128:131],a[100:103],v[80:83]
 mf v[96:99],a[128:131],a[104:107],v[96:99]
 rt a[144:145],v228 offset:0
 pk v128,v0,v1
 mf v[96:99],a[132:135],a[120:123],v[96:99]
 bl v223,s[8:11],s63 offen offset:3072 lds
 mf v[112:115],a[132:135],a[124:127],v[112:115]
 rt a[146:147],v228 offset:2048
 pk v129,v2,v3
 mf v[112:115],a[128:131],a[108:111],v[112:115]
 s_waitcnt lgkmcnt(2)
 pk v130,v4,v5
 pk v131,v6,v7
 mf v[116:119],a[136:139],a[108:111],v[116:119]
 rt a[148:149],v228 offset:4096
 pk v132,v8,v9
 mf v[116:119],a[140:143],a[124:127],v[116:119]
 pk v133,v10,v11
 pk v134,v12,v13
 mf v[100:103],a[140:143],a[120:123],v[100:103]
 rt a[150:151],v228 offset:6144
 pk v135,v14,v15
 mf v[100:103],a[136:139],a[104:107],v[100:103]
 pk v144,v16,v17
 pk v145,v18,v19
 mf v[84:87],a[136:139],a[100:103],v[84:87]
 rt a[152:153],v229 offset:0
 pk v146,v20,v21
 mf v[84:87],a[140:143],a[116:119],v[84:87]
 pk v147,v22,v23
 pk v148,v24,v25
 mf v[68:71],a[140:143],a[112:115],v[68:71]
 rt a[154:155],v229 offset:2048
 pk v149,v26,v27
 mf v[68:71],a[136:139],a[96:99],v[68:71]
 s_waitcnt lgkmcnt(2)
 pk v150,v28,v29
 pk v151,v30,v31
 mf v[72:75],a[144:147],a[96:99],v[72:75]
 rt a[156:157],v229 offset:4096
 pk v160,v32,v33
 mf v[72:75],a[148:151],a[112:115],v[72:75]
 pk v161,v34,v35
 pk v162,v36,v37
 mf v[88:91],a[148:151],a[116:119],v[88:91]
 rt a[158:159],v229 offset:6144
 pk v163,v38,v39
 mf v[88:91],a[144:147],a[100:103],v[88:91]
 pk v164,v40,v41
 pk v165,v42,v43
 mf v[104:107],a[144:147],a[104:107],v[104:107]
 pk v166,v44,v45
 pk v167,v46,v47
 mf v[104:107],a[148:151],a[120:123],v[104:107]
 pk v176,v48,v49
 pk v177,v50,v51
 mf v[120:123],a[148:151],a[124:127],v[120:123]
 pk v178,v52,v53
 pk v179,v54,v55
 mf v[120:123],a[144:147],a[108:111],v[120:123]
 s_waitcnt lgkmcnt(0)
 pk v180,v56,v57
 pk v181,v58,v59
 mf v[124:127],a[152:155],a[108:111],v[124:127]
 pk v182,v60,v61
 pk v183,v62,v63
 mf v[124:127],a[156:159],a[124:127],v[124:127]
 mf v[108:111],a[156:159],a[120:123],v[108:111]
 mf v[108:111],a[152:155],a[104:107],v[108:111]
 mf v[92:95],a[152:155],a[100:103],v[92:95]
 mf v[92:95],a[156:159],a[116:119],v[92:95]
 mf v[76:79],a[156:159],a[112:115],v[76:79]
 mf v[76:79],a[152:155],a[96:99],v[76:79]
 s_waitcnt vmcnt(8)
 s_barrier
 rq a[128:131],v208 offset:0
 rq a[132:135],v209 offset:0
 rq a[136:139],v210 offset:0
 rq a[140:143],v211 offset:0
 rq a[144:147],v208 offset:4096
 rq a[148:151],v209 offset:4096
 rq a[152:155],v210 offset:4096
 rq a[156:159],v211 offset:4096
 pk v136,v64,v65
 pk v137,v66,v67
 pk v138,v68,v69
 pk v139,v70,v71
 pk v140,v72,v73
 pk v141,v74,v75
 pk v142,v76,v77
 pk v143,v78,v79
 pk v152,v80,v81
 pk v153,v82,v83
 pk v154,v84,v85
 pk v155,v86,v87
 pk v156,v88,v89
 pk v157,v90,v91
 pk v158,v92,v93
 pk v159,v94,v95
 s_waitcnt lgkmcnt(4)
 mf v[0:3],a[128:131],v[128:131],0
 pk v168,v96,v97
 pk v169,v98,v99
 mf v[0:3],a[132:135],v[132:135],v[0:3]
 pk v170,v100,v101
 pk v171,v102,v103
 mf v[0:3],a[136:139],v[136:139],v[0:3]
 pk v172,v104,v105
 pk v173,v106,v107
 mf v[0:3],a[140:143],v[140:143],v[0:3]
 pk v174,v108,v109
 pk v175,v110,v111
 mf v[16:19],a[140:143],v[156:159],0
 pk v184,v112,v113
 pk v185,v114,v115
 mf v[16:19],a[136:139],v[152:155],v[16:19]
 pk v186,v116,v117
 pk v187,v118,v119
 mf v[16:19],a[132:135],v[148:151],v[16:19]
 pk v188,v120,v121
 pk v189,v122,v123
 mf v[16:19],a[128:131],v[144:147],v[16:19]
 s_add_u32 m0,s61,65536
 pk v190,v124,v125
 pk v191,v126,v127
 mf v[32:35],a[128:131],v[160:163],0
 s_mov_b32 s63,0
 mf v[32:35],a[132:135],v[164:167],v[32:35]
 bl v224,s[12:15],s63 offen offset:0 lds
 mf v[32:35],a[136:139],v[168:171],v[32:35]
 mf v[32:35],a[140:143],v[172:175],v[32:35]
 bl v225,s[12:15],s63 offen offset:1024 lds
 mf v[48:51],a[140:143],v[188:191],0
 mf v[48:51],a[136:139],v[184:187],v[48:51]
 bl v224,s[12:15],s63 offen offset:2048 lds
 mf v[48:51],a[132:135],v[180:183],v[48:51]
 mf v[48:51],a[128:131],v[176:179],v[48:51]
 bl v225,s[12:15],s63 offen offset:3072 lds
 rq a[128:131],v208 offset:8192
 rq a[132:135],v209 offset:8192
 rq a[136:139],v210 offset:8192
 rq a[140:143],v211 offset:8192
 v_max3_f32 v192,v0,v1,v2
 v_max3_f32 v196,v16,v17,v18
 v_max3_f32 v200,v32,v33,v34
 v_max3_f32 v204,v48,v49,v50
 v_max_f32 v192,v192,v3
 v_max_f32 v196,v196,v19
 v_max_f32 v200,v200,v35
 v_max_f32 v204,v204,v51
 v_mov_b32 v193,v192
 v_mov_b32 v197,v196
 v_mov_b32 v201,v200
 v_mov_b32 v205,v204
 v_permlane32_swap_b32 v192,v193
 v_permlane32_swap_b32 v196,v197
 v_permlane32_swap_b32 v200,v201
 v_permlane32_swap_b32 v204,v205
 v_max_f32 v192,v192,v193
 v_max_f32 v196,v196,v197
 v_max_f32 v200,v200,v201
 v_max_f32 v204,v204,v205
 v_mov_b32 v193,v192
 v_mov_b32 v197,v196
 v_mov_b32 v201,v200
 v_mov_b32 v205,v204
 v_permlane16_swap_b32 v192,v193
 v_permlane16_swap_b32 v196,v197
 v_permlane16_swap_b32 v200,v201
 v_permlane16_swap_b32 v204,v205
 v_max_f32 v192,v192,v193
 v_max_f32 v196,v196,v197
 v_max_f32 v200,v200,v201
 v_max_f32 v204,v204,v205
 s_mov_b32 s55,0xc1cb3333
 v_sub_f32 v193,s55,v192
 v_sub_f32 v194,s55,v192
 v_sub_f32 v195,s55,v192
 v_sub_f32 v192,s55,v192
 v_sub_f32 v197,s55,v196
 v_sub_f32 v198,s55,v196
 v_sub_f32 v199,s55,v196
 v_sub_f32 v196,s55,v196
 v_sub_f32 v201,s55,v200
 v_sub_f32 v202,s55,v200
 v_sub_f32 v203,s55,v200
 v_sub_f32 v200,s55,v200
 v_sub_f32 v205,s55,v204
 v_sub_f32 v206,s55,v204
 v_sub_f32 v207,s55,v204
 v_sub_f32 v204,s55,v204
 s_waitcnt lgkmcnt(4)
 s_nop 0
 mf v[52:55],a[144:147],v[176:179],v[204:207]
 v_add_f32 v0,v0,v192
 v_add_f32 v1,v1,v192
 mf v[52:55],a[148:151],v[180:183],v[52:55]
 s_add_u32 m0,s61,81920
 v_add_f32 v2,v2,v192
 v_add_f32 v3,v3,v192
 mf v[52:55],a[152:155],v[184:187],v[52:55]
 s_mov_b32 s63,16384
 v_exp_f32 v0,v0
 mf v[52:55],a[156:159],v[188:191],v[52:55]
 bl v224,s[12:15],s63 offen offset:0 lds
 mf v[36:39],a[156:159],v[172:175],v[200:203]
 v_exp_f32 v1,v1
 mf v[36:39],a[152:155],v[168:171],v[36:39]
 v_exp_f32 v2,v2
 mf v[36:39],a[148:151],v[164:167],v[36:39]
 v_exp_f32 v3,v3
 mf v[36:39],a[144:147],v[160:163],v[36:39]
 v_add_f32 v16,v16,v196
 v_add_f32 v17,v17,v196
 mf v[20:23],a[144:147],v[144:147],v[196:199]
 v_add_f32 v18,v18,v196
 v_add_f32 v19,v19,v196
 mf v[20:23],a[148:151],v[148:151],v[20:23]
 bl v225,s[12:15],s63 offen offset:1024 lds
 mf v[20:23],a[152:155],v[152:155],v[20:23]
 v_exp_f32 v16,v16
 mf v[20:23],a[156:159],v[156:159],v[20:23]
 v_exp_f32 v17,v17
 mf v[4:7],a[156:159],v[140:143],v[192:195]
 v_exp_f32 v18,v18
 mf v[4:7],a[152:155],v[136:139],v[4:7]
 v_exp_f32 v19,v19
 mf v[4:7],a[148:151],v[132:135],v[4:7]
 v_add_f32 v32,v32,v200
 v_add_f32 v33,v33,v200
 mf v[4:7],a[144:147],v[128:131],v[4:7]
 s_waitcnt lgkmcnt(0)
 bl v224,s[12:15],s63 offen offset:2048 lds
 mf v[8:11],a[128:131],v[128:131],v[192:195]
 rq a[144:147],v208 offset:12288
 v_add_f32 v34,v34,v200
 mf v[8:11],a[132:135],v[132:135],v[8:11]
 rq a[148:151],v209 offset:12288
 v_add_f32 v35,v35,v200
 mf v[8:11],a[136:139],v[136:139],v[8:11]
 rq a[152:155],v210 offset:12288
 mf v[8:11],a[140:143],v[140:143],v[8:11]
 rq a[156:159],v211 offset:12288
 mf v[24:27],a[140:143],v[156:159],v[196:199]
 v_exp_f32 v32,v32
 mf v[24:27],a[136:139],v[152:155],v[24:27]
 bl v225,s[12:15],s63 offen offset:3072 lds
 mf v[24:27],a[132:135],v[148:151],v[24:27]
 v_exp_f32 v33,v33
 mf v[24:27],a[128:131],v[144:147],v[24:27]
 v_exp_f32 v34,v34
 mf v[40:43],a[128:131],v[160:163],v[200:203]
 v_exp_f32 v35,v35
 mf v[40:43],a[132:135],v[164:167],v[40:43]
 s_add_u32 m0,s61,49152
 v_add_f32 v48,v48,v204
 v_add_f32 v49,v49,v204
 mf v[40:43],a[136:139],v[168:171],v[40:43]
 s_mov_b32 s63,49152
 v_add_f32 v50,v50,v204
 v_add_f32 v51,v51,v204
 mf v[40:43],a[140:143],v[172:175],v[40:43]
 bl v220,s[8:11],s63 offen offset:0 lds
 mf v[56:59],a[140:143],v[188:191],v[204:207]
 v_exp_f32 v48,v48
 mf v[56:59],a[136:139],v[184:187],v[56:59]
 v_exp_f32 v49,v49
 mf v[56:59],a[132:135],v[180:183],v[56:59]
 v_exp_f32 v50,v50
 mf v[56:59],a[128:131],v[176:179],v[56:59]
 s_waitcnt lgkmcnt(0)
 v_exp_f32 v51,v51
 mf v[60:63],a[144:147],v[176:179],v[204:207]
 rq a[128:131],v208 offset:16384
 pk v0,v0,v1
 mf v[60:63],a[148:151],v[180:183],v[60:63]
 rq a[132:135],v209 offset:16384
 bl v221,s[8:11],s63 offen offset:1024 lds
 mf v[60:63],a[152:155],v[184:187],v[60:63]
 rq a[136:139],v210 offset:16384
 pk v1,v2,v3
 mf v[60:63],a[156:159],v[188:191],v[60:63]
 rq a[140:143],v211 offset:16384
 pk v16,v16,v17
 mf v[44:47],a[156:159],v[172:175],v[200:203]
 pk v17,v18,v19
 pk v32,v32,v33
 mf v[44:47],a[152:155],v[168:171],v[44:47]
 pk v33,v34,v35
 pk v48,v48,v49
 mf v[44:47],a[148:151],v[164:167],v[44:47]
 pk v49,v50,v51
 mf v[44:47],a[144:147],v[160:163],v[44:47]
 bl v222,s[8:11],s63 offen offset:2048 lds
 mf v[28:31],a[144:147],v[144:147],v[196:199]
 s_waitcnt vmcnt(14)
 v_exp_f32 v4,v4
 mf v[28:31],a[148:151],v[148:151],v[28:31]
 s_barrier
 v_exp_f32 v5,v5
 mf v[28:31],a[152:155],v[152:155],v[28:31]
 v_exp_f32 v6,v6
 mf v[28:31],a[156:159],v[156:159],v[28:31]
 v_exp_f32 v7,v7
 mf v[12:15],a[156:159],v[140:143],v[192:195]
 v_exp_f32 v20,v20
 mf v[12:15],a[152:155],v[136:139],v[12:15]
 bl v223,s[8:11],s63 offen offset:3072 lds
 mf v[12:15],a[148:151],v[132:135],v[12:15]
 v_exp_f32 v21,v21
 mf v[12:15],a[144:147],v[128:131],v[12:15]
 v_exp_f32 v22,v22
 v_exp_f32 v23,v23
 v_exp_f32 v36,v36
 v_exp_f32 v37,v37
 v_exp_f32 v38,v38
 v_exp_f32 v39,v39
 v_exp_f32 v52,v52
 v_exp_f32 v53,v53
 v_exp_f32 v54,v54
 v_exp_f32 v55,v55
 pk v2,v4,v5
 pk v3,v6,v7
 pk v18,v20,v21
 pk v19,v22,v23
 pk v34,v36,v37
 pk v35,v38,v39
 pk v50,v52,v53
 pk v51,v54,v55
 v_mov_b32 v226,1
 s_lshl_b32 s64,s53,3
 s_cmp_lg_u32 s54,0
 s_cbranch_scc1 L_noarr
 s_mov_b64 exec,1
 buffer_atomic_add v226,off,s[48:51],s64 sc1
 s_mov_b64 exec,-1
L_noarr:
 s_waitcnt vmcnt(8) lgkmcnt(0)
 s_barrier
 mf v[64:67],a[128:131],v[128:131],v[192:195]
 v_exp_f32 v8,v8
 mf v[64:67],a[132:135],v[132:135],v[64:67]
 s_add_u32 m0,s61,98304
 v_exp_f32 v9,v9
 mf v[64:67],a[136:139],v[136:139],v[64:67]
 s_mov_b32 s63,32768
 rq a[144:147],v208 offset:20480
 mf v[64:67],a[140:143],v[140:143],v[64:67]
 bl v224,s[12:15],s63 offen offset:0 lds
 mf v[80:83],a[140:143],v[156:159],v[196:199]
 rq a[148:151],v209 offset:20480
 pk v4,v8,v9
 mf v[80:83],a[136:139],v[152:155],v[80:83]
 v_exp_f32 v10,v10
 mf v[80:83],a[132:135],v[148:151],v[80:83]
 rq a[152:155],v210 offset:20480
 global_load_dword a255,v[248:249],off
 mf v[80:83],a[128:131],v[144:147],v[80:83]
 v_exp_f32 v11,v11
 mf v[96:99],a[128:131],v[160:163],v[200:203]
 rq a[156:159],v211 offset:20480
 pk v5,v10,v11
 mf v[96:99],a[132:135],v[164:167],v[96:99]
 v_exp_f32 v12,v12
 mf v[96:99],a[136:139],v[168:171],v[96:99]
 v_exp_f32 v13,v13
 mf v[96:99],a[140:143],v[172:175],v[96:99]
 bl v225,s[12:15],s63 offen offset:1024 lds
 pk v6,v12,v13
 mf v[112:115],a[140:143],v[188:191],v[204:207]
 v_exp_f32 v14,v14
 mf v[112:115],a[136:139],v[184:187],v[112:115]
 buffer_load_dword a255,v239,s[32:35],0 offen
 mf v[112:115],a[132:135],v[180:183],v[112:115]
 v_exp_f32 v15,v15
 mf v[112:115],a[128:131],v[176:179],v[112:115]
 s_waitcnt lgkmcnt(0)
 bl v224,s[12:15],s63 offen offset:2048 lds
 pk v7,v14,v15
 mf v[116:119],a[144:147],v[176:179],v[204:207]
 v_exp_f32 v24,v24
 mf v[116:119],a[148:151],v[180:183],v[116:119]
 v_exp_f32 v25,v25
 mf v[116:119],a[152:155],v[184:187],v[116:119]
 rq a[128:131],v208 offset:24576
 mf v[116:119],a[156:159],v[188:191],v[116:119]
 bl v225,s[12:15],s63 offen offset:3072 lds
 mf v[100:103],a[156:159],v[172:175],v[200:203]
 rq a[132:135],v209 offset:24576
 pk v20,v24,v25
 mf v[100:103],a[152:155],v[168:171],v[100:103]
 v_exp_f32 v26,v26
 mf v[100:103],a[148:151],v[164:167],v[100:103]
 rq a[136:139],v210 offset:24576
 mf v[100:103],a[144:147],v[160:163],v[100:103]
 v_exp_f32 v27,v27
 mf v[84:87],a[144:147],v[144:147],v[196:199]
 rq a[140:143],v211 offset:24576
 pk v21,v26,v27
 mf v[84:87],a[148:151],v[148:151],v[84:87]
 v_exp_f32 v28,v28
 mf v[84:87],a[152:155],v[152:155],v[84:87]
 v_exp_f32 v29,v29
 mf v[84:87],a[156:159],v[156:159],v[84:87]
 pk v22,v28,v29
 mf v[68:71],a[156:159],v[140:143],v[192:195]
 v_exp_f32 v30,v30
 mf v[68:71],a[152:155],v[136:139],v[68:71]
 s_add_u32 m0,s61,0
 mf v[68:71],a[148:151],v[132:135],v[68:71]
 s_mov_b32 s63,65536
 v_exp_f32 v31,v31
 mf v[68:71],a[144:147],v[128:131],v[68:71]
 s_waitcnt lgkmcnt(0)
 bl v220,s[8:11],s63 offen offset:0 lds
 pk v23,v30,v31
 mf v[72:75],a[128:131],v[128:131],v[192:195]
 v_exp_f32 v40,v40
 mf v[72:75],a[132:135],v[132:135],v[72:75]
 v_exp_f32 v41,v41
 mf v[72:75],a[136:139],v[136:139],v[72:75]
 rq a[144:147],v208 offset:28672
 mf v[72:75],a[140:143],v[140:143],v[72:75]
 bl v221,s[8:11],s63 offen offset:1024 lds
 mf v[88:91],a[140:143],v[156:159],v[196:199]
 rq a[148:151],v209 offset:28672
 pk v36,v40,v41
 mf v[88:91],a[136:139],v[152:155],v[88:91]
 v_exp_f32 v42,v42
 mf v[88:91],a[132:135],v[148:151],v[88:91]
 rq a[152:155],v210 offset:28672
 mf v[88:91],a[128:131],v[144:147],v[88:91]
 v_exp_f32 v43,v43
 mf v[104:107],a[128:131],v[160:163],v[200:203]
 rq a[156:159],v211 offset:28672
 pk v37,v42,v43
 mf v[104:107],a[132:135],v[164:167],v[104:107]
 v_exp_f32 v44,v44
 mf v[104:107],a[136:139],v[168:171],v[104:107]
 v_exp_f32 v45,v45
 mf v[104:107],a[140:143],v[172:175],v[104:107]
 pk v38,v44,v45
 mf v[120:123],a[140:143],v[188:191],v[204:207]
 v_exp_f32 v46,v46
 mf v[120:123],a[136:139],v[184:187],v[120:123]
 bl v222,s[8:11],s63 offen offset:2048 lds
 mf v[120:123],a[132:135],v[180:183],v[120:123]
 v_exp_f32 v47,v47
 mf v[120:123],a[128:131],v[176:179],v[120:123]
 s_waitcnt lgkmcnt(0)
 rt a[130:131],v212 offset:4096
 pk v39,v46,v47
 mf v[124:127],a[144:147],v[176:179],v[204:207]
 v_exp_f32 v56,v56
 mf v[124:127],a[148:151],v[180:183],v[124:127]
 v_exp_f32 v57,v57
 mf v[124:127],a[152:155],v[184:187],v[124:127]
 rt a[128:129],v212 offset:0
 rt a[132:133],v212 offset:8192
 mf v[124:127],a[156:159],v[188:191],v[124:127]
 bl v223,s[8:11],s63 offen offset:3072 lds
 mf v[108:111],a[156:159],v[172:175],v[200:203]
 rt a[134:135],v212 offset:12288
 pk v52,v56,v57
 mf v[108:111],a[152:155],v[168:171],v[108:111]
 v_exp_f32 v58,v58
 mf v[108:111],a[148:151],v[164:167],v[108:111]
 rt a[136:137],v213 offset:0
 mf v[108:111],a[144:147],v[160:163],v[108:111]
 v_exp_f32 v59,v59
 mf v[92:95],a[144:147],v[144:147],v[196:199]
 rt a[138:139],v213 offset:4096
 pk v53,v58,v59
 mf v[92:95],a[148:151],v[148:151],v[92:95]
 v_exp_f32 v60,v60
 mf v[92:95],a[152:155],v[152:155],v[92:95]
 v_exp_f32 v61,v61
 mf v[92:95],a[156:159],v[156:159],v[92:95]
 rt a[140:141],v213 offset:8192
 pk v54,v60,v61
 mf v[76:79],a[156:159],v[140:143],v[192:195]
 v_exp_f32 v62,v62
 mf v[76:79],a[152:155],v[136:139],v[76:79]
 rt a[142:143],v213 offset:12288
 mf v[76:79],a[148:151],v[132:135],v[76:79]
 v_exp_f32 v63,v63
 mf v[76:79],a[144:147],v[128:131],v[76:79]
 s_waitcnt lgkmcnt(4)
 rt a[148:149],v214 offset:8192
 pk v55,v62,v63
 mf a[0:3],v[0:3],a[128:131],0
 v_exp_f32 v64,v64
 mf a[0:3],v[4:7],a[132:135],a[0:3]
 v_exp_f32 v65,v65
 mf a[4:7],v[20:23],a[132:135],0
 rt a[150:151],v214 offset:12288
 pk v64,v64,v65
 mf a[4:7],v[16:19],a[128:131],a[4:7]
 v_exp_f32 v66,v66
 mf a[8:11],v[32:35],a[128:131],0
 rt a[146:147],v214 offset:4096
 rt a[152:153],v215 offset:0
 mf a[8:11],v[36:39],a[132:135],a[8:11]
 v_exp_f32 v67,v67
 mf a[12:15],v[52:55],a[132:135],0
 rt a[154:155],v215 offset:4096
 pk v65,v66,v67
 mf a[12:15],v[48:51],a[128:131],a[12:15]
 s_waitcnt lgkmcnt(5)
 v_exp_f32 v68,v68
 mf a[28:31],v[48:51],a[136:139],0
 v_exp_f32 v69,v69
 mf a[28:31],v[52:55],a[140:143],a[28:31]
 s_add_u32 m0,s61,114688
 rt a[156:157],v215 offset:8192
 pk v66,v68,v69
 mf a[24:27],v[36:39],a[140:143],0
 s_mov_b32 s63,49152
 rt a[144:145],v214 offset:0
 rt a[158:159],v215 offset:12288
 mf a[24:27],v[32:35],a[136:139],a[24:27]
 bl v224,s[12:15],s63 offen offset:0 lds
 mf a[20:23],v[16:19],a[136:139],0
 v_exp_f32 v70,v70
 mf a[20:23],v[20:23],a[140:143],a[20:23]
 rt a[128:129],v216 offset:0
 v_bfe_u32 v231,v254,4,11
 mf a[16:19],v[4:7],a[140:143],0
L_pad_pg5:
 s_cbranch_execz L_hop1
 v_exp_f32 v71,v71
 mf a[16:19],v[0:3],a[136:139],a[16:19]
 s_waitcnt lgkmcnt(2)
 rt a[130:131],v216 offset:4096
 pk v67,v70,v71
 mf a[32:35],v[0:3],a[144:147],0
 v_exp_f32 v80,v80
 mf a[32:35],v[4:7],a[148:151],a[32:35]
 rt a[132:133],v216 offset:8192
 v_lshlrev_b32 v231,10,v231
 mf a[36:39],v[20:23],a[148:151],0
 v_exp_f32 v81,v81
 mf a[36:39],v[16:19],a[144:147],a[36:39]
 v_exp_f32 v82,v82
 mf a[40:43],v[32:35],a[144:147],0
 rt a[134:135],v216 offset:12288
 pk v80,v80,v81
 mf a[40:43],v[36:39],a[148:151],a[40:43]
 v_exp_f32 v83,v83
 mf a[44:47],v[52:55],a[148:151],0
 rt a[136:137],v217 offset:0
 pk v81,v82,v83
 mf a[44:47],v[48:51],a[144:147],a[44:47]
 s_waitcnt lgkmcnt(5)
 v_exp_f32 v84,v84
 mf a[60:63],v[48:51],a[152:155],0
 rt a[138:139],v217 offset:4096
 v_bfe_u32 v232,v255,8,2
 mf a[60:63],v[52:55],a[156:159],a[60:63]
 v_exp_f32 v85,v85
 mf a[56:59],v[36:39],a[156:159],0
 rt a[140:141],v217 offset:8192
 mf a[56:59],v[32:35],a[152:155],a[56:59]
 bl v225,s[12:15],s63 offen offset:1024 lds
 mf a[52:55],v[16:19],a[152:155],0
 v_exp_f32 v86,v86
 mf a[52:55],v[20:23],a[156:159],a[52:55]
 rt a[142:143],v217 offset:12288
 pk v82,v84,v85
 mf a[48:51],v[4:7],a[156:159],0
 v_exp_f32 v87,v87
 mf a[48:51],v[0:3],a[152:155],a[48:51]
 s_waitcnt lgkmcnt(4)
 rt a[144:145],v218 offset:0
 pk v83,v86,v87
 mf a[64:67],v[0:3],a[128:131],0
 v_exp_f32 v96,v96
 mf a[64:67],v[4:7],a[132:135],a[64:67]
 rt a[146:147],v218 offset:4096
 v_lshl_add_u32 v231,v232,3,v231
 mf a[68:71],v[20:23],a[132:135],0
 s_lshl_b32 s64,s52,7
 v_exp_f32 v97,v97
 mf a[68:71],v[16:19],a[128:131],a[68:71]
 rt a[148:149],v218 offset:8192
 pk v96,v96,v97
 mf a[72:75],v[32:35],a[128:131],0
 v_exp_f32 v98,v98
 mf a[72:75],v[36:39],a[132:135],a[72:75]
 v_exp_f32 v99,v99
 mf a[76:79],v[52:55],a[132:135],0
 rt a[150:151],v218 offset:12288
 pk v97,v98,v99
 mf a[76:79],v[48:51],a[128:131],a[76:79]
 s_waitcnt lgkmcnt(4)
 v_exp_f32 v100,v100
 mf a[92:95],v[48:51],a[136:139],0
 rt a[152:153],v219 offset:0
 buffer_load_dwordx2 v[232:233],v231,s[4:7],s64 offen offset:0
 mf a[92:95],v[52:55],a[140:143],a[92:95]
 v_exp_f32 v101,v101
 mf a[88:91],v[36:39],a[140:143],0
 rt a[154:155],v219 offset:4096
 mf a[88:91],v[32:35],a[136:139],a[88:91]
 bl v224,s[12:15],s63 offen offset:2048 lds
 mf a[84:87],v[16:19],a[136:139],0
 rt a[156:157],v219 offset:8192
 pk v98,v100,v101
 mf a[84:87],v[20:23],a[140:143],a[84:87]
 v_exp_f32 v102,v102
 mf a[80:83],v[4:7],a[140:143],0
 v_exp_f32 v103,v103
 mf a[80:83],v[0:3],a[136:139],a[80:83]
 s_waitcnt lgkmcnt(3)
 rt a[158:159],v219 offset:12288
 pk v99,v102,v103
 mf a[96:99],v[0:3],a[144:147],0
 v_exp_f32 v112,v112
 mf a[96:99],v[4:7],a[148:151],a[96:99]
 buffer_load_dwordx2 v[234:235],v231,s[4:7],s64 offen offset:32
 mf a[100:103],v[20:23],a[148:151],0
 v_exp_f32 v113,v113
 mf a[100:103],v[16:19],a[144:147],a[100:103]
 buffer_load_dwordx2 v[236:237],v231,s[4:7],s64 offen offset:64
 pk v112,v112,v113
 mf a[104:107],v[32:35],a[144:147],0
 v_exp_f32 v114,v114
 mf a[104:107],v[36:39],a[148:151],a[104:107]
 rq a[128:131],v208 offset:32768
 buffer_load_dwordx2 v[238:239],v231,s[4:7],s64 offen offset:96
 mf a[108:111],v[52:55],a[148:151],0
 v_exp_f32 v115,v115
 mf a[108:111],v[48:51],a[144:147],a[108:111]
 s_waitcnt lgkmcnt(1)
 v_exp_f32 v116,v116
 mf a[124:127],v[48:51],a[152:155],0
 rq a[132:135],v209 offset:32768
 pk v113,v114,v115
 mf a[124:127],v[52:55],a[156:159],a[124:127]
 v_exp_f32 v117,v117
 mf a[120:123],v[36:39],a[156:159],0
 rq a[136:139],v210 offset:32768
 mf a[120:123],v[32:35],a[152:155],a[120:123]
 bl v225,s[12:15],s63 offen offset:3072 lds
 mf a[116:119],v[16:19],a[152:155],0
 rq a[140:143],v211 offset:32768
 pk v114,v116,v117
 mf a[116:119],v[20:23],a[156:159],a[116:119]
 v_exp_f32 v118,v118
 mf a[112:115],v[4:7],a[156:159],0
 v_lshrrev_b32 v226,4,v255
 v_min_u32 v226,2,v226
 mf a[112:115],v[0:3],a[152:155],a[112:115]
 v_exp_f32 v119,v119
 v_smfmac_f32_16x16x64_bf16 a[192:195],a[208:211],v[0:7],v250
 pk v115,v118,v119
 v_smfmac_f32_16x16x64_bf16 a[196:199],a[208:211],v[16:23],v250
 s_waitcnt vmcnt(18)
 v_add_u32 v226,s53,v226
 v_smfmac_f32_16x16x64_bf16 a[200:203],a[208:211],v[32:39],v250
 s_barrier
 v_add_u32 v226,-1,v226
 v_smfmac_f32_16x16x64_bf16 a[204:207],a[208:211],v[48:55],v250
 s_waitcnt lgkmcnt(0)
 v_med3_i32 v226,v226,0,31
 mf v[0:3],a[128:131],v[128:131],v[192:195]
 v_exp_f32 v72,v72
 mf v[0:3],a[132:135],v[132:135],v[0:3]
 s_add_u32 m0,s61,16384
 v_exp_f32 v73,v73
 mf v[0:3],a[136:139],v[136:139],v[0:3]
 s_mov_b32 s63,81920
 rq a[144:147],v208 offset:36864
 mf v[0:3],a[140:143],v[140:143],v[0:3]
 bl v220,s[8:11],s63 offen offset:0 lds
 mf v[16:19],a[140:143],v[156:159],v[196:199]
 rq a[148:151],v209 offset:36864
 pk v68,v72,v73
 mf v[16:19],a[136:139],v[152:155],v[16:19]
 v_exp_f32 v74,v74
 mf v[16:19],a[132:135],v[148:151],v[16:19]
 rq a[152:155],v210 offset:36864
 v_lshlrev_b32 v242,3,v226
 mf v[16:19],a[128:131],v[144:147],v[16:19]
 v_exp_f32 v75,v75
 mf v[32:35],a[128:131],v[160:163],v[200:203]
 rq a[156:159],v211 offset:36864
 pk v69,v74,v75
 mf v[32:35],a[132:135],v[164:167],v[32:35]
 v_exp_f32 v76,v76
 mf v[32:35],a[136:139],v[168:171],v[32:35]
 v_exp_f32 v77,v77
 mf v[32:35],a[140:143],v[172:175],v[32:35]
 bl v221,s[8:11],s63 offen offset:1024 lds
 pk v70,v76,v77
 mf v[48:51],a[140:143],v[188:191],v[204:207]
 v_exp_f32 v78,v78
 mf v[48:51],a[136:139],v[184:187],v[48:51]
 bl v222,s[8:11],s63 offen offset:2048 lds
 mf v[48:51],a[132:135],v[180:183],v[48:51]
 v_exp_f32 v79,v79
 mf v[48:51],a[128:131],v[176:179],v[48:51]
 s_waitcnt lgkmcnt(0)
 bl v223,s[8:11],s63 offen offset:3072 lds
 pk v71,v78,v79
 mf v[52:55],a[144:147],v[176:179],v[204:207]
 v_exp_f32 v88,v88
 mf v[52:55],a[148:151],v[180:183],v[52:55]
 s_add_u32 m0,s61,65536
 v_exp_f32 v89,v89
 mf v[52:55],a[152:155],v[184:187],v[52:55]
 s_mov_b32 s63,65536
 rq a[128:131],v208 offset:40960
 mf v[52:55],a[156:159],v[188:191],v[52:55]
 bl v224,s[12:15],s63 offen offset:0 lds
 mf v[36:39],a[156:159],v[172:175],v[200:203]
 rq a[132:135],v209 offset:40960
 pk v84,v88,v89
 mf v[36:39],a[152:155],v[168:171],v[36:39]
 v_exp_f32 v90,v90
 mf v[36:39],a[148:151],v[164:167],v[36:39]
 rq a[136:139],v210 offset:40960
 mf v[36:39],a[144:147],v[160:163],v[36:39]
 v_exp_f32 v91,v91
 mf v[20:23],a[144:147],v[144:147],v[196:199]
 rq a[140:143],v211 offset:40960
 pk v85,v90,v91
 mf v[20:23],a[148:151],v[148:151],v[20:23]
 v_exp_f32 v92,v92
 mf v[20:23],a[152:155],v[152:155],v[20:23]
 v_exp_f32 v93,v93
 mf v[20:23],a[156:159],v[156:159],v[20:23]
 bl v225,s[12:15],s63 offen offset:1024 lds
 pk v86,v92,v93
 mf v[4:7],a[156:159],v[140:143],v[192:195]
 v_exp_f32 v94,v94
 mf v[4:7],a[152:155],v[136:139],v[4:7]
 mf v[4:7],a[148:151],v[132:135],v[4:7]
 v_exp_f32 v95,v95
 mf v[4:7],a[144:147],v[128:131],v[4:7]
 s_waitcnt lgkmcnt(0)
 bl v224,s[12:15],s63 offen offset:2048 lds
 pk v87,v94,v95
 mf v[8:11],a[128:131],v[128:131],v[192:195]
 v_exp_f32 v104,v104
 mf v[8:11],a[132:135],v[132:135],v[8:11]
 v_exp_f32 v105,v105
 mf v[8:11],a[136:139],v[136:139],v[8:11]
 rq a[144:147],v208 offset:45056
 mf v[8:11],a[140:143],v[140:143],v[8:11]
 bl v225,s[12:15],s63 offen offset:3072 lds
 mf v[24:27],a[140:143],v[156:159],v[196:199]
 rq a[148:151],v209 offset:45056
 pk v100,v104,v105
 mf v[24:27],a[136:139],v[152:155],v[24:27]
 v_exp_f32 v106,v106
 mf v[24:27],a[132:135],v[148:151],v[24:27]
 rq a[152:155],v210 offset:45056
 mf v[24:27],a[128:131],v[144:147],v[24:27]
 v_exp_f32 v107,v107
 mf v[40:43],a[128:131],v[160:163],v[200:203]
 rq a[156:159],v211 offset:45056
 pk v101,v106,v107
 mf v[40:43],a[132:135],v[164:167],v[40:43]
 s_add_u32 m0,s62,65536
 v_exp_f32 v108,v108
 mf v[40:43],a[136:139],v[168:171],v[40:43]
 s_mov_b32 s63,0
 v_exp_f32 v109,v109
 mf v[40:43],a[140:143],v[172:175],v[40:43]
 bl v243,s[32:35],s63 offen offset:0 lds
 pk v102,v108,v109
 mf v[56:59],a[140:143],v[188:191],v[204:207]
 s_mov_b32 s63,7168
 v_exp_f32 v110,v110
 mf v[56:59],a[136:139],v[184:187],v[56:59]
 bl v243,s[32:35],s63 offen offset:1024 lds
 mf v[56:59],a[132:135],v[180:183],v[56:59]
 s_mov_b32 s63,14336
 v_exp_f32 v111,v111
 mf v[56:59],a[128:131],v[176:179],v[56:59]
 s_waitcnt lgkmcnt(0)
 rt a[130:131],v212 offset:20480
 pk v103,v110,v111
 mf v[60:63],a[144:147],v[176:179],v[204:207]
 v_exp_f32 v120,v120
 mf v[60:63],a[148:151],v[180:183],v[60:63]
 v_exp_f32 v121,v121
 mf v[60:63],a[152:155],v[184:187],v[60:63]
 rt a[128:129],v212 offset:16384
 rt a[132:133],v212 offset:24576
 mf v[60:63],a[156:159],v[188:191],v[60:63]
 bl v243,s[32:35],s63 offen offset:2048 lds
 mf v[44:47],a[156:159],v[172:175],v[200:203]
 rt a[134:135],v212 offset:28672
 pk v116,v120,v121
 mf v[44:47],a[152:155],v[168:171],v[44:47]
 v_exp_f32 v122,v122
 mf v[44:47],a[148:151],v[164:167],v[44:47]
 rt a[136:137],v213 offset:16384
 mf v[44:47],a[144:147],v[160:163],v[44:47]
 v_exp_f32 v123,v123
 mf v[28:31],a[144:147],v[144:147],v[196:199]
 rt a[138:139],v213 offset:20480
 pk v117,v122,v123
 mf v[28:31],a[148:151],v[148:151],v[28:31]
 v_exp_f32 v124,v124
 mf v[28:31],a[152:155],v[152:155],v[28:31]
 v_exp_f32 v125,v125
 mf v[28:31],a[156:159],v[156:159],v[28:31]
 rt a[140:141],v213 offset:24576
 pk v118,v124,v125
 mf v[12:15],a[156:159],v[140:143],v[192:195]
 v_exp_f32 v126,v126
 mf v[12:15],a[152:155],v[136:139],v[12:15]
 rt a[142:143],v213 offset:28672
 mf v[12:15],a[148:151],v[132:135],v[12:15]
 v_exp_f32 v127,v127
 mf v[12:15],a[144:147],v[128:131],v[12:15]
 s_waitcnt lgkmcnt(4)
 rt a[148:149],v214 offset:24576
 pk v119,v126,v127
 mf a[0:3],v[64:67],a[128:131],a[0:3]
 v_exp_f32 v0,v0
 mf a[0:3],v[68:71],a[132:135],a[0:3]
 v_exp_f32 v1,v1
 mf a[4:7],v[84:87],a[132:135],a[4:7]
 rt a[150:151],v214 offset:28672
 pk v0,v0,v1
 mf a[4:7],v[80:83],a[128:131],a[4:7]
 v_exp_f32 v2,v2
 mf a[8:11],v[96:99],a[128:131],a[8:11]
 rt a[146:147],v214 offset:20480
 rt a[152:153],v215 offset:16384
 mf a[8:11],v[100:103],a[132:135],a[8:11]
 v_exp_f32 v3,v3
 mf a[12:15],v[116:119],a[132:135],a[12:15]
 rt a[154:155],v215 offset:20480
 pk v1,v2,v3
 mf a[12:15],v[112:115],a[128:131],a[12:15]
 s_waitcnt lgkmcnt(5)
 v_exp_f32 v4,v4
 mf a[28:31],v[112:115],a[136:139],a[28:31]
 v_exp_f32 v5,v5
 mf a[28:31],v[116:119],a[140:143],a[28:31]
 rt a[156:157],v215 offset:24576
 pk v2,v4,v5
 mf a[24:27],v[100:103],a[140:143],a[24:27]
 s_mov_b32 s63,21504
 rt a[144:145],v214 offset:16384
 rt a[158:159],v215 offset:28672
 mf a[24:27],v[96:99],a[136:139],a[24:27]
 bl v243,s[32:35],s63 offen offset:3072 lds
 mf a[20:23],v[80:83],a[136:139],a[20:23]
 v_exp_f32 v6,v6
 mf a[20:23],v[84:87],a[140:143],a[20:23]
 rt a[128:129],v216 offset:16384
 mf a[16:19],v[68:71],a[140:143],a[16:19]
 v_exp_f32 v7,v7
 mf a[16:19],v[64:67],a[136:139],a[16:19]
 s_waitcnt lgkmcnt(2)
 rt a[130:131],v216 offset:20480
 pk v3,v6,v7
 mf a[32:35],v[64:67],a[144:147],a[32:35]
 v_exp_f32 v16,v16
 mf a[32:35],v[68:71],a[148:151],a[32:35]
 rt a[132:133],v216 offset:24576
 mf a[36:39],v[84:87],a[148:151],a[36:39]
 v_exp_f32 v17,v17
 mf a[36:39],v[80:83],a[144:147],a[36:39]
 v_exp_f32 v18,v18
 mf a[40:43],v[96:99],a[144:147],a[40:43]
 rt a[134:135],v216 offset:28672
 pk v16,v16,v17
 mf a[40:43],v[100:103],a[148:151],a[40:43]
 v_exp_f32 v19,v19
 mf a[44:47],v[116:119],a[148:151],a[44:47]
 rt a[136:137],v217 offset:16384
 pk v17,v18,v19
 mf a[44:47],v[112:115],a[144:147],a[44:47]
 s_waitcnt lgkmcnt(5)
 v_exp_f32 v20,v20
 mf a[60:63],v[112:115],a[152:155],a[60:63]
 rt a[138:139],v217 offset:20480
 mf a[60:63],v[116:119],a[156:159],a[60:63]
 s_add_u32 m0,s62,69632
 v_exp_f32 v21,v21
 mf a[56:59],v[100:103],a[156:159],a[56:59]
 s_mov_b32 s63,32768
 rt a[140:141],v217 offset:24576
 mf a[56:59],v[96:99],a[152:155],a[56:59]
 bl v243,s[32:35],s63 offen offset:0 lds
 mf a[52:55],v[80:83],a[152:155],a[52:55]
 v_exp_f32 v22,v22
 mf a[52:55],v[84:87],a[156:159],a[52:55]
 rt a[142:143],v217 offset:28672
 pk v18,v20,v21
 mf a[48:51],v[68:71],a[156:159],a[48:51]
 v_exp_f32 v23,v23
 mf a[48:51],v[64:67],a[152:155],a[48:51]
 s_waitcnt lgkmcnt(4)
 rt a[144:145],v218 offset:16384
 pk v19,v22,v23
 mf a[64:67],v[64:67],a[128:131],a[64:67]
 v_exp_f32 v32,v32
 mf a[64:67],v[68:71],a[132:135],a[64:67]
 rt a[146:147],v218 offset:20480
 mf a[68:71],v[84:87],a[132:135],a[68:71]
 v_exp_f32 v33,v33
 mf a[68:71],v[80:83],a[128:131],a[68:71]
 rt a[148:149],v218 offset:24576
 pk v32,v32,v33
 mf a[72:75],v[96:99],a[128:131],a[72:75]
 v_exp_f32 v34,v34
 mf a[72:75],v[100:103],a[132:135],a[72:75]
 v_exp_f32 v35,v35
 mf a[76:79],v[116:119],a[132:135],a[76:79]
 rt a[150:151],v218 offset:28672
 pk v33,v34,v35
 mf a[76:79],v[112:115],a[128:131],a[76:79]
 s_waitcnt lgkmcnt(4)
 v_exp_f32 v36,v36
 mf a[92:95],v[112:115],a[136:139],a[92:95]
 rt a[152:153],v219 offset:16384
 mf a[92:95],v[116:119],a[140:143],a[92:95]
 v_exp_f32 v37,v37
 mf a[88:91],v[100:103],a[140:143],a[88:91]
 s_mov_b32 s63,39936
 rt a[154:155],v219 offset:20480
 mf a[88:91],v[96:99],a[136:139],a[88:91]
 bl v243,s[32:35],s63 offen offset:1024 lds
 mf a[84:87],v[80:83],a[136:139],a[84:87]
 rt a[156:157],v219 offset:24576
 pk v34,v36,v37
 mf a[84:87],v[84:87],a[140:143],a[84:87]
 v_exp_f32 v38,v38
 mf a[80:83],v[68:71],a[140:143],a[80:83]
 s_mov_b32 s63,47104
 v_exp_f32 v39,v39
 mf a[80:83],v[64:67],a[136:139],a[80:83]
 s_waitcnt lgkmcnt(3)
 rt a[158:159],v219 offset:28672
 pk v35,v38,v39
 mf a[96:99],v[64:67],a[144:147],a[96:99]
 v_exp_f32 v48,v48
 mf a[96:99],v[68:71],a[148:151],a[96:99]
 bl v243,s[32:35],s63 offen offset:2048 lds
 mf a[100:103],v[84:87],a[148:151],a[100:103]
 v_exp_f32 v49,v49
 mf a[100:103],v[80:83],a[144:147],a[100:103]
 pk v48,v48,v49
 mf a[104:107],v[96:99],a[144:147],a[104:107]
 v_exp_f32 v50,v50
 mf a[104:107],v[100:103],a[148:151],a[104:107]
 rq a[128:131],v208 offset:49152
 mf a[108:111],v[116:119],a[148:151],a[108:111]
 v_exp_f32 v51,v51
 mf a[108:111],v[112:115],a[144:147],a[108:111]
 s_waitcnt lgkmcnt(1)
 v_exp_f32 v52,v52
 mf a[124:127],v[112:115],a[152:155],a[124:127]
 rq a[132:135],v209 offset:49152
 pk v49,v50,v51
 mf a[124:127],v[116:119],a[156:159],a[124:127]
 v_exp_f32 v53,v53
 mf a[120:123],v[100:103],a[156:159],a[120:123]
 s_mov_b32 s63,54272
 rq a[136:139],v210 offset:49152
 mf a[120:123],v[96:99],a[152:155],a[120:123]
 bl v243,s[32:35],s63 offen offset:3072 lds
 mf a[116:119],v[80:83],a[152:155],a[116:119]
 rq a[140:143],v211 offset:49152
 pk v50,v52,v53
 mf a[116:119],v[84:87],a[156:159],a[116:119]
 v_exp_f32 v54,v54
 mf a[112:115],v[68:71],a[156:159],a[112:115]
 mf a[112:115],v[64:67],a[152:155],a[112:115]
 v_exp_f32 v55,v55
 v_smfmac_f32_16x16x64_bf16 a[192:195],a[208:211],v[64:71],v250
 pk v51,v54,v55
 v_smfmac_f32_16x16x64_bf16 a[196:199],a[208:211],v[80:87],v250
 s_waitcnt vmcnt(24)
 v_smfmac_f32_16x16x64_bf16 a[200:203],a[208:211],v[96:103],v250
 s_barrier
 v_smfmac_f32_16x16x64_bf16 a[204:207],a[208:211],v[112:119],v250
 s_waitcnt lgkmcnt(0)
 mf v[64:67],a[128:131],v[128:131],v[192:195]
 v_exp_f32 v8,v8
 mf v[64:67],a[132:135],v[132:135],v[64:67]
 s_add_u32 m0,s61,32768
 v_exp_f32 v9,v9
 mf v[64:67],a[136:139],v[136:139],v[64:67]
 s_mov_b32 s63,98304
 rq a[144:147],v208 offset:53248
 mf v[64:67],a[140:143],v[140:143],v[64:67]
 bl v220,s[8:11],s63 offen offset:0 lds
 mf v[80:83],a[140:143],v[156:159],v[196:199]
 rq a[148:151],v209 offset:53248
 pk v4,v8,v9
 mf v[80:83],a[136:139],v[152:155],v[80:83]
 v_exp_f32 v10,v10
 mf v[80:83],a[132:135],v[148:151],v[80:83]
 rq a[152:155],v210 offset:53248
 buffer_load_dword v241,v242,s[48:51],0 offen sc1
 mf v[80:83],a[128:131],v[144:147],v[80:83]
 v_exp_f32 v11,v11
 mf v[96:99],a[128:131],v[160:163],v[200:203]
 rq a[156:159],v211 offset:53248
 pk v5,v10,v11
 mf v[96:99],a[132:135],v[164:167],v[96:99]
 v_exp_f32 v12,v12
 mf v[96:99],a[136:139],v[168:171],v[96:99]
 v_exp_f32 v13,v13
 mf v[96:99],a[140:143],v[172:175],v[96:99]
 pk v6,v12,v13
 s_waitcnt vmcnt(19)
 v_lshlrev_b32 v226,16,v232
 mf v[112:115],a[140:143],v[188:191],v[204:207]
 v_exp_f32 v14,v14
 mf v[112:115],a[136:139],v[184:187],v[112:115]
 v_and_b32 v227,0xffff0000,v232
 v_fma_f32 v226,v226,v252,v253
 mf v[112:115],a[132:135],v[180:183],v[112:115]
 v_exp_f32 v15,v15
 mf v[112:115],a[128:131],v[176:179],v[112:115]
 s_waitcnt lgkmcnt(0)
 pk v7,v14,v15
 v_fma_f32 v227,v227,v252,v253
 mf v[116:119],a[144:147],v[176:179],v[204:207]
 v_exp_f32 v24,v24
 mf v[116:119],a[148:151],v[180:183],v[116:119]
 v_exp_f32 v25,v25
 mf v[116:119],a[152:155],v[184:187],v[116:119]
 rq a[128:131],v208 offset:57344
 mf v[116:119],a[156:159],v[188:191],v[116:119]
 bl v221,s[8:11],s63 offen offset:1024 lds
 mf v[100:103],a[156:159],v[172:175],v[200:203]
 rq a[132:135],v209 offset:57344
 pk v20,v24,v25
 mf v[100:103],a[152:155],v[168:171],v[100:103]
 v_exp_f32 v26,v26
 mf v[100:103],a[148:151],v[164:167],v[100:103]
 rq a[136:139],v210 offset:57344
 v_accvgpr_write_b32 a212,v226
 mf v[100:103],a[144:147],v[160:163],v[100:103]
 v_exp_f32 v27,v27
 mf v[84:87],a[144:147],v[144:147],v[196:199]
 rq a[140:143],v211 offset:57344
 pk v21,v26,v27
 mf v[84:87],a[148:151],v[148:151],v[84:87]
 v_exp_f32 v28,v28
 mf v[84:87],a[152:155],v[152:155],v[84:87]
 v_exp_f32 v29,v29
 mf v[84:87],a[156:159],v[156:159],v[84:87]
 pk v22,v28,v29
 v_accvgpr_write_b32 a213,v227
 mf v[68:71],a[156:159],v[140:143],v[192:195]
 v_exp_f32 v30,v30
 mf v[68:71],a[152:155],v[136:139],v[68:71]
 v_lshlrev_b32 v228,16,v233
 v_and_b32 v229,0xffff0000,v233
 mf v[68:71],a[148:151],v[132:135],v[68:71]
 v_exp_f32 v31,v31
 mf v[68:71],a[144:147],v[128:131],v[68:71]
 s_waitcnt lgkmcnt(0)
 pk v23,v30,v31
 v_fma_f32 v228,v228,v252,v253
 mf v[72:75],a[128:131],v[128:131],v[192:195]
 v_exp_f32 v40,v40
 mf v[72:75],a[132:135],v[132:135],v[72:75]
 v_exp_f32 v41,v41
 mf v[72:75],a[136:139],v[136:139],v[72:75]
 rq a[144:147],v208 offset:61440
 mf v[72:75],a[140:143],v[140:143],v[72:75]
 bl v222,s[8:11],s63 offen offset:2048 lds
 mf v[88:91],a[140:143],v[156:159],v[196:199]
 rq a[148:151],v209 offset:61440
 pk v36,v40,v41
 mf v[88:91],a[136:139],v[152:155],v[88:91]
 v_exp_f32 v42,v42
 mf v[88:91],a[132:135],v[148:151],v[88:91]
 rq a[152:155],v210 offset:61440
 v_fma_f32 v229,v229,v252,v253
 mf v[88:91],a[128:131],v[144:147],v[88:91]
 v_exp_f32 v43,v43
 mf v[104:107],a[128:131],v[160:163],v[200:203]
 rq a[156:159],v211 offset:61440
 pk v37,v42,v43
 mf v[104:107],a[132:135],v[164:167],v[104:107]
 v_exp_f32 v44,v44
 mf v[104:107],a[136:139],v[168:171],v[104:107]
 v_exp_f32 v45,v45
 mf v[104:107],a[140:143],v[172:175],v[104:107]
 pk v38,v44,v45
 v_accvgpr_write_b32 a214,v228
 mf v[120:123],a[140:143],v[188:191],v[204:207]
 v_exp_f32 v46,v46
 mf v[120:123],a[136:139],v[184:187],v[120:123]
 v_accvgpr_write_b32 a215,v229
 v_lshlrev_b32 v226,16,v234
 mf v[120:123],a[132:135],v[180:183],v[120:123]
 v_exp_f32 v47,v47
 mf v[120:123],a[128:131],v[176:179],v[120:123]
 s_waitcnt lgkmcnt(0)
 rt a[130:131],v212 offset:36864
 pk v39,v46,v47
 mf v[124:127],a[144:147],v[176:179],v[204:207]
 v_exp_f32 v56,v56
 mf v[124:127],a[148:151],v[180:183],v[124:127]
 v_exp_f32 v57,v57
 mf v[124:127],a[152:155],v[184:187],v[124:127]
 rt a[128:129],v212 offset:32768
 rt a[132:133],v212 offset:40960
 mf v[124:127],a[156:159],v[188:191],v[124:127]
 bl v223,s[8:11],s63 offen offset:3072 lds
 mf v[108:111],a[156:159],v[172:175],v[200:203]
 rt a[134:135],v212 offset:45056
 pk v52,v56,v57
 mf v[108:111],a[152:155],v[168:171],v[108:111]
L_pad_pg6:
 s_cbranch_execz L_hop1
 v_exp_f32 v58,v58
 mf v[108:111],a[148:151],v[164:167],v[108:111]
 rt a[136:137],v213 offset:32768
 v_and_b32 v227,0xffff0000,v234
 mf v[108:111],a[144:147],v[160:163],v[108:111]
 v_exp_f32 v59,v59
 mf v[92:95],a[144:147],v[144:147],v[196:199]
 rt a[138:139],v213 offset:36864
 pk v53,v58,v59
 mf v[92:95],a[148:151],v[148:151],v[92:95]
 v_exp_f32 v60,v60
 mf v[92:95],a[152:155],v[152:155],v[92:95]
 v_exp_f32 v61,v61
 mf v[92:95],a[156:159],v[156:159],v[92:95]
 rt a[140:141],v213 offset:40960
 pk v54,v60,v61
 mf v[76:79],a[156:159],v[140:143],v[192:195]
 v_exp_f32 v62,v62
 mf v[76:79],a[152:155],v[136:139],v[76:79]
 rt a[142:143],v213 offset:45056
 v_fma_f32 v226,v226,v252,v253
 mf v[76:79],a[148:151],v[132:135],v[76:79]
 v_exp_f32 v63,v63
 mf v[76:79],a[144:147],v[128:131],v[76:79]
 s_waitcnt lgkmcnt(4)
 rt a[148:149],v214 offset:40960
 pk v55,v62,v63
 mf a[0:3],v[0:3],a[128:131],a[0:3]
 v_exp_f32 v64,v64
 mf a[0:3],v[4:7],a[132:135],a[0:3]
 v_exp_f32 v65,v65
 mf a[4:7],v[20:23],a[132:135],a[4:7]
 rt a[150:151],v214 offset:45056
 pk v64,v64,v65
 mf a[4:7],v[16:19],a[128:131],a[4:7]
 v_exp_f32 v66,v66
 mf a[8:11],v[32:35],a[128:131],a[8:11]
 rt a[146:147],v214 offset:36864
 rt a[152:153],v215 offset:32768
 mf a[8:11],v[36:39],a[132:135],a[8:11]
 v_exp_f32 v67,v67
 mf a[12:15],v[52:55],a[132:135],a[12:15]
 rt a[154:155],v215 offset:36864
 pk v65,v66,v67
 mf a[12:15],v[48:51],a[128:131],a[12:15]
 s_waitcnt lgkmcnt(5)
 v_exp_f32 v68,v68
 mf a[28:31],v[48:51],a[136:139],a[28:31]
 v_exp_f32 v69,v69
 mf a[28:31],v[52:55],a[140:143],a[28:31]
 s_add_u32 m0,s61,81920
 rt a[156:157],v215 offset:40960
 pk v66,v68,v69
 mf a[24:27],v[36:39],a[140:143],a[24:27]
 s_mov_b32 s63,81920
 rt a[144:145],v214 offset:32768
 rt a[158:159],v215 offset:45056
 mf a[24:27],v[32:35],a[136:139],a[24:27]
 bl v224,s[12:15],s63 offen offset:0 lds
 mf a[20:23],v[16:19],a[136:139],a[20:23]
 v_exp_f32 v70,v70
 mf a[20:23],v[20:23],a[140:143],a[20:23]
 rt a[128:129],v216 offset:32768
 v_fma_f32 v227,v227,v252,v253
 mf a[16:19],v[4:7],a[140:143],a[16:19]
 v_exp_f32 v71,v71
 mf a[16:19],v[0:3],a[136:139],a[16:19]
 s_waitcnt lgkmcnt(2)
 rt a[130:131],v216 offset:36864
 pk v67,v70,v71
 mf a[32:35],v[0:3],a[144:147],a[32:35]
 v_exp_f32 v80,v80
 mf a[32:35],v[4:7],a[148:151],a[32:35]
 rt a[132:133],v216 offset:40960
 v_accvgpr_write_b32 a216,v226
 mf a[36:39],v[20:23],a[148:151],a[36:39]
 v_exp_f32 v81,v81
 mf a[36:39],v[16:19],a[144:147],a[36:39]
 v_exp_f32 v82,v82
 mf a[40:43],v[32:35],a[144:147],a[40:43]
 rt a[134:135],v216 offset:45056
 pk v80,v80,v81
 mf a[40:43],v[36:39],a[148:151],a[40:43]
 v_exp_f32 v83,v83
 mf a[44:47],v[52:55],a[148:151],a[44:47]
 rt a[136:137],v217 offset:32768
 pk v81,v82,v83
 mf a[44:47],v[48:51],a[144:147],a[44:47]
 s_waitcnt lgkmcnt(5)
 v_exp_f32 v84,v84
 mf a[60:63],v[48:51],a[152:155],a[60:63]
 rt a[138:139],v217 offset:36864
 v_accvgpr_write_b32 a217,v227
 mf a[60:63],v[52:55],a[156:159],a[60:63]
 v_exp_f32 v85,v85
 mf a[56:59],v[36:39],a[156:159],a[56:59]
 rt a[140:141],v217 offset:40960
 mf a[56:59],v[32:35],a[152:155],a[56:59]
 bl v225,s[12:15],s63 offen offset:1024 lds
 mf a[52:55],v[16:19],a[152:155],a[52:55]
 v_exp_f32 v86,v86
 mf a[52:55],v[20:23],a[156:159],a[52:55]
 rt a[142:143],v217 offset:45056
 pk v82,v84,v85
 mf a[48:51],v[4:7],a[156:159],a[48:51]
 v_exp_f32 v87,v87
 mf a[48:51],v[0:3],a[152:155],a[48:51]
 s_waitcnt lgkmcnt(4)
 rt a[144:145],v218 offset:32768
 pk v83,v86,v87
 mf a[64:67],v[0:3],a[128:131],a[64:67]
 v_exp_f32 v96,v96
 mf a[64:67],v[4:7],a[132:135],a[64:67]
 rt a[146:147],v218 offset:36864
 v_lshlrev_b32 v228,16,v235
 mf a[68:71],v[20:23],a[132:135],a[68:71]
 v_exp_f32 v97,v97
 mf a[68:71],v[16:19],a[128:131],a[68:71]
 rt a[148:149],v218 offset:40960
 pk v96,v96,v97
 mf a[72:75],v[32:35],a[128:131],a[72:75]
 v_exp_f32 v98,v98
 mf a[72:75],v[36:39],a[132:135],a[72:75]
 v_exp_f32 v99,v99
 mf a[76:79],v[52:55],a[132:135],a[76:79]
 rt a[150:151],v218 offset:45056
 pk v97,v98,v99
 mf a[76:79],v[48:51],a[128:131],a[76:79]
 s_waitcnt lgkmcnt(4)
 v_exp_f32 v100,v100
 mf a[92:95],v[48:51],a[136:139],a[92:95]
 rt a[152:153],v219 offset:32768
 v_and_b32 v229,0xffff0000,v235
 mf a[92:95],v[52:55],a[140:143],a[92:95]
 v_exp_f32 v101,v101
 mf a[88:91],v[36:39],a[140:143],a[88:91]
 rt a[154:155],v219 offset:36864
 mf a[88:91],v[32:35],a[136:139],a[88:91]
 bl v224,s[12:15],s63 offen offset:2048 lds
 mf a[84:87],v[16:19],a[136:139],a[84:87]
 rt a[156:157],v219 offset:40960
 pk v98,v100,v101
 mf a[84:87],v[20:23],a[140:143],a[84:87]
 v_exp_f32 v102,v102
 mf a[80:83],v[4:7],a[140:143],a[80:83]
 v_exp_f32 v103,v103
 mf a[80:83],v[0:3],a[136:139],a[80:83]
 s_waitcnt lgkmcnt(3)
 rt a[158:159],v219 offset:45056
 pk v99,v102,v103
 mf a[96:99],v[0:3],a[144:147],a[96:99]
 v_exp_f32 v112,v112
 mf a[96:99],v[4:7],a[148:151],a[96:99]
 v_fma_f32 v228,v228,v252,v253
 v_fma_f32 v229,v229,v252,v253
 mf a[100:103],v[20:23],a[148:151],a[100:103]
 v_exp_f32 v113,v113
 mf a[100:103],v[16:19],a[144:147],a[100:103]
 pk v112,v112,v113
 v_accvgpr_write_b32 a218,v228
 mf a[104:107],v[32:35],a[144:147],a[104:107]
 v_exp_f32 v114,v114
 mf a[104:107],v[36:39],a[148:151],a[104:107]
 rq a[128:131],v208 offset:0
 v_accvgpr_write_b32 a219,v229
 mf a[108:111],v[52:55],a[148:151],a[108:111]
 v_exp_f32 v115,v115
 mf a[108:111],v[48:51],a[144:147],a[108:111]
 s_waitcnt lgkmcnt(1)
 v_exp_f32 v116,v116
 mf a[124:127],v[48:51],a[152:155],a[124:127]
 rq a[132:135],v209 offset:0
 pk v113,v114,v115
 mf a[124:127],v[52:55],a[156:159],a[124:127]
 v_exp_f32 v117,v117
 mf a[120:123],v[36:39],a[156:159],a[120:123]
 rq a[136:139],v210 offset:0
 mf a[120:123],v[32:35],a[152:155],a[120:123]
 bl v225,s[12:15],s63 offen offset:3072 lds
 mf a[116:119],v[16:19],a[152:155],a[116:119]
 rq a[140:143],v211 offset:0
 pk v114,v116,v117
 mf a[116:119],v[20:23],a[156:159],a[116:119]
 v_exp_f32 v118,v118
 mf a[112:115],v[4:7],a[156:159],a[112:115]
 v_lshlrev_b32 v226,16,v236
 v_and_b32 v227,0xffff0000,v236
 mf a[112:115],v[0:3],a[152:155],a[112:115]
 v_exp_f32 v119,v119
 v_smfmac_f32_16x16x64_bf16 a[192:195],a[208:211],v[0:7],v250
 pk v115,v118,v119
 v_smfmac_f32_16x16x64_bf16 a[196:199],a[208:211],v[16:23],v250
 s_waitcnt vmcnt(21)
 v_fma_f32 v226,v226,v252,v253
 v_smfmac_f32_16x16x64_bf16 a[200:203],a[208:211],v[32:39],v250
 s_barrier
 v_fma_f32 v227,v227,v252,v253
 v_smfmac_f32_16x16x64_bf16 a[204:207],a[208:211],v[48:55],v250
 s_waitcnt lgkmcnt(0)
 v_accvgpr_write_b32 a220,v226
 mf v[0:3],a[128:131],v[128:131],v[192:195]
 v_exp_f32 v72,v72
 mf v[0:3],a[132:135],v[132:135],v[0:3]
 s_add_u32 m0,s61,49152
 v_exp_f32 v73,v73
 v_accvgpr_write_b32 a221,v227
 mf v[0:3],a[136:139],v[136:139],v[0:3]
 s_mov_b32 s63,114688
 rq a[144:147],v208 offset:4096
 mf v[0:3],a[140:143],v[140:143],v[0:3]
 bl v220,s[8:11],s63 offen offset:0 lds
 mf v[16:19],a[140:143],v[156:159],v[196:199]
 rq a[148:151],v209 offset:4096
 pk v68,v72,v73
 mf v[16:19],a[136:139],v[152:155],v[16:19]
 v_exp_f32 v74,v74
 v_lshlrev_b32 v228,16,v237
 mf v[16:19],a[132:135],v[148:151],v[16:19]
 rq a[152:155],v210 offset:4096
 v_and_b32 v229,0xffff0000,v237
 mf v[16:19],a[128:131],v[144:147],v[16:19]
 v_exp_f32 v75,v75
 mf v[32:35],a[128:131],v[160:163],v[200:203]
 rq a[156:159],v211 offset:4096
 pk v69,v74,v75
 mf v[32:35],a[132:135],v[164:167],v[32:35]
 v_exp_f32 v76,v76
 v_fma_f32 v228,v228,v252,v253
 mf v[32:35],a[136:139],v[168:171],v[32:35]
 v_exp_f32 v77,v77
 mf v[32:35],a[140:143],v[172:175],v[32:35]
 pk v70,v76,v77
 v_fma_f32 v229,v229,v252,v253
 mf v[48:51],a[140:143],v[188:191],v[204:207]
 v_exp_f32 v78,v78
 mf v[48:51],a[136:139],v[184:187],v[48:51]
 v_accvgpr_write_b32 a222,v228
 v_accvgpr_write_b32 a223,v229
 v_lshlrev_b32 v226,16,v238
 mf v[48:51],a[132:135],v[180:183],v[48:51]
 v_exp_f32 v79,v79
 mf v[48:51],a[128:131],v[176:179],v[48:51]
 s_waitcnt lgkmcnt(0)
 pk v71,v78,v79
 v_and_b32 v227,0xffff0000,v238
 mf v[52:55],a[144:147],v[176:179],v[204:207]
 v_exp_f32 v88,v88
 mf v[52:55],a[148:151],v[180:183],v[52:55]
 v_exp_f32 v89,v89
 v_fma_f32 v226,v226,v252,v253
 mf v[52:55],a[152:155],v[184:187],v[52:55]
 rq a[128:131],v208 offset:8192
 mf v[52:55],a[156:159],v[188:191],v[52:55]
 bl v221,s[8:11],s63 offen offset:1024 lds
 mf v[36:39],a[156:159],v[172:175],v[200:203]
 rq a[132:135],v209 offset:8192
 pk v84,v88,v89
 mf v[36:39],a[152:155],v[168:171],v[36:39]
 v_exp_f32 v90,v90
 v_fma_f32 v227,v227,v252,v253
 mf v[36:39],a[148:151],v[164:167],v[36:39]
 rq a[136:139],v210 offset:8192
 v_accvgpr_write_b32 a224,v226
 mf v[36:39],a[144:147],v[160:163],v[36:39]
 v_exp_f32 v91,v91
 mf v[20:23],a[144:147],v[144:147],v[196:199]
 rq a[140:143],v211 offset:8192
 pk v85,v90,v91
 mf v[20:23],a[148:151],v[148:151],v[20:23]
 v_exp_f32 v92,v92
 v_accvgpr_write_b32 a225,v227
 mf v[20:23],a[152:155],v[152:155],v[20:23]
 v_exp_f32 v93,v93
 mf v[20:23],a[156:159],v[156:159],v[20:23]
 pk v86,v92,v93
 v_lshlrev_b32 v228,16,v239
 mf v[4:7],a[156:159],v[140:143],v[192:195]
 v_exp_f32 v94,v94
 mf v[4:7],a[152:155],v[136:139],v[4:7]
 v_and_b32 v229,0xffff0000,v239
 v_fma_f32 v228,v228,v252,v253
 v_fma_f32 v229,v229,v252,v253
 mf v[4:7],a[148:151],v[132:135],v[4:7]
 v_exp_f32 v95,v95
 mf v[4:7],a[144:147],v[128:131],v[4:7]
 s_waitcnt lgkmcnt(0)
 pk v87,v94,v95
 v_accvgpr_write_b32 a226,v228
 mf v[8:11],a[128:131],v[128:131],v[192:195]
 v_exp_f32 v104,v104
 mf v[8:11],a[132:135],v[132:135],v[8:11]
 v_exp_f32 v105,v105
 v_accvgpr_write_b32 a227,v229
 mf v[8:11],a[136:139],v[136:139],v[8:11]
 rq a[144:147],v208 offset:12288
 mf v[8:11],a[140:143],v[140:143],v[8:11]
 bl v222,s[8:11],s63 offen offset:2048 lds
 mf v[24:27],a[140:143],v[156:159],v[196:199]
 rq a[148:151],v209 offset:12288
 pk v100,v104,v105
 mf v[24:27],a[136:139],v[152:155],v[24:27]
 v_exp_f32 v106,v106
 s_waitcnt vmcnt(10)
 v_cmp_gt_u32 vcc,8,v241
 mf v[24:27],a[132:135],v[148:151],v[24:27]
 rq a[152:155],v210 offset:12288
 s_cbranch_vccnz L_slow_h
L_back_h:
 mf v[24:27],a[128:131],v[144:147],v[24:27]
 v_exp_f32 v107,v107
 mf v[40:43],a[128:131],v[160:163],v[200:203]
 rq a[156:159],v211 offset:12288
 pk v101,v106,v107
 mf v[40:43],a[132:135],v[164:167],v[40:43]
 v_exp_f32 v108,v108
 v_bfe_u32 v226,v254,4,11
 mf v[40:43],a[136:139],v[168:171],v[40:43]
 v_exp_f32 v109,v109
 mf v[40:43],a[140:143],v[172:175],v[40:43]
 pk v102,v108,v109
 v_add_u32 v227,-1,v226
 mf v[56:59],a[140:143],v[188:191],v[204:207]
 v_exp_f32 v110,v110
 mf v[56:59],a[136:139],v[184:187],v[56:59]
 v_cmp_gt_u32 vcc,0x800,v227
 v_add_u32 v227,-16,v254
 v_mov_b32 v228,0x7f000000
 mf v[56:59],a[132:135],v[180:183],v[56:59]
 v_exp_f32 v111,v111
 mf v[56:59],a[128:131],v[176:179],v[56:59]
 s_waitcnt lgkmcnt(0)
 rt a[130:131],v212 offset:53248
 pk v103,v110,v111
 mf v[60:63],a[144:147],v[176:179],v[204:207]
 v_exp_f32 v120,v120
 mf v[60:63],a[148:151],v[180:183],v[60:63]
 v_exp_f32 v121,v121
 v_cndmask_b32 v228,v228,v227,vcc
 mf v[60:63],a[152:155],v[184:187],v[60:63]
 rt a[128:129],v212 offset:49152
 rt a[132:133],v212 offset:57344
 mf v[60:63],a[156:159],v[188:191],v[60:63]
 bl v223,s[8:11],s63 offen offset:3072 lds
 mf v[44:47],a[156:159],v[172:175],v[200:203]
 rt a[134:135],v212 offset:61440
 pk v116,v120,v121
 mf v[44:47],a[152:155],v[168:171],v[44:47]
 v_exp_f32 v122,v122
 v_add_u32 v227,1,v226
 mf v[44:47],a[148:151],v[164:167],v[44:47]
 rt a[136:137],v213 offset:49152
 v_cmp_gt_u32 vcc,0x800,v227
 mf v[44:47],a[144:147],v[160:163],v[44:47]
 v_exp_f32 v123,v123
 mf v[28:31],a[144:147],v[144:147],v[196:199]
 rt a[138:139],v213 offset:53248
 pk v117,v122,v123
 mf v[28:31],a[148:151],v[148:151],v[28:31]
 v_exp_f32 v124,v124
 v_add_u32 v227,16,v254
 mf v[28:31],a[152:155],v[152:155],v[28:31]
 v_exp_f32 v125,v125
 mf v[28:31],a[156:159],v[156:159],v[28:31]
 rt a[140:141],v213 offset:57344
 pk v118,v124,v125
 mf v[12:15],a[156:159],v[140:143],v[192:195]
 v_exp_f32 v126,v126
 mf v[12:15],a[152:155],v[136:139],v[12:15]
 rt a[142:143],v213 offset:61440
 v_mov_b32 v229,0x7f000000
 v_cndmask_b32 v229,v229,v227,vcc
 mf v[12:15],a[148:151],v[132:135],v[12:15]
 s_mov_b32 s64,0
 v_exp_f32 v127,v127
 mf v[12:15],a[144:147],v[128:131],v[12:15]
 s_waitcnt lgkmcnt(4)
 rt a[148:149],v214 offset:57344
 pk v119,v126,v127
 mf a[0:3],v[64:67],a[128:131],a[0:3]
 v_exp_f32 v0,v0
 mf a[0:3],v[68:71],a[132:135],a[0:3]
 bl a[160:163],v228,s[16:19],s64 offen sc1
 v_exp_f32 v1,v1
 mf a[4:7],v[84:87],a[132:135],a[4:7]
 s_mov_b32 s64,131072
 rt a[150:151],v214 offset:61440
 pk v0,v0,v1
 mf a[4:7],v[80:83],a[128:131],a[4:7]
 v_exp_f32 v2,v2
 mf a[8:11],v[96:99],a[128:131],a[8:11]
 rt a[146:147],v214 offset:53248
 rt a[152:153],v215 offset:49152
 mf a[8:11],v[100:103],a[132:135],a[8:11]
 bl a[164:167],v228,s[16:19],s64 offen sc1
 v_exp_f32 v3,v3
 mf a[12:15],v[116:119],a[132:135],a[12:15]
 s_mov_b32 s64,262144
 rt a[154:155],v215 offset:53248
 pk v1,v2,v3
 mf a[12:15],v[112:115],a[128:131],a[12:15]
 s_waitcnt lgkmcnt(5)
 v_exp_f32 v4,v4
 mf a[28:31],v[112:115],a[136:139],a[28:31]
 v_exp_f32 v5,v5
 mf a[28:31],v[116:119],a[140:143],a[28:31]
 s_add_u32 m0,s61,98304
 rt a[156:157],v215 offset:57344
 bl a[168:171],v228,s[16:19],s64 offen sc1
 pk v2,v4,v5
 mf a[24:27],v[100:103],a[140:143],a[24:27]
 s_mov_b32 s63,98304
 rt a[144:145],v214 offset:49152
 rt a[158:159],v215 offset:61440
 mf a[24:27],v[96:99],a[136:139],a[24:27]
 bl v224,s[12:15],s63 offen offset:0 lds
 mf a[20:23],v[80:83],a[136:139],a[20:23]
 v_exp_f32 v6,v6
 mf a[20:23],v[84:87],a[140:143],a[20:23]
 rt a[128:129],v216 offset:49152
 mf a[16:19],v[68:71],a[140:143],a[16:19]
 v_exp_f32 v7,v7
 mf a[16:19],v[64:67],a[136:139],a[16:19]
 s_waitcnt lgkmcnt(2)
 rt a[130:131],v216 offset:53248
 pk v3,v6,v7
 mf a[32:35],v[64:67],a[144:147],a[32:35]
 v_exp_f32 v16,v16
 mf a[32:35],v[68:71],a[148:151],a[32:35]
 rt a[132:133],v216 offset:57344
 mf a[36:39],v[84:87],a[148:151],a[36:39]
 v_exp_f32 v17,v17
 mf a[36:39],v[80:83],a[144:147],a[36:39]
 v_exp_f32 v18,v18
 mf a[40:43],v[96:99],a[144:147],a[40:43]
 s_mov_b32 s64,393216
 rt a[134:135],v216 offset:61440
 pk v16,v16,v17
 mf a[40:43],v[100:103],a[148:151],a[40:43]
 bl a[172:175],v228,s[16:19],s64 offen sc1
 v_exp_f32 v19,v19
 mf a[44:47],v[116:119],a[148:151],a[44:47]
 rt a[136:137],v217 offset:49152
 pk v17,v18,v19
 mf a[44:47],v[112:115],a[144:147],a[44:47]
 s_waitcnt lgkmcnt(5)
 v_exp_f32 v20,v20
 mf a[60:63],v[112:115],a[152:155],a[60:63]
 rt a[138:139],v217 offset:53248
 mf a[60:63],v[116:119],a[156:159],a[60:63]
 v_exp_f32 v21,v21
 mf a[56:59],v[100:103],a[156:159],a[56:59]
 rt a[140:141],v217 offset:57344
 mf a[56:59],v[96:99],a[152:155],a[56:59]
 bl v225,s[12:15],s63 offen offset:1024 lds
 mf a[52:55],v[80:83],a[152:155],a[52:55]
 v_exp_f32 v22,v22
 mf a[52:55],v[84:87],a[156:159],a[52:55]
 rt a[142:143],v217 offset:61440
 pk v18,v20,v21
 mf a[48:51],v[68:71],a[156:159],a[48:51]
 v_exp_f32 v23,v23
 mf a[48:51],v[64:67],a[152:155],a[48:51]
 s_waitcnt lgkmcnt(4)
 rt a[144:145],v218 offset:49152
 pk v19,v22,v23
 mf a[64:67],v[64:67],a[128:131],a[64:67]
 v_exp_f32 v32,v32
 mf a[64:67],v[68:71],a[132:135],a[64:67]
 rt a[146:147],v218 offset:53248
 mf a[68:71],v[84:87],a[132:135],a[68:71]
 v_exp_f32 v33,v33
 mf a[68:71],v[80:83],a[128:131],a[68:71]
 rt a[148:149],v218 offset:57344
 pk v32,v32,v33
 mf a[72:75],v[96:99],a[128:131],a[72:75]
 v_exp_f32 v34,v34
 mf a[72:75],v[100:103],a[132:135],a[72:75]
 v_exp_f32 v35,v35
 mf a[76:79],v[116:119],a[132:135],a[76:79]
 s_mov_b32 s64,524288
 rt a[150:151],v218 offset:61440
 pk v33,v34,v35
 mf a[76:79],v[112:115],a[128:131],a[76:79]
 s_waitcnt lgkmcnt(4)
 v_exp_f32 v36,v36
 mf a[92:95],v[112:115],a[136:139],a[92:95]
 rt a[152:153],v219 offset:49152
 bl a[176:179],v229,s[16:19],s64 offen sc1
 mf a[92:95],v[116:119],a[140:143],a[92:95]
 v_exp_f32 v37,v37
 mf a[88:91],v[100:103],a[140:143],a[88:91]
 rt a[154:155],v219 offset:53248
 mf a[88:91],v[96:99],a[136:139],a[88:91]
 bl v224,s[12:15],s63 offen offset:2048 lds
 mf a[84:87],v[80:83],a[136:139],a[84:87]
 rt a[156:157],v219 offset:57344
 pk v34,v36,v37
 mf a[84:87],v[84:87],a[140:143],a[84:87]
 v_exp_f32 v38,v38
 mf a[80:83],v[68:71],a[140:143],a[80:83]
 v_exp_f32 v39,v39
 mf a[80:83],v[64:67],a[136:139],a[80:83]
 s_waitcnt lgkmcnt(3)
 rt a[158:159],v219 offset:61440
 pk v35,v38,v39
 mf a[96:99],v[64:67],a[144:147],a[96:99]
 v_exp_f32 v48,v48
 mf a[96:99],v[68:71],a[148:151],a[96:99]
 mf a[100:103],v[84:87],a[148:151],a[100:103]
 v_exp_f32 v49,v49
 mf a[100:103],v[80:83],a[144:147],a[100:103]
 pk v48,v48,v49
 mf a[104:107],v[96:99],a[144:147],a[104:107]
 v_exp_f32 v50,v50
 mf a[104:107],v[100:103],a[148:151],a[104:107]
 rq a[128:131],v208 offset:16384
 mf a[108:111],v[116:119],a[148:151],a[108:111]
 v_exp_f32 v51,v51
 mf a[108:111],v[112:115],a[144:147],a[108:111]
 s_waitcnt lgkmcnt(1)
 v_exp_f32 v52,v52
 mf a[124:127],v[112:115],a[152:155],a[124:127]
 s_mov_b32 s64,655360
 rq a[132:135],v209 offset:16384
 pk v49,v50,v51
 mf a[124:127],v[116:119],a[156:159],a[124:127]
 bl a[180:183],v229,s[16:19],s64 offen sc1
 v_exp_f32 v53,v53
 mf a[120:123],v[100:103],a[156:159],a[120:123]
 rq a[136:139],v210 offset:16384
 mf a[120:123],v[96:99],a[152:155],a[120:123]
 bl v225,s[12:15],s63 offen offset:3072 lds
 mf a[116:119],v[80:83],a[152:155],a[116:119]
 rq a[140:143],v211 offset:16384
 pk v50,v52,v53
 mf a[116:119],v[84:87],a[156:159],a[116:119]
 v_exp_f32 v54,v54
 mf a[112:115],v[68:71],a[156:159],a[112:115]
 mf a[112:115],v[64:67],a[152:155],a[112:115]
 v_exp_f32 v55,v55
 v_smfmac_f32_16x16x64_bf16 a[192:195],a[208:211],v[64:71],v250
 pk v51,v54,v55
 v_smfmac_f32_16x16x64_bf16 a[196:199],a[208:211],v[80:87],v250
 s_waitcnt vmcnt(18)
 v_smfmac_f32_16x16x64_bf16 a[200:203],a[208:211],v[96:103],v250
 s_barrier
 v_smfmac_f32_16x16x64_bf16 a[204:207],a[208:211],v[112:119],v250
 s_waitcnt lgkmcnt(0)
 mf v[64:67],a[128:131],v[128:131],v[192:195]
 v_exp_f32 v8,v8
 mf v[64:67],a[132:135],v[132:135],v[64:67]
 s_add_u32 m0,s61,0
 v_exp_f32 v9,v9
 mf v[64:67],a[136:139],v[136:139],v[64:67]
 s_mov_b32 s63,131072
 rq a[144:147],v208 offset:20480
 mf v[64:67],a[140:143],v[140:143],v[64:67]
 bl v220,s[8:11],s63 offen offset:0 lds
 mf v[80:83],a[140:143],v[156:159],v[196:199]
 rq a[148:151],v209 offset:20480
 pk v4,v8,v9
 mf v[80:83],a[136:139],v[152:155],v[80:83]
 v_exp_f32 v10,v10
 mf v[80:83],a[132:135],v[148:151],v[80:83]
 s_mov_b32 s64,786432
 rq a[152:155],v210 offset:20480
 mf v[80:83],a[128:131],v[144:147],v[80:83]
 v_exp_f32 v11,v11
 mf v[96:99],a[128:131],v[160:163],v[200:203]
 rq a[156:159],v211 offset:20480
 pk v5,v10,v11
 mf v[96:99],a[132:135],v[164:167],v[96:99]
 v_exp_f32 v12,v12
 mf v[96:99],a[136:139],v[168:171],v[96:99]
 v_exp_f32 v13,v13
 mf v[96:99],a[140:143],v[172:175],v[96:99]
 bl a[184:187],v229,s[16:19],s64 offen sc1
 pk v6,v12,v13
 mf v[112:115],a[140:143],v[188:191],v[204:207]
 v_exp_f32 v14,v14
 mf v[112:115],a[136:139],v[184:187],v[112:115]
 mf v[112:115],a[132:135],v[180:183],v[112:115]
 v_exp_f32 v15,v15
 mf v[112:115],a[128:131],v[176:179],v[112:115]
 s_waitcnt lgkmcnt(0)
 pk v7,v14,v15
 mf v[116:119],a[144:147],v[176:179],v[204:207]
L_pad_pg7:
 s_cbranch_execz L_hop1
 v_exp_f32 v24,v24
 mf v[116:119],a[148:151],v[180:183],v[116:119]
 v_exp_f32 v25,v25
 mf v[116:119],a[152:155],v[184:187],v[116:119]
 rq a[128:131],v208 offset:24576
 mf v[116:119],a[156:159],v[188:191],v[116:119]
 bl v221,s[8:11],s63 offen offset:1024 lds
 mf v[100:103],a[156:159],v[172:175],v[200:203]
 rq a[132:135],v209 offset:24576
 pk v20,v24,v25
 mf v[100:103],a[152:155],v[168:171],v[100:103]
 v_exp_f32 v26,v26
 mf v[100:103],a[148:151],v[164:167],v[100:103]
 rq a[136:139],v210 offset:24576
 mf v[100:103],a[144:147],v[160:163],v[100:103]
 v_exp_f32 v27,v27
 mf v[84:87],a[144:147],v[144:147],v[196:199]
 s_mov_b32 s64,917504
 rq a[140:143],v211 offset:24576
 pk v21,v26,v27
 mf v[84:87],a[148:151],v[148:151],v[84:87]
 v_exp_f32 v28,v28
 mf v[84:87],a[152:155],v[152:155],v[84:87]
 v_exp_f32 v29,v29
 mf v[84:87],a[156:159],v[156:159],v[84:87]
 bl a[188:191],v229,s[16:19],s64 offen sc1
 pk v22,v28,v29
 mf v[68:71],a[156:159],v[140:143],v[192:195]
 v_exp_f32 v30,v30
 mf v[68:71],a[152:155],v[136:139],v[68:71]
 mf v[68:71],a[148:151],v[132:135],v[68:71]
 v_exp_f32 v31,v31
 mf v[68:71],a[144:147],v[128:131],v[68:71]
 s_waitcnt lgkmcnt(0)
 pk v23,v30,v31
 mf v[72:75],a[128:131],v[128:131],v[192:195]
 v_exp_f32 v40,v40
 mf v[72:75],a[132:135],v[132:135],v[72:75]
 v_exp_f32 v41,v41
 mf v[72:75],a[136:139],v[136:139],v[72:75]
 rq a[144:147],v208 offset:28672
 mf v[72:75],a[140:143],v[140:143],v[72:75]
 bl v222,s[8:11],s63 offen offset:2048 lds
 mf v[88:91],a[140:143],v[156:159],v[196:199]
 rq a[148:151],v209 offset:28672
 pk v36,v40,v41
 mf v[88:91],a[136:139],v[152:155],v[88:91]
 v_exp_f32 v42,v42
 mf v[88:91],a[132:135],v[148:151],v[88:91]
 rq a[152:155],v210 offset:28672
 mf v[88:91],a[128:131],v[144:147],v[88:91]
 v_exp_f32 v43,v43
 mf v[104:107],a[128:131],v[160:163],v[200:203]
 rq a[156:159],v211 offset:28672
 pk v37,v42,v43
 mf v[104:107],a[132:135],v[164:167],v[104:107]
 v_exp_f32 v44,v44
 mf v[104:107],a[136:139],v[168:171],v[104:107]
 v_exp_f32 v45,v45
 mf v[104:107],a[140:143],v[172:175],v[104:107]
 pk v38,v44,v45
 mf v[120:123],a[140:143],v[188:191],v[204:207]
 v_exp_f32 v46,v46
 mf v[120:123],a[136:139],v[184:187],v[120:123]
 mf v[120:123],a[132:135],v[180:183],v[120:123]
 v_exp_f32 v47,v47
 mf v[120:123],a[128:131],v[176:179],v[120:123]
 s_waitcnt lgkmcnt(0)
 rt a[130:131],v212 offset:4096
 pk v39,v46,v47
 mf v[124:127],a[144:147],v[176:179],v[204:207]
 v_exp_f32 v56,v56
 mf v[124:127],a[148:151],v[180:183],v[124:127]
 v_exp_f32 v57,v57
 mf v[124:127],a[152:155],v[184:187],v[124:127]
 rt a[128:129],v212 offset:0
 rt a[132:133],v212 offset:8192
 mf v[124:127],a[156:159],v[188:191],v[124:127]
 bl v223,s[8:11],s63 offen offset:3072 lds
 mf v[108:111],a[156:159],v[172:175],v[200:203]
 rt a[134:135],v212 offset:12288
 pk v52,v56,v57
 mf v[108:111],a[152:155],v[168:171],v[108:111]
 v_exp_f32 v58,v58
 mf v[108:111],a[148:151],v[164:167],v[108:111]
 rt a[136:137],v213 offset:0
 mf v[108:111],a[144:147],v[160:163],v[108:111]
 v_exp_f32 v59,v59
 mf v[92:95],a[144:147],v[144:147],v[196:199]
 rt a[138:139],v213 offset:4096
 pk v53,v58,v59
 mf v[92:95],a[148:151],v[148:151],v[92:95]
 v_exp_f32 v60,v60
 mf v[92:95],a[152:155],v[152:155],v[92:95]
 v_exp_f32 v61,v61
 mf v[92:95],a[156:159],v[156:159],v[92:95]
 rt a[140:141],v213 offset:8192
 pk v54,v60,v61
 mf v[76:79],a[156:159],v[140:143],v[192:195]
 v_exp_f32 v62,v62
 mf v[76:79],a[152:155],v[136:139],v[76:79]
 rt a[142:143],v213 offset:12288
 mf v[76:79],a[148:151],v[132:135],v[76:79]
 v_exp_f32 v63,v63
 mf v[76:79],a[144:147],v[128:131],v[76:79]
 s_waitcnt lgkmcnt(4)
 rt a[148:149],v214 offset:8192
 pk v55,v62,v63
 mf a[0:3],v[0:3],a[128:131],a[0:3]
 v_exp_f32 v64,v64
 mf a[0:3],v[4:7],a[132:135],a[0:3]
 v_exp_f32 v65,v65
 mf a[4:7],v[20:23],a[132:135],a[4:7]
 rt a[150:151],v214 offset:12288
 pk v64,v64,v65
 mf a[4:7],v[16:19],a[128:131],a[4:7]
 v_exp_f32 v66,v66
 mf a[8:11],v[32:35],a[128:131],a[8:11]
 rt a[146:147],v214 offset:4096
 rt a[152:153],v215 offset:0
 mf a[8:11],v[36:39],a[132:135],a[8:11]
 v_exp_f32 v67,v67
 mf a[12:15],v[52:55],a[132:135],a[12:15]
 rt a[154:155],v215 offset:4096
 pk v65,v66,v67
 mf a[12:15],v[48:51],a[128:131],a[12:15]
 s_waitcnt lgkmcnt(5)
 v_exp_f32 v68,v68
 mf a[28:31],v[48:51],a[136:139],a[28:31]
 v_exp_f32 v69,v69
 mf a[28:31],v[52:55],a[140:143],a[28:31]
 s_add_u32 m0,s61,114688
 rt a[156:157],v215 offset:8192
 pk v66,v68,v69
 mf a[24:27],v[36:39],a[140:143],a[24:27]
 s_mov_b32 s63,114688
 rt a[144:145],v214 offset:0
 rt a[158:159],v215 offset:12288
 mf a[24:27],v[32:35],a[136:139],a[24:27]
 bl v224,s[12:15],s63 offen offset:0 lds
 mf a[20:23],v[16:19],a[136:139],a[20:23]
 v_exp_f32 v70,v70
 mf a[20:23],v[20:23],a[140:143],a[20:23]
 rt a[128:129],v216 offset:0
 mf a[16:19],v[4:7],a[140:143],a[16:19]
 v_exp_f32 v71,v71
 mf a[16:19],v[0:3],a[136:139],a[16:19]
 s_waitcnt lgkmcnt(2)
 rt a[130:131],v216 offset:4096
 pk v67,v70,v71
 mf a[32:35],v[0:3],a[144:147],a[32:35]
 v_exp_f32 v80,v80
 mf a[32:35],v[4:7],a[148:151],a[32:35]
 rt a[132:133],v216 offset:8192
 mf a[36:39],v[20:23],a[148:151],a[36:39]
 v_exp_f32 v81,v81
 mf a[36:39],v[16:19],a[144:147],a[36:39]
 v_exp_f32 v82,v82
 mf a[40:43],v[32:35],a[144:147],a[40:43]
 rt a[134:135],v216 offset:12288
 pk v80,v80,v81
 mf a[40:43],v[36:39],a[148:151],a[40:43]
 v_exp_f32 v83,v83
 mf a[44:47],v[52:55],a[148:151],a[44:47]
 rt a[136:137],v217 offset:0
 pk v81,v82,v83
 mf a[44:47],v[48:51],a[144:147],a[44:47]
 s_waitcnt lgkmcnt(5)
 v_exp_f32 v84,v84
 mf a[60:63],v[48:51],a[152:155],a[60:63]
 rt a[138:139],v217 offset:4096
 mf a[60:63],v[52:55],a[156:159],a[60:63]
 v_exp_f32 v85,v85
 mf a[56:59],v[36:39],a[156:159],a[56:59]
 rt a[140:141],v217 offset:8192
 mf a[56:59],v[32:35],a[152:155],a[56:59]
 bl v225,s[12:15],s63 offen offset:1024 lds
 mf a[52:55],v[16:19],a[152:155],a[52:55]
 v_exp_f32 v86,v86
 mf a[52:55],v[20:23],a[156:159],a[52:55]
 rt a[142:143],v217 offset:12288
 pk v82,v84,v85
 mf a[48:51],v[4:7],a[156:159],a[48:51]
 v_exp_f32 v87,v87
 mf a[48:51],v[0:3],a[152:155],a[48:51]
 s_waitcnt lgkmcnt(4)
 rt a[144:145],v218 offset:0
 pk v83,v86,v87
 mf a[64:67],v[0:3],a[128:131],a[64:67]
 v_exp_f32 v96,v96
 mf a[64:67],v[4:7],a[132:135],a[64:67]
 rt a[146:147],v218 offset:4096
 mf a[68:71],v[20:23],a[132:135],a[68:71]
 v_exp_f32 v97,v97
 mf a[68:71],v[16:19],a[128:131],a[68:71]
 rt a[148:149],v218 offset:8192
 pk v96,v96,v97
 mf a[72:75],v[32:35],a[128:131],a[72:75]
 v_exp_f32 v98,v98
 mf a[72:75],v[36:39],a[132:135],a[72:75]
 v_exp_f32 v99,v99
 mf a[76:79],v[52:55],a[132:135],a[76:79]
 rt a[150:151],v218 offset:12288
 pk v97,v98,v99
 mf a[76:79],v[48:51],a[128:131],a[76:79]
 s_waitcnt lgkmcnt(4)
 v_exp_f32 v100,v100
 mf a[92:95],v[48:51],a[136:139],a[92:95]
 rt a[152:153],v219 offset:0
 mf a[92:95],v[52:55],a[140:143],a[92:95]
 v_exp_f32 v101,v101
 mf a[88:91],v[36:39],a[140:143],a[88:91]
 rt a[154:155],v219 offset:4096
 mf a[88:91],v[32:35],a[136:139],a[88:91]
 bl v224,s[12:15],s63 offen offset:2048 lds
 mf a[84:87],v[16:19],a[136:139],a[84:87]
 rt a[156:157],v219 offset:8192
 pk v98,v100,v101
 mf a[84:87],v[20:23],a[140:143],a[84:87]
 v_exp_f32 v102,v102
 mf a[80:83],v[4:7],a[140:143],a[80:83]
 v_exp_f32 v103,v103
 mf a[80:83],v[0:3],a[136:139],a[80:83]
 s_waitcnt lgkmcnt(3)
 rt a[158:159],v219 offset:12288
 pk v99,v102,v103
 mf a[96:99],v[0:3],a[144:147],a[96:99]
 v_exp_f32 v112,v112
 mf a[96:99],v[4:7],a[148:151],a[96:99]
 mf a[100:103],v[20:23],a[148:151],a[100:103]
 v_exp_f32 v113,v113
 mf a[100:103],v[16:19],a[144:147],a[100:103]
 pk v112,v112,v113
 mf a[104:107],v[32:35],a[144:147],a[104:107]
 v_exp_f32 v114,v114
 mf a[104:107],v[36:39],a[148:151],a[104:107]
 rq a[128:131],v208 offset:32768
 mf a[108:111],v[52:55],a[148:151],a[108:111]
 v_exp_f32 v115,v115
 mf a[108:111],v[48:51],a[144:147],a[108:111]
 s_waitcnt lgkmcnt(1)
 v_exp_f32 v116,v116
 mf a[124:127],v[48:51],a[152:155],a[124:127]
 rq a[132:135],v209 offset:32768
 pk v113,v114,v115
 mf a[124:127],v[52:55],a[156:159],a[124:127]
 v_exp_f32 v117,v117
 mf a[120:123],v[36:39],a[156:159],a[120:123]
 rq a[136:139],v210 offset:32768
 mf a[120:123],v[32:35],a[152:155],a[120:123]
 bl v225,s[12:15],s63 offen offset:3072 lds
 mf a[116:119],v[16:19],a[152:155],a[116:119]
 rq a[140:143],v211 offset:32768
 pk v114,v116,v117
 mf a[116:119],v[20:23],a[156:159],a[116:119]
 v_exp_f32 v118,v118
 mf a[112:115],v[4:7],a[156:159],a[112:115]
 mf a[112:115],v[0:3],a[152:155],a[112:115]
 v_exp_f32 v119,v119
 v_smfmac_f32_16x16x64_bf16 a[192:195],a[208:211],v[0:7],v250
 pk v115,v118,v119
 v_smfmac_f32_16x16x64_bf16 a[196:199],a[208:211],v[16:23],v250
 s_waitcnt vmcnt(20)
 v_smfmac_f32_16x16x64_bf16 a[200:203],a[208:211],v[32:39],v250
 s_barrier
 v_smfmac_f32_16x16x64_bf16 a[204:207],a[208:211],v[48:55],v250
 s_waitcnt lgkmcnt(0)
 mf v[0:3],a[128:131],v[128:131],v[192:195]
 v_exp_f32 v72,v72
 mf v[0:3],a[132:135],v[132:135],v[0:3]
 s_add_u32 m0,s61,16384
 rt a[228:229],v244 offset:0
 v_exp_f32 v73,v73
 mf v[0:3],a[136:139],v[136:139],v[0:3]
 s_mov_b32 s63,147456
 rq a[144:147],v208 offset:36864
 mf v[0:3],a[140:143],v[140:143],v[0:3]
 bl v220,s[8:11],s63 offen offset:0 lds
 rt a[230:231],v244 offset:2048
 mf v[16:19],a[140:143],v[156:159],v[196:199]
 rq a[148:151],v209 offset:36864
 pk v68,v72,v73
 mf v[16:19],a[136:139],v[152:155],v[16:19]
 rt a[232:233],v244 offset:4096
 v_exp_f32 v74,v74
 mf v[16:19],a[132:135],v[148:151],v[16:19]
 rq a[152:155],v210 offset:36864
 mf v[16:19],a[128:131],v[144:147],v[16:19]
 rt a[234:235],v244 offset:6144
 v_exp_f32 v75,v75
 mf v[32:35],a[128:131],v[160:163],v[200:203]
 rq a[156:159],v211 offset:36864
 pk v69,v74,v75
 mf v[32:35],a[132:135],v[164:167],v[32:35]
 rt a[236:237],v244 offset:8192
 v_exp_f32 v76,v76
 mf v[32:35],a[136:139],v[168:171],v[32:35]
 v_exp_f32 v77,v77
 mf v[32:35],a[140:143],v[172:175],v[32:35]
 rt a[238:239],v244 offset:10240
 pk v70,v76,v77
 mf v[48:51],a[140:143],v[188:191],v[204:207]
 v_exp_f32 v78,v78
 mf v[48:51],a[136:139],v[184:187],v[48:51]
 s_waitcnt vmcnt(20) lgkmcnt(7)
 mf a[212:215],a[228:231],a[160:163],a[212:215]
 rt a[240:241],v244 offset:12288
 rt a[242:243],v244 offset:14336
 mf v[48:51],a[132:135],v[180:183],v[48:51]
 v_exp_f32 v79,v79
 mf v[48:51],a[128:131],v[176:179],v[48:51]
 s_waitcnt lgkmcnt(4)
 pk v71,v78,v79
 mf v[52:55],a[144:147],v[176:179],v[204:207]
 v_exp_f32 v88,v88
 mf v[52:55],a[148:151],v[180:183],v[52:55]
 s_waitcnt vmcnt(19)
 v_exp_f32 v89,v89
 mf a[212:215],a[232:235],a[164:167],a[212:215]
 rt a[228:229],v244 offset:16384
 rt a[230:231],v244 offset:18432
 mf v[52:55],a[152:155],v[184:187],v[52:55]
 rq a[128:131],v208 offset:40960
 mf v[52:55],a[156:159],v[188:191],v[52:55]
 s_waitcnt vmcnt(18) lgkmcnt(5)
 bl v221,s[8:11],s63 offen offset:1024 lds
 mf a[212:215],a[236:239],a[168:171],a[212:215]
 rt a[232:233],v244 offset:20480
 rt a[234:235],v244 offset:22528
 mf v[36:39],a[156:159],v[172:175],v[200:203]
 rq a[132:135],v209 offset:40960
 pk v84,v88,v89
 mf v[36:39],a[152:155],v[168:171],v[36:39]
 v_exp_f32 v90,v90
 mf v[36:39],a[148:151],v[164:167],v[36:39]
 rq a[136:139],v210 offset:40960
 mf v[36:39],a[144:147],v[160:163],v[36:39]
 s_waitcnt vmcnt(17) lgkmcnt(7)
 v_exp_f32 v91,v91
 mf a[212:215],a[240:243],a[172:175],a[212:215]
 rt a[236:237],v244 offset:24576
 rt a[238:239],v244 offset:26624
 mf v[20:23],a[144:147],v[144:147],v[196:199]
 rq a[140:143],v211 offset:40960
 pk v85,v90,v91
 mf v[20:23],a[148:151],v[148:151],v[20:23]
 v_exp_f32 v92,v92
 mf v[20:23],a[152:155],v[152:155],v[20:23]
 v_exp_f32 v93,v93
 mf v[20:23],a[156:159],v[156:159],v[20:23]
 s_waitcnt vmcnt(15) lgkmcnt(8)
 pk v86,v92,v93
 mf a[212:215],a[228:231],a[176:179],a[212:215]
 rt a[240:241],v244 offset:28672
 rt a[242:243],v244 offset:30720
 mf v[4:7],a[156:159],v[140:143],v[192:195]
 v_exp_f32 v94,v94
 mf v[4:7],a[152:155],v[136:139],v[4:7]
 mf v[4:7],a[148:151],v[132:135],v[4:7]
 v_exp_f32 v95,v95
 mf v[4:7],a[144:147],v[128:131],v[4:7]
 s_waitcnt vmcnt(13) lgkmcnt(7)
 pk v87,v94,v95
 mf a[212:215],a[232:235],a[180:183],a[212:215]
 s_waitcnt lgkmcnt(2)
 rt a[228:229],v245 offset:0
 rt a[230:231],v245 offset:2048
 mf v[8:11],a[128:131],v[128:131],v[192:195]
 v_exp_f32 v104,v104
 mf v[8:11],a[132:135],v[132:135],v[8:11]
 s_waitcnt vmcnt(10)
 v_exp_f32 v105,v105
 mf a[212:215],a[236:239],a[184:187],a[212:215]
 rt a[232:233],v245 offset:4096
 rt a[234:235],v245 offset:6144
 mf v[8:11],a[136:139],v[136:139],v[8:11]
 rq a[144:147],v208 offset:45056
 mf v[8:11],a[140:143],v[140:143],v[8:11]
 bl v222,s[8:11],s63 offen offset:2048 lds
 mf v[24:27],a[140:143],v[156:159],v[196:199]
 rq a[148:151],v209 offset:45056
 pk v100,v104,v105
 mf v[24:27],a[136:139],v[152:155],v[24:27]
 s_waitcnt vmcnt(9) lgkmcnt(6)
 v_exp_f32 v106,v106
 mf a[212:215],a[240:243],a[188:191],a[212:215]
 rt a[236:237],v245 offset:8192
 rt a[238:239],v245 offset:10240
 mf v[24:27],a[132:135],v[148:151],v[24:27]
 rq a[152:155],v210 offset:45056
 mf v[24:27],a[128:131],v[144:147],v[24:27]
 v_exp_f32 v107,v107
 mf v[40:43],a[128:131],v[160:163],v[200:203]
 rq a[156:159],v211 offset:45056
 pk v101,v106,v107
 mf v[40:43],a[132:135],v[164:167],v[40:43]
 s_waitcnt lgkmcnt(8)
 v_exp_f32 v108,v108
 mf a[216:219],a[228:231],a[160:163],a[216:219]
 rt a[240:241],v245 offset:12288
 rt a[242:243],v245 offset:14336
 mf v[40:43],a[136:139],v[168:171],v[40:43]
 v_exp_f32 v109,v109
 mf v[40:43],a[140:143],v[172:175],v[40:43]
 pk v102,v108,v109
 mf v[56:59],a[140:143],v[188:191],v[204:207]
 v_exp_f32 v110,v110
 mf v[56:59],a[136:139],v[184:187],v[56:59]
 s_waitcnt lgkmcnt(8)
 mf a[216:219],a[232:235],a[164:167],a[216:219]
 rt a[228:229],v245 offset:16384
 rt a[230:231],v245 offset:18432
 mf v[56:59],a[132:135],v[180:183],v[56:59]
 v_exp_f32 v111,v111
 mf v[56:59],a[128:131],v[176:179],v[56:59]
 s_waitcnt lgkmcnt(6)
 rt a[130:131],v212 offset:20480
 pk v103,v110,v111
 mf a[216:219],a[236:239],a[168:171],a[216:219]
 s_waitcnt lgkmcnt(5)
 rt a[232:233],v245 offset:20480
 rt a[234:235],v245 offset:22528
 mf v[60:63],a[144:147],v[176:179],v[204:207]
 v_exp_f32 v120,v120
 mf v[60:63],a[148:151],v[180:183],v[60:63]
 v_exp_f32 v121,v121
 mf v[60:63],a[152:155],v[184:187],v[60:63]
 rt a[128:129],v212 offset:16384
 rt a[132:133],v212 offset:24576
 mf v[60:63],a[156:159],v[188:191],v[60:63]
 s_waitcnt lgkmcnt(7)
 bl v223,s[8:11],s63 offen offset:3072 lds
 mf a[216:219],a[240:243],a[172:175],a[216:219]
 rt a[236:237],v245 offset:24576
 rt a[238:239],v245 offset:26624
 mf v[44:47],a[156:159],v[172:175],v[200:203]
 rt a[134:135],v212 offset:28672
 pk v116,v120,v121
 mf v[44:47],a[152:155],v[168:171],v[44:47]
 v_exp_f32 v122,v122
 mf v[44:47],a[148:151],v[164:167],v[44:47]
 rt a[136:137],v213 offset:16384
 mf v[44:47],a[144:147],v[160:163],v[44:47]
 s_waitcnt lgkmcnt(9)
 v_exp_f32 v123,v123
 mf a[216:219],a[228:231],a[176:179],a[216:219]
 rt a[240:241],v245 offset:28672
 rt a[242:243],v245 offset:30720
 mf v[28:31],a[144:147],v[144:147],v[196:199]
 rt a[138:139],v213 offset:20480
 pk v117,v122,v123
 mf v[28:31],a[148:151],v[148:151],v[28:31]
 v_exp_f32 v124,v124
 mf v[28:31],a[152:155],v[152:155],v[28:31]
 v_exp_f32 v125,v125
 mf v[28:31],a[156:159],v[156:159],v[28:31]
 s_waitcnt lgkmcnt(9)
 rt a[140:141],v213 offset:24576
 pk v118,v124,v125
 mf a[216:219],a[232:235],a[180:183],a[216:219]
 rt a[228:229],v246 offset:0
 rt a[230:231],v246 offset:2048
 mf v[12:15],a[156:159],v[140:143],v[192:195]
 v_exp_f32 v126,v126
 mf v[12:15],a[152:155],v[136:139],v[12:15]
 s_waitcnt lgkmcnt(8)
 rt a[142:143],v213 offset:28672
 mf a[216:219],a[236:239],a[184:187],a[216:219]
 rt a[232:233],v246 offset:4096
 rt a[234:235],v246 offset:6144
 mf v[12:15],a[148:151],v[132:135],v[12:15]
 v_exp_f32 v127,v127
 mf v[12:15],a[144:147],v[128:131],v[12:15]
 s_waitcnt lgkmcnt(10)
 rt a[148:149],v214 offset:24576
 pk v119,v126,v127
 mf a[0:3],v[64:67],a[128:131],a[0:3]
 v_exp_f32 v0,v0
 mf a[0:3],v[68:71],a[132:135],a[0:3]
 s_waitcnt lgkmcnt(8)
 v_exp_f32 v1,v1
 mf a[216:219],a[240:243],a[188:191],a[216:219]
 rt a[236:237],v246 offset:8192
 rt a[238:239],v246 offset:10240
 mf a[4:7],v[84:87],a[132:135],a[4:7]
 rt a[150:151],v214 offset:28672
 pk v0,v0,v1
 mf a[4:7],v[80:83],a[128:131],a[4:7]
 v_exp_f32 v2,v2
 mf a[8:11],v[96:99],a[128:131],a[8:11]
 rt a[146:147],v214 offset:20480
 rt a[152:153],v215 offset:16384
 mf a[8:11],v[100:103],a[132:135],a[8:11]
 s_waitcnt lgkmcnt(9)
 v_exp_f32 v3,v3
 mf a[220:223],a[228:231],a[160:163],a[220:223]
 rt a[240:241],v246 offset:12288
 rt a[242:243],v246 offset:14336
 mf a[12:15],v[116:119],a[132:135],a[12:15]
 rt a[154:155],v215 offset:20480
 pk v1,v2,v3
 mf a[12:15],v[112:115],a[128:131],a[12:15]
 s_waitcnt lgkmcnt(11)
 v_exp_f32 v4,v4
 mf a[28:31],v[112:115],a[136:139],a[28:31]
 v_exp_f32 v5,v5
 mf a[28:31],v[116:119],a[140:143],a[28:31]
 s_waitcnt lgkmcnt(9)
 s_add_u32 m0,s61,65536
 rt a[156:157],v215 offset:24576
 pk v2,v4,v5
 mf a[220:223],a[232:235],a[164:167],a[220:223]
 rt a[228:229],v246 offset:16384
 rt a[230:231],v246 offset:18432
 mf a[24:27],v[100:103],a[140:143],a[24:27]
 s_mov_b32 s63,131072
 rt a[144:145],v214 offset:16384
 rt a[158:159],v215 offset:28672
 mf a[24:27],v[96:99],a[136:139],a[24:27]
 s_waitcnt lgkmcnt(11)
 bl v224,s[12:15],s63 offen offset:0 lds
 mf a[220:223],a[236:239],a[168:171],a[220:223]
 rt a[232:233],v246 offset:20480
 rt a[234:235],v246 offset:22528
 mf a[20:23],v[80:83],a[136:139],a[20:23]
 v_exp_f32 v6,v6
 mf a[20:23],v[84:87],a[140:143],a[20:23]
 rt a[128:129],v216 offset:16384
 mf a[16:19],v[68:71],a[140:143],a[16:19]
 v_exp_f32 v7,v7
 mf a[16:19],v[64:67],a[136:139],a[16:19]
 s_waitcnt lgkmcnt(9)
 rt a[130:131],v216 offset:20480
 pk v3,v6,v7
 mf a[220:223],a[240:243],a[172:175],a[220:223]
 s_waitcnt lgkmcnt(5)
 rt a[236:237],v246 offset:24576
 rt a[238:239],v246 offset:26624
 mf a[32:35],v[64:67],a[144:147],a[32:35]
 v_exp_f32 v16,v16
 mf a[32:35],v[68:71],a[148:151],a[32:35]
 rt a[132:133],v216 offset:24576
 mf a[36:39],v[84:87],a[148:151],a[36:39]
 v_exp_f32 v17,v17
 mf a[36:39],v[80:83],a[144:147],a[36:39]
 v_exp_f32 v18,v18
 mf a[220:223],a[228:231],a[176:179],a[220:223]
 rt a[240:241],v246 offset:28672
 rt a[242:243],v246 offset:30720
 mf a[40:43],v[96:99],a[144:147],a[40:43]
 rt a[134:135],v216 offset:28672
 pk v16,v16,v17
 mf a[40:43],v[100:103],a[148:151],a[40:43]
 v_exp_f32 v19,v19
 mf a[44:47],v[116:119],a[148:151],a[44:47]
 rt a[136:137],v217 offset:16384
 pk v17,v18,v19
 mf a[44:47],v[112:115],a[144:147],a[44:47]
 s_waitcnt lgkmcnt(9)
 v_exp_f32 v20,v20
 mf a[220:223],a[232:235],a[180:183],a[220:223]
 rt a[228:229],v247 offset:0
 rt a[230:231],v247 offset:2048
 mf a[60:63],v[112:115],a[152:155],a[60:63]
 rt a[138:139],v217 offset:20480
 mf a[60:63],v[116:119],a[156:159],a[60:63]
 s_waitcnt lgkmcnt(8)
 v_exp_f32 v21,v21
 mf a[220:223],a[236:239],a[184:187],a[220:223]
 rt a[232:233],v247 offset:4096
 rt a[234:235],v247 offset:6144
 mf a[56:59],v[100:103],a[156:159],a[56:59]
 rt a[140:141],v217 offset:24576
 mf a[56:59],v[96:99],a[152:155],a[56:59]
 bl v225,s[12:15],s63 offen offset:1024 lds
 mf a[52:55],v[80:83],a[152:155],a[52:55]
 v_exp_f32 v22,v22
 mf a[52:55],v[84:87],a[156:159],a[52:55]
 s_waitcnt lgkmcnt(8)
 rt a[142:143],v217 offset:28672
 pk v18,v20,v21
 mf a[220:223],a[240:243],a[188:191],a[220:223]
 rt a[236:237],v247 offset:8192
 rt a[238:239],v247 offset:10240
 mf a[48:51],v[68:71],a[156:159],a[48:51]
L_pad_pg8:
 s_cbranch_execz L_hop1
 v_exp_f32 v23,v23
 mf a[48:51],v[64:67],a[152:155],a[48:51]
 s_waitcnt lgkmcnt(10)
 rt a[144:145],v218 offset:16384
 pk v19,v22,v23
 mf a[64:67],v[64:67],a[128:131],a[64:67]
 v_exp_f32 v32,v32
 mf a[64:67],v[68:71],a[132:135],a[64:67]
 s_waitcnt lgkmcnt(8)
 rt a[146:147],v218 offset:20480
 mf a[224:227],a[228:231],a[160:163],a[224:227]
 rt a[240:241],v247 offset:12288
 rt a[242:243],v247 offset:14336
 mf a[68:71],v[84:87],a[132:135],a[68:71]
 v_exp_f32 v33,v33
 mf a[68:71],v[80:83],a[128:131],a[68:71]
 rt a[148:149],v218 offset:24576
 pk v32,v32,v33
 mf a[72:75],v[96:99],a[128:131],a[72:75]
 v_exp_f32 v34,v34
 mf a[72:75],v[100:103],a[132:135],a[72:75]
 s_waitcnt lgkmcnt(9)
 v_exp_f32 v35,v35
 mf a[224:227],a[232:235],a[164:167],a[224:227]
 rt a[228:229],v247 offset:16384
 rt a[230:231],v247 offset:18432
 mf a[76:79],v[116:119],a[132:135],a[76:79]
 rt a[150:151],v218 offset:28672
 pk v33,v34,v35
 mf a[76:79],v[112:115],a[128:131],a[76:79]
 s_waitcnt lgkmcnt(8)
 v_exp_f32 v36,v36
 mf a[224:227],a[236:239],a[168:171],a[224:227]
 rt a[232:233],v247 offset:20480
 rt a[234:235],v247 offset:22528
 mf a[92:95],v[112:115],a[136:139],a[92:95]
 rt a[152:153],v219 offset:16384
 mf a[92:95],v[116:119],a[140:143],a[92:95]
 v_exp_f32 v37,v37
 mf a[88:91],v[100:103],a[140:143],a[88:91]
 rt a[154:155],v219 offset:20480
 mf a[88:91],v[96:99],a[136:139],a[88:91]
 s_waitcnt lgkmcnt(8)
 bl v224,s[12:15],s63 offen offset:2048 lds
 mf a[224:227],a[240:243],a[172:175],a[224:227]
 rt a[236:237],v247 offset:24576
 rt a[238:239],v247 offset:26624
 mf a[84:87],v[80:83],a[136:139],a[84:87]
 rt a[156:157],v219 offset:24576
 pk v34,v36,v37
 mf a[84:87],v[84:87],a[140:143],a[84:87]
 v_exp_f32 v38,v38
 mf a[80:83],v[68:71],a[140:143],a[80:83]
 v_exp_f32 v39,v39
 mf a[80:83],v[64:67],a[136:139],a[80:83]
 s_waitcnt lgkmcnt(8)
 rt a[158:159],v219 offset:28672
 pk v35,v38,v39
 mf a[224:227],a[228:231],a[176:179],a[224:227]
 s_waitcnt lgkmcnt(8)
 rt a[240:241],v247 offset:28672
 rt a[242:243],v247 offset:30720
 mf a[96:99],v[64:67],a[144:147],a[96:99]
 v_exp_f32 v48,v48
 mf a[96:99],v[68:71],a[148:151],a[96:99]
 mf a[100:103],v[84:87],a[148:151],a[100:103]
 v_exp_f32 v49,v49
 mf a[100:103],v[80:83],a[144:147],a[100:103]
 s_waitcnt lgkmcnt(8)
 pk v48,v48,v49
 mf a[224:227],a[232:235],a[180:183],a[224:227]
 mf a[104:107],v[96:99],a[144:147],a[104:107]
 v_exp_f32 v50,v50
 mf a[104:107],v[100:103],a[148:151],a[104:107]
 s_waitcnt lgkmcnt(4)
 rq a[128:131],v208 offset:49152
 mf a[224:227],a[236:239],a[184:187],a[224:227]
 mf a[108:111],v[116:119],a[148:151],a[108:111]
 v_exp_f32 v51,v51
 mf a[108:111],v[112:115],a[144:147],a[108:111]
 s_waitcnt lgkmcnt(3)
 v_exp_f32 v52,v52
 mf a[124:127],v[112:115],a[152:155],a[124:127]
 rq a[132:135],v209 offset:49152
 pk v49,v50,v51
 mf a[124:127],v[116:119],a[156:159],a[124:127]
 s_waitcnt lgkmcnt(2)
 v_exp_f32 v53,v53
 mf a[224:227],a[240:243],a[188:191],a[224:227]
 mf a[120:123],v[100:103],a[156:159],a[120:123]
 rq a[136:139],v210 offset:49152
 mf a[120:123],v[96:99],a[152:155],a[120:123]
 bl v225,s[12:15],s63 offen offset:3072 lds
 mf a[116:119],v[80:83],a[152:155],a[116:119]
 rq a[140:143],v211 offset:49152
 pk v50,v52,v53
 mf a[116:119],v[84:87],a[156:159],a[116:119]
 v_exp_f32 v54,v54
 mf a[112:115],v[68:71],a[156:159],a[112:115]
 mf a[112:115],v[64:67],a[152:155],a[112:115]
 v_exp_f32 v55,v55
 v_smfmac_f32_16x16x64_bf16 a[192:195],a[208:211],v[64:71],v250
 pk v51,v54,v55
 v_smfmac_f32_16x16x64_bf16 a[196:199],a[208:211],v[80:87],v250
 s_waitcnt vmcnt(12)
 v_smfmac_f32_16x16x64_bf16 a[200:203],a[208:211],v[96:103],v250
 s_barrier
 v_smfmac_f32_16x16x64_bf16 a[204:207],a[208:211],v[112:119],v250
 s_waitcnt lgkmcnt(0)
 mf v[64:67],a[128:131],v[128:131],v[192:195]
 v_exp_f32 v8,v8
 mf v[64:67],a[132:135],v[132:135],v[64:67]
 s_add_u32 m0,s61,32768
 v_exp_f32 v9,v9
 mf v[64:67],a[136:139],v[136:139],v[64:67]
 s_mov_b32 s63,163840
 rq a[144:147],v208 offset:53248
 mf v[64:67],a[140:143],v[140:143],v[64:67]
 bl v220,s[8:11],s63 offen offset:0 lds
 mf v[80:83],a[140:143],v[156:159],v[196:199]
 rq a[148:151],v209 offset:53248
 pk v4,v8,v9
 mf v[80:83],a[136:139],v[152:155],v[80:83]
 v_exp_f32 v10,v10
 mf v[80:83],a[132:135],v[148:151],v[80:83]
 rq a[152:155],v210 offset:53248
 v_bfe_u32 v226,v254,4,11
 mf v[80:83],a[128:131],v[144:147],v[80:83]
 v_exp_f32 v11,v11
 mf v[96:99],a[128:131],v[160:163],v[200:203]
 rq a[156:159],v211 offset:53248
 pk v5,v10,v11
 mf v[96:99],a[132:135],v[164:167],v[96:99]
 v_exp_f32 v12,v12
 mf v[96:99],a[136:139],v[168:171],v[96:99]
 v_exp_f32 v13,v13
 mf v[96:99],a[140:143],v[172:175],v[96:99]
 bl v221,s[8:11],s63 offen offset:1024 lds
 pk v6,v12,v13
 mf v[112:115],a[140:143],v[188:191],v[204:207]
 v_exp_f32 v14,v14
 mf v[112:115],a[136:139],v[184:187],v[112:115]
 bl v222,s[8:11],s63 offen offset:2048 lds
 mf v[112:115],a[132:135],v[180:183],v[112:115]
 v_exp_f32 v15,v15
 mf v[112:115],a[128:131],v[176:179],v[112:115]
 s_waitcnt lgkmcnt(0)
 bl v223,s[8:11],s63 offen offset:3072 lds
 pk v7,v14,v15
 mf v[116:119],a[144:147],v[176:179],v[204:207]
 v_exp_f32 v24,v24
 mf v[116:119],a[148:151],v[180:183],v[116:119]
 s_add_u32 m0,s61,81920
 v_exp_f32 v25,v25
 mf v[116:119],a[152:155],v[184:187],v[116:119]
 s_mov_b32 s63,147456
 rq a[128:131],v208 offset:57344
 mf v[116:119],a[156:159],v[188:191],v[116:119]
 bl v224,s[12:15],s63 offen offset:0 lds
 mf v[100:103],a[156:159],v[172:175],v[200:203]
 rq a[132:135],v209 offset:57344
 pk v20,v24,v25
 mf v[100:103],a[152:155],v[168:171],v[100:103]
 v_exp_f32 v26,v26
 mf v[100:103],a[148:151],v[164:167],v[100:103]
 rq a[136:139],v210 offset:57344
 v_add_u32 v227,-2,v226
 mf v[100:103],a[144:147],v[160:163],v[100:103]
 v_exp_f32 v27,v27
 mf v[84:87],a[144:147],v[144:147],v[196:199]
 rq a[140:143],v211 offset:57344
 pk v21,v26,v27
 mf v[84:87],a[148:151],v[148:151],v[84:87]
 v_exp_f32 v28,v28
 mf v[84:87],a[152:155],v[152:155],v[84:87]
 v_exp_f32 v29,v29
 mf v[84:87],a[156:159],v[156:159],v[84:87]
 bl v225,s[12:15],s63 offen offset:1024 lds
 pk v22,v28,v29
 mf v[68:71],a[156:159],v[140:143],v[192:195]
 v_exp_f32 v30,v30
 mf v[68:71],a[152:155],v[136:139],v[68:71]
 v_cmp_gt_u32 vcc,0x800,v227
 v_add_u32 v227,-32,v254
 mf v[68:71],a[148:151],v[132:135],v[68:71]
 v_exp_f32 v31,v31
 mf v[68:71],a[144:147],v[128:131],v[68:71]
 s_waitcnt lgkmcnt(0)
 bl v224,s[12:15],s63 offen offset:2048 lds
 pk v23,v30,v31
 mf v[72:75],a[128:131],v[128:131],v[192:195]
 v_exp_f32 v40,v40
 mf v[72:75],a[132:135],v[132:135],v[72:75]
 v_exp_f32 v41,v41
 mf v[72:75],a[136:139],v[136:139],v[72:75]
 rq a[144:147],v208 offset:61440
 mf v[72:75],a[140:143],v[140:143],v[72:75]
 bl v225,s[12:15],s63 offen offset:3072 lds
 mf v[88:91],a[140:143],v[156:159],v[196:199]
 rq a[148:151],v209 offset:61440
 pk v36,v40,v41
 mf v[88:91],a[136:139],v[152:155],v[88:91]
 v_exp_f32 v42,v42
 mf v[88:91],a[132:135],v[148:151],v[88:91]
 rq a[152:155],v210 offset:61440
 v_mov_b32 v228,0x7f000000
 mf v[88:91],a[128:131],v[144:147],v[88:91]
 v_exp_f32 v43,v43
 mf v[104:107],a[128:131],v[160:163],v[200:203]
 rq a[156:159],v211 offset:61440
 pk v37,v42,v43
 mf v[104:107],a[132:135],v[164:167],v[104:107]
 s_add_u32 m0,s62,65536
 v_exp_f32 v44,v44
 mf v[104:107],a[136:139],v[168:171],v[104:107]
 s_mov_b32 s63,262144
 v_exp_f32 v45,v45
 mf v[104:107],a[140:143],v[172:175],v[104:107]
 bl v243,s[32:35],s63 offen offset:0 lds
 pk v38,v44,v45
 mf v[120:123],a[140:143],v[188:191],v[204:207]
 s_mov_b32 s63,269312
 v_exp_f32 v46,v46
 mf v[120:123],a[136:139],v[184:187],v[120:123]
 bl v243,s[32:35],s63 offen offset:1024 lds
 mf v[120:123],a[132:135],v[180:183],v[120:123]
 s_mov_b32 s63,276480
 v_exp_f32 v47,v47
 mf v[120:123],a[128:131],v[176:179],v[120:123]
 s_waitcnt lgkmcnt(0)
 rt a[130:131],v212 offset:36864
 pk v39,v46,v47
 mf v[124:127],a[144:147],v[176:179],v[204:207]
 v_exp_f32 v56,v56
 mf v[124:127],a[148:151],v[180:183],v[124:127]
 v_exp_f32 v57,v57
 mf v[124:127],a[152:155],v[184:187],v[124:127]
 rt a[128:129],v212 offset:32768
 rt a[132:133],v212 offset:40960
 mf v[124:127],a[156:159],v[188:191],v[124:127]
 bl v243,s[32:35],s63 offen offset:2048 lds
 mf v[108:111],a[156:159],v[172:175],v[200:203]
 rt a[134:135],v212 offset:45056
 pk v52,v56,v57
 mf v[108:111],a[152:155],v[168:171],v[108:111]
 v_exp_f32 v58,v58
 mf v[108:111],a[148:151],v[164:167],v[108:111]
 rt a[136:137],v213 offset:32768
 v_cndmask_b32 v228,v228,v227,vcc
 mf v[108:111],a[144:147],v[160:163],v[108:111]
 v_exp_f32 v59,v59
 mf v[92:95],a[144:147],v[144:147],v[196:199]
 rt a[138:139],v213 offset:36864
 pk v53,v58,v59
 mf v[92:95],a[148:151],v[148:151],v[92:95]
 v_exp_f32 v60,v60
 mf v[92:95],a[152:155],v[152:155],v[92:95]
 v_exp_f32 v61,v61
 mf v[92:95],a[156:159],v[156:159],v[92:95]
 rt a[140:141],v213 offset:40960
 pk v54,v60,v61
 mf v[76:79],a[156:159],v[140:143],v[192:195]
 v_exp_f32 v62,v62
 mf v[76:79],a[152:155],v[136:139],v[76:79]
 rt a[142:143],v213 offset:45056
 v_add_u32 v227,2,v226
 mf v[76:79],a[148:151],v[132:135],v[76:79]
 v_exp_f32 v63,v63
 mf v[76:79],a[144:147],v[128:131],v[76:79]
 s_waitcnt lgkmcnt(4)
 rt a[148:149],v214 offset:40960
 pk v55,v62,v63
 mf a[0:3],v[0:3],a[128:131],a[0:3]
 v_exp_f32 v64,v64
 mf a[0:3],v[4:7],a[132:135],a[0:3]
 v_exp_f32 v65,v65
 mf a[4:7],v[20:23],a[132:135],a[4:7]
 rt a[150:151],v214 offset:45056
 pk v64,v64,v65
 mf a[4:7],v[16:19],a[128:131],a[4:7]
 v_exp_f32 v66,v66
 mf a[8:11],v[32:35],a[128:131],a[8:11]
 rt a[146:147],v214 offset:36864
 rt a[152:153],v215 offset:32768
 mf a[8:11],v[36:39],a[132:135],a[8:11]
 v_exp_f32 v67,v67
 mf a[12:15],v[52:55],a[132:135],a[12:15]
 rt a[154:155],v215 offset:36864
 pk v65,v66,v67
 mf a[12:15],v[48:51],a[128:131],a[12:15]
 s_waitcnt lgkmcnt(5)
 v_exp_f32 v68,v68
 mf a[28:31],v[48:51],a[136:139],a[28:31]
 v_exp_f32 v69,v69
 mf a[28:31],v[52:55],a[140:143],a[28:31]
 rt a[156:157],v215 offset:40960
 pk v66,v68,v69
 mf a[24:27],v[36:39],a[140:143],a[24:27]
 s_mov_b32 s63,283648
 rt a[144:145],v214 offset:32768
 rt a[158:159],v215 offset:45056
 mf a[24:27],v[32:35],a[136:139],a[24:27]
 bl v243,s[32:35],s63 offen offset:3072 lds
 mf a[20:23],v[16:19],a[136:139],a[20:23]
 v_exp_f32 v70,v70
 mf a[20:23],v[20:23],a[140:143],a[20:23]
 rt a[128:129],v216 offset:32768
 v_cmp_gt_u32 vcc,0x800,v227
 mf a[16:19],v[4:7],a[140:143],a[16:19]
 v_exp_f32 v71,v71
 mf a[16:19],v[0:3],a[136:139],a[16:19]
 s_waitcnt lgkmcnt(2)
 rt a[130:131],v216 offset:36864
 pk v67,v70,v71
 mf a[32:35],v[0:3],a[144:147],a[32:35]
 v_exp_f32 v80,v80
 mf a[32:35],v[4:7],a[148:151],a[32:35]
 rt a[132:133],v216 offset:40960
 v_add_u32 v227,32,v254
 mf a[36:39],v[20:23],a[148:151],a[36:39]
 v_exp_f32 v81,v81
 mf a[36:39],v[16:19],a[144:147],a[36:39]
 v_exp_f32 v82,v82
 mf a[40:43],v[32:35],a[144:147],a[40:43]
 rt a[134:135],v216 offset:45056
 pk v80,v80,v81
 mf a[40:43],v[36:39],a[148:151],a[40:43]
 v_exp_f32 v83,v83
 mf a[44:47],v[52:55],a[148:151],a[44:47]
 rt a[136:137],v217 offset:32768
 pk v81,v82,v83
 mf a[44:47],v[48:51],a[144:147],a[44:47]
 s_waitcnt lgkmcnt(5)
 v_exp_f32 v84,v84
 mf a[60:63],v[48:51],a[152:155],a[60:63]
 rt a[138:139],v217 offset:36864
 v_mov_b32 v229,0x7f000000
 mf a[60:63],v[52:55],a[156:159],a[60:63]
 s_add_u32 m0,s62,69632
 v_exp_f32 v85,v85
 mf a[56:59],v[36:39],a[156:159],a[56:59]
 s_mov_b32 s63,294912
 rt a[140:141],v217 offset:40960
 mf a[56:59],v[32:35],a[152:155],a[56:59]
 bl v243,s[32:35],s63 offen offset:0 lds
 mf a[52:55],v[16:19],a[152:155],a[52:55]
 v_exp_f32 v86,v86
 mf a[52:55],v[20:23],a[156:159],a[52:55]
 rt a[142:143],v217 offset:45056
 pk v82,v84,v85
 mf a[48:51],v[4:7],a[156:159],a[48:51]
 v_exp_f32 v87,v87
 mf a[48:51],v[0:3],a[152:155],a[48:51]
 s_waitcnt lgkmcnt(4)
 rt a[144:145],v218 offset:32768
 pk v83,v86,v87
 mf a[64:67],v[0:3],a[128:131],a[64:67]
 v_exp_f32 v96,v96
 mf a[64:67],v[4:7],a[132:135],a[64:67]
 rt a[146:147],v218 offset:36864
 v_cndmask_b32 v229,v229,v227,vcc
 mf a[68:71],v[20:23],a[132:135],a[68:71]
 s_mov_b32 s64,1048576
 v_exp_f32 v97,v97
 mf a[68:71],v[16:19],a[128:131],a[68:71]
 rt a[148:149],v218 offset:40960
 pk v96,v96,v97
 mf a[72:75],v[32:35],a[128:131],a[72:75]
 v_exp_f32 v98,v98
 mf a[72:75],v[36:39],a[132:135],a[72:75]
 v_exp_f32 v99,v99
 mf a[76:79],v[52:55],a[132:135],a[76:79]
 rt a[150:151],v218 offset:45056
 pk v97,v98,v99
 mf a[76:79],v[48:51],a[128:131],a[76:79]
 s_waitcnt lgkmcnt(4)
 v_exp_f32 v100,v100
 mf a[92:95],v[48:51],a[136:139],a[92:95]
 rt a[152:153],v219 offset:32768
 bl a[160:163],v228,s[16:19],s64 offen sc1
 mf a[92:95],v[52:55],a[140:143],a[92:95]
 s_mov_b32 s64,1179648
 v_exp_f32 v101,v101
 mf a[88:91],v[36:39],a[140:143],a[88:91]
 s_mov_b32 s63,302080
 rt a[154:155],v219 offset:36864
 mf a[88:91],v[32:35],a[136:139],a[88:91]
 bl v243,s[32:35],s63 offen offset:1024 lds
 mf a[84:87],v[16:19],a[136:139],a[84:87]
 rt a[156:157],v219 offset:40960
 pk v98,v100,v101
 mf a[84:87],v[20:23],a[140:143],a[84:87]
 v_exp_f32 v102,v102
 mf a[80:83],v[4:7],a[140:143],a[80:83]
 s_mov_b32 s63,309248
 v_exp_f32 v103,v103
 mf a[80:83],v[0:3],a[136:139],a[80:83]
 s_waitcnt lgkmcnt(3)
 rt a[158:159],v219 offset:45056
 pk v99,v102,v103
 mf a[96:99],v[0:3],a[144:147],a[96:99]
 v_exp_f32 v112,v112
 mf a[96:99],v[4:7],a[148:151],a[96:99]
 bl v243,s[32:35],s63 offen offset:2048 lds
 mf a[100:103],v[20:23],a[148:151],a[100:103]
 v_exp_f32 v113,v113
 mf a[100:103],v[16:19],a[144:147],a[100:103]
 bl a[164:167],v228,s[16:19],s64 offen sc1
 pk v112,v112,v113
 mf a[104:107],v[32:35],a[144:147],a[104:107]
 s_mov_b32 s64,1310720
 v_exp_f32 v114,v114
 mf a[104:107],v[36:39],a[148:151],a[104:107]
 rq a[128:131],v208 offset:0
 bl a[168:171],v228,s[16:19],s64 offen sc1
 mf a[108:111],v[52:55],a[148:151],a[108:111]
 s_mov_b32 s64,1441792
 v_exp_f32 v115,v115
 mf a[108:111],v[48:51],a[144:147],a[108:111]
 s_waitcnt lgkmcnt(1)
 v_exp_f32 v116,v116
 mf a[124:127],v[48:51],a[152:155],a[124:127]
 rq a[132:135],v209 offset:0
 pk v113,v114,v115
 mf a[124:127],v[52:55],a[156:159],a[124:127]
 v_exp_f32 v117,v117
 mf a[120:123],v[36:39],a[156:159],a[120:123]
 s_mov_b32 s63,316416
 rq a[136:139],v210 offset:0
 mf a[120:123],v[32:35],a[152:155],a[120:123]
 bl v243,s[32:35],s63 offen offset:3072 lds
 mf a[116:119],v[16:19],a[152:155],a[116:119]
 rq a[140:143],v211 offset:0
 pk v114,v116,v117
 mf a[116:119],v[20:23],a[156:159],a[116:119]
 v_exp_f32 v118,v118
 mf a[112:115],v[4:7],a[156:159],a[112:115]
 bl a[172:175],v228,s[16:19],s64 offen sc1
 mf a[112:115],v[0:3],a[152:155],a[112:115]
 s_mov_b32 s64,1572864
 v_exp_f32 v119,v119
 v_smfmac_f32_16x16x64_bf16 a[192:195],a[208:211],v[0:7],v250
 pk v115,v118,v119
 v_smfmac_f32_16x16x64_bf16 a[196:199],a[208:211],v[16:23],v250
 s_waitcnt vmcnt(24)
 bl a[176:179],v229,s[16:19],s64 offen sc1
 v_smfmac_f32_16x16x64_bf16 a[200:203],a[208:211],v[32:39],v250
 s_barrier
 s_mov_b32 s64,1703936
 v_smfmac_f32_16x16x64_bf16 a[204:207],a[208:211],v[48:55],v250
 s_waitcnt lgkmcnt(0)
 bl a[180:183],v229,s[16:19],s64 offen sc1
 mf v[0:3],a[128:131],v[128:131],v[192:195]
 s_mov_b32 s64,1835008
 v_exp_f32 v72,v72
 mf v[0:3],a[132:135],v[132:135],v[0:3]
 s_add_u32 m0,s61,49152
 v_exp_f32 v73,v73
 mf v[0:3],a[136:139],v[136:139],v[0:3]
 s_mov_b32 s63,180224
 rq a[144:147],v208 offset:4096
 mf v[0:3],a[140:143],v[140:143],v[0:3]
 bl v220,s[8:11],s63 offen offset:0 lds
 mf v[16:19],a[140:143],v[156:159],v[196:199]
 rq a[148:151],v209 offset:4096
 pk v68,v72,v73
 mf v[16:19],a[136:139],v[152:155],v[16:19]
 v_exp_f32 v74,v74
 mf v[16:19],a[132:135],v[148:151],v[16:19]
 rq a[152:155],v210 offset:4096
 bl a[184:187],v229,s[16:19],s64 offen sc1
 mf v[16:19],a[128:131],v[144:147],v[16:19]
 v_exp_f32 v75,v75
 mf v[32:35],a[128:131],v[160:163],v[200:203]
 rq a[156:159],v211 offset:4096
 pk v69,v74,v75
 mf v[32:35],a[132:135],v[164:167],v[32:35]
 v_exp_f32 v76,v76
 mf v[32:35],a[136:139],v[168:171],v[32:35]
 v_exp_f32 v77,v77
 mf v[32:35],a[140:143],v[172:175],v[32:35]
 pk v70,v76,v77
 mf v[48:51],a[140:143],v[188:191],v[204:207]
 v_exp_f32 v78,v78
 mf v[48:51],a[136:139],v[184:187],v[48:51]
 mf v[48:51],a[132:135],v[180:183],v[48:51]
 v_exp_f32 v79,v79
 mf v[48:51],a[128:131],v[176:179],v[48:51]
 s_waitcnt lgkmcnt(0)
 pk v71,v78,v79
 mf v[52:55],a[144:147],v[176:179],v[204:207]
 v_exp_f32 v88,v88
 mf v[52:55],a[148:151],v[180:183],v[52:55]
 v_exp_f32 v89,v89
 mf v[52:55],a[152:155],v[184:187],v[52:55]
 rq a[128:131],v208 offset:8192
 mf v[52:55],a[156:159],v[188:191],v[52:55]
 bl v221,s[8:11],s63 offen offset:1024 lds
 mf v[36:39],a[156:159],v[172:175],v[200:203]
 s_mov_b32 s64,1966080
 rq a[132:135],v209 offset:8192
 pk v84,v88,v89
 mf v[36:39],a[152:155],v[168:171],v[36:39]
 v_exp_f32 v90,v90
 mf v[36:39],a[148:151],v[164:167],v[36:39]
 rq a[136:139],v210 offset:8192
 bl a[188:191],v229,s[16:19],s64 offen sc1
 mf v[36:39],a[144:147],v[160:163],v[36:39]
 s_lshl_b32 s55,s54,7
 v_exp_f32 v91,v91
 mf v[20:23],a[144:147],v[144:147],v[196:199]
 s_lshl_b32 s59,s89,0
 rq a[140:143],v211 offset:8192
 pk v85,v90,v91
 mf v[20:23],a[148:151],v[148:151],v[20:23]
 s_add_u32 s55,s55,s59
 v_exp_f32 v92,v92
 mf v[20:23],a[152:155],v[152:155],v[20:23]
 v_exp_f32 v93,v93
 mf v[20:23],a[156:159],v[156:159],v[20:23]
 pk v86,v92,v93
 v_lshrrev_b32 v226,10,v251
 mf v[4:7],a[156:159],v[140:143],v[192:195]
 v_exp_f32 v94,v94
 mf v[4:7],a[152:155],v[136:139],v[4:7]
 v_bfe_u32 v227,v255,4,3
 v_and_b32 v243,6,v226
 mf v[4:7],a[148:151],v[132:135],v[4:7]
 v_exp_f32 v95,v95
 mf v[4:7],a[144:147],v[128:131],v[4:7]
 s_waitcnt lgkmcnt(0)
 pk v87,v94,v95
 v_xor_b32 v227,v227,v243
 mf v[8:11],a[128:131],v[128:131],v[192:195]
 v_exp_f32 v104,v104
 mf v[8:11],a[132:135],v[132:135],v[8:11]
 v_exp_f32 v105,v105
 mf v[8:11],a[136:139],v[136:139],v[8:11]
 rq a[144:147],v208 offset:12288
 mf v[8:11],a[140:143],v[140:143],v[8:11]
 bl v222,s[8:11],s63 offen offset:2048 lds
 mf v[24:27],a[140:143],v[156:159],v[196:199]
 rq a[148:151],v209 offset:12288
 pk v100,v104,v105
 mf v[24:27],a[136:139],v[152:155],v[24:27]
 v_exp_f32 v106,v106
 mf v[24:27],a[132:135],v[148:151],v[24:27]
 rq a[152:155],v210 offset:12288
 v_mul_u32_u24 v226,3584,v226
 mf v[24:27],a[128:131],v[144:147],v[24:27]
 v_exp_f32 v107,v107
 mf v[40:43],a[128:131],v[160:163],v[200:203]
 rq a[156:159],v211 offset:12288
 pk v101,v106,v107
 mf v[40:43],a[132:135],v[164:167],v[40:43]
 v_exp_f32 v108,v108
 mf v[40:43],a[136:139],v[168:171],v[40:43]
 v_exp_f32 v109,v109
 mf v[40:43],a[140:143],v[172:175],v[40:43]
 pk v102,v108,v109
 v_lshl_add_u32 v226,v227,4,v226
 mf v[56:59],a[140:143],v[188:191],v[204:207]
 v_exp_f32 v110,v110
 mf v[56:59],a[136:139],v[184:187],v[56:59]
 v_add_u32 v243,s55,v226
 mf v[56:59],a[132:135],v[180:183],v[56:59]
 v_exp_f32 v111,v111
 mf v[56:59],a[128:131],v[176:179],v[56:59]
 s_waitcnt lgkmcnt(0)
 rt a[130:131],v212 offset:53248
 pk v103,v110,v111
 mf v[60:63],a[144:147],v[176:179],v[204:207]
 v_exp_f32 v120,v120
 mf v[60:63],a[148:151],v[180:183],v[60:63]
 v_exp_f32 v121,v121
 mf v[60:63],a[152:155],v[184:187],v[60:63]
 rt a[128:129],v212 offset:49152
 rt a[132:133],v212 offset:57344
 mf v[60:63],a[156:159],v[188:191],v[60:63]
 bl v223,s[8:11],s63 offen offset:3072 lds
 mf v[44:47],a[156:159],v[172:175],v[200:203]
 rt a[134:135],v212 offset:61440
 pk v116,v120,v121
 mf v[44:47],a[152:155],v[168:171],v[44:47]
 v_exp_f32 v122,v122
 mf v[44:47],a[148:151],v[164:167],v[44:47]
L_pad_pg9:
 s_cbranch_execz L_hop2
 rt a[136:137],v213 offset:49152
 mf v[44:47],a[144:147],v[160:163],v[44:47]
 v_exp_f32 v123,v123
 mf v[28:31],a[144:147],v[144:147],v[196:199]
 rt a[138:139],v213 offset:53248
 pk v117,v122,v123
 mf v[28:31],a[148:151],v[148:151],v[28:31]
 v_exp_f32 v124,v124
 mf v[28:31],a[152:155],v[152:155],v[28:31]
 v_exp_f32 v125,v125
 mf v[28:31],a[156:159],v[156:159],v[28:31]
 rt a[140:141],v213 offset:57344
 pk v118,v124,v125
 mf v[12:15],a[156:159],v[140:143],v[192:195]
 v_exp_f32 v126,v126
 mf v[12:15],a[152:155],v[136:139],v[12:15]
 rt a[142:143],v213 offset:61440
 mf v[12:15],a[148:151],v[132:135],v[12:15]
 v_exp_f32 v127,v127
 mf v[12:15],a[144:147],v[128:131],v[12:15]
 s_waitcnt lgkmcnt(4)
 rt a[148:149],v214 offset:57344
 pk v119,v126,v127
 mf a[0:3],v[64:67],a[128:131],a[0:3]
 v_exp_f32 v0,v0
 mf a[0:3],v[68:71],a[132:135],a[0:3]
 v_exp_f32 v1,v1
 mf a[4:7],v[84:87],a[132:135],a[4:7]
 rt a[150:151],v214 offset:61440
 pk v0,v0,v1
 mf a[4:7],v[80:83],a[128:131],a[4:7]
 v_exp_f32 v2,v2
 mf a[8:11],v[96:99],a[128:131],a[8:11]
 rt a[146:147],v214 offset:53248
 rt a[152:153],v215 offset:49152
 mf a[8:11],v[100:103],a[132:135],a[8:11]
 v_exp_f32 v3,v3
 mf a[12:15],v[116:119],a[132:135],a[12:15]
 rt a[154:155],v215 offset:53248
 pk v1,v2,v3
 mf a[12:15],v[112:115],a[128:131],a[12:15]
 s_waitcnt lgkmcnt(5)
 v_exp_f32 v4,v4
 mf a[28:31],v[112:115],a[136:139],a[28:31]
 v_exp_f32 v5,v5
 mf a[28:31],v[116:119],a[140:143],a[28:31]
 s_add_u32 m0,s61,98304
 rt a[156:157],v215 offset:57344
 pk v2,v4,v5
 mf a[24:27],v[100:103],a[140:143],a[24:27]
 s_mov_b32 s63,163840
 rt a[144:145],v214 offset:49152
 rt a[158:159],v215 offset:61440
 mf a[24:27],v[96:99],a[136:139],a[24:27]
 bl v224,s[12:15],s63 offen offset:0 lds
 mf a[20:23],v[80:83],a[136:139],a[20:23]
 v_exp_f32 v6,v6
 mf a[20:23],v[84:87],a[140:143],a[20:23]
 rt a[128:129],v216 offset:49152
 mf a[16:19],v[68:71],a[140:143],a[16:19]
 v_exp_f32 v7,v7
 mf a[16:19],v[64:67],a[136:139],a[16:19]
 s_waitcnt lgkmcnt(2)
 rt a[130:131],v216 offset:53248
 pk v3,v6,v7
 mf a[32:35],v[64:67],a[144:147],a[32:35]
 v_exp_f32 v16,v16
 mf a[32:35],v[68:71],a[148:151],a[32:35]
 rt a[132:133],v216 offset:57344
 mf a[36:39],v[84:87],a[148:151],a[36:39]
 v_exp_f32 v17,v17
 mf a[36:39],v[80:83],a[144:147],a[36:39]
 v_exp_f32 v18,v18
 mf a[40:43],v[96:99],a[144:147],a[40:43]
 rt a[134:135],v216 offset:61440
 pk v16,v16,v17
 mf a[40:43],v[100:103],a[148:151],a[40:43]
 v_exp_f32 v19,v19
 mf a[44:47],v[116:119],a[148:151],a[44:47]
 rt a[136:137],v217 offset:49152
 pk v17,v18,v19
 mf a[44:47],v[112:115],a[144:147],a[44:47]
 s_waitcnt lgkmcnt(5)
 v_exp_f32 v20,v20
 mf a[60:63],v[112:115],a[152:155],a[60:63]
 rt a[138:139],v217 offset:53248
 mf a[60:63],v[116:119],a[156:159],a[60:63]
 v_exp_f32 v21,v21
 mf a[56:59],v[100:103],a[156:159],a[56:59]
 rt a[140:141],v217 offset:57344
 mf a[56:59],v[96:99],a[152:155],a[56:59]
 bl v225,s[12:15],s63 offen offset:1024 lds
 mf a[52:55],v[80:83],a[152:155],a[52:55]
 v_exp_f32 v22,v22
 mf a[52:55],v[84:87],a[156:159],a[52:55]
 rt a[142:143],v217 offset:61440
 pk v18,v20,v21
 mf a[48:51],v[68:71],a[156:159],a[48:51]
 v_exp_f32 v23,v23
 mf a[48:51],v[64:67],a[152:155],a[48:51]
 s_waitcnt lgkmcnt(4)
 rt a[144:145],v218 offset:49152
 pk v19,v22,v23
 mf a[64:67],v[64:67],a[128:131],a[64:67]
 v_exp_f32 v32,v32
 mf a[64:67],v[68:71],a[132:135],a[64:67]
 rt a[146:147],v218 offset:53248
 mf a[68:71],v[84:87],a[132:135],a[68:71]
 v_exp_f32 v33,v33
 mf a[68:71],v[80:83],a[128:131],a[68:71]
 rt a[148:149],v218 offset:57344
 pk v32,v32,v33
 mf a[72:75],v[96:99],a[128:131],a[72:75]
 v_exp_f32 v34,v34
 mf a[72:75],v[100:103],a[132:135],a[72:75]
 v_exp_f32 v35,v35
 mf a[76:79],v[116:119],a[132:135],a[76:79]
 rt a[150:151],v218 offset:61440
 pk v33,v34,v35
 mf a[76:79],v[112:115],a[128:131],a[76:79]
 s_waitcnt lgkmcnt(4)
 v_exp_f32 v36,v36
 mf a[92:95],v[112:115],a[136:139],a[92:95]
 rt a[152:153],v219 offset:49152
 mf a[92:95],v[116:119],a[140:143],a[92:95]
 v_exp_f32 v37,v37
 mf a[88:91],v[100:103],a[140:143],a[88:91]
 rt a[154:155],v219 offset:53248
 mf a[88:91],v[96:99],a[136:139],a[88:91]
 bl v224,s[12:15],s63 offen offset:2048 lds
 mf a[84:87],v[80:83],a[136:139],a[84:87]
 rt a[156:157],v219 offset:57344
 pk v34,v36,v37
 mf a[84:87],v[84:87],a[140:143],a[84:87]
 v_exp_f32 v38,v38
 mf a[80:83],v[68:71],a[140:143],a[80:83]
 v_exp_f32 v39,v39
 mf a[80:83],v[64:67],a[136:139],a[80:83]
 s_waitcnt lgkmcnt(3)
 rt a[158:159],v219 offset:61440
 pk v35,v38,v39
 mf a[96:99],v[64:67],a[144:147],a[96:99]
 v_exp_f32 v48,v48
 mf a[96:99],v[68:71],a[148:151],a[96:99]
 mf a[100:103],v[84:87],a[148:151],a[100:103]
 v_exp_f32 v49,v49
 mf a[100:103],v[80:83],a[144:147],a[100:103]
 pk v48,v48,v49
 mf a[104:107],v[96:99],a[144:147],a[104:107]
 v_exp_f32 v50,v50
 mf a[104:107],v[100:103],a[148:151],a[104:107]
 rq a[128:131],v208 offset:16384
 mf a[108:111],v[116:119],a[148:151],a[108:111]
 v_exp_f32 v51,v51
 mf a[108:111],v[112:115],a[144:147],a[108:111]
 s_waitcnt lgkmcnt(1)
 v_exp_f32 v52,v52
 mf a[124:127],v[112:115],a[152:155],a[124:127]
 rq a[132:135],v209 offset:16384
 pk v49,v50,v51
 mf a[124:127],v[116:119],a[156:159],a[124:127]
 v_exp_f32 v53,v53
 mf a[120:123],v[100:103],a[156:159],a[120:123]
 rq a[136:139],v210 offset:16384
 mf a[120:123],v[96:99],a[152:155],a[120:123]
 bl v225,s[12:15],s63 offen offset:3072 lds
 mf a[116:119],v[80:83],a[152:155],a[116:119]
 rq a[140:143],v211 offset:16384
 pk v50,v52,v53
 mf a[116:119],v[84:87],a[156:159],a[116:119]
 v_exp_f32 v54,v54
 mf a[112:115],v[68:71],a[156:159],a[112:115]
 mf a[112:115],v[64:67],a[152:155],a[112:115]
 v_exp_f32 v55,v55
 v_smfmac_f32_16x16x64_bf16 a[192:195],a[208:211],v[64:71],v250
 pk v51,v54,v55
 v_smfmac_f32_16x16x64_bf16 a[196:199],a[208:211],v[80:87],v250
 s_waitcnt vmcnt(13)
 v_smfmac_f32_16x16x64_bf16 a[200:203],a[208:211],v[96:103],v250
 s_barrier
 v_smfmac_f32_16x16x64_bf16 a[204:207],a[208:211],v[112:119],v250
 s_waitcnt lgkmcnt(0)
 mf v[64:67],a[128:131],v[128:131],v[192:195]
 v_exp_f32 v8,v8
 mf v[64:67],a[132:135],v[132:135],v[64:67]
 s_add_u32 m0,s61,0
 rt a[228:229],v244 offset:0
 v_exp_f32 v9,v9
 mf v[64:67],a[136:139],v[136:139],v[64:67]
 s_mov_b32 s63,196608
 rq a[144:147],v208 offset:20480
 mf v[64:67],a[140:143],v[140:143],v[64:67]
 bl v220,s[8:11],s63 offen offset:0 lds
 rt a[230:231],v244 offset:2048
 mf v[80:83],a[140:143],v[156:159],v[196:199]
 rq a[148:151],v209 offset:20480
 pk v4,v8,v9
 mf v[80:83],a[136:139],v[152:155],v[80:83]
 rt a[232:233],v244 offset:4096
 v_exp_f32 v10,v10
 mf v[80:83],a[132:135],v[148:151],v[80:83]
 rq a[152:155],v210 offset:20480
 mf v[80:83],a[128:131],v[144:147],v[80:83]
 rt a[234:235],v244 offset:6144
 v_exp_f32 v11,v11
 mf v[96:99],a[128:131],v[160:163],v[200:203]
 rq a[156:159],v211 offset:20480
 pk v5,v10,v11
 mf v[96:99],a[132:135],v[164:167],v[96:99]
 rt a[236:237],v244 offset:8192
 v_exp_f32 v12,v12
 mf v[96:99],a[136:139],v[168:171],v[96:99]
 v_exp_f32 v13,v13
 mf v[96:99],a[140:143],v[172:175],v[96:99]
 rt a[238:239],v244 offset:10240
 pk v6,v12,v13
 mf v[112:115],a[140:143],v[188:191],v[204:207]
 v_exp_f32 v14,v14
 mf v[112:115],a[136:139],v[184:187],v[112:115]
 s_waitcnt lgkmcnt(7)
 mf a[212:215],a[228:231],a[160:163],a[212:215]
 rt a[240:241],v244 offset:12288
 rt a[242:243],v244 offset:14336
 mf v[112:115],a[132:135],v[180:183],v[112:115]
 v_exp_f32 v15,v15
 mf v[112:115],a[128:131],v[176:179],v[112:115]
 s_waitcnt lgkmcnt(4)
 pk v7,v14,v15
 mf v[116:119],a[144:147],v[176:179],v[204:207]
 v_exp_f32 v24,v24
 mf v[116:119],a[148:151],v[180:183],v[116:119]
 v_exp_f32 v25,v25
 mf a[212:215],a[232:235],a[164:167],a[212:215]
 rt a[228:229],v244 offset:16384
 rt a[230:231],v244 offset:18432
 mf v[116:119],a[152:155],v[184:187],v[116:119]
 rq a[128:131],v208 offset:24576
 mf v[116:119],a[156:159],v[188:191],v[116:119]
 s_waitcnt lgkmcnt(5)
 bl v221,s[8:11],s63 offen offset:1024 lds
 mf a[212:215],a[236:239],a[168:171],a[212:215]
 rt a[232:233],v244 offset:20480
 rt a[234:235],v244 offset:22528
 mf v[100:103],a[156:159],v[172:175],v[200:203]
 rq a[132:135],v209 offset:24576
 pk v20,v24,v25
 mf v[100:103],a[152:155],v[168:171],v[100:103]
 v_exp_f32 v26,v26
 mf v[100:103],a[148:151],v[164:167],v[100:103]
 rq a[136:139],v210 offset:24576
 mf v[100:103],a[144:147],v[160:163],v[100:103]
 s_waitcnt vmcnt(14) lgkmcnt(7)
 v_exp_f32 v27,v27
 mf a[212:215],a[240:243],a[172:175],a[212:215]
 rt a[236:237],v244 offset:24576
 rt a[238:239],v244 offset:26624
 mf v[84:87],a[144:147],v[144:147],v[196:199]
 rq a[140:143],v211 offset:24576
 pk v21,v26,v27
 mf v[84:87],a[148:151],v[148:151],v[84:87]
 v_exp_f32 v28,v28
 mf v[84:87],a[152:155],v[152:155],v[84:87]
 v_exp_f32 v29,v29
 mf v[84:87],a[156:159],v[156:159],v[84:87]
 s_waitcnt vmcnt(13) lgkmcnt(8)
 pk v22,v28,v29
 mf a[212:215],a[228:231],a[176:179],a[212:215]
 rt a[240:241],v244 offset:28672
 rt a[242:243],v244 offset:30720
 mf v[68:71],a[156:159],v[140:143],v[192:195]
 v_exp_f32 v30,v30
 mf v[68:71],a[152:155],v[136:139],v[68:71]
 mf v[68:71],a[148:151],v[132:135],v[68:71]
 v_exp_f32 v31,v31
 mf v[68:71],a[144:147],v[128:131],v[68:71]
 s_waitcnt vmcnt(12) lgkmcnt(7)
 pk v23,v30,v31
 mf a[212:215],a[232:235],a[180:183],a[212:215]
 s_waitcnt lgkmcnt(2)
 rt a[228:229],v245 offset:0
 rt a[230:231],v245 offset:2048
 mf v[72:75],a[128:131],v[128:131],v[192:195]
 v_exp_f32 v40,v40
 mf v[72:75],a[132:135],v[132:135],v[72:75]
 s_waitcnt vmcnt(10)
 v_exp_f32 v41,v41
 mf a[212:215],a[236:239],a[184:187],a[212:215]
 rt a[232:233],v245 offset:4096
 rt a[234:235],v245 offset:6144
 mf v[72:75],a[136:139],v[136:139],v[72:75]
 rq a[144:147],v208 offset:28672
 mf v[72:75],a[140:143],v[140:143],v[72:75]
 bl v222,s[8:11],s63 offen offset:2048 lds
 mf v[88:91],a[140:143],v[156:159],v[196:199]
 rq a[148:151],v209 offset:28672
 pk v36,v40,v41
 mf v[88:91],a[136:139],v[152:155],v[88:91]
 s_waitcnt vmcnt(9) lgkmcnt(6)
 v_exp_f32 v42,v42
 mf a[212:215],a[240:243],a[188:191],a[212:215]
 rt a[236:237],v245 offset:8192
 rt a[238:239],v245 offset:10240
 mf v[88:91],a[132:135],v[148:151],v[88:91]
 rq a[152:155],v210 offset:28672
 mf v[88:91],a[128:131],v[144:147],v[88:91]
 v_exp_f32 v43,v43
 mf v[104:107],a[128:131],v[160:163],v[200:203]
 rq a[156:159],v211 offset:28672
 pk v37,v42,v43
 mf v[104:107],a[132:135],v[164:167],v[104:107]
 s_waitcnt lgkmcnt(8)
 v_exp_f32 v44,v44
 mf a[216:219],a[228:231],a[160:163],a[216:219]
 rt a[240:241],v245 offset:12288
 rt a[242:243],v245 offset:14336
 mf v[104:107],a[136:139],v[168:171],v[104:107]
 v_exp_f32 v45,v45
 mf v[104:107],a[140:143],v[172:175],v[104:107]
 pk v38,v44,v45
 mf v[120:123],a[140:143],v[188:191],v[204:207]
 v_exp_f32 v46,v46
 mf v[120:123],a[136:139],v[184:187],v[120:123]
 s_waitcnt lgkmcnt(8)
 mf a[216:219],a[232:235],a[164:167],a[216:219]
 rt a[228:229],v245 offset:16384
 rt a[230:231],v245 offset:18432
 mf v[120:123],a[132:135],v[180:183],v[120:123]
 v_exp_f32 v47,v47
 mf v[120:123],a[128:131],v[176:179],v[120:123]
 s_waitcnt lgkmcnt(6)
 rt a[130:131],v212 offset:4096
 pk v39,v46,v47
 mf a[216:219],a[236:239],a[168:171],a[216:219]
 s_waitcnt lgkmcnt(5)
 rt a[232:233],v245 offset:20480
 rt a[234:235],v245 offset:22528
 mf v[124:127],a[144:147],v[176:179],v[204:207]
 v_exp_f32 v56,v56
 mf v[124:127],a[148:151],v[180:183],v[124:127]
 v_exp_f32 v57,v57
 mf v[124:127],a[152:155],v[184:187],v[124:127]
 rt a[128:129],v212 offset:0
 rt a[132:133],v212 offset:8192
 mf v[124:127],a[156:159],v[188:191],v[124:127]
 s_waitcnt lgkmcnt(7)
 bl v223,s[8:11],s63 offen offset:3072 lds
 mf a[216:219],a[240:243],a[172:175],a[216:219]
 rt a[236:237],v245 offset:24576
 rt a[238:239],v245 offset:26624
 mf v[108:111],a[156:159],v[172:175],v[200:203]
 rt a[134:135],v212 offset:12288
 pk v52,v56,v57
 mf v[108:111],a[152:155],v[168:171],v[108:111]
 v_exp_f32 v58,v58
 mf v[108:111],a[148:151],v[164:167],v[108:111]
 rt a[136:137],v213 offset:0
 mf v[108:111],a[144:147],v[160:163],v[108:111]
 s_waitcnt lgkmcnt(9)
 v_exp_f32 v59,v59
 mf a[216:219],a[228:231],a[176:179],a[216:219]
 rt a[240:241],v245 offset:28672
 rt a[242:243],v245 offset:30720
 mf v[92:95],a[144:147],v[144:147],v[196:199]
 rt a[138:139],v213 offset:4096
 pk v53,v58,v59
 mf v[92:95],a[148:151],v[148:151],v[92:95]
 v_exp_f32 v60,v60
 mf v[92:95],a[152:155],v[152:155],v[92:95]
 v_exp_f32 v61,v61
 mf v[92:95],a[156:159],v[156:159],v[92:95]
 s_waitcnt lgkmcnt(9)
 rt a[140:141],v213 offset:8192
 pk v54,v60,v61
 mf a[216:219],a[232:235],a[180:183],a[216:219]
 rt a[228:229],v246 offset:0
 rt a[230:231],v246 offset:2048
 mf v[76:79],a[156:159],v[140:143],v[192:195]
 v_exp_f32 v62,v62
 mf v[76:79],a[152:155],v[136:139],v[76:79]
 s_waitcnt lgkmcnt(8)
 rt a[142:143],v213 offset:12288
 mf a[216:219],a[236:239],a[184:187],a[216:219]
 rt a[232:233],v246 offset:4096
 rt a[234:235],v246 offset:6144
 mf v[76:79],a[148:151],v[132:135],v[76:79]
 v_exp_f32 v63,v63
 mf v[76:79],a[144:147],v[128:131],v[76:79]
 s_waitcnt lgkmcnt(10)
 rt a[148:149],v214 offset:8192
 pk v55,v62,v63
 mf a[0:3],v[0:3],a[128:131],a[0:3]
 v_exp_f32 v64,v64
 mf a[0:3],v[4:7],a[132:135],a[0:3]
 s_waitcnt lgkmcnt(8)
 v_exp_f32 v65,v65
 mf a[216:219],a[240:243],a[188:191],a[216:219]
 rt a[236:237],v246 offset:8192
 rt a[238:239],v246 offset:10240
 mf a[4:7],v[20:23],a[132:135],a[4:7]
 rt a[150:151],v214 offset:12288
 pk v64,v64,v65
 mf a[4:7],v[16:19],a[128:131],a[4:7]
 v_exp_f32 v66,v66
 mf a[8:11],v[32:35],a[128:131],a[8:11]
 rt a[146:147],v214 offset:4096
 rt a[152:153],v215 offset:0
 mf a[8:11],v[36:39],a[132:135],a[8:11]
 s_waitcnt lgkmcnt(9)
 v_exp_f32 v67,v67
 mf a[220:223],a[228:231],a[160:163],a[220:223]
 rt a[240:241],v246 offset:12288
 rt a[242:243],v246 offset:14336
 mf a[12:15],v[52:55],a[132:135],a[12:15]
 rt a[154:155],v215 offset:4096
 pk v65,v66,v67
 mf a[12:15],v[48:51],a[128:131],a[12:15]
 s_waitcnt lgkmcnt(11)
 v_exp_f32 v68,v68
 mf a[28:31],v[48:51],a[136:139],a[28:31]
 v_exp_f32 v69,v69
 mf a[28:31],v[52:55],a[140:143],a[28:31]
 s_waitcnt lgkmcnt(9)
 s_add_u32 m0,s61,114688
 rt a[156:157],v215 offset:8192
 pk v66,v68,v69
 mf a[220:223],a[232:235],a[164:167],a[220:223]
 rt a[228:229],v246 offset:16384
 rt a[230:231],v246 offset:18432
 mf a[24:27],v[36:39],a[140:143],a[24:27]
 s_mov_b32 s63,180224
 rt a[144:145],v214 offset:0
 rt a[158:159],v215 offset:12288
 mf a[24:27],v[32:35],a[136:139],a[24:27]
 s_waitcnt lgkmcnt(11)
 bl v224,s[12:15],s63 offen offset:0 lds
 mf a[220:223],a[236:239],a[168:171],a[220:223]
 rt a[232:233],v246 offset:20480
 rt a[234:235],v246 offset:22528
 mf a[20:23],v[16:19],a[136:139],a[20:23]
 v_exp_f32 v70,v70
 mf a[20:23],v[20:23],a[140:143],a[20:23]
 rt a[128:129],v216 offset:0
 mf a[16:19],v[4:7],a[140:143],a[16:19]
 v_exp_f32 v71,v71
 mf a[16:19],v[0:3],a[136:139],a[16:19]
 s_waitcnt lgkmcnt(9)
 rt a[130:131],v216 offset:4096
 pk v67,v70,v71
 mf a[220:223],a[240:243],a[172:175],a[220:223]
 s_waitcnt lgkmcnt(5)
 rt a[236:237],v246 offset:24576
 rt a[238:239],v246 offset:26624
 mf a[32:35],v[0:3],a[144:147],a[32:35]
 v_exp_f32 v80,v80
 mf a[32:35],v[4:7],a[148:151],a[32:35]
 rt a[132:133],v216 offset:8192
 mf a[36:39],v[20:23],a[148:151],a[36:39]
 v_exp_f32 v81,v81
 mf a[36:39],v[16:19],a[144:147],a[36:39]
 v_exp_f32 v82,v82
 mf a[220:223],a[228:231],a[176:179],a[220:223]
 rt a[240:241],v246 offset:28672
 rt a[242:243],v246 offset:30720
 mf a[40:43],v[32:35],a[144:147],a[40:43]
 rt a[134:135],v216 offset:12288
 pk v80,v80,v81
 mf a[40:43],v[36:39],a[148:151],a[40:43]
 v_exp_f32 v83,v83
 mf a[44:47],v[52:55],a[148:151],a[44:47]
 rt a[136:137],v217 offset:0
 pk v81,v82,v83
 mf a[44:47],v[48:51],a[144:147],a[44:47]
 s_waitcnt lgkmcnt(9)
 v_exp_f32 v84,v84
 mf a[220:223],a[232:235],a[180:183],a[220:223]
 rt a[228:229],v247 offset:0
 rt a[230:231],v247 offset:2048
 mf a[60:63],v[48:51],a[152:155],a[60:63]
 rt a[138:139],v217 offset:4096
 mf a[60:63],v[52:55],a[156:159],a[60:63]
 s_waitcnt lgkmcnt(8)
 v_exp_f32 v85,v85
 mf a[220:223],a[236:239],a[184:187],a[220:223]
 rt a[232:233],v247 offset:4096
 rt a[234:235],v247 offset:6144
 mf a[56:59],v[36:39],a[156:159],a[56:59]
 rt a[140:141],v217 offset:8192
 mf a[56:59],v[32:35],a[152:155],a[56:59]
 bl v225,s[12:15],s63 offen offset:1024 lds
 mf a[52:55],v[16:19],a[152:155],a[52:55]
 v_exp_f32 v86,v86
 mf a[52:55],v[20:23],a[156:159],a[52:55]
 s_waitcnt lgkmcnt(8)
 rt a[142:143],v217 offset:12288
 pk v82,v84,v85
 mf a[220:223],a[240:243],a[188:191],a[220:223]
 rt a[236:237],v247 offset:8192
 rt a[238:239],v247 offset:10240
 mf a[48:51],v[4:7],a[156:159],a[48:51]
 v_exp_f32 v87,v87
 mf a[48:51],v[0:3],a[152:155],a[48:51]
 s_waitcnt lgkmcnt(10)
 rt a[144:145],v218 offset:0
 pk v83,v86,v87
 mf a[64:67],v[0:3],a[128:131],a[64:67]
 v_exp_f32 v96,v96
 mf a[64:67],v[4:7],a[132:135],a[64:67]
 s_waitcnt lgkmcnt(8)
 rt a[146:147],v218 offset:4096
 mf a[224:227],a[228:231],a[160:163],a[224:227]
 rt a[240:241],v247 offset:12288
 rt a[242:243],v247 offset:14336
 mf a[68:71],v[20:23],a[132:135],a[68:71]
 v_exp_f32 v97,v97
 mf a[68:71],v[16:19],a[128:131],a[68:71]
 rt a[148:149],v218 offset:8192
 pk v96,v96,v97
 mf a[72:75],v[32:35],a[128:131],a[72:75]
 v_exp_f32 v98,v98
 mf a[72:75],v[36:39],a[132:135],a[72:75]
 s_waitcnt lgkmcnt(9)
 v_exp_f32 v99,v99
 mf a[224:227],a[232:235],a[164:167],a[224:227]
 rt a[228:229],v247 offset:16384
 rt a[230:231],v247 offset:18432
 mf a[76:79],v[52:55],a[132:135],a[76:79]
 rt a[150:151],v218 offset:12288
 pk v97,v98,v99
 mf a[76:79],v[48:51],a[128:131],a[76:79]
 s_waitcnt lgkmcnt(8)
 v_exp_f32 v100,v100
 mf a[224:227],a[236:239],a[168:171],a[224:227]
 rt a[232:233],v247 offset:20480
 rt a[234:235],v247 offset:22528
 mf a[92:95],v[48:51],a[136:139],a[92:95]
 rt a[152:153],v219 offset:0
 mf a[92:95],v[52:55],a[140:143],a[92:95]
 v_exp_f32 v101,v101
 mf a[88:91],v[36:39],a[140:143],a[88:91]
 rt a[154:155],v219 offset:4096
 mf a[88:91],v[32:35],a[136:139],a[88:91]
 s_waitcnt lgkmcnt(8)
 bl v224,s[12:15],s63 offen offset:2048 lds
 mf a[224:227],a[240:243],a[172:175],a[224:227]
 rt a[236:237],v247 offset:24576
 rt a[238:239],v247 offset:26624
 mf a[84:87],v[16:19],a[136:139],a[84:87]
 rt a[156:157],v219 offset:8192
 pk v98,v100,v101
 mf a[84:87],v[20:23],a[140:143],a[84:87]
 v_exp_f32 v102,v102
 mf a[80:83],v[4:7],a[140:143],a[80:83]
 v_exp_f32 v103,v103
 mf a[80:83],v[0:3],a[136:139],a[80:83]
 s_waitcnt lgkmcnt(8)
 rt a[158:159],v219 offset:12288
 pk v99,v102,v103
 mf a[224:227],a[228:231],a[176:179],a[224:227]
 s_waitcnt lgkmcnt(8)
 rt a[240:241],v247 offset:28672
 rt a[242:243],v247 offset:30720
 mf a[96:99],v[0:3],a[144:147],a[96:99]
 v_exp_f32 v112,v112
 mf a[96:99],v[4:7],a[148:151],a[96:99]
 mf a[100:103],v[20:23],a[148:151],a[100:103]
 v_exp_f32 v113,v113
 mf a[100:103],v[16:19],a[144:147],a[100:103]
 s_waitcnt lgkmcnt(8)
 pk v112,v112,v113
 mf a[224:227],a[232:235],a[180:183],a[224:227]
 mf a[104:107],v[32:35],a[144:147],a[104:107]
 v_exp_f32 v114,v114
 mf a[104:107],v[36:39],a[148:151],a[104:107]
 s_waitcnt lgkmcnt(4)
 rq a[128:131],v208 offset:32768
 mf a[224:227],a[236:239],a[184:187],a[224:227]
 mf a[108:111],v[52:55],a[148:151],a[108:111]
 v_exp_f32 v115,v115
 mf a[108:111],v[48:51],a[144:147],a[108:111]
 s_waitcnt lgkmcnt(3)
 v_exp_f32 v116,v116
 mf a[124:127],v[48:51],a[152:155],a[124:127]
 rq a[132:135],v209 offset:32768
 pk v113,v114,v115
 mf a[124:127],v[52:55],a[156:159],a[124:127]
 s_waitcnt lgkmcnt(2)
 v_exp_f32 v117,v117
 mf a[224:227],a[240:243],a[188:191],a[224:227]
L_pad_pg10:
 s_cbranch_execz L_hop2
 mf a[120:123],v[36:39],a[156:159],a[120:123]
 rq a[136:139],v210 offset:32768
 mf a[120:123],v[32:35],a[152:155],a[120:123]
 bl v225,s[12:15],s63 offen offset:3072 lds
 mf a[116:119],v[16:19],a[152:155],a[116:119]
 rq a[140:143],v211 offset:32768
 pk v114,v116,v117
 mf a[116:119],v[20:23],a[156:159],a[116:119]
 v_exp_f32 v118,v118
 mf a[112:115],v[4:7],a[156:159],a[112:115]
 mf a[112:115],v[0:3],a[152:155],a[112:115]
 v_exp_f32 v119,v119
 v_smfmac_f32_16x16x64_bf16 a[192:195],a[208:211],v[0:7],v250
 pk v115,v118,v119
 v_smfmac_f32_16x16x64_bf16 a[196:199],a[208:211],v[16:23],v250
 s_waitcnt vmcnt(12)
 v_accvgpr_read_b32 v226,a212
 v_smfmac_f32_16x16x64_bf16 a[200:203],a[208:211],v[32:39],v250
 s_barrier
 v_accvgpr_read_b32 v227,a213
 v_smfmac_f32_16x16x64_bf16 a[204:207],a[208:211],v[48:55],v250
 s_waitcnt lgkmcnt(0)
 v_accvgpr_read_b32 v228,a214
 mf v[0:3],a[128:131],v[128:131],v[192:195]
 v_exp_f32 v72,v72
 mf v[0:3],a[132:135],v[132:135],v[0:3]
 s_add_u32 m0,s61,16384
 v_exp_f32 v73,v73
 v_accvgpr_read_b32 v229,a215
 mf v[0:3],a[136:139],v[136:139],v[0:3]
 s_mov_b32 s63,212992
 rq a[144:147],v208 offset:36864
 mf v[0:3],a[140:143],v[140:143],v[0:3]
 bl v220,s[8:11],s63 offen offset:0 lds
 mf v[16:19],a[140:143],v[156:159],v[196:199]
 rq a[148:151],v209 offset:36864
 pk v68,v72,v73
 mf v[16:19],a[136:139],v[152:155],v[16:19]
 v_exp_f32 v74,v74
 v_accvgpr_read_b32 v230,a216
 mf v[16:19],a[132:135],v[148:151],v[16:19]
 rq a[152:155],v210 offset:36864
 v_accvgpr_read_b32 v231,a217
 mf v[16:19],a[128:131],v[144:147],v[16:19]
 v_exp_f32 v75,v75
 mf v[32:35],a[128:131],v[160:163],v[200:203]
 rq a[156:159],v211 offset:36864
 pk v69,v74,v75
 mf v[32:35],a[132:135],v[164:167],v[32:35]
 v_exp_f32 v76,v76
 v_accvgpr_read_b32 v232,a218
 mf v[32:35],a[136:139],v[168:171],v[32:35]
 v_exp_f32 v77,v77
 mf v[32:35],a[140:143],v[172:175],v[32:35]
 pk v70,v76,v77
 v_accvgpr_read_b32 v233,a219
 mf v[48:51],a[140:143],v[188:191],v[204:207]
 v_exp_f32 v78,v78
 mf v[48:51],a[136:139],v[184:187],v[48:51]
 v_accvgpr_read_b32 v234,a220
 v_accvgpr_read_b32 v235,a221
 v_accvgpr_read_b32 v236,a222
 mf v[48:51],a[132:135],v[180:183],v[48:51]
 v_exp_f32 v79,v79
 mf v[48:51],a[128:131],v[176:179],v[48:51]
 s_waitcnt lgkmcnt(0)
 pk v71,v78,v79
 v_accvgpr_read_b32 v237,a223
 mf v[52:55],a[144:147],v[176:179],v[204:207]
 v_exp_f32 v88,v88
 mf v[52:55],a[148:151],v[180:183],v[52:55]
 v_exp_f32 v89,v89
 v_accvgpr_read_b32 v238,a224
 mf v[52:55],a[152:155],v[184:187],v[52:55]
 rq a[128:131],v208 offset:40960
 mf v[52:55],a[156:159],v[188:191],v[52:55]
 bl v221,s[8:11],s63 offen offset:1024 lds
 mf v[36:39],a[156:159],v[172:175],v[200:203]
 rq a[132:135],v209 offset:40960
 pk v84,v88,v89
 mf v[36:39],a[152:155],v[168:171],v[36:39]
 v_exp_f32 v90,v90
 v_accvgpr_read_b32 v239,a225
 mf v[36:39],a[148:151],v[164:167],v[36:39]
 rq a[136:139],v210 offset:40960
 v_accvgpr_read_b32 v240,a226
 mf v[36:39],a[144:147],v[160:163],v[36:39]
 v_exp_f32 v91,v91
 mf v[20:23],a[144:147],v[144:147],v[196:199]
 rq a[140:143],v211 offset:40960
 pk v85,v90,v91
 mf v[20:23],a[148:151],v[148:151],v[20:23]
 v_exp_f32 v92,v92
 v_accvgpr_read_b32 v241,a227
 mf v[20:23],a[152:155],v[152:155],v[20:23]
 v_exp_f32 v93,v93
 mf v[20:23],a[156:159],v[156:159],v[20:23]
 pk v86,v92,v93
 v_add_f32 v252,v226,v227
 mf v[4:7],a[156:159],v[140:143],v[192:195]
 v_exp_f32 v94,v94
 mf v[4:7],a[152:155],v[136:139],v[4:7]
 v_mul_f32 v253,v226,v226
 v_fmac_f32 v253,v227,v227
 v_fmac_f32 v253,v228,v228
 mf v[4:7],a[148:151],v[132:135],v[4:7]
 v_exp_f32 v95,v95
 mf v[4:7],a[144:147],v[128:131],v[4:7]
 s_waitcnt lgkmcnt(0)
 pk v87,v94,v95
 v_add_f32 v252,v252,v228
 mf v[8:11],a[128:131],v[128:131],v[192:195]
 v_exp_f32 v104,v104
 mf v[8:11],a[132:135],v[132:135],v[8:11]
 v_exp_f32 v105,v105
 v_fmac_f32 v253,v229,v229
 mf v[8:11],a[136:139],v[136:139],v[8:11]
 rq a[144:147],v208 offset:45056
 mf v[8:11],a[140:143],v[140:143],v[8:11]
 bl v222,s[8:11],s63 offen offset:2048 lds
 mf v[24:27],a[140:143],v[156:159],v[196:199]
 rq a[148:151],v209 offset:45056
 pk v100,v104,v105
 mf v[24:27],a[136:139],v[152:155],v[24:27]
 v_exp_f32 v106,v106
 v_add_f32 v252,v252,v229
 mf v[24:27],a[132:135],v[148:151],v[24:27]
 rq a[152:155],v210 offset:45056
 v_fmac_f32 v253,v230,v230
 mf v[24:27],a[128:131],v[144:147],v[24:27]
 v_exp_f32 v107,v107
 mf v[40:43],a[128:131],v[160:163],v[200:203]
 rq a[156:159],v211 offset:45056
 pk v101,v106,v107
 mf v[40:43],a[132:135],v[164:167],v[40:43]
 v_exp_f32 v108,v108
 v_add_f32 v252,v252,v230
 mf v[40:43],a[136:139],v[168:171],v[40:43]
 v_exp_f32 v109,v109
 mf v[40:43],a[140:143],v[172:175],v[40:43]
 pk v102,v108,v109
 v_fmac_f32 v253,v231,v231
 mf v[56:59],a[140:143],v[188:191],v[204:207]
 v_exp_f32 v110,v110
 mf v[56:59],a[136:139],v[184:187],v[56:59]
 v_add_f32 v252,v252,v231
 v_fmac_f32 v253,v232,v232
 v_add_f32 v252,v252,v232
 mf v[56:59],a[132:135],v[180:183],v[56:59]
 v_exp_f32 v111,v111
 mf v[56:59],a[128:131],v[176:179],v[56:59]
 s_waitcnt lgkmcnt(0)
 rt a[130:131],v212 offset:20480
 pk v103,v110,v111
 mf v[60:63],a[144:147],v[176:179],v[204:207]
 v_exp_f32 v120,v120
 mf v[60:63],a[148:151],v[180:183],v[60:63]
 v_exp_f32 v121,v121
 v_fmac_f32 v253,v233,v233
 mf v[60:63],a[152:155],v[184:187],v[60:63]
 rt a[128:129],v212 offset:16384
 rt a[132:133],v212 offset:24576
 mf v[60:63],a[156:159],v[188:191],v[60:63]
 bl v223,s[8:11],s63 offen offset:3072 lds
 mf v[44:47],a[156:159],v[172:175],v[200:203]
 rt a[134:135],v212 offset:28672
 pk v116,v120,v121
 mf v[44:47],a[152:155],v[168:171],v[44:47]
 v_exp_f32 v122,v122
 v_add_f32 v252,v252,v233
 mf v[44:47],a[148:151],v[164:167],v[44:47]
 rt a[136:137],v213 offset:16384
 v_fmac_f32 v253,v234,v234
 mf v[44:47],a[144:147],v[160:163],v[44:47]
 v_exp_f32 v123,v123
 mf v[28:31],a[144:147],v[144:147],v[196:199]
 rt a[138:139],v213 offset:20480
 pk v117,v122,v123
 mf v[28:31],a[148:151],v[148:151],v[28:31]
 v_exp_f32 v124,v124
 v_add_f32 v252,v252,v234
 mf v[28:31],a[152:155],v[152:155],v[28:31]
 v_exp_f32 v125,v125
 mf v[28:31],a[156:159],v[156:159],v[28:31]
 rt a[140:141],v213 offset:24576
 pk v118,v124,v125
 mf v[12:15],a[156:159],v[140:143],v[192:195]
 v_exp_f32 v126,v126
 mf v[12:15],a[152:155],v[136:139],v[12:15]
 rt a[142:143],v213 offset:28672
 v_fmac_f32 v253,v235,v235
 v_add_f32 v252,v252,v235
 mf v[12:15],a[148:151],v[132:135],v[12:15]
 v_exp_f32 v127,v127
 mf v[12:15],a[144:147],v[128:131],v[12:15]
 s_waitcnt lgkmcnt(4)
 rt a[148:149],v214 offset:24576
 pk v119,v126,v127
 mf a[0:3],v[64:67],a[128:131],a[0:3]
 v_exp_f32 v0,v0
 mf a[0:3],v[68:71],a[132:135],a[0:3]
 v_exp_f32 v1,v1
 v_fmac_f32 v253,v236,v236
 mf a[4:7],v[84:87],a[132:135],a[4:7]
 rt a[150:151],v214 offset:28672
 pk v0,v0,v1
 mf a[4:7],v[80:83],a[128:131],a[4:7]
 v_exp_f32 v2,v2
 mf a[8:11],v[96:99],a[128:131],a[8:11]
 rt a[146:147],v214 offset:20480
 rt a[152:153],v215 offset:16384
 mf a[8:11],v[100:103],a[132:135],a[8:11]
 v_exp_f32 v3,v3
 v_add_f32 v252,v252,v236
 mf a[12:15],v[116:119],a[132:135],a[12:15]
 rt a[154:155],v215 offset:20480
 pk v1,v2,v3
 mf a[12:15],v[112:115],a[128:131],a[12:15]
 s_waitcnt lgkmcnt(5)
 v_exp_f32 v4,v4
 mf a[28:31],v[112:115],a[136:139],a[28:31]
 v_exp_f32 v5,v5
 mf a[28:31],v[116:119],a[140:143],a[28:31]
 s_add_u32 m0,s61,65536
 rt a[156:157],v215 offset:24576
 pk v2,v4,v5
 v_fmac_f32 v253,v237,v237
 mf a[24:27],v[100:103],a[140:143],a[24:27]
 s_mov_b32 s63,196608
 rt a[144:145],v214 offset:16384
 rt a[158:159],v215 offset:28672
 mf a[24:27],v[96:99],a[136:139],a[24:27]
 bl v224,s[12:15],s63 offen offset:0 lds
 mf a[20:23],v[80:83],a[136:139],a[20:23]
 v_exp_f32 v6,v6
 mf a[20:23],v[84:87],a[140:143],a[20:23]
 rt a[128:129],v216 offset:16384
 v_add_f32 v252,v252,v237
 v_fmac_f32 v253,v238,v238
 mf a[16:19],v[68:71],a[140:143],a[16:19]
 v_exp_f32 v7,v7
 mf a[16:19],v[64:67],a[136:139],a[16:19]
 s_waitcnt lgkmcnt(2)
 rt a[130:131],v216 offset:20480
 pk v3,v6,v7
 mf a[32:35],v[64:67],a[144:147],a[32:35]
 v_exp_f32 v16,v16
 mf a[32:35],v[68:71],a[148:151],a[32:35]
 rt a[132:133],v216 offset:24576
 v_add_f32 v252,v252,v238
 v_fmac_f32 v253,v239,v239
 mf a[36:39],v[84:87],a[148:151],a[36:39]
 v_exp_f32 v17,v17
 mf a[36:39],v[80:83],a[144:147],a[36:39]
 v_exp_f32 v18,v18
 mf a[40:43],v[96:99],a[144:147],a[40:43]
 rt a[134:135],v216 offset:28672
 pk v16,v16,v17
 mf a[40:43],v[100:103],a[148:151],a[40:43]
 v_exp_f32 v19,v19
 v_add_f32 v252,v252,v239
 mf a[44:47],v[116:119],a[148:151],a[44:47]
 rt a[136:137],v217 offset:16384
 pk v17,v18,v19
 mf a[44:47],v[112:115],a[144:147],a[44:47]
 s_waitcnt lgkmcnt(5)
 v_exp_f32 v20,v20
 mf a[60:63],v[112:115],a[152:155],a[60:63]
 rt a[138:139],v217 offset:20480
 v_fmac_f32 v253,v240,v240
 mf a[60:63],v[116:119],a[156:159],a[60:63]
 v_exp_f32 v21,v21
 v_add_f32 v252,v252,v240
 mf a[56:59],v[100:103],a[156:159],a[56:59]
 rt a[140:141],v217 offset:24576
 mf a[56:59],v[96:99],a[152:155],a[56:59]
 bl v225,s[12:15],s63 offen offset:1024 lds
 mf a[52:55],v[80:83],a[152:155],a[52:55]
 v_exp_f32 v22,v22
 mf a[52:55],v[84:87],a[156:159],a[52:55]
 rt a[142:143],v217 offset:28672
 pk v18,v20,v21
 v_fmac_f32 v253,v241,v241
 mf a[48:51],v[68:71],a[156:159],a[48:51]
 v_exp_f32 v23,v23
 mf a[48:51],v[64:67],a[152:155],a[48:51]
 s_waitcnt lgkmcnt(4)
 rt a[144:145],v218 offset:16384
 pk v19,v22,v23
 mf a[64:67],v[64:67],a[128:131],a[64:67]
 v_exp_f32 v32,v32
 mf a[64:67],v[68:71],a[132:135],a[64:67]
 rt a[146:147],v218 offset:20480
 v_add_f32 v252,v252,v241
 v_mov_b32 v226,v252
 mf a[68:71],v[84:87],a[132:135],a[68:71]
 v_exp_f32 v33,v33
 mf a[68:71],v[80:83],a[128:131],a[68:71]
 rt a[148:149],v218 offset:24576
 pk v32,v32,v33
 mf a[72:75],v[96:99],a[128:131],a[72:75]
 v_exp_f32 v34,v34
 mf a[72:75],v[100:103],a[132:135],a[72:75]
 v_exp_f32 v35,v35
 v_mov_b32 v227,v253
 mf a[76:79],v[116:119],a[132:135],a[76:79]
 rt a[150:151],v218 offset:28672
 pk v33,v34,v35
 mf a[76:79],v[112:115],a[128:131],a[76:79]
 s_waitcnt lgkmcnt(4)
 v_exp_f32 v36,v36
 mf a[92:95],v[112:115],a[136:139],a[92:95]
 rt a[152:153],v219 offset:16384
 v_permlane32_swap_b32 v252,v226
 mf a[92:95],v[116:119],a[140:143],a[92:95]
 v_exp_f32 v37,v37
 v_permlane32_swap_b32 v253,v227
 mf a[88:91],v[100:103],a[140:143],a[88:91]
 rt a[154:155],v219 offset:20480
 mf a[88:91],v[96:99],a[136:139],a[88:91]
 bl v224,s[12:15],s63 offen offset:2048 lds
 mf a[84:87],v[80:83],a[136:139],a[84:87]
 rt a[156:157],v219 offset:24576
 pk v34,v36,v37
 mf a[84:87],v[84:87],a[140:143],a[84:87]
 v_exp_f32 v38,v38
 v_add_f32 v252,v252,v226
 mf a[80:83],v[68:71],a[140:143],a[80:83]
 v_exp_f32 v39,v39
 mf a[80:83],v[64:67],a[136:139],a[80:83]
 s_waitcnt lgkmcnt(3)
 rt a[158:159],v219 offset:28672
 pk v35,v38,v39
 mf a[96:99],v[64:67],a[144:147],a[96:99]
 v_exp_f32 v48,v48
 mf a[96:99],v[68:71],a[148:151],a[96:99]
 v_add_f32 v253,v253,v227
 v_mov_b32 v226,v252
 v_mov_b32 v227,v253
 mf a[100:103],v[84:87],a[148:151],a[100:103]
 v_exp_f32 v49,v49
 mf a[100:103],v[80:83],a[144:147],a[100:103]
 pk v48,v48,v49
 v_permlane16_swap_b32 v252,v226
 mf a[104:107],v[96:99],a[144:147],a[104:107]
 v_exp_f32 v50,v50
 mf a[104:107],v[100:103],a[148:151],a[104:107]
 rq a[128:131],v208 offset:49152
 v_permlane16_swap_b32 v253,v227
 v_add_f32 v252,v252,v226
 mf a[108:111],v[116:119],a[148:151],a[108:111]
 v_exp_f32 v51,v51
 mf a[108:111],v[112:115],a[144:147],a[108:111]
 s_waitcnt lgkmcnt(1)
 v_exp_f32 v52,v52
 mf a[124:127],v[112:115],a[152:155],a[124:127]
 rq a[132:135],v209 offset:49152
 pk v49,v50,v51
 mf a[124:127],v[116:119],a[156:159],a[124:127]
 v_exp_f32 v53,v53
 v_add_f32 v253,v253,v227
 mf a[120:123],v[100:103],a[156:159],a[120:123]
 rq a[136:139],v210 offset:49152
 mf a[120:123],v[96:99],a[152:155],a[120:123]
 bl v225,s[12:15],s63 offen offset:3072 lds
 mf a[116:119],v[80:83],a[152:155],a[116:119]
 rq a[140:143],v211 offset:49152
 pk v50,v52,v53
 mf a[116:119],v[84:87],a[156:159],a[116:119]
 v_exp_f32 v54,v54
 v_lshrrev_b32 v226,1,v255
 mf a[112:115],v[68:71],a[156:159],a[112:115]
 v_min_u32 v252,-2,v252
 v_min_u32 v253,-2,v253
 mf a[112:115],v[64:67],a[152:155],a[112:115]
 v_exp_f32 v55,v55
 v_smfmac_f32_16x16x64_bf16 a[192:195],a[208:211],v[64:71],v250
 pk v51,v54,v55
 v_smfmac_f32_16x16x64_bf16 a[196:199],a[208:211],v[80:87],v250
 s_waitcnt vmcnt(12)
 s_mov_b64 exec,65535
 buffer_store_dwordx2 v[252:253],v226,s[16:19],s73 offen sc1
 s_mov_b64 exec,-1
 v_smfmac_f32_16x16x64_bf16 a[200:203],a[208:211],v[96:103],v250
 s_barrier
 global_load_dword a255,v[248:249],off
 v_smfmac_f32_16x16x64_bf16 a[204:207],a[208:211],v[112:119],v250
 s_waitcnt lgkmcnt(0)
 v_and_b32 v226,0xf0,v255
 mf v[64:67],a[128:131],v[128:131],v[192:195]
 v_exp_f32 v8,v8
 mf v[64:67],a[132:135],v[132:135],v[64:67]
 s_add_u32 m0,s61,32768
 v_exp_f32 v9,v9
 mf v[64:67],a[136:139],v[136:139],v[64:67]
 s_mov_b32 s63,229376
 rq a[144:147],v208 offset:53248
 mf v[64:67],a[140:143],v[140:143],v[64:67]
 bl v220,s[8:11],s63 offen offset:0 lds
 mf v[80:83],a[140:143],v[156:159],v[196:199]
 rq a[148:151],v209 offset:53248
 pk v4,v8,v9
 mf v[80:83],a[136:139],v[152:155],v[80:83]
 v_exp_f32 v10,v10
 mf v[80:83],a[132:135],v[148:151],v[80:83]
 rq a[152:155],v210 offset:53248
 v_lshrrev_b32 v226,1,v226
 mf v[80:83],a[128:131],v[144:147],v[80:83]
 v_exp_f32 v11,v11
 mf v[96:99],a[128:131],v[160:163],v[200:203]
 rq a[156:159],v211 offset:53248
 pk v5,v10,v11
 mf v[96:99],a[132:135],v[164:167],v[96:99]
 v_exp_f32 v12,v12
 mf v[96:99],a[136:139],v[168:171],v[96:99]
 v_exp_f32 v13,v13
 mf v[96:99],a[140:143],v[172:175],v[96:99]
 pk v6,v12,v13
 v_and_b32 v227,0x300,v255
 mf v[112:115],a[140:143],v[188:191],v[204:207]
 v_exp_f32 v14,v14
 mf v[112:115],a[136:139],v[184:187],v[112:115]
 v_add_u32 v242,v226,v227
 mf v[112:115],a[132:135],v[180:183],v[112:115]
 v_exp_f32 v15,v15
 mf v[112:115],a[128:131],v[176:179],v[112:115]
 s_waitcnt lgkmcnt(0)
 pk v7,v14,v15
 mf v[116:119],a[144:147],v[176:179],v[204:207]
 v_exp_f32 v24,v24
 mf v[116:119],a[148:151],v[180:183],v[116:119]
 v_exp_f32 v25,v25
 mf v[116:119],a[152:155],v[184:187],v[116:119]
 rq a[128:131],v208 offset:57344
 mf v[116:119],a[156:159],v[188:191],v[116:119]
 bl v221,s[8:11],s63 offen offset:1024 lds
 mf v[100:103],a[156:159],v[172:175],v[200:203]
 rq a[132:135],v209 offset:57344
 pk v20,v24,v25
 mf v[100:103],a[152:155],v[168:171],v[100:103]
 v_exp_f32 v26,v26
 mf v[100:103],a[148:151],v[164:167],v[100:103]
 rq a[136:139],v210 offset:57344
 mf v[100:103],a[144:147],v[160:163],v[100:103]
 v_exp_f32 v27,v27
 mf v[84:87],a[144:147],v[144:147],v[196:199]
 rq a[140:143],v211 offset:57344
 pk v21,v26,v27
 mf v[84:87],a[148:151],v[148:151],v[84:87]
 v_exp_f32 v28,v28
 mf v[84:87],a[152:155],v[152:155],v[84:87]
 v_exp_f32 v29,v29
 mf v[84:87],a[156:159],v[156:159],v[84:87]
 pk v22,v28,v29
 mf v[68:71],a[156:159],v[140:143],v[192:195]
 v_exp_f32 v30,v30
 mf v[68:71],a[152:155],v[136:139],v[68:71]
 mf v[68:71],a[148:151],v[132:135],v[68:71]
 v_exp_f32 v31,v31
 mf v[68:71],a[144:147],v[128:131],v[68:71]
 s_waitcnt lgkmcnt(0)
 pk v23,v30,v31
 mf v[72:75],a[128:131],v[128:131],v[192:195]
 v_exp_f32 v40,v40
 mf v[72:75],a[132:135],v[132:135],v[72:75]
 v_exp_f32 v41,v41
 mf v[72:75],a[136:139],v[136:139],v[72:75]
 rq a[144:147],v208 offset:61440
 mf v[72:75],a[140:143],v[140:143],v[72:75]
 bl v222,s[8:11],s63 offen offset:2048 lds
 mf v[88:91],a[140:143],v[156:159],v[196:199]
 rq a[148:151],v209 offset:61440
 pk v36,v40,v41
 mf v[88:91],a[136:139],v[152:155],v[88:91]
 v_exp_f32 v42,v42
 mf v[88:91],a[132:135],v[148:151],v[88:91]
 rq a[152:155],v210 offset:61440
 mf v[88:91],a[128:131],v[144:147],v[88:91]
 v_exp_f32 v43,v43
 mf v[104:107],a[128:131],v[160:163],v[200:203]
 rq a[156:159],v211 offset:61440
 pk v37,v42,v43
 mf v[104:107],a[132:135],v[164:167],v[104:107]
 v_exp_f32 v44,v44
 mf v[104:107],a[136:139],v[168:171],v[104:107]
 v_exp_f32 v45,v45
 mf v[104:107],a[140:143],v[172:175],v[104:107]
 pk v38,v44,v45
 mf v[120:123],a[140:143],v[188:191],v[204:207]
 v_exp_f32 v46,v46
 mf v[120:123],a[136:139],v[184:187],v[120:123]
 mf v[120:123],a[132:135],v[180:183],v[120:123]
 v_exp_f32 v47,v47
 mf v[120:123],a[128:131],v[176:179],v[120:123]
 s_waitcnt lgkmcnt(0)
 rt a[130:131],v212 offset:36864
 pk v39,v46,v47
 mf v[124:127],a[144:147],v[176:179],v[204:207]
 v_exp_f32 v56,v56
 mf v[124:127],a[148:151],v[180:183],v[124:127]
 v_exp_f32 v57,v57
 mf v[124:127],a[152:155],v[184:187],v[124:127]
 rt a[128:129],v212 offset:32768
 rt a[132:133],v212 offset:40960
 mf v[124:127],a[156:159],v[188:191],v[124:127]
 bl v223,s[8:11],s63 offen offset:3072 lds
 mf v[108:111],a[156:159],v[172:175],v[200:203]
 rt a[134:135],v212 offset:45056
 pk v52,v56,v57
 mf v[108:111],a[152:155],v[168:171],v[108:111]
 v_exp_f32 v58,v58
 mf v[108:111],a[148:151],v[164:167],v[108:111]
 rt a[136:137],v213 offset:32768
 mf v[108:111],a[144:147],v[160:163],v[108:111]
 v_exp_f32 v59,v59
 mf v[92:95],a[144:147],v[144:147],v[196:199]
 rt a[138:139],v213 offset:36864
 pk v53,v58,v59
 mf v[92:95],a[148:151],v[148:151],v[92:95]
 v_exp_f32 v60,v60
 mf v[92:95],a[152:155],v[152:155],v[92:95]
 v_exp_f32 v61,v61
 mf v[92:95],a[156:159],v[156:159],v[92:95]
 rt a[140:141],v213 offset:40960
 pk v54,v60,v61
 mf v[76:79],a[156:159],v[140:143],v[192:195]
 v_exp_f32 v62,v62
 mf v[76:79],a[152:155],v[136:139],v[76:79]
 rt a[142:143],v213 offset:45056
 mf v[76:79],a[148:151],v[132:135],v[76:79]
 v_exp_f32 v63,v63
 mf v[76:79],a[144:147],v[128:131],v[76:79]
 s_waitcnt lgkmcnt(4)
 rt a[148:149],v214 offset:40960
 pk v55,v62,v63
 mf a[0:3],v[0:3],a[128:131],a[0:3]
 v_exp_f32 v64,v64
 mf a[0:3],v[4:7],a[132:135],a[0:3]
 v_exp_f32 v65,v65
 mf a[4:7],v[20:23],a[132:135],a[4:7]
 rt a[150:151],v214 offset:45056
 pk v64,v64,v65
 mf a[4:7],v[16:19],a[128:131],a[4:7]
 v_exp_f32 v66,v66
 mf a[8:11],v[32:35],a[128:131],a[8:11]
 rt a[146:147],v214 offset:36864
 rt a[152:153],v215 offset:32768
 mf a[8:11],v[36:39],a[132:135],a[8:11]
 v_exp_f32 v67,v67
 mf a[12:15],v[52:55],a[132:135],a[12:15]
 rt a[154:155],v215 offset:36864
 pk v65,v66,v67
 mf a[12:15],v[48:51],a[128:131],a[12:15]
 s_waitcnt lgkmcnt(5)
 v_exp_f32 v68,v68
 mf a[28:31],v[48:51],a[136:139],a[28:31]
 v_exp_f32 v69,v69
 mf a[28:31],v[52:55],a[140:143],a[28:31]
 s_add_u32 m0,s61,81920
 rt a[156:157],v215 offset:40960
 pk v66,v68,v69
 mf a[24:27],v[36:39],a[140:143],a[24:27]
 s_mov_b32 s63,212992
 rt a[144:145],v214 offset:32768
 rt a[158:159],v215 offset:45056
 mf a[24:27],v[32:35],a[136:139],a[24:27]
 bl v224,s[12:15],s63 offen offset:0 lds
 mf a[20:23],v[16:19],a[136:139],a[20:23]
 v_exp_f32 v70,v70
 mf a[20:23],v[20:23],a[140:143],a[20:23]
 rt a[128:129],v216 offset:32768
 mf a[16:19],v[4:7],a[140:143],a[16:19]
 v_exp_f32 v71,v71
 mf a[16:19],v[0:3],a[136:139],a[16:19]
 s_waitcnt lgkmcnt(2)
 rt a[130:131],v216 offset:36864
 pk v67,v70,v71
 mf a[32:35],v[0:3],a[144:147],a[32:35]
 v_exp_f32 v80,v80
 mf a[32:35],v[4:7],a[148:151],a[32:35]
 rt a[132:133],v216 offset:40960
 mf a[36:39],v[20:23],a[148:151],a[36:39]
 v_exp_f32 v81,v81
 mf a[36:39],v[16:19],a[144:147],a[36:39]
 v_exp_f32 v82,v82
 mf a[40:43],v[32:35],a[144:147],a[40:43]
 rt a[134:135],v216 offset:45056
 pk v80,v80,v81
 mf a[40:43],v[36:39],a[148:151],a[40:43]
 v_exp_f32 v83,v83
 mf a[44:47],v[52:55],a[148:151],a[44:47]
 rt a[136:137],v217 offset:32768
 pk v81,v82,v83
 mf a[44:47],v[48:51],a[144:147],a[44:47]
 s_waitcnt lgkmcnt(5)
 v_exp_f32 v84,v84
 mf a[60:63],v[48:51],a[152:155],a[60:63]
 rt a[138:139],v217 offset:36864
 mf a[60:63],v[52:55],a[156:159],a[60:63]
 v_exp_f32 v85,v85
 mf a[56:59],v[36:39],a[156:159],a[56:59]
 rt a[140:141],v217 offset:40960
 mf a[56:59],v[32:35],a[152:155],a[56:59]
L_pad_pg11:
 s_cbranch_execz L_hop2
 bl v225,s[12:15],s63 offen offset:1024 lds
 mf a[52:55],v[16:19],a[152:155],a[52:55]
 v_exp_f32 v86,v86
 mf a[52:55],v[20:23],a[156:159],a[52:55]
 rt a[142:143],v217 offset:45056
 pk v82,v84,v85
 mf a[48:51],v[4:7],a[156:159],a[48:51]
 v_exp_f32 v87,v87
 mf a[48:51],v[0:3],a[152:155],a[48:51]
 s_waitcnt lgkmcnt(4)
 rt a[144:145],v218 offset:32768
 pk v83,v86,v87
 mf a[64:67],v[0:3],a[128:131],a[64:67]
 v_exp_f32 v96,v96
 mf a[64:67],v[4:7],a[132:135],a[64:67]
 rt a[146:147],v218 offset:36864
 mf a[68:71],v[20:23],a[132:135],a[68:71]
 v_exp_f32 v97,v97
 mf a[68:71],v[16:19],a[128:131],a[68:71]
 rt a[148:149],v218 offset:40960
 pk v96,v96,v97
 mf a[72:75],v[32:35],a[128:131],a[72:75]
 v_exp_f32 v98,v98
 mf a[72:75],v[36:39],a[132:135],a[72:75]
 v_exp_f32 v99,v99
 mf a[76:79],v[52:55],a[132:135],a[76:79]
 rt a[150:151],v218 offset:45056
 pk v97,v98,v99
 mf a[76:79],v[48:51],a[128:131],a[76:79]
 s_waitcnt lgkmcnt(4)
 v_exp_f32 v100,v100
 mf a[92:95],v[48:51],a[136:139],a[92:95]
 rt a[152:153],v219 offset:32768
 mf a[92:95],v[52:55],a[140:143],a[92:95]
 v_exp_f32 v101,v101
 mf a[88:91],v[36:39],a[140:143],a[88:91]
 rt a[154:155],v219 offset:36864
 mf a[88:91],v[32:35],a[136:139],a[88:91]
 bl v224,s[12:15],s63 offen offset:2048 lds
 mf a[84:87],v[16:19],a[136:139],a[84:87]
 rt a[156:157],v219 offset:40960
 pk v98,v100,v101
 mf a[84:87],v[20:23],a[140:143],a[84:87]
 v_exp_f32 v102,v102
 mf a[80:83],v[4:7],a[140:143],a[80:83]
 v_exp_f32 v103,v103
 mf a[80:83],v[0:3],a[136:139],a[80:83]
 s_waitcnt lgkmcnt(3)
 rt a[158:159],v219 offset:45056
 pk v99,v102,v103
 mf a[96:99],v[0:3],a[144:147],a[96:99]
 v_exp_f32 v112,v112
 mf a[96:99],v[4:7],a[148:151],a[96:99]
 mf a[100:103],v[20:23],a[148:151],a[100:103]
 v_exp_f32 v113,v113
 mf a[100:103],v[16:19],a[144:147],a[100:103]
 pk v112,v112,v113
 mf a[104:107],v[32:35],a[144:147],a[104:107]
 v_exp_f32 v114,v114
 mf a[104:107],v[36:39],a[148:151],a[104:107]
 rq a[128:131],v208 offset:0
 mf a[108:111],v[52:55],a[148:151],a[108:111]
 v_exp_f32 v115,v115
 mf a[108:111],v[48:51],a[144:147],a[108:111]
 s_waitcnt lgkmcnt(1)
 v_exp_f32 v116,v116
 mf a[124:127],v[48:51],a[152:155],a[124:127]
 rq a[132:135],v209 offset:0
 pk v113,v114,v115
 mf a[124:127],v[52:55],a[156:159],a[124:127]
 v_exp_f32 v117,v117
 mf a[120:123],v[36:39],a[156:159],a[120:123]
 rq a[136:139],v210 offset:0
 mf a[120:123],v[32:35],a[152:155],a[120:123]
 bl v225,s[12:15],s63 offen offset:3072 lds
 mf a[116:119],v[16:19],a[152:155],a[116:119]
 rq a[140:143],v211 offset:0
 pk v114,v116,v117
 mf a[116:119],v[20:23],a[156:159],a[116:119]
 v_exp_f32 v118,v118
 mf a[112:115],v[4:7],a[156:159],a[112:115]
 mf a[112:115],v[0:3],a[152:155],a[112:115]
 v_exp_f32 v119,v119
 v_smfmac_f32_16x16x64_bf16 a[192:195],a[208:211],v[0:7],v250
 pk v115,v118,v119
 v_smfmac_f32_16x16x64_bf16 a[196:199],a[208:211],v[16:23],v250
 s_waitcnt vmcnt(14)
 v_smfmac_f32_16x16x64_bf16 a[200:203],a[208:211],v[32:39],v250
 s_barrier
 v_smfmac_f32_16x16x64_bf16 a[204:207],a[208:211],v[48:55],v250
 s_waitcnt lgkmcnt(0)
 mf v[0:3],a[128:131],v[128:131],v[192:195]
 v_exp_f32 v72,v72
 mf v[0:3],a[132:135],v[132:135],v[0:3]
 s_add_u32 m0,s61,49152
 v_exp_f32 v73,v73
 mf v[0:3],a[136:139],v[136:139],v[0:3]
 s_mov_b32 s63,245760
 rq a[144:147],v208 offset:4096
 mf v[0:3],a[140:143],v[140:143],v[0:3]
 bl v220,s[8:11],s63 offen offset:0 lds
 mf v[16:19],a[140:143],v[156:159],v[196:199]
 rq a[148:151],v209 offset:4096
 pk v68,v72,v73
 mf v[16:19],a[136:139],v[152:155],v[16:19]
 v_exp_f32 v74,v74
 mf v[16:19],a[132:135],v[148:151],v[16:19]
 rq a[152:155],v210 offset:4096
 mf v[16:19],a[128:131],v[144:147],v[16:19]
 v_exp_f32 v75,v75
 mf v[32:35],a[128:131],v[160:163],v[200:203]
 rq a[156:159],v211 offset:4096
 pk v69,v74,v75
 mf v[32:35],a[132:135],v[164:167],v[32:35]
 v_exp_f32 v76,v76
 mf v[32:35],a[136:139],v[168:171],v[32:35]
 v_exp_f32 v77,v77
 mf v[32:35],a[140:143],v[172:175],v[32:35]
 pk v70,v76,v77
 mf v[48:51],a[140:143],v[188:191],v[204:207]
 v_exp_f32 v78,v78
 mf v[48:51],a[136:139],v[184:187],v[48:51]
 mf v[48:51],a[132:135],v[180:183],v[48:51]
 v_exp_f32 v79,v79
 mf v[48:51],a[128:131],v[176:179],v[48:51]
 s_waitcnt lgkmcnt(0)
 pk v71,v78,v79
 mf v[52:55],a[144:147],v[176:179],v[204:207]
 v_exp_f32 v88,v88
 mf v[52:55],a[148:151],v[180:183],v[52:55]
 v_exp_f32 v89,v89
 mf v[52:55],a[152:155],v[184:187],v[52:55]
 rq a[128:131],v208 offset:8192
 mf v[52:55],a[156:159],v[188:191],v[52:55]
 bl v221,s[8:11],s63 offen offset:1024 lds
 mf v[36:39],a[156:159],v[172:175],v[200:203]
 rq a[132:135],v209 offset:8192
 pk v84,v88,v89
 mf v[36:39],a[152:155],v[168:171],v[36:39]
 v_exp_f32 v90,v90
 mf v[36:39],a[148:151],v[164:167],v[36:39]
 rq a[136:139],v210 offset:8192
 mf v[36:39],a[144:147],v[160:163],v[36:39]
 v_exp_f32 v91,v91
 mf v[20:23],a[144:147],v[144:147],v[196:199]
 rq a[140:143],v211 offset:8192
 pk v85,v90,v91
 mf v[20:23],a[148:151],v[148:151],v[20:23]
 v_exp_f32 v92,v92
 mf v[20:23],a[152:155],v[152:155],v[20:23]
 v_exp_f32 v93,v93
 mf v[20:23],a[156:159],v[156:159],v[20:23]
 pk v86,v92,v93
 mf v[4:7],a[156:159],v[140:143],v[192:195]
 v_exp_f32 v94,v94
 mf v[4:7],a[152:155],v[136:139],v[4:7]
 mf v[4:7],a[148:151],v[132:135],v[4:7]
 v_exp_f32 v95,v95
 mf v[4:7],a[144:147],v[128:131],v[4:7]
 s_waitcnt lgkmcnt(0)
 pk v87,v94,v95
 mf v[8:11],a[128:131],v[128:131],v[192:195]
 v_exp_f32 v104,v104
 mf v[8:11],a[132:135],v[132:135],v[8:11]
 v_exp_f32 v105,v105
 mf v[8:11],a[136:139],v[136:139],v[8:11]
 rq a[144:147],v208 offset:12288
 mf v[8:11],a[140:143],v[140:143],v[8:11]
 bl v222,s[8:11],s63 offen offset:2048 lds
 mf v[24:27],a[140:143],v[156:159],v[196:199]
 rq a[148:151],v209 offset:12288
 pk v100,v104,v105
 mf v[24:27],a[136:139],v[152:155],v[24:27]
 v_exp_f32 v106,v106
 mf v[24:27],a[132:135],v[148:151],v[24:27]
 rq a[152:155],v210 offset:12288
 mf v[24:27],a[128:131],v[144:147],v[24:27]
 v_exp_f32 v107,v107
 mf v[40:43],a[128:131],v[160:163],v[200:203]
 rq a[156:159],v211 offset:12288
 pk v101,v106,v107
 mf v[40:43],a[132:135],v[164:167],v[40:43]
 v_exp_f32 v108,v108
 mf v[40:43],a[136:139],v[168:171],v[40:43]
 v_exp_f32 v109,v109
 mf v[40:43],a[140:143],v[172:175],v[40:43]
 pk v102,v108,v109
 mf v[56:59],a[140:143],v[188:191],v[204:207]
 v_exp_f32 v110,v110
 mf v[56:59],a[136:139],v[184:187],v[56:59]
 mf v[56:59],a[132:135],v[180:183],v[56:59]
 v_exp_f32 v111,v111
 mf v[56:59],a[128:131],v[176:179],v[56:59]
 s_waitcnt lgkmcnt(0)
 rt a[130:131],v212 offset:53248
 pk v103,v110,v111
 mf v[60:63],a[144:147],v[176:179],v[204:207]
 v_exp_f32 v120,v120
 mf v[60:63],a[148:151],v[180:183],v[60:63]
 v_exp_f32 v121,v121
 mf v[60:63],a[152:155],v[184:187],v[60:63]
 rt a[128:129],v212 offset:49152
 rt a[132:133],v212 offset:57344
 mf v[60:63],a[156:159],v[188:191],v[60:63]
 bl v223,s[8:11],s63 offen offset:3072 lds
 mf v[44:47],a[156:159],v[172:175],v[200:203]
 rt a[134:135],v212 offset:61440
 pk v116,v120,v121
 mf v[44:47],a[152:155],v[168:171],v[44:47]
 v_exp_f32 v122,v122
 mf v[44:47],a[148:151],v[164:167],v[44:47]
 rt a[136:137],v213 offset:49152
 mf v[44:47],a[144:147],v[160:163],v[44:47]
 v_exp_f32 v123,v123
 mf v[28:31],a[144:147],v[144:147],v[196:199]
 rt a[138:139],v213 offset:53248
 pk v117,v122,v123
 mf v[28:31],a[148:151],v[148:151],v[28:31]
 v_exp_f32 v124,v124
 mf v[28:31],a[152:155],v[152:155],v[28:31]
 v_exp_f32 v125,v125
 mf v[28:31],a[156:159],v[156:159],v[28:31]
 rt a[140:141],v213 offset:57344
 pk v118,v124,v125
 mf v[12:15],a[156:159],v[140:143],v[192:195]
 v_exp_f32 v126,v126
 mf v[12:15],a[152:155],v[136:139],v[12:15]
 rt a[142:143],v213 offset:61440
 mf v[12:15],a[148:151],v[132:135],v[12:15]
 v_exp_f32 v127,v127
 mf v[12:15],a[144:147],v[128:131],v[12:15]
 s_waitcnt lgkmcnt(4)
 rt a[148:149],v214 offset:57344
 pk v119,v126,v127
 mf a[0:3],v[64:67],a[128:131],a[0:3]
 v_exp_f32 v0,v0
 mf a[0:3],v[68:71],a[132:135],a[0:3]
 v_exp_f32 v1,v1
 mf a[4:7],v[84:87],a[132:135],a[4:7]
 rt a[150:151],v214 offset:61440
 pk v0,v0,v1
 mf a[4:7],v[80:83],a[128:131],a[4:7]
 v_exp_f32 v2,v2
 mf a[8:11],v[96:99],a[128:131],a[8:11]
 rt a[146:147],v214 offset:53248
 rt a[152:153],v215 offset:49152
 mf a[8:11],v[100:103],a[132:135],a[8:11]
 v_exp_f32 v3,v3
 mf a[12:15],v[116:119],a[132:135],a[12:15]
 rt a[154:155],v215 offset:53248
 pk v1,v2,v3
 mf a[12:15],v[112:115],a[128:131],a[12:15]
 s_waitcnt lgkmcnt(5)
 v_exp_f32 v4,v4
 mf a[28:31],v[112:115],a[136:139],a[28:31]
 v_exp_f32 v5,v5
 mf a[28:31],v[116:119],a[140:143],a[28:31]
 s_add_u32 m0,s61,98304
 rt a[156:157],v215 offset:57344
 pk v2,v4,v5
 mf a[24:27],v[100:103],a[140:143],a[24:27]
 s_mov_b32 s63,229376
 rt a[144:145],v214 offset:49152
 rt a[158:159],v215 offset:61440
 mf a[24:27],v[96:99],a[136:139],a[24:27]
 bl v224,s[12:15],s63 offen offset:0 lds
 mf a[20:23],v[80:83],a[136:139],a[20:23]
 v_exp_f32 v6,v6
 mf a[20:23],v[84:87],a[140:143],a[20:23]
 rt a[128:129],v216 offset:49152
 buffer_load_dwordx2 v[226:227],v242,s[16:19],s74 offen offset:0 sc1
 mf a[16:19],v[68:71],a[140:143],a[16:19]
 v_exp_f32 v7,v7
 mf a[16:19],v[64:67],a[136:139],a[16:19]
 s_waitcnt lgkmcnt(2)
 rt a[130:131],v216 offset:53248
 pk v3,v6,v7
 mf a[32:35],v[64:67],a[144:147],a[32:35]
 v_exp_f32 v16,v16
 mf a[32:35],v[68:71],a[148:151],a[32:35]
 rt a[132:133],v216 offset:57344
 buffer_load_dwordx2 v[228:229],v242,s[16:19],s74 offen offset:128 sc1
 mf a[36:39],v[84:87],a[148:151],a[36:39]
 v_exp_f32 v17,v17
 mf a[36:39],v[80:83],a[144:147],a[36:39]
 v_exp_f32 v18,v18
 mf a[40:43],v[96:99],a[144:147],a[40:43]
 rt a[134:135],v216 offset:61440
 pk v16,v16,v17
 mf a[40:43],v[100:103],a[148:151],a[40:43]
 v_exp_f32 v19,v19
 mf a[44:47],v[116:119],a[148:151],a[44:47]
 rt a[136:137],v217 offset:49152
 pk v17,v18,v19
 mf a[44:47],v[112:115],a[144:147],a[44:47]
 s_waitcnt lgkmcnt(5)
 v_exp_f32 v20,v20
 mf a[60:63],v[112:115],a[152:155],a[60:63]
 rt a[138:139],v217 offset:53248
 buffer_load_dwordx2 v[230:231],v242,s[16:19],s86 offen offset:0 sc1
 mf a[60:63],v[116:119],a[156:159],a[60:63]
 v_exp_f32 v21,v21
 mf a[56:59],v[100:103],a[156:159],a[56:59]
 rt a[140:141],v217 offset:57344
 mf a[56:59],v[96:99],a[152:155],a[56:59]
 bl v225,s[12:15],s63 offen offset:1024 lds
 mf a[52:55],v[80:83],a[152:155],a[52:55]
 v_exp_f32 v22,v22
 mf a[52:55],v[84:87],a[156:159],a[52:55]
 rt a[142:143],v217 offset:61440
 pk v18,v20,v21
 mf a[48:51],v[68:71],a[156:159],a[48:51]
 v_exp_f32 v23,v23
 mf a[48:51],v[64:67],a[152:155],a[48:51]
 s_waitcnt lgkmcnt(4)
 rt a[144:145],v218 offset:49152
 pk v19,v22,v23
 mf a[64:67],v[64:67],a[128:131],a[64:67]
 v_exp_f32 v32,v32
 mf a[64:67],v[68:71],a[132:135],a[64:67]
 rt a[146:147],v218 offset:53248
 buffer_load_dwordx2 v[232:233],v242,s[16:19],s86 offen offset:128 sc1
 mf a[68:71],v[84:87],a[132:135],a[68:71]
 v_exp_f32 v33,v33
 mf a[68:71],v[80:83],a[128:131],a[68:71]
 rt a[148:149],v218 offset:57344
 pk v32,v32,v33
 mf a[72:75],v[96:99],a[128:131],a[72:75]
 v_exp_f32 v34,v34
 mf a[72:75],v[100:103],a[132:135],a[72:75]
 v_exp_f32 v35,v35
 mf a[76:79],v[116:119],a[132:135],a[76:79]
 rt a[150:151],v218 offset:61440
 pk v33,v34,v35
 mf a[76:79],v[112:115],a[128:131],a[76:79]
 s_waitcnt lgkmcnt(4)
 v_exp_f32 v36,v36
 mf a[92:95],v[112:115],a[136:139],a[92:95]
 rt a[152:153],v219 offset:49152
 mf a[92:95],v[116:119],a[140:143],a[92:95]
 v_exp_f32 v37,v37
 mf a[88:91],v[100:103],a[140:143],a[88:91]
 rt a[154:155],v219 offset:53248
 mf a[88:91],v[96:99],a[136:139],a[88:91]
 bl v224,s[12:15],s63 offen offset:2048 lds
 mf a[84:87],v[80:83],a[136:139],a[84:87]
 rt a[156:157],v219 offset:57344
 pk v34,v36,v37
 mf a[84:87],v[84:87],a[140:143],a[84:87]
 v_exp_f32 v38,v38
 mf a[80:83],v[68:71],a[140:143],a[80:83]
 v_exp_f32 v39,v39
 mf a[80:83],v[64:67],a[136:139],a[80:83]
 s_waitcnt lgkmcnt(3)
 rt a[158:159],v219 offset:61440
 pk v35,v38,v39
 mf a[96:99],v[64:67],a[144:147],a[96:99]
 v_exp_f32 v48,v48
 mf a[96:99],v[68:71],a[148:151],a[96:99]
 mf a[100:103],v[84:87],a[148:151],a[100:103]
 v_exp_f32 v49,v49
 mf a[100:103],v[80:83],a[144:147],a[100:103]
 pk v48,v48,v49
 mf a[104:107],v[96:99],a[144:147],a[104:107]
 v_exp_f32 v50,v50
 mf a[104:107],v[100:103],a[148:151],a[104:107]
 rq a[128:131],v208 offset:16384
 mf a[108:111],v[116:119],a[148:151],a[108:111]
 v_exp_f32 v51,v51
 mf a[108:111],v[112:115],a[144:147],a[108:111]
 s_waitcnt lgkmcnt(1)
 v_exp_f32 v52,v52
 mf a[124:127],v[112:115],a[152:155],a[124:127]
 rq a[132:135],v209 offset:16384
 pk v49,v50,v51
 mf a[124:127],v[116:119],a[156:159],a[124:127]
 v_exp_f32 v53,v53
 mf a[120:123],v[100:103],a[156:159],a[120:123]
 rq a[136:139],v210 offset:16384
 mf a[120:123],v[96:99],a[152:155],a[120:123]
 bl v225,s[12:15],s63 offen offset:3072 lds
 mf a[116:119],v[80:83],a[152:155],a[116:119]
 rq a[140:143],v211 offset:16384
 pk v50,v52,v53
 mf a[116:119],v[84:87],a[156:159],a[116:119]
 v_exp_f32 v54,v54
 mf a[112:115],v[68:71],a[156:159],a[112:115]
 mf a[112:115],v[64:67],a[152:155],a[112:115]
 v_exp_f32 v55,v55
 v_smfmac_f32_16x16x64_bf16 a[192:195],a[208:211],v[64:71],v250
 pk v51,v54,v55
 v_smfmac_f32_16x16x64_bf16 a[196:199],a[208:211],v[80:87],v250
 s_waitcnt vmcnt(16)
 v_smfmac_f32_16x16x64_bf16 a[200:203],a[208:211],v[96:103],v250
 s_barrier
 v_smfmac_f32_16x16x64_bf16 a[204:207],a[208:211],v[112:119],v250
 s_waitcnt lgkmcnt(0)
 mf v[64:67],a[128:131],v[128:131],v[192:195]
 v_exp_f32 v8,v8
 mf v[64:67],a[132:135],v[132:135],v[64:67]
 s_add_u32 m0,s61,0
 v_exp_f32 v9,v9
 mf v[64:67],a[136:139],v[136:139],v[64:67]
 s_mov_b32 s63,262144
 rq a[144:147],v208 offset:20480
 mf v[64:67],a[140:143],v[140:143],v[64:67]
 bl v220,s[8:11],s63 offen offset:0 lds
 mf v[80:83],a[140:143],v[156:159],v[196:199]
 rq a[148:151],v209 offset:20480
 pk v4,v8,v9
 mf v[80:83],a[136:139],v[152:155],v[80:83]
 v_exp_f32 v10,v10
 mf v[80:83],a[132:135],v[148:151],v[80:83]
 rq a[152:155],v210 offset:20480
 mf v[80:83],a[128:131],v[144:147],v[80:83]
 v_exp_f32 v11,v11
 mf v[96:99],a[128:131],v[160:163],v[200:203]
 rq a[156:159],v211 offset:20480
 pk v5,v10,v11
 mf v[96:99],a[132:135],v[164:167],v[96:99]
 v_exp_f32 v12,v12
 mf v[96:99],a[136:139],v[168:171],v[96:99]
 v_exp_f32 v13,v13
 mf v[96:99],a[140:143],v[172:175],v[96:99]
 pk v6,v12,v13
 mf v[112:115],a[140:143],v[188:191],v[204:207]
 v_exp_f32 v14,v14
 mf v[112:115],a[136:139],v[184:187],v[112:115]
 mf v[112:115],a[132:135],v[180:183],v[112:115]
 v_exp_f32 v15,v15
 mf v[112:115],a[128:131],v[176:179],v[112:115]
 s_waitcnt lgkmcnt(0)
 pk v7,v14,v15
 mf v[116:119],a[144:147],v[176:179],v[204:207]
 v_exp_f32 v24,v24
 mf v[116:119],a[148:151],v[180:183],v[116:119]
 v_exp_f32 v25,v25
 mf v[116:119],a[152:155],v[184:187],v[116:119]
 rq a[128:131],v208 offset:24576
 mf v[116:119],a[156:159],v[188:191],v[116:119]
 bl v221,s[8:11],s63 offen offset:1024 lds
 mf v[100:103],a[156:159],v[172:175],v[200:203]
 rq a[132:135],v209 offset:24576
 pk v20,v24,v25
 mf v[100:103],a[152:155],v[168:171],v[100:103]
 v_exp_f32 v26,v26
 mf v[100:103],a[148:151],v[164:167],v[100:103]
 rq a[136:139],v210 offset:24576
 mf v[100:103],a[144:147],v[160:163],v[100:103]
 v_exp_f32 v27,v27
 mf v[84:87],a[144:147],v[144:147],v[196:199]
 rq a[140:143],v211 offset:24576
 pk v21,v26,v27
 mf v[84:87],a[148:151],v[148:151],v[84:87]
 v_exp_f32 v28,v28
 mf v[84:87],a[152:155],v[152:155],v[84:87]
 v_exp_f32 v29,v29
 mf v[84:87],a[156:159],v[156:159],v[84:87]
 pk v22,v28,v29
 mf v[68:71],a[156:159],v[140:143],v[192:195]
 v_exp_f32 v30,v30
 mf v[68:71],a[152:155],v[136:139],v[68:71]
 mf v[68:71],a[148:151],v[132:135],v[68:71]
 v_exp_f32 v31,v31
 mf v[68:71],a[144:147],v[128:131],v[68:71]
 s_waitcnt lgkmcnt(0)
 pk v23,v30,v31
 mf v[72:75],a[128:131],v[128:131],v[192:195]
 v_exp_f32 v40,v40
 mf v[72:75],a[132:135],v[132:135],v[72:75]
 v_exp_f32 v41,v41
 mf v[72:75],a[136:139],v[136:139],v[72:75]
 rq a[144:147],v208 offset:28672
 mf v[72:75],a[140:143],v[140:143],v[72:75]
 bl v222,s[8:11],s63 offen offset:2048 lds
 mf v[88:91],a[140:143],v[156:159],v[196:199]
 rq a[148:151],v209 offset:28672
 pk v36,v40,v41
 mf v[88:91],a[136:139],v[152:155],v[88:91]
 v_exp_f32 v42,v42
 mf v[88:91],a[132:135],v[148:151],v[88:91]
 rq a[152:155],v210 offset:28672
 mf v[88:91],a[128:131],v[144:147],v[88:91]
 v_exp_f32 v43,v43
 mf v[104:107],a[128:131],v[160:163],v[200:203]
 rq a[156:159],v211 offset:28672
 pk v37,v42,v43
 mf v[104:107],a[132:135],v[164:167],v[104:107]
 v_exp_f32 v44,v44
 mf v[104:107],a[136:139],v[168:171],v[104:107]
 v_exp_f32 v45,v45
 mf v[104:107],a[140:143],v[172:175],v[104:107]
 pk v38,v44,v45
 mf v[120:123],a[140:143],v[188:191],v[204:207]
 v_exp_f32 v46,v46
 mf v[120:123],a[136:139],v[184:187],v[120:123]
 mf v[120:123],a[132:135],v[180:183],v[120:123]
 v_exp_f32 v47,v47
 mf v[120:123],a[128:131],v[176:179],v[120:123]
 s_waitcnt lgkmcnt(0)
 rt a[130:131],v212 offset:4096
 pk v39,v46,v47
 mf v[124:127],a[144:147],v[176:179],v[204:207]
 v_exp_f32 v56,v56
 mf v[124:127],a[148:151],v[180:183],v[124:127]
 v_exp_f32 v57,v57
 mf v[124:127],a[152:155],v[184:187],v[124:127]
 rt a[128:129],v212 offset:0
 rt a[132:133],v212 offset:8192
 mf v[124:127],a[156:159],v[188:191],v[124:127]
 bl v223,s[8:11],s63 offen offset:3072 lds
 mf v[108:111],a[156:159],v[172:175],v[200:203]
 rt a[134:135],v212 offset:12288
 pk v52,v56,v57
 mf v[108:111],a[152:155],v[168:171],v[108:111]
 v_exp_f32 v58,v58
 mf v[108:111],a[148:151],v[164:167],v[108:111]
 rt a[136:137],v213 offset:0
 mf v[108:111],a[144:147],v[160:163],v[108:111]
 v_exp_f32 v59,v59
 mf v[92:95],a[144:147],v[144:147],v[196:199]
 rt a[138:139],v213 offset:4096
 pk v53,v58,v59
 mf v[92:95],a[148:151],v[148:151],v[92:95]
 v_exp_f32 v60,v60
 mf v[92:95],a[152:155],v[152:155],v[92:95]
 v_exp_f32 v61,v61
 mf v[92:95],a[156:159],v[156:159],v[92:95]
 rt a[140:141],v213 offset:8192
 pk v54,v60,v61
 mf v[76:79],a[156:159],v[140:143],v[192:195]
 v_exp_f32 v62,v62
 mf v[76:79],a[152:155],v[136:139],v[76:79]
 rt a[142:143],v213 offset:12288
 s_waitcnt vmcnt(6)
 v_max3_u32 v234,v226,v227,v228
 mf v[76:79],a[148:151],v[132:135],v[76:79]
 v_exp_f32 v63,v63
 mf v[76:79],a[144:147],v[128:131],v[76:79]
 s_waitcnt lgkmcnt(4)
 rt a[148:149],v214 offset:8192
 pk v55,v62,v63
 mf a[0:3],v[0:3],a[128:131],a[0:3]
 v_exp_f32 v64,v64
 mf a[0:3],v[4:7],a[132:135],a[0:3]
 v_exp_f32 v65,v65
 mf a[4:7],v[20:23],a[132:135],a[4:7]
 rt a[150:151],v214 offset:12288
 pk v64,v64,v65
 mf a[4:7],v[16:19],a[128:131],a[4:7]
 v_exp_f32 v66,v66
 mf a[8:11],v[32:35],a[128:131],a[8:11]
 rt a[146:147],v214 offset:4096
 rt a[152:153],v215 offset:0
 mf a[8:11],v[36:39],a[132:135],a[8:11]
 v_exp_f32 v67,v67
 mf a[12:15],v[52:55],a[132:135],a[12:15]
 rt a[154:155],v215 offset:4096
 pk v65,v66,v67
 mf a[12:15],v[48:51],a[128:131],a[12:15]
 s_waitcnt lgkmcnt(5)
 v_exp_f32 v68,v68
 mf a[28:31],v[48:51],a[136:139],a[28:31]
 v_exp_f32 v69,v69
 mf a[28:31],v[52:55],a[140:143],a[28:31]
 s_add_u32 m0,s61,114688
 rt a[156:157],v215 offset:8192
 pk v66,v68,v69
 mf a[24:27],v[36:39],a[140:143],a[24:27]
 s_mov_b32 s63,245760
 rt a[144:145],v214 offset:0
 rt a[158:159],v215 offset:12288
 mf a[24:27],v[32:35],a[136:139],a[24:27]
 bl v224,s[12:15],s63 offen offset:0 lds
 mf a[20:23],v[16:19],a[136:139],a[20:23]
 v_exp_f32 v70,v70
 mf a[20:23],v[20:23],a[140:143],a[20:23]
 rt a[128:129],v216 offset:0
 v_max3_u32 v234,v234,v229,v230
 mf a[16:19],v[4:7],a[140:143],a[16:19]
 v_exp_f32 v71,v71
 mf a[16:19],v[0:3],a[136:139],a[16:19]
 s_waitcnt lgkmcnt(2)
 rt a[130:131],v216 offset:4096
 pk v67,v70,v71
 mf a[32:35],v[0:3],a[144:147],a[32:35]
 v_exp_f32 v80,v80
 mf a[32:35],v[4:7],a[148:151],a[32:35]
L_pad_pg12:
 s_cbranch_execz L_hop2
 rt a[132:133],v216 offset:8192
 v_max3_u32 v234,v234,v231,v232
 mf a[36:39],v[20:23],a[148:151],a[36:39]
 v_exp_f32 v81,v81
 mf a[36:39],v[16:19],a[144:147],a[36:39]
 v_exp_f32 v82,v82
 mf a[40:43],v[32:35],a[144:147],a[40:43]
 rt a[134:135],v216 offset:12288
 pk v80,v80,v81
 mf a[40:43],v[36:39],a[148:151],a[40:43]
 v_exp_f32 v83,v83
 mf a[44:47],v[52:55],a[148:151],a[44:47]
 rt a[136:137],v217 offset:0
 pk v81,v82,v83
 mf a[44:47],v[48:51],a[144:147],a[44:47]
 s_waitcnt lgkmcnt(5)
 v_exp_f32 v84,v84
 mf a[60:63],v[48:51],a[152:155],a[60:63]
 rt a[138:139],v217 offset:4096
 v_max_u32 v234,v234,v233
 mf a[60:63],v[52:55],a[156:159],a[60:63]
 v_exp_f32 v85,v85
 mf a[56:59],v[36:39],a[156:159],a[56:59]
 rt a[140:141],v217 offset:8192
 mf a[56:59],v[32:35],a[152:155],a[56:59]
 bl v225,s[12:15],s63 offen offset:1024 lds
 mf a[52:55],v[16:19],a[152:155],a[52:55]
 v_exp_f32 v86,v86
 mf a[52:55],v[20:23],a[156:159],a[52:55]
 rt a[142:143],v217 offset:12288
 pk v82,v84,v85
 mf a[48:51],v[4:7],a[156:159],a[48:51]
 v_exp_f32 v87,v87
 mf a[48:51],v[0:3],a[152:155],a[48:51]
 s_waitcnt lgkmcnt(4)
 rt a[144:145],v218 offset:0
 pk v83,v86,v87
 mf a[64:67],v[0:3],a[128:131],a[64:67]
 v_exp_f32 v96,v96
 mf a[64:67],v[4:7],a[132:135],a[64:67]
 rt a[146:147],v218 offset:4096
 v_cmp_eq_u32 vcc,-1,v234
 mf a[68:71],v[20:23],a[132:135],a[68:71]
 v_exp_f32 v97,v97
 mf a[68:71],v[16:19],a[128:131],a[68:71]
 rt a[148:149],v218 offset:8192
 pk v96,v96,v97
 mf a[72:75],v[32:35],a[128:131],a[72:75]
 v_exp_f32 v98,v98
 mf a[72:75],v[36:39],a[132:135],a[72:75]
 v_exp_f32 v99,v99
 mf a[76:79],v[52:55],a[132:135],a[76:79]
 rt a[150:151],v218 offset:12288
 pk v97,v98,v99
 mf a[76:79],v[48:51],a[128:131],a[76:79]
 s_waitcnt lgkmcnt(4)
 v_exp_f32 v100,v100
 mf a[92:95],v[48:51],a[136:139],a[92:95]
 rt a[152:153],v219 offset:0
 s_cbranch_vccnz L_slow_st
L_back_st:
 mf a[92:95],v[52:55],a[140:143],a[92:95]
 v_exp_f32 v101,v101
 mf a[88:91],v[36:39],a[140:143],a[88:91]
 rt a[154:155],v219 offset:4096
 mf a[88:91],v[32:35],a[136:139],a[88:91]
 bl v224,s[12:15],s63 offen offset:2048 lds
 mf a[84:87],v[16:19],a[136:139],a[84:87]
 rt a[156:157],v219 offset:8192
 pk v98,v100,v101
 mf a[84:87],v[20:23],a[140:143],a[84:87]
 v_exp_f32 v102,v102
 mf a[80:83],v[4:7],a[140:143],a[80:83]
 v_exp_f32 v103,v103
 mf a[80:83],v[0:3],a[136:139],a[80:83]
 s_waitcnt lgkmcnt(3)
 rt a[158:159],v219 offset:12288
 pk v99,v102,v103
 mf a[96:99],v[0:3],a[144:147],a[96:99]
 v_exp_f32 v112,v112
 mf a[96:99],v[4:7],a[148:151],a[96:99]
 v_add_f32 v241,v226,v228
 v_add_f32 v242,v227,v229
 mf a[100:103],v[20:23],a[148:151],a[100:103]
 v_exp_f32 v113,v113
 mf a[100:103],v[16:19],a[144:147],a[100:103]
 pk v112,v112,v113
 v_add_f32 v253,v230,v232
 mf a[104:107],v[32:35],a[144:147],a[104:107]
 v_exp_f32 v114,v114
 mf a[104:107],v[36:39],a[148:151],a[104:107]
 rq a[128:131],v208 offset:32768
 v_add_f32 v252,v231,v233
 mf a[108:111],v[52:55],a[148:151],a[108:111]
 v_exp_f32 v115,v115
 mf a[108:111],v[48:51],a[144:147],a[108:111]
 s_waitcnt lgkmcnt(1)
 v_exp_f32 v116,v116
 mf a[124:127],v[48:51],a[152:155],a[124:127]
 rq a[132:135],v209 offset:32768
 pk v113,v114,v115
 mf a[124:127],v[52:55],a[156:159],a[124:127]
 v_exp_f32 v117,v117
 mf a[120:123],v[36:39],a[156:159],a[120:123]
 rq a[136:139],v210 offset:32768
 mf a[120:123],v[32:35],a[152:155],a[120:123]
 bl v225,s[12:15],s63 offen offset:3072 lds
 mf a[116:119],v[16:19],a[152:155],a[116:119]
 rq a[140:143],v211 offset:32768
 pk v114,v116,v117
 mf a[116:119],v[20:23],a[156:159],a[116:119]
 v_exp_f32 v118,v118
 mf a[112:115],v[4:7],a[156:159],a[112:115]
 v_mov_b32 v226,v241
 v_mov_b32 v227,v242
 mf a[112:115],v[0:3],a[152:155],a[112:115]
 v_exp_f32 v119,v119
 v_smfmac_f32_16x16x64_bf16 a[192:195],a[208:211],v[0:7],v250
 pk v115,v118,v119
 v_smfmac_f32_16x16x64_bf16 a[196:199],a[208:211],v[16:23],v250
 v_mov_b32 v228,v253
 v_smfmac_f32_16x16x64_bf16 a[200:203],a[208:211],v[32:39],v250
 s_barrier
 v_mov_b32 v229,v252
 v_smfmac_f32_16x16x64_bf16 a[204:207],a[208:211],v[48:55],v250
 s_waitcnt lgkmcnt(0)
 v_permlane32_swap_b32 v241,v226
 mf v[0:3],a[128:131],v[128:131],v[192:195]
 v_exp_f32 v72,v72
 mf v[0:3],a[132:135],v[132:135],v[0:3]
 s_add_u32 m0,s61,16384
 v_exp_f32 v73,v73
 v_permlane32_swap_b32 v242,v227
 mf v[0:3],a[136:139],v[136:139],v[0:3]
 s_mov_b32 s63,278528
 rq a[144:147],v208 offset:36864
 mf v[0:3],a[140:143],v[140:143],v[0:3]
 bl v220,s[8:11],s63 offen offset:0 lds
 mf v[16:19],a[140:143],v[156:159],v[196:199]
 rq a[148:151],v209 offset:36864
 pk v68,v72,v73
 mf v[16:19],a[136:139],v[152:155],v[16:19]
 v_exp_f32 v74,v74
 v_permlane32_swap_b32 v253,v228
 mf v[16:19],a[132:135],v[148:151],v[16:19]
 rq a[152:155],v210 offset:36864
 v_permlane32_swap_b32 v252,v229
 mf v[16:19],a[128:131],v[144:147],v[16:19]
 v_exp_f32 v75,v75
 mf v[32:35],a[128:131],v[160:163],v[200:203]
 rq a[156:159],v211 offset:36864
 pk v69,v74,v75
 mf v[32:35],a[132:135],v[164:167],v[32:35]
 v_exp_f32 v76,v76
 v_add_f32 v241,v241,v226
 mf v[32:35],a[136:139],v[168:171],v[32:35]
 v_exp_f32 v77,v77
 mf v[32:35],a[140:143],v[172:175],v[32:35]
 pk v70,v76,v77
 v_add_f32 v242,v242,v227
 mf v[48:51],a[140:143],v[188:191],v[204:207]
 v_exp_f32 v78,v78
 mf v[48:51],a[136:139],v[184:187],v[48:51]
 v_add_f32 v253,v253,v228
 v_add_f32 v252,v252,v229
 v_mov_b32 v226,v241
 mf v[48:51],a[132:135],v[180:183],v[48:51]
 v_exp_f32 v79,v79
 mf v[48:51],a[128:131],v[176:179],v[48:51]
 s_waitcnt lgkmcnt(0)
 pk v71,v78,v79
 v_mov_b32 v227,v242
 mf v[52:55],a[144:147],v[176:179],v[204:207]
 v_exp_f32 v88,v88
 mf v[52:55],a[148:151],v[180:183],v[52:55]
 v_exp_f32 v89,v89
 v_mov_b32 v228,v253
 mf v[52:55],a[152:155],v[184:187],v[52:55]
 rq a[128:131],v208 offset:40960
 mf v[52:55],a[156:159],v[188:191],v[52:55]
 bl v221,s[8:11],s63 offen offset:1024 lds
 mf v[36:39],a[156:159],v[172:175],v[200:203]
 rq a[132:135],v209 offset:40960
 pk v84,v88,v89
 mf v[36:39],a[152:155],v[168:171],v[36:39]
 v_exp_f32 v90,v90
 v_mov_b32 v229,v252
 mf v[36:39],a[148:151],v[164:167],v[36:39]
 rq a[136:139],v210 offset:40960
 v_permlane16_swap_b32 v241,v226
 mf v[36:39],a[144:147],v[160:163],v[36:39]
 v_exp_f32 v91,v91
 mf v[20:23],a[144:147],v[144:147],v[196:199]
 rq a[140:143],v211 offset:40960
 pk v85,v90,v91
 mf v[20:23],a[148:151],v[148:151],v[20:23]
 v_exp_f32 v92,v92
 v_permlane16_swap_b32 v242,v227
 mf v[20:23],a[152:155],v[152:155],v[20:23]
 v_exp_f32 v93,v93
 mf v[20:23],a[156:159],v[156:159],v[20:23]
 pk v86,v92,v93
 v_permlane16_swap_b32 v253,v228
 mf v[4:7],a[156:159],v[140:143],v[192:195]
 v_exp_f32 v94,v94
 mf v[4:7],a[152:155],v[136:139],v[4:7]
 v_permlane16_swap_b32 v252,v229
 v_add_f32 v241,v241,v226
 v_add_f32 v242,v242,v227
 mf v[4:7],a[148:151],v[132:135],v[4:7]
 v_exp_f32 v95,v95
 mf v[4:7],a[144:147],v[128:131],v[4:7]
 s_waitcnt lgkmcnt(0)
 pk v87,v94,v95
 v_add_f32 v253,v253,v228
 mf v[8:11],a[128:131],v[128:131],v[192:195]
 v_exp_f32 v104,v104
 mf v[8:11],a[132:135],v[132:135],v[8:11]
 v_exp_f32 v105,v105
 v_add_f32 v252,v252,v229
 mf v[8:11],a[136:139],v[136:139],v[8:11]
 rq a[144:147],v208 offset:45056
 mf v[8:11],a[140:143],v[140:143],v[8:11]
 bl v222,s[8:11],s63 offen offset:2048 lds
 mf v[24:27],a[140:143],v[156:159],v[196:199]
 rq a[148:151],v209 offset:45056
 pk v100,v104,v105
 mf v[24:27],a[136:139],v[152:155],v[24:27]
 v_exp_f32 v106,v106
 v_mul_f32 v241,0x3b000000,v241
 mf v[24:27],a[132:135],v[148:151],v[24:27]
 rq a[152:155],v210 offset:45056
 v_mul_f32 v242,0x3b000000,v242
 mf v[24:27],a[128:131],v[144:147],v[24:27]
 v_exp_f32 v107,v107
 mf v[40:43],a[128:131],v[160:163],v[200:203]
 rq a[156:159],v211 offset:45056
 pk v101,v106,v107
 mf v[40:43],a[132:135],v[164:167],v[40:43]
 v_exp_f32 v108,v108
 v_mul_f32 v253,0x3b000000,v253
 mf v[40:43],a[136:139],v[168:171],v[40:43]
 v_exp_f32 v109,v109
 mf v[40:43],a[140:143],v[172:175],v[40:43]
 pk v102,v108,v109
 v_mul_f32 v252,0x3b000000,v252
 mf v[56:59],a[140:143],v[188:191],v[204:207]
 v_exp_f32 v110,v110
 mf v[56:59],a[136:139],v[184:187],v[56:59]
 v_fma_f32 v242,-v241,v241,v242
 v_max_f32 v242,0,v242
 v_mul_f32 v242,0x4091afa4,v242
 mf v[56:59],a[132:135],v[180:183],v[56:59]
 v_exp_f32 v111,v111
 mf v[56:59],a[128:131],v[176:179],v[56:59]
 s_waitcnt lgkmcnt(0)
 rt a[130:131],v212 offset:20480
 pk v103,v110,v111
 mf v[60:63],a[144:147],v[176:179],v[204:207]
 v_exp_f32 v120,v120
 mf v[60:63],a[148:151],v[180:183],v[60:63]
 v_exp_f32 v121,v121
 v_add_f32 v242,0x3727c5ac,v242
 mf v[60:63],a[152:155],v[184:187],v[60:63]
 rt a[128:129],v212 offset:16384
 rt a[132:133],v212 offset:24576
 mf v[60:63],a[156:159],v[188:191],v[60:63]
 bl v223,s[8:11],s63 offen offset:3072 lds
 mf v[44:47],a[156:159],v[172:175],v[200:203]
 rt a[134:135],v212 offset:28672
 pk v116,v120,v121
 mf v[44:47],a[152:155],v[168:171],v[44:47]
 v_exp_f32 v122,v122
 v_fma_f32 v252,-v253,v253,v252
 mf v[44:47],a[148:151],v[164:167],v[44:47]
 rt a[136:137],v213 offset:16384
 v_max_f32 v252,0,v252
 mf v[44:47],a[144:147],v[160:163],v[44:47]
 v_exp_f32 v123,v123
 mf v[28:31],a[144:147],v[144:147],v[196:199]
 rt a[138:139],v213 offset:20480
 pk v117,v122,v123
 mf v[28:31],a[148:151],v[148:151],v[28:31]
 v_exp_f32 v124,v124
 v_mul_f32 v252,0x4091afa4,v252
 mf v[28:31],a[152:155],v[152:155],v[28:31]
 v_exp_f32 v125,v125
 mf v[28:31],a[156:159],v[156:159],v[28:31]
 rt a[140:141],v213 offset:24576
 pk v118,v124,v125
 mf v[12:15],a[156:159],v[140:143],v[192:195]
 v_exp_f32 v126,v126
 mf v[12:15],a[152:155],v[136:139],v[12:15]
 rt a[142:143],v213 offset:28672
 v_add_f32 v252,0x3727c5ac,v252
 v_rsq_f32 v242,v242
 mf v[12:15],a[148:151],v[132:135],v[12:15]
 v_exp_f32 v127,v127
 mf v[12:15],a[144:147],v[128:131],v[12:15]
 s_waitcnt lgkmcnt(4)
 rt a[148:149],v214 offset:24576
 pk v119,v126,v127
 mf a[0:3],v[64:67],a[128:131],a[0:3]
 v_exp_f32 v0,v0
 mf a[0:3],v[68:71],a[132:135],a[0:3]
 v_exp_f32 v1,v1
 v_sqrt_f32 v252,v252
 mf a[4:7],v[84:87],a[132:135],a[4:7]
 rt a[150:151],v214 offset:28672
 pk v0,v0,v1
 mf a[4:7],v[80:83],a[128:131],a[4:7]
 v_exp_f32 v2,v2
 mf a[8:11],v[96:99],a[128:131],a[8:11]
 rt a[146:147],v214 offset:20480
 rt a[152:153],v215 offset:16384
 mf a[8:11],v[100:103],a[132:135],a[8:11]
 v_exp_f32 v3,v3
 v_accvgpr_read_b32 v226,a212
 mf a[12:15],v[116:119],a[132:135],a[12:15]
 rt a[154:155],v215 offset:20480
 pk v1,v2,v3
 mf a[12:15],v[112:115],a[128:131],a[12:15]
 s_waitcnt lgkmcnt(5)
 v_exp_f32 v4,v4
 mf a[28:31],v[112:115],a[136:139],a[28:31]
 v_exp_f32 v5,v5
 mf a[28:31],v[116:119],a[140:143],a[28:31]
 s_add_u32 m0,s61,65536
 rt a[156:157],v215 offset:24576
 pk v2,v4,v5
 v_accvgpr_read_b32 v227,a213
 mf a[24:27],v[100:103],a[140:143],a[24:27]
 s_mov_b32 s63,262144
 rt a[144:145],v214 offset:16384
 rt a[158:159],v215 offset:28672
 mf a[24:27],v[96:99],a[136:139],a[24:27]
 bl v224,s[12:15],s63 offen offset:0 lds
 mf a[20:23],v[80:83],a[136:139],a[20:23]
 v_exp_f32 v6,v6
 mf a[20:23],v[84:87],a[140:143],a[20:23]
 rt a[128:129],v216 offset:16384
 v_accvgpr_read_b32 v228,a214
 v_accvgpr_read_b32 v229,a215
 mf a[16:19],v[68:71],a[140:143],a[16:19]
 v_exp_f32 v7,v7
 mf a[16:19],v[64:67],a[136:139],a[16:19]
 s_waitcnt lgkmcnt(2)
 rt a[130:131],v216 offset:20480
 pk v3,v6,v7
 mf a[32:35],v[64:67],a[144:147],a[32:35]
 v_exp_f32 v16,v16
 mf a[32:35],v[68:71],a[148:151],a[32:35]
 rt a[132:133],v216 offset:24576
 v_accvgpr_read_b32 v230,a216
 v_accvgpr_read_b32 v231,a217
 mf a[36:39],v[84:87],a[148:151],a[36:39]
 v_exp_f32 v17,v17
 mf a[36:39],v[80:83],a[144:147],a[36:39]
 v_exp_f32 v18,v18
 mf a[40:43],v[96:99],a[144:147],a[40:43]
 rt a[134:135],v216 offset:28672
 pk v16,v16,v17
 mf a[40:43],v[100:103],a[148:151],a[40:43]
 v_exp_f32 v19,v19
 v_accvgpr_read_b32 v232,a218
 mf a[44:47],v[116:119],a[148:151],a[44:47]
 rt a[136:137],v217 offset:16384
 pk v17,v18,v19
 mf a[44:47],v[112:115],a[144:147],a[44:47]
 s_waitcnt lgkmcnt(5)
 v_exp_f32 v20,v20
 mf a[60:63],v[112:115],a[152:155],a[60:63]
 rt a[138:139],v217 offset:20480
 v_accvgpr_read_b32 v233,a219
 mf a[60:63],v[116:119],a[156:159],a[60:63]
 v_exp_f32 v21,v21
 v_accvgpr_read_b32 v234,a220
 mf a[56:59],v[100:103],a[156:159],a[56:59]
 rt a[140:141],v217 offset:24576
 mf a[56:59],v[96:99],a[152:155],a[56:59]
 bl v225,s[12:15],s63 offen offset:1024 lds
 mf a[52:55],v[80:83],a[152:155],a[52:55]
 v_exp_f32 v22,v22
 mf a[52:55],v[84:87],a[156:159],a[52:55]
 rt a[142:143],v217 offset:28672
 pk v18,v20,v21
 v_accvgpr_read_b32 v235,a221
 mf a[48:51],v[68:71],a[156:159],a[48:51]
 v_exp_f32 v23,v23
 mf a[48:51],v[64:67],a[152:155],a[48:51]
 s_waitcnt lgkmcnt(4)
 rt a[144:145],v218 offset:16384
 pk v19,v22,v23
 mf a[64:67],v[64:67],a[128:131],a[64:67]
 v_exp_f32 v32,v32
 mf a[64:67],v[68:71],a[132:135],a[64:67]
 rt a[146:147],v218 offset:20480
 v_accvgpr_read_b32 v236,a222
 v_accvgpr_read_b32 v237,a223
 mf a[68:71],v[84:87],a[132:135],a[68:71]
 v_exp_f32 v33,v33
 mf a[68:71],v[80:83],a[128:131],a[68:71]
 rt a[148:149],v218 offset:24576
 pk v32,v32,v33
 mf a[72:75],v[96:99],a[128:131],a[72:75]
 v_exp_f32 v34,v34
 mf a[72:75],v[100:103],a[132:135],a[72:75]
 v_exp_f32 v35,v35
 v_accvgpr_read_b32 v238,a224
 mf a[76:79],v[116:119],a[132:135],a[76:79]
 rt a[150:151],v218 offset:28672
 pk v33,v34,v35
 mf a[76:79],v[112:115],a[128:131],a[76:79]
 s_waitcnt lgkmcnt(4)
 v_exp_f32 v36,v36
 mf a[92:95],v[112:115],a[136:139],a[92:95]
 rt a[152:153],v219 offset:16384
 v_accvgpr_read_b32 v239,a225
 mf a[92:95],v[116:119],a[140:143],a[92:95]
 v_exp_f32 v37,v37
 v_accvgpr_read_b32 v240,a226
 mf a[88:91],v[100:103],a[140:143],a[88:91]
 rt a[154:155],v219 offset:20480
 mf a[88:91],v[96:99],a[136:139],a[88:91]
 bl v224,s[12:15],s63 offen offset:2048 lds
 mf a[84:87],v[80:83],a[136:139],a[84:87]
 rt a[156:157],v219 offset:24576
 pk v34,v36,v37
 mf a[84:87],v[84:87],a[140:143],a[84:87]
 v_exp_f32 v38,v38
 v_mul_f32 v241,v241,v242
 mf a[80:83],v[68:71],a[140:143],a[80:83]
 v_exp_f32 v39,v39
 mf a[80:83],v[64:67],a[136:139],a[80:83]
 s_waitcnt lgkmcnt(3)
 rt a[158:159],v219 offset:28672
 pk v35,v38,v39
 mf a[96:99],v[64:67],a[144:147],a[96:99]
 v_exp_f32 v48,v48
 mf a[96:99],v[68:71],a[148:151],a[96:99]
 v_fma_f32 v226,v226,v242,-v241
 v_fma_f32 v227,v227,v242,-v241
 v_fma_f32 v228,v228,v242,-v241
 mf a[100:103],v[84:87],a[148:151],a[100:103]
 v_exp_f32 v49,v49
 mf a[100:103],v[80:83],a[144:147],a[100:103]
 pk v48,v48,v49
 v_fma_f32 v229,v229,v242,-v241
 mf a[104:107],v[96:99],a[144:147],a[104:107]
 v_exp_f32 v50,v50
 mf a[104:107],v[100:103],a[148:151],a[104:107]
 rq a[128:131],v208 offset:49152
 v_fma_f32 v230,v230,v242,-v241
 v_fma_f32 v231,v231,v242,-v241
 mf a[108:111],v[116:119],a[148:151],a[108:111]
 v_exp_f32 v51,v51
 mf a[108:111],v[112:115],a[144:147],a[108:111]
 s_waitcnt lgkmcnt(1)
 v_exp_f32 v52,v52
 mf a[124:127],v[112:115],a[152:155],a[124:127]
 rq a[132:135],v209 offset:49152
 pk v49,v50,v51
 mf a[124:127],v[116:119],a[156:159],a[124:127]
 v_exp_f32 v53,v53
 v_fma_f32 v232,v232,v242,-v241
 mf a[120:123],v[100:103],a[156:159],a[120:123]
 rq a[136:139],v210 offset:49152
 mf a[120:123],v[96:99],a[152:155],a[120:123]
 bl v225,s[12:15],s63 offen offset:3072 lds
 mf a[116:119],v[80:83],a[152:155],a[116:119]
 rq a[140:143],v211 offset:49152
 pk v50,v52,v53
 mf a[116:119],v[84:87],a[156:159],a[116:119]
 v_exp_f32 v54,v54
 v_fma_f32 v233,v233,v242,-v241
 mf a[112:115],v[68:71],a[156:159],a[112:115]
 v_fma_f32 v234,v234,v242,-v241
 v_fma_f32 v235,v235,v242,-v241
 mf a[112:115],v[64:67],a[152:155],a[112:115]
 v_exp_f32 v55,v55
 v_smfmac_f32_16x16x64_bf16 a[192:195],a[208:211],v[64:71],v250
 s_mov_b64 exec,0
 s_cmp_eq_u32 s54,0
 s_cbranch_scc1 L_pad_pg13
 s_cmp_eq_u32 s54,1
 s_cbranch_scc1 L_pad_pg14
 s_cmp_eq_u32 s54,2
 s_cbranch_scc1 L_pad_pg15
 s_branch L_pad_pg16
L_hop3:
 s_mov_b64 exec,-1
 pk v51,v54,v55
 v_smfmac_f32_16x16x64_bf16 a[196:199],a[208:211],v[80:87],v250
 s_waitcnt vmcnt(12)
 v_fma_f32 v236,v236,v242,-v241
 v_fma_f32 v237,v237,v242,-v241
 v_smfmac_f32_16x16x64_bf16 a[200:203],a[208:211],v[96:103],v250
 s_barrier
 v_fma_f32 v238,v238,v242,-v241
 v_smfmac_f32_16x16x64_bf16 a[204:207],a[208:211],v[112:119],v250
 s_waitcnt lgkmcnt(0)
 v_fma_f32 v239,v239,v242,-v241
 mf v[64:67],a[128:131],v[128:131],v[192:195]
 v_exp_f32 v8,v8
 mf v[64:67],a[132:135],v[132:135],v[64:67]
 s_add_u32 m0,s61,32768
 v_exp_f32 v9,v9
 mf v[64:67],a[136:139],v[136:139],v[64:67]
 s_mov_b32 s63,294912
 rq a[144:147],v208 offset:53248
 mf v[64:67],a[140:143],v[140:143],v[64:67]
 bl v220,s[8:11],s63 offen offset:0 lds
 mf v[80:83],a[140:143],v[156:159],v[196:199]
 rq a[148:151],v209 offset:53248
 pk v4,v8,v9
 mf v[80:83],a[136:139],v[152:155],v[80:83]
 v_exp_f32 v10,v10
 mf v[80:83],a[132:135],v[148:151],v[80:83]
 rq a[152:155],v210 offset:53248
 v_fma_f32 v240,v240,v242,-v241
 mf v[80:83],a[128:131],v[144:147],v[80:83]
 v_exp_f32 v11,v11
 mf v[96:99],a[128:131],v[160:163],v[200:203]
 rq a[156:159],v211 offset:53248
 pk v5,v10,v11
 mf v[96:99],a[132:135],v[164:167],v[96:99]
 v_exp_f32 v12,v12
 mf v[96:99],a[136:139],v[168:171],v[96:99]
 v_exp_f32 v13,v13
 mf v[96:99],a[140:143],v[172:175],v[96:99]
 pk v6,v12,v13
 pk v226,v226,v227
 mf v[112:115],a[140:143],v[188:191],v[204:207]
 v_exp_f32 v14,v14
 mf v[112:115],a[136:139],v[184:187],v[112:115]
 pk v227,v228,v229
 v_accvgpr_read_b32 v229,a227
 mf v[112:115],a[132:135],v[180:183],v[112:115]
 v_exp_f32 v15,v15
 mf v[112:115],a[128:131],v[176:179],v[112:115]
 s_waitcnt lgkmcnt(0)
 pk v7,v14,v15
 v_fma_f32 v241,v229,v242,-v241
 mf v[116:119],a[144:147],v[176:179],v[204:207]
 v_exp_f32 v24,v24
 mf v[116:119],a[148:151],v[180:183],v[116:119]
 v_exp_f32 v25,v25
 mf v[116:119],a[152:155],v[184:187],v[116:119]
 rq a[128:131],v208 offset:57344
 mf v[116:119],a[156:159],v[188:191],v[116:119]
 bl v221,s[8:11],s63 offen offset:1024 lds
 mf v[100:103],a[156:159],v[172:175],v[200:203]
 rq a[132:135],v209 offset:57344
 pk v20,v24,v25
 mf v[100:103],a[152:155],v[168:171],v[100:103]
 v_exp_f32 v26,v26
 mf v[100:103],a[148:151],v[164:167],v[100:103]
 rq a[136:139],v210 offset:57344
 pk v228,v230,v231
 mf v[100:103],a[144:147],v[160:163],v[100:103]
 v_exp_f32 v27,v27
 mf v[84:87],a[144:147],v[144:147],v[196:199]
 rq a[140:143],v211 offset:57344
 pk v21,v26,v27
 mf v[84:87],a[148:151],v[148:151],v[84:87]
 v_exp_f32 v28,v28
 mf v[84:87],a[152:155],v[152:155],v[84:87]
 v_exp_f32 v29,v29
 mf v[84:87],a[156:159],v[156:159],v[84:87]
 pk v22,v28,v29
 pk v229,v232,v233
 mf v[68:71],a[156:159],v[140:143],v[192:195]
 v_exp_f32 v30,v30
 mf v[68:71],a[152:155],v[136:139],v[68:71]
 pk v230,v234,v235
 pk v231,v236,v237
 mf v[68:71],a[148:151],v[132:135],v[68:71]
 v_exp_f32 v31,v31
 mf v[68:71],a[144:147],v[128:131],v[68:71]
 s_waitcnt lgkmcnt(0)
 pk v23,v30,v31
 pk v232,v238,v239
 mf v[72:75],a[128:131],v[128:131],v[192:195]
 v_exp_f32 v40,v40
 mf v[72:75],a[132:135],v[132:135],v[72:75]
 v_exp_f32 v41,v41
 mf v[72:75],a[136:139],v[136:139],v[72:75]
 rq a[144:147],v208 offset:61440
 mf v[72:75],a[140:143],v[140:143],v[72:75]
 bl v222,s[8:11],s63 offen offset:2048 lds
 mf v[88:91],a[140:143],v[156:159],v[196:199]
 rq a[148:151],v209 offset:61440
 pk v36,v40,v41
 mf v[88:91],a[136:139],v[152:155],v[88:91]
 v_exp_f32 v42,v42
 mf v[88:91],a[132:135],v[148:151],v[88:91]
 rq a[152:155],v210 offset:61440
 pk v233,v240,v241
 mf v[88:91],a[128:131],v[144:147],v[88:91]
 s_add_u32 s64,s67,2097152
 v_exp_f32 v43,v43
 mf v[104:107],a[128:131],v[160:163],v[200:203]
L_pad_pg13:
 s_cbranch_execz L_hop3
 rq a[156:159],v211 offset:61440
 pk v37,v42,v43
 mf v[104:107],a[132:135],v[164:167],v[104:107]
 v_exp_f32 v44,v44
 mf v[104:107],a[136:139],v[168:171],v[104:107]
 v_exp_f32 v45,v45
 mf v[104:107],a[140:143],v[172:175],v[104:107]
 buffer_store_dwordx4 v[226:229],v254,s[16:19],s64 offen sc1
 pk v38,v44,v45
 mf v[120:123],a[140:143],v[188:191],v[204:207]
 s_add_u32 s64,s67,2228224
 v_exp_f32 v46,v46
 mf v[120:123],a[136:139],v[184:187],v[120:123]
 buffer_store_dwordx4 v[230:233],v254,s[16:19],s64 offen sc1
 mf v[120:123],a[132:135],v[180:183],v[120:123]
 v_exp_f32 v47,v47
 mf v[120:123],a[128:131],v[176:179],v[120:123]
 s_waitcnt lgkmcnt(0)
 rt a[130:131],v212 offset:36864
 pk v39,v46,v47
 mf v[124:127],a[144:147],v[176:179],v[204:207]
 v_exp_f32 v56,v56
 mf v[124:127],a[148:151],v[180:183],v[124:127]
 v_exp_f32 v57,v57
 mf v[124:127],a[152:155],v[184:187],v[124:127]
 rt a[128:129],v212 offset:32768
 rt a[132:133],v212 offset:40960
 mf v[124:127],a[156:159],v[188:191],v[124:127]
 bl v223,s[8:11],s63 offen offset:3072 lds
 mf v[108:111],a[156:159],v[172:175],v[200:203]
 rt a[134:135],v212 offset:45056
 pk v52,v56,v57
 mf v[108:111],a[152:155],v[168:171],v[108:111]
 v_exp_f32 v58,v58
 mf v[108:111],a[148:151],v[164:167],v[108:111]
 rt a[136:137],v213 offset:32768
 v_bfe_u32 v242,v255,4,3
 mf v[108:111],a[144:147],v[160:163],v[108:111]
 v_exp_f32 v59,v59
 mf v[92:95],a[144:147],v[144:147],v[196:199]
 rt a[138:139],v213 offset:36864
 pk v53,v58,v59
 mf v[92:95],a[148:151],v[148:151],v[92:95]
 v_exp_f32 v60,v60
 mf v[92:95],a[152:155],v[152:155],v[92:95]
 v_exp_f32 v61,v61
 mf v[92:95],a[156:159],v[156:159],v[92:95]
 rt a[140:141],v213 offset:40960
 pk v54,v60,v61
 mf v[76:79],a[156:159],v[140:143],v[192:195]
 v_exp_f32 v62,v62
 mf v[76:79],a[152:155],v[136:139],v[76:79]
 rt a[142:143],v213 offset:45056
 v_lshlrev_b32 v242,2,v242
 mf v[76:79],a[148:151],v[132:135],v[76:79]
 v_exp_f32 v63,v63
 mf v[76:79],a[144:147],v[128:131],v[76:79]
 s_waitcnt lgkmcnt(4)
 rt a[148:149],v214 offset:40960
 pk v55,v62,v63
 mf a[0:3],v[0:3],a[128:131],a[0:3]
 v_exp_f32 v64,v64
 mf a[0:3],v[4:7],a[132:135],a[0:3]
 v_exp_f32 v65,v65
 mf a[4:7],v[20:23],a[132:135],a[4:7]
 rt a[150:151],v214 offset:45056
 pk v64,v64,v65
 mf a[4:7],v[16:19],a[128:131],a[4:7]
 v_exp_f32 v66,v66
 mf a[8:11],v[32:35],a[128:131],a[8:11]
 rt a[146:147],v214 offset:36864
 rt a[152:153],v215 offset:32768
 mf a[8:11],v[36:39],a[132:135],a[8:11]
 v_exp_f32 v67,v67
 mf a[12:15],v[52:55],a[132:135],a[12:15]
 rt a[154:155],v215 offset:36864
 pk v65,v66,v67
 mf a[12:15],v[48:51],a[128:131],a[12:15]
 s_waitcnt lgkmcnt(5)
 v_exp_f32 v68,v68
 mf a[28:31],v[48:51],a[136:139],a[28:31]
 v_exp_f32 v69,v69
 mf a[28:31],v[52:55],a[140:143],a[28:31]
 s_add_u32 m0,s61,81920
 rt a[156:157],v215 offset:40960
 pk v66,v68,v69
 mf a[24:27],v[36:39],a[140:143],a[24:27]
 s_mov_b32 s63,278528
 rt a[144:145],v214 offset:32768
 rt a[158:159],v215 offset:45056
 mf a[24:27],v[32:35],a[136:139],a[24:27]
 bl v224,s[12:15],s63 offen offset:0 lds
 mf a[20:23],v[16:19],a[136:139],a[20:23]
 v_exp_f32 v70,v70
 mf a[20:23],v[20:23],a[140:143],a[20:23]
 rt a[128:129],v216 offset:32768
 mf a[16:19],v[4:7],a[140:143],a[16:19]
 v_exp_f32 v71,v71
 mf a[16:19],v[0:3],a[136:139],a[16:19]
 s_waitcnt lgkmcnt(2)
 rt a[130:131],v216 offset:36864
 pk v67,v70,v71
 mf a[32:35],v[0:3],a[144:147],a[32:35]
 v_exp_f32 v80,v80
 mf a[32:35],v[4:7],a[148:151],a[32:35]
 rt a[132:133],v216 offset:40960
 mf a[36:39],v[20:23],a[148:151],a[36:39]
 v_exp_f32 v81,v81
 mf a[36:39],v[16:19],a[144:147],a[36:39]
 v_exp_f32 v82,v82
 mf a[40:43],v[32:35],a[144:147],a[40:43]
 rt a[134:135],v216 offset:45056
 pk v80,v80,v81
 mf a[40:43],v[36:39],a[148:151],a[40:43]
 v_exp_f32 v83,v83
 mf a[44:47],v[52:55],a[148:151],a[44:47]
 rt a[136:137],v217 offset:32768
 pk v81,v82,v83
 mf a[44:47],v[48:51],a[144:147],a[44:47]
 s_waitcnt lgkmcnt(5)
 v_exp_f32 v84,v84
 mf a[60:63],v[48:51],a[152:155],a[60:63]
 rt a[138:139],v217 offset:36864
 mf a[60:63],v[52:55],a[156:159],a[60:63]
 v_exp_f32 v85,v85
 mf a[56:59],v[36:39],a[156:159],a[56:59]
 rt a[140:141],v217 offset:40960
 mf a[56:59],v[32:35],a[152:155],a[56:59]
 bl v225,s[12:15],s63 offen offset:1024 lds
 mf a[52:55],v[16:19],a[152:155],a[52:55]
 v_exp_f32 v86,v86
 mf a[52:55],v[20:23],a[156:159],a[52:55]
 rt a[142:143],v217 offset:45056
 pk v82,v84,v85
 mf a[48:51],v[4:7],a[156:159],a[48:51]
 v_exp_f32 v87,v87
 mf a[48:51],v[0:3],a[152:155],a[48:51]
 s_waitcnt lgkmcnt(4)
 rt a[144:145],v218 offset:32768
 pk v83,v86,v87
 mf a[64:67],v[0:3],a[128:131],a[64:67]
 v_exp_f32 v96,v96
 mf a[64:67],v[4:7],a[132:135],a[64:67]
 rt a[146:147],v218 offset:36864
 mf a[68:71],v[20:23],a[132:135],a[68:71]
 v_exp_f32 v97,v97
 mf a[68:71],v[16:19],a[128:131],a[68:71]
 rt a[148:149],v218 offset:40960
 pk v96,v96,v97
 mf a[72:75],v[32:35],a[128:131],a[72:75]
 v_exp_f32 v98,v98
 mf a[72:75],v[36:39],a[132:135],a[72:75]
 v_exp_f32 v99,v99
 mf a[76:79],v[52:55],a[132:135],a[76:79]
 rt a[150:151],v218 offset:45056
 pk v97,v98,v99
 mf a[76:79],v[48:51],a[128:131],a[76:79]
 s_waitcnt lgkmcnt(4)
 v_exp_f32 v100,v100
 mf a[92:95],v[48:51],a[136:139],a[92:95]
 rt a[152:153],v219 offset:32768
 mf a[92:95],v[52:55],a[140:143],a[92:95]
 v_exp_f32 v101,v101
 mf a[88:91],v[36:39],a[140:143],a[88:91]
 rt a[154:155],v219 offset:36864
 mf a[88:91],v[32:35],a[136:139],a[88:91]
 bl v224,s[12:15],s63 offen offset:2048 lds
 mf a[84:87],v[16:19],a[136:139],a[84:87]
 rt a[156:157],v219 offset:40960
 pk v98,v100,v101
 mf a[84:87],v[20:23],a[140:143],a[84:87]
 v_exp_f32 v102,v102
 mf a[80:83],v[4:7],a[140:143],a[80:83]
 v_exp_f32 v103,v103
 mf a[80:83],v[0:3],a[136:139],a[80:83]
 s_waitcnt lgkmcnt(3)
 rt a[158:159],v219 offset:45056
 pk v99,v102,v103
 mf a[96:99],v[0:3],a[144:147],a[96:99]
 v_exp_f32 v112,v112
 mf a[96:99],v[4:7],a[148:151],a[96:99]
 mf a[100:103],v[20:23],a[148:151],a[100:103]
 v_exp_f32 v113,v113
 mf a[100:103],v[16:19],a[144:147],a[100:103]
 pk v112,v112,v113
 mf a[104:107],v[32:35],a[144:147],a[104:107]
 v_exp_f32 v114,v114
 mf a[104:107],v[36:39],a[148:151],a[104:107]
 rq a[128:131],v208 offset:0
 mf a[108:111],v[52:55],a[148:151],a[108:111]
 v_exp_f32 v115,v115
 mf a[108:111],v[48:51],a[144:147],a[108:111]
 s_waitcnt lgkmcnt(1)
 v_exp_f32 v116,v116
 mf a[124:127],v[48:51],a[152:155],a[124:127]
 rq a[132:135],v209 offset:0
 pk v113,v114,v115
 mf a[124:127],v[52:55],a[156:159],a[124:127]
 v_exp_f32 v117,v117
 mf a[120:123],v[36:39],a[156:159],a[120:123]
 rq a[136:139],v210 offset:0
 mf a[120:123],v[32:35],a[152:155],a[120:123]
 bl v225,s[12:15],s63 offen offset:3072 lds
 mf a[116:119],v[16:19],a[152:155],a[116:119]
 rq a[140:143],v211 offset:0
 pk v114,v116,v117
 mf a[116:119],v[20:23],a[156:159],a[116:119]
 v_exp_f32 v118,v118
 mf a[112:115],v[4:7],a[156:159],a[112:115]
 mf a[112:115],v[0:3],a[152:155],a[112:115]
 v_exp_f32 v119,v119
 v_smfmac_f32_16x16x64_bf16 a[192:195],a[208:211],v[0:7],v250
 pk v115,v118,v119
 v_smfmac_f32_16x16x64_bf16 a[196:199],a[208:211],v[16:23],v250
 s_waitcnt vmcnt(14)
 v_smfmac_f32_16x16x64_bf16 a[200:203],a[208:211],v[32:39],v250
 s_barrier
 v_smfmac_f32_16x16x64_bf16 a[204:207],a[208:211],v[48:55],v250
 s_waitcnt lgkmcnt(0)
 mf v[0:3],a[128:131],v[128:131],v[192:195]
 v_exp_f32 v72,v72
 mf v[0:3],a[132:135],v[132:135],v[0:3]
 s_add_u32 m0,s61,49152
 v_exp_f32 v73,v73
 mf v[0:3],a[136:139],v[136:139],v[0:3]
 s_mov_b32 s63,311296
 rq a[144:147],v208 offset:4096
 mf v[0:3],a[140:143],v[140:143],v[0:3]
 bl v220,s[8:11],s63 offen offset:0 lds
 mf v[16:19],a[140:143],v[156:159],v[196:199]
 rq a[148:151],v209 offset:4096
 pk v68,v72,v73
 mf v[16:19],a[136:139],v[152:155],v[16:19]
 v_exp_f32 v74,v74
 mf v[16:19],a[132:135],v[148:151],v[16:19]
 rq a[152:155],v210 offset:4096
 mf v[16:19],a[128:131],v[144:147],v[16:19]
 v_exp_f32 v75,v75
 mf v[32:35],a[128:131],v[160:163],v[200:203]
 rq a[156:159],v211 offset:4096
 pk v69,v74,v75
 mf v[32:35],a[132:135],v[164:167],v[32:35]
 v_exp_f32 v76,v76
 mf v[32:35],a[136:139],v[168:171],v[32:35]
 v_exp_f32 v77,v77
 mf v[32:35],a[140:143],v[172:175],v[32:35]
 pk v70,v76,v77
 mf v[48:51],a[140:143],v[188:191],v[204:207]
 v_exp_f32 v78,v78
 mf v[48:51],a[136:139],v[184:187],v[48:51]
 mf v[48:51],a[132:135],v[180:183],v[48:51]
 v_exp_f32 v79,v79
 mf v[48:51],a[128:131],v[176:179],v[48:51]
 s_waitcnt lgkmcnt(0)
 pk v71,v78,v79
 mf v[52:55],a[144:147],v[176:179],v[204:207]
 v_exp_f32 v88,v88
 mf v[52:55],a[148:151],v[180:183],v[52:55]
 v_exp_f32 v89,v89
 mf v[52:55],a[152:155],v[184:187],v[52:55]
 rq a[128:131],v208 offset:8192
 mf v[52:55],a[156:159],v[188:191],v[52:55]
 bl v221,s[8:11],s63 offen offset:1024 lds
 mf v[36:39],a[156:159],v[172:175],v[200:203]
 rq a[132:135],v209 offset:8192
 pk v84,v88,v89
 mf v[36:39],a[152:155],v[168:171],v[36:39]
 v_exp_f32 v90,v90
 mf v[36:39],a[148:151],v[164:167],v[36:39]
 rq a[136:139],v210 offset:8192
 mf v[36:39],a[144:147],v[160:163],v[36:39]
 v_exp_f32 v91,v91
 mf v[20:23],a[144:147],v[144:147],v[196:199]
 rq a[140:143],v211 offset:8192
 pk v85,v90,v91
 mf v[20:23],a[148:151],v[148:151],v[20:23]
 v_exp_f32 v92,v92
 mf v[20:23],a[152:155],v[152:155],v[20:23]
 v_exp_f32 v93,v93
 mf v[20:23],a[156:159],v[156:159],v[20:23]
 pk v86,v92,v93
 mf v[4:7],a[156:159],v[140:143],v[192:195]
 v_exp_f32 v94,v94
 mf v[4:7],a[152:155],v[136:139],v[4:7]
 mf v[4:7],a[148:151],v[132:135],v[4:7]
 v_exp_f32 v95,v95
 mf v[4:7],a[144:147],v[128:131],v[4:7]
 s_waitcnt lgkmcnt(0)
 pk v87,v94,v95
 mf v[8:11],a[128:131],v[128:131],v[192:195]
 v_exp_f32 v104,v104
 mf v[8:11],a[132:135],v[132:135],v[8:11]
 v_exp_f32 v105,v105
 mf v[8:11],a[136:139],v[136:139],v[8:11]
 rq a[144:147],v208 offset:12288
 mf v[8:11],a[140:143],v[140:143],v[8:11]
 bl v222,s[8:11],s63 offen offset:2048 lds
 mf v[24:27],a[140:143],v[156:159],v[196:199]
 rq a[148:151],v209 offset:12288
 pk v100,v104,v105
 mf v[24:27],a[136:139],v[152:155],v[24:27]
 v_exp_f32 v106,v106
 mf v[24:27],a[132:135],v[148:151],v[24:27]
 rq a[152:155],v210 offset:12288
 mf v[24:27],a[128:131],v[144:147],v[24:27]
 v_exp_f32 v107,v107
 mf v[40:43],a[128:131],v[160:163],v[200:203]
 rq a[156:159],v211 offset:12288
 pk v101,v106,v107
 mf v[40:43],a[132:135],v[164:167],v[40:43]
 v_exp_f32 v108,v108
 mf v[40:43],a[136:139],v[168:171],v[40:43]
 v_exp_f32 v109,v109
 mf v[40:43],a[140:143],v[172:175],v[40:43]
 pk v102,v108,v109
 v_mov_b32 v240,1
 mf v[56:59],a[140:143],v[188:191],v[204:207]
 s_add_u32 s64,s70,0
 v_exp_f32 v110,v110
 mf v[56:59],a[136:139],v[184:187],v[56:59]
 s_waitcnt vmcnt(8)
 mf v[56:59],a[132:135],v[180:183],v[56:59]
 v_exp_f32 v111,v111
 mf v[56:59],a[128:131],v[176:179],v[56:59]
 s_waitcnt lgkmcnt(0)
 rt a[130:131],v212 offset:53248
 pk v103,v110,v111
 mf v[60:63],a[144:147],v[176:179],v[204:207]
 v_exp_f32 v120,v120
 mf v[60:63],a[148:151],v[180:183],v[60:63]
 v_exp_f32 v121,v121
 mf v[60:63],a[152:155],v[184:187],v[60:63]
 rt a[128:129],v212 offset:49152
 rt a[132:133],v212 offset:57344
 mf v[60:63],a[156:159],v[188:191],v[60:63]
 bl v223,s[8:11],s63 offen offset:3072 lds
 mf v[44:47],a[156:159],v[172:175],v[200:203]
 rt a[134:135],v212 offset:61440
 pk v116,v120,v121
 mf v[44:47],a[152:155],v[168:171],v[44:47]
 v_exp_f32 v122,v122
 mf v[44:47],a[148:151],v[164:167],v[44:47]
 rt a[136:137],v213 offset:49152
 s_mov_b64 exec,1
 buffer_store_dword v240,v251,s[16:19],s64 offen sc1
 s_mov_b64 exec,-1
 mf v[44:47],a[144:147],v[160:163],v[44:47]
 v_exp_f32 v123,v123
 mf v[28:31],a[144:147],v[144:147],v[196:199]
 rt a[138:139],v213 offset:53248
 pk v117,v122,v123
 mf v[28:31],a[148:151],v[148:151],v[28:31]
 v_exp_f32 v124,v124
 mf v[28:31],a[152:155],v[152:155],v[28:31]
 v_exp_f32 v125,v125
 mf v[28:31],a[156:159],v[156:159],v[28:31]
 rt a[140:141],v213 offset:57344
 pk v118,v124,v125
 mf v[12:15],a[156:159],v[140:143],v[192:195]
 v_exp_f32 v126,v126
 mf v[12:15],a[152:155],v[136:139],v[12:15]
 rt a[142:143],v213 offset:61440
 v_lshrrev_b32 v226,9,v251
 mf v[12:15],a[148:151],v[132:135],v[12:15]
 v_exp_f32 v127,v127
 mf v[12:15],a[144:147],v[128:131],v[12:15]
 s_waitcnt lgkmcnt(4)
 rt a[148:149],v214 offset:57344
 pk v119,v126,v127
 mf a[0:3],v[64:67],a[128:131],a[0:3]
 v_exp_f32 v0,v0
 mf a[0:3],v[68:71],a[132:135],a[0:3]
 v_exp_f32 v1,v1
 mf a[4:7],v[84:87],a[132:135],a[4:7]
 rt a[150:151],v214 offset:61440
 pk v0,v0,v1
 mf a[4:7],v[80:83],a[128:131],a[4:7]
 v_exp_f32 v2,v2
 mf a[8:11],v[96:99],a[128:131],a[8:11]
 rt a[146:147],v214 offset:53248
 rt a[152:153],v215 offset:49152
 mf a[8:11],v[100:103],a[132:135],a[8:11]
 v_exp_f32 v3,v3
 mf a[12:15],v[116:119],a[132:135],a[12:15]
 rt a[154:155],v215 offset:53248
 pk v1,v2,v3
 mf a[12:15],v[112:115],a[128:131],a[12:15]
 s_waitcnt lgkmcnt(5)
 v_exp_f32 v4,v4
 mf a[28:31],v[112:115],a[136:139],a[28:31]
 v_exp_f32 v5,v5
 mf a[28:31],v[116:119],a[140:143],a[28:31]
 s_add_u32 m0,s61,98304
 rt a[156:157],v215 offset:57344
 pk v2,v4,v5
 mf a[24:27],v[100:103],a[140:143],a[24:27]
 s_mov_b32 s63,294912
 rt a[144:145],v214 offset:49152
 rt a[158:159],v215 offset:61440
 mf a[24:27],v[96:99],a[136:139],a[24:27]
 bl v224,s[12:15],s63 offen offset:0 lds
 mf a[20:23],v[80:83],a[136:139],a[20:23]
 v_exp_f32 v6,v6
 mf a[20:23],v[84:87],a[140:143],a[20:23]
 rt a[128:129],v216 offset:49152
 v_min_u32 v226,3,v226
 mf a[16:19],v[68:71],a[140:143],a[16:19]
 s_mul_i32 s55,s91,4
 v_exp_f32 v7,v7
 mf a[16:19],v[64:67],a[136:139],a[16:19]
 s_waitcnt lgkmcnt(2)
 rt a[130:131],v216 offset:53248
 pk v3,v6,v7
 mf a[32:35],v[64:67],a[144:147],a[32:35]
 v_exp_f32 v16,v16
 mf a[32:35],v[68:71],a[148:151],a[32:35]
 rt a[132:133],v216 offset:57344
 v_add_u32 v226,s55,v226
 mf a[36:39],v[84:87],a[148:151],a[36:39]
 v_exp_f32 v17,v17
 mf a[36:39],v[80:83],a[144:147],a[36:39]
 v_exp_f32 v18,v18
 mf a[40:43],v[96:99],a[144:147],a[40:43]
 rt a[134:135],v216 offset:61440
 pk v16,v16,v17
 mf a[40:43],v[100:103],a[148:151],a[40:43]
 v_exp_f32 v19,v19
 mf a[44:47],v[116:119],a[148:151],a[44:47]
 rt a[136:137],v217 offset:49152
 pk v17,v18,v19
 mf a[44:47],v[112:115],a[144:147],a[44:47]
 s_waitcnt lgkmcnt(5)
 v_exp_f32 v20,v20
 mf a[60:63],v[112:115],a[152:155],a[60:63]
 rt a[138:139],v217 offset:53248
 v_mul_u32_u24 v226,3584,v226
 mf a[60:63],v[116:119],a[156:159],a[60:63]
 s_lshl_b32 s55,s89,0
 v_exp_f32 v21,v21
 mf a[56:59],v[100:103],a[156:159],a[56:59]
 rt a[140:141],v217 offset:57344
 mf a[56:59],v[96:99],a[152:155],a[56:59]
 bl v225,s[12:15],s63 offen offset:1024 lds
 mf a[52:55],v[80:83],a[152:155],a[52:55]
 v_exp_f32 v22,v22
 mf a[52:55],v[84:87],a[156:159],a[52:55]
 rt a[142:143],v217 offset:61440
 pk v18,v20,v21
 mf a[48:51],v[68:71],a[156:159],a[48:51]
 v_exp_f32 v23,v23
 mf a[48:51],v[64:67],a[152:155],a[48:51]
 s_waitcnt lgkmcnt(4)
 rt a[144:145],v218 offset:49152
 pk v19,v22,v23
 mf a[64:67],v[64:67],a[128:131],a[64:67]
 v_exp_f32 v32,v32
 mf a[64:67],v[68:71],a[132:135],a[64:67]
 rt a[146:147],v218 offset:53248
 v_and_b32 v227,384,v251
 mf a[68:71],v[84:87],a[132:135],a[68:71]
 v_exp_f32 v33,v33
 mf a[68:71],v[80:83],a[128:131],a[68:71]
 rt a[148:149],v218 offset:57344
 pk v32,v32,v33
 mf a[72:75],v[96:99],a[128:131],a[72:75]
 v_exp_f32 v34,v34
 mf a[72:75],v[100:103],a[132:135],a[72:75]
 v_exp_f32 v35,v35
 mf a[76:79],v[116:119],a[132:135],a[76:79]
 rt a[150:151],v218 offset:61440
 pk v33,v34,v35
 mf a[76:79],v[112:115],a[128:131],a[76:79]
 s_waitcnt lgkmcnt(4)
 v_exp_f32 v36,v36
 mf a[92:95],v[112:115],a[136:139],a[92:95]
 rt a[152:153],v219 offset:49152
 v_add3_u32 v226,v226,v227,s55
 mf a[92:95],v[116:119],a[140:143],a[92:95]
 v_exp_f32 v37,v37
 mf a[88:91],v[100:103],a[140:143],a[88:91]
 rt a[154:155],v219 offset:53248
 mf a[88:91],v[96:99],a[136:139],a[88:91]
 bl v224,s[12:15],s63 offen offset:2048 lds
 mf a[84:87],v[80:83],a[136:139],a[84:87]
 rt a[156:157],v219 offset:57344
 pk v34,v36,v37
 mf a[84:87],v[84:87],a[140:143],a[84:87]
 v_exp_f32 v38,v38
 mf a[80:83],v[68:71],a[140:143],a[80:83]
 v_exp_f32 v39,v39
 mf a[80:83],v[64:67],a[136:139],a[80:83]
 s_waitcnt lgkmcnt(3)
 rt a[158:159],v219 offset:61440
 pk v35,v38,v39
 mf a[96:99],v[64:67],a[144:147],a[96:99]
 v_exp_f32 v48,v48
 mf a[96:99],v[68:71],a[148:151],a[96:99]
 buffer_load_dword a255,v226,s[36:39],0 offen
 mf a[100:103],v[84:87],a[148:151],a[100:103]
 v_exp_f32 v49,v49
 mf a[100:103],v[80:83],a[144:147],a[100:103]
 pk v48,v48,v49
 v_lshrrev_b32 v226,7,v251
 mf a[104:107],v[96:99],a[144:147],a[104:107]
 v_exp_f32 v50,v50
 mf a[104:107],v[100:103],a[148:151],a[104:107]
 rq a[128:131],v208 offset:16384
 v_min_u32 v226,15,v226
 mf a[108:111],v[116:119],a[148:151],a[108:111]
 s_mul_i32 s55,s91,16
 v_exp_f32 v51,v51
 mf a[108:111],v[112:115],a[144:147],a[108:111]
 s_waitcnt lgkmcnt(1)
 v_exp_f32 v52,v52
 mf a[124:127],v[112:115],a[152:155],a[124:127]
 rq a[132:135],v209 offset:16384
 pk v49,v50,v51
 mf a[124:127],v[116:119],a[156:159],a[124:127]
 v_exp_f32 v53,v53
 mf a[120:123],v[100:103],a[156:159],a[120:123]
 rq a[136:139],v210 offset:16384
 mf a[120:123],v[96:99],a[152:155],a[120:123]
 bl v225,s[12:15],s63 offen offset:3072 lds
 mf a[116:119],v[80:83],a[152:155],a[116:119]
 rq a[140:143],v211 offset:16384
 pk v50,v52,v53
 mf a[116:119],v[84:87],a[156:159],a[116:119]
 v_exp_f32 v54,v54
 mf a[112:115],v[68:71],a[156:159],a[112:115]
 v_add_u32 v226,s55,v226
 v_mul_u32_u24 v226,128,v226
 mf a[112:115],v[64:67],a[152:155],a[112:115]
 s_lshl_b32 s55,s89,9
 v_exp_f32 v55,v55
 v_smfmac_f32_16x16x64_bf16 a[192:195],a[208:211],v[64:71],v250
 pk v51,v54,v55
 v_smfmac_f32_16x16x64_bf16 a[196:199],a[208:211],v[80:87],v250
 s_waitcnt vmcnt(14)
 v_add_u32 v226,s55,v226
 v_smfmac_f32_16x16x64_bf16 a[200:203],a[208:211],v[96:103],v250
 s_barrier
 buffer_load_dword a255,v226,s[40:43],0 offen
 v_smfmac_f32_16x16x64_bf16 a[204:207],a[208:211],v[112:119],v250
 s_waitcnt lgkmcnt(0)
 s_lshl_b32 s55,s54,8
 mf v[64:67],a[128:131],v[128:131],v[192:195]
 v_exp_f32 v8,v8
 mf v[64:67],a[132:135],v[132:135],v[64:67]
 s_add_u32 m0,s61,0
 v_exp_f32 v9,v9
 mf v[64:67],a[136:139],v[136:139],v[64:67]
 s_mov_b32 s63,327680
 rq a[144:147],v208 offset:20480
 mf v[64:67],a[140:143],v[140:143],v[64:67]
 bl v220,s[8:11],s63 offen offset:0 lds
 mf v[80:83],a[140:143],v[156:159],v[196:199]
 rq a[148:151],v209 offset:20480
 pk v4,v8,v9
 mf v[80:83],a[136:139],v[152:155],v[80:83]
 v_exp_f32 v10,v10
 mf v[80:83],a[132:135],v[148:151],v[80:83]
 rq a[152:155],v210 offset:20480
 v_lshrrev_b32 v226,10,v251
 mf v[80:83],a[128:131],v[144:147],v[80:83]
 v_exp_f32 v11,v11
 mf v[96:99],a[128:131],v[160:163],v[200:203]
 rq a[156:159],v211 offset:20480
 pk v5,v10,v11
 mf v[96:99],a[132:135],v[164:167],v[96:99]
 v_exp_f32 v12,v12
 mf v[96:99],a[136:139],v[168:171],v[96:99]
 v_exp_f32 v13,v13
 mf v[96:99],a[140:143],v[172:175],v[96:99]
 pk v6,v12,v13
 v_bfe_u32 v227,v255,4,3
 mf v[112:115],a[140:143],v[188:191],v[204:207]
 v_exp_f32 v14,v14
 mf v[112:115],a[136:139],v[184:187],v[112:115]
 v_and_b32 v239,6,v226
 v_xor_b32 v227,v227,v239
 mf v[112:115],a[132:135],v[180:183],v[112:115]
 v_exp_f32 v15,v15
 mf v[112:115],a[128:131],v[176:179],v[112:115]
 s_waitcnt lgkmcnt(0)
 pk v7,v14,v15
 v_mul_u32_u24 v226,1024,v226
 mf v[116:119],a[144:147],v[176:179],v[204:207]
 v_exp_f32 v24,v24
 mf v[116:119],a[148:151],v[180:183],v[116:119]
 v_exp_f32 v25,v25
 mf v[116:119],a[152:155],v[184:187],v[116:119]
 rq a[128:131],v208 offset:24576
 mf v[116:119],a[156:159],v[188:191],v[116:119]
L_pad_pg14:
 s_cbranch_execz L_hop3
 bl v221,s[8:11],s63 offen offset:1024 lds
 mf v[100:103],a[156:159],v[172:175],v[200:203]
 rq a[132:135],v209 offset:24576
 pk v20,v24,v25
 mf v[100:103],a[152:155],v[168:171],v[100:103]
 v_exp_f32 v26,v26
 mf v[100:103],a[148:151],v[164:167],v[100:103]
 rq a[136:139],v210 offset:24576
 v_lshl_add_u32 v226,v227,4,v226
 mf v[100:103],a[144:147],v[160:163],v[100:103]
 v_exp_f32 v27,v27
 mf v[84:87],a[144:147],v[144:147],v[196:199]
 rq a[140:143],v211 offset:24576
 pk v21,v26,v27
 mf v[84:87],a[148:151],v[148:151],v[84:87]
 v_exp_f32 v28,v28
 mf v[84:87],a[152:155],v[152:155],v[84:87]
 v_exp_f32 v29,v29
 mf v[84:87],a[156:159],v[156:159],v[84:87]
 pk v22,v28,v29
 v_add_u32 v239,s55,v226
 mf v[68:71],a[156:159],v[140:143],v[192:195]
 s_lshl_b32 s55,s52,19
 v_exp_f32 v30,v30
 mf v[68:71],a[152:155],v[136:139],v[68:71]
 v_add_u32 v238,s55,v239
 s_lshl_b32 s55,s89,9
 mf v[68:71],a[148:151],v[132:135],v[68:71]
 v_exp_f32 v31,v31
 mf v[68:71],a[144:147],v[128:131],v[68:71]
 s_waitcnt lgkmcnt(0)
 pk v23,v30,v31
 v_add_u32 v239,s55,v239
 mf v[72:75],a[128:131],v[128:131],v[192:195]
 s_and_b32 s55,s52,1
 v_exp_f32 v40,v40
 mf v[72:75],a[132:135],v[132:135],v[72:75]
 s_sub_u32 s55,4,s55
 v_exp_f32 v41,v41
 mf v[72:75],a[136:139],v[136:139],v[72:75]
 rq a[144:147],v208 offset:28672
 mf v[72:75],a[140:143],v[140:143],v[72:75]
 bl v222,s[8:11],s63 offen offset:2048 lds
 mf v[88:91],a[140:143],v[156:159],v[196:199]
 s_mul_i32 s55,s55,s54
 rq a[148:151],v209 offset:28672
 pk v36,v40,v41
 mf v[88:91],a[136:139],v[152:155],v[88:91]
 s_and_b32 s56,s55,3
 v_exp_f32 v42,v42
 mf v[88:91],a[132:135],v[148:151],v[88:91]
 s_lshl_b32 s56,s56,5
 rq a[152:155],v210 offset:28672
 v_xor_b32 v230,s56,v244
 mf v[88:91],a[128:131],v[144:147],v[88:91]
 s_lshr_b32 s56,s55,2
 v_exp_f32 v43,v43
 mf v[104:107],a[128:131],v[160:163],v[200:203]
 s_lshl_b32 s56,s56,13
 rq a[156:159],v211 offset:28672
 pk v37,v42,v43
 mf v[104:107],a[132:135],v[164:167],v[104:107]
 v_exp_f32 v44,v44
 mf v[104:107],a[136:139],v[168:171],v[104:107]
 v_exp_f32 v45,v45
 mf v[104:107],a[140:143],v[172:175],v[104:107]
 pk v38,v44,v45
 v_add_u32 v230,s56,v230
 mf v[120:123],a[140:143],v[188:191],v[204:207]
 v_exp_f32 v46,v46
 mf v[120:123],a[136:139],v[184:187],v[120:123]
 v_add_u32 v226,0xffff0000,v230
 s_add_u32 s55,s55,1
 mf v[120:123],a[132:135],v[180:183],v[120:123]
 s_and_b32 s56,s55,3
 v_exp_f32 v47,v47
 mf v[120:123],a[128:131],v[176:179],v[120:123]
 s_waitcnt lgkmcnt(0)
 rt a[130:131],v212 offset:4096
 pk v39,v46,v47
 mf v[124:127],a[144:147],v[176:179],v[204:207]
 s_lshl_b32 s56,s56,5
 v_exp_f32 v56,v56
 mf v[124:127],a[148:151],v[180:183],v[124:127]
 v_exp_f32 v57,v57
 mf v[124:127],a[152:155],v[184:187],v[124:127]
 rt a[128:129],v212 offset:0
 rt a[132:133],v212 offset:8192
 mf v[124:127],a[156:159],v[188:191],v[124:127]
 bl v223,s[8:11],s63 offen offset:3072 lds
 mf v[108:111],a[156:159],v[172:175],v[200:203]
 rt a[134:135],v212 offset:12288
 pk v52,v56,v57
 mf v[108:111],a[152:155],v[168:171],v[108:111]
 v_exp_f32 v58,v58
 mf v[108:111],a[148:151],v[164:167],v[108:111]
 rt a[136:137],v213 offset:0
 v_xor_b32 v231,s56,v244
 mf v[108:111],a[144:147],v[160:163],v[108:111]
 s_lshr_b32 s56,s55,2
 v_exp_f32 v59,v59
 mf v[92:95],a[144:147],v[144:147],v[196:199]
 s_lshl_b32 s56,s56,13
 rt a[138:139],v213 offset:4096
 pk v53,v58,v59
 mf v[92:95],a[148:151],v[148:151],v[92:95]
 v_exp_f32 v60,v60
 mf v[92:95],a[152:155],v[152:155],v[92:95]
 v_exp_f32 v61,v61
 mf v[92:95],a[156:159],v[156:159],v[92:95]
 rt a[140:141],v213 offset:8192
 pk v54,v60,v61
 mf v[76:79],a[156:159],v[140:143],v[192:195]
 v_exp_f32 v62,v62
 mf v[76:79],a[152:155],v[136:139],v[76:79]
 rt a[142:143],v213 offset:12288
 v_add_u32 v231,s56,v231
 mf v[76:79],a[148:151],v[132:135],v[76:79]
 v_exp_f32 v63,v63
 mf v[76:79],a[144:147],v[128:131],v[76:79]
 s_waitcnt lgkmcnt(4)
 rt a[148:149],v214 offset:8192
 pk v55,v62,v63
 mf a[0:3],v[0:3],a[128:131],a[0:3]
 v_exp_f32 v64,v64
 mf a[0:3],v[4:7],a[132:135],a[0:3]
 v_exp_f32 v65,v65
 mf a[4:7],v[20:23],a[132:135],a[4:7]
 rt a[150:151],v214 offset:12288
 pk v64,v64,v65
 mf a[4:7],v[16:19],a[128:131],a[4:7]
 v_exp_f32 v66,v66
 mf a[8:11],v[32:35],a[128:131],a[8:11]
 rt a[146:147],v214 offset:4096
 rt a[152:153],v215 offset:0
 mf a[8:11],v[36:39],a[132:135],a[8:11]
 v_exp_f32 v67,v67
 mf a[12:15],v[52:55],a[132:135],a[12:15]
 rt a[154:155],v215 offset:4096
 pk v65,v66,v67
 mf a[12:15],v[48:51],a[128:131],a[12:15]
 s_waitcnt lgkmcnt(5)
 v_exp_f32 v68,v68
 mf a[28:31],v[48:51],a[136:139],a[28:31]
 v_exp_f32 v69,v69
 mf a[28:31],v[52:55],a[140:143],a[28:31]
 s_add_u32 m0,s61,114688
 rt a[156:157],v215 offset:8192
 pk v66,v68,v69
 mf a[24:27],v[36:39],a[140:143],a[24:27]
 s_mov_b32 s63,311296
 rt a[144:145],v214 offset:0
 rt a[158:159],v215 offset:12288
 mf a[24:27],v[32:35],a[136:139],a[24:27]
 bl v224,s[12:15],s63 offen offset:0 lds
 mf a[20:23],v[16:19],a[136:139],a[20:23]
 v_exp_f32 v70,v70
 mf a[20:23],v[20:23],a[140:143],a[20:23]
 rt a[128:129],v216 offset:0
 v_add_u32 v227,0xffff0000,v231
 mf a[16:19],v[4:7],a[140:143],a[16:19]
 s_add_u32 s55,s55,1
 v_exp_f32 v71,v71
 mf a[16:19],v[0:3],a[136:139],a[16:19]
 s_waitcnt lgkmcnt(2)
 rt a[130:131],v216 offset:4096
 pk v67,v70,v71
 mf a[32:35],v[0:3],a[144:147],a[32:35]
 s_and_b32 s56,s55,3
 v_exp_f32 v80,v80
 mf a[32:35],v[4:7],a[148:151],a[32:35]
 s_lshl_b32 s56,s56,5
 rt a[132:133],v216 offset:8192
 v_xor_b32 v232,s56,v244
 mf a[36:39],v[20:23],a[148:151],a[36:39]
 s_lshr_b32 s56,s55,2
 v_exp_f32 v81,v81
 mf a[36:39],v[16:19],a[144:147],a[36:39]
 s_lshl_b32 s56,s56,13
 v_exp_f32 v82,v82
 mf a[40:43],v[32:35],a[144:147],a[40:43]
 rt a[134:135],v216 offset:12288
 pk v80,v80,v81
 mf a[40:43],v[36:39],a[148:151],a[40:43]
 v_exp_f32 v83,v83
 mf a[44:47],v[52:55],a[148:151],a[44:47]
 rt a[136:137],v217 offset:0
 pk v81,v82,v83
 mf a[44:47],v[48:51],a[144:147],a[44:47]
 s_waitcnt lgkmcnt(5)
 v_exp_f32 v84,v84
 mf a[60:63],v[48:51],a[152:155],a[60:63]
 rt a[138:139],v217 offset:4096
 v_add_u32 v232,s56,v232
 mf a[60:63],v[52:55],a[156:159],a[60:63]
 v_exp_f32 v85,v85
 mf a[56:59],v[36:39],a[156:159],a[56:59]
 rt a[140:141],v217 offset:8192
 mf a[56:59],v[32:35],a[152:155],a[56:59]
 bl v225,s[12:15],s63 offen offset:1024 lds
 mf a[52:55],v[16:19],a[152:155],a[52:55]
 v_exp_f32 v86,v86
 mf a[52:55],v[20:23],a[156:159],a[52:55]
 rt a[142:143],v217 offset:12288
 pk v82,v84,v85
 mf a[48:51],v[4:7],a[156:159],a[48:51]
 v_exp_f32 v87,v87
 mf a[48:51],v[0:3],a[152:155],a[48:51]
 s_waitcnt lgkmcnt(4)
 rt a[144:145],v218 offset:0
 pk v83,v86,v87
 mf a[64:67],v[0:3],a[128:131],a[64:67]
 v_exp_f32 v96,v96
 mf a[64:67],v[4:7],a[132:135],a[64:67]
 rt a[146:147],v218 offset:4096
 v_add_u32 v228,0xffff0000,v232
 mf a[68:71],v[20:23],a[132:135],a[68:71]
 s_add_u32 s55,s55,1
 v_exp_f32 v97,v97
 mf a[68:71],v[16:19],a[128:131],a[68:71]
 s_and_b32 s56,s55,3
 rt a[148:149],v218 offset:8192
 pk v96,v96,v97
 mf a[72:75],v[32:35],a[128:131],a[72:75]
 s_lshl_b32 s56,s56,5
 v_exp_f32 v98,v98
 mf a[72:75],v[36:39],a[132:135],a[72:75]
 v_exp_f32 v99,v99
 mf a[76:79],v[52:55],a[132:135],a[76:79]
 rt a[150:151],v218 offset:12288
 pk v97,v98,v99
 mf a[76:79],v[48:51],a[128:131],a[76:79]
 s_waitcnt lgkmcnt(4)
 v_exp_f32 v100,v100
 mf a[92:95],v[48:51],a[136:139],a[92:95]
 rt a[152:153],v219 offset:0
 v_xor_b32 v233,s56,v244
 mf a[92:95],v[52:55],a[140:143],a[92:95]
 s_lshr_b32 s56,s55,2
 v_exp_f32 v101,v101
 mf a[88:91],v[36:39],a[140:143],a[88:91]
 rt a[154:155],v219 offset:4096
 mf a[88:91],v[32:35],a[136:139],a[88:91]
 bl v224,s[12:15],s63 offen offset:2048 lds
 mf a[84:87],v[16:19],a[136:139],a[84:87]
 s_lshl_b32 s56,s56,13
 rt a[156:157],v219 offset:8192
 pk v98,v100,v101
 mf a[84:87],v[20:23],a[140:143],a[84:87]
 v_exp_f32 v102,v102
 mf a[80:83],v[4:7],a[140:143],a[80:83]
 v_exp_f32 v103,v103
 mf a[80:83],v[0:3],a[136:139],a[80:83]
 s_waitcnt lgkmcnt(3)
 rt a[158:159],v219 offset:12288
 pk v99,v102,v103
 mf a[96:99],v[0:3],a[144:147],a[96:99]
 v_exp_f32 v112,v112
 mf a[96:99],v[4:7],a[148:151],a[96:99]
 v_add_u32 v233,s56,v233
 v_add_u32 v229,0xffff0000,v233
 mf a[100:103],v[20:23],a[148:151],a[100:103]
 s_add_u32 s55,s55,1
 v_exp_f32 v113,v113
 mf a[100:103],v[16:19],a[144:147],a[100:103]
 pk v112,v112,v113
 mf a[104:107],v[32:35],a[144:147],a[104:107]
 v_exp_f32 v114,v114
 mf a[104:107],v[36:39],a[148:151],a[104:107]
 rq a[128:131],v208 offset:32768
 mf a[108:111],v[52:55],a[148:151],a[108:111]
 v_exp_f32 v115,v115
 mf a[108:111],v[48:51],a[144:147],a[108:111]
 s_waitcnt lgkmcnt(1)
 v_exp_f32 v116,v116
 mf a[124:127],v[48:51],a[152:155],a[124:127]
 rq a[132:135],v209 offset:32768
 pk v113,v114,v115
 mf a[124:127],v[52:55],a[156:159],a[124:127]
 v_exp_f32 v117,v117
 mf a[120:123],v[36:39],a[156:159],a[120:123]
 rq a[136:139],v210 offset:32768
 mf a[120:123],v[32:35],a[152:155],a[120:123]
 bl v225,s[12:15],s63 offen offset:3072 lds
 mf a[116:119],v[16:19],a[152:155],a[116:119]
 rq a[140:143],v211 offset:32768
 pk v114,v116,v117
 mf a[116:119],v[20:23],a[156:159],a[116:119]
 v_exp_f32 v118,v118
 mf a[112:115],v[4:7],a[156:159],a[112:115]
 mf a[112:115],v[0:3],a[152:155],a[112:115]
 v_exp_f32 v119,v119
 v_smfmac_f32_16x16x64_bf16 a[192:195],a[208:211],v[0:7],v250
 pk v115,v118,v119
 v_smfmac_f32_16x16x64_bf16 a[196:199],a[208:211],v[16:23],v250
 s_waitcnt vmcnt(15)
 v_smfmac_f32_16x16x64_bf16 a[200:203],a[208:211],v[32:39],v250
 s_barrier
 v_smfmac_f32_16x16x64_bf16 a[204:207],a[208:211],v[48:55],v250
 s_waitcnt lgkmcnt(0)
 mf v[0:3],a[128:131],v[128:131],v[192:195]
 v_exp_f32 v72,v72
 mf v[0:3],a[132:135],v[132:135],v[0:3]
 s_add_u32 m0,s61,16384
 v_exp_f32 v73,v73
 mf v[0:3],a[136:139],v[136:139],v[0:3]
 s_mov_b32 s63,344064
 rq a[144:147],v208 offset:36864
 mf v[0:3],a[140:143],v[140:143],v[0:3]
 bl v220,s[8:11],s63 offen offset:0 lds
 mf v[16:19],a[140:143],v[156:159],v[196:199]
 rq a[148:151],v209 offset:36864
 pk v68,v72,v73
 mf v[16:19],a[136:139],v[152:155],v[16:19]
 v_exp_f32 v74,v74
 mf v[16:19],a[132:135],v[148:151],v[16:19]
 rq a[152:155],v210 offset:36864
 mf v[16:19],a[128:131],v[144:147],v[16:19]
 v_exp_f32 v75,v75
 mf v[32:35],a[128:131],v[160:163],v[200:203]
 rq a[156:159],v211 offset:36864
 pk v69,v74,v75
 mf v[32:35],a[132:135],v[164:167],v[32:35]
 v_exp_f32 v76,v76
 mf v[32:35],a[136:139],v[168:171],v[32:35]
 v_exp_f32 v77,v77
 mf v[32:35],a[140:143],v[172:175],v[32:35]
 pk v70,v76,v77
 mf v[48:51],a[140:143],v[188:191],v[204:207]
 v_exp_f32 v78,v78
 mf v[48:51],a[136:139],v[184:187],v[48:51]
 mf v[48:51],a[132:135],v[180:183],v[48:51]
 v_exp_f32 v79,v79
 mf v[48:51],a[128:131],v[176:179],v[48:51]
 s_waitcnt lgkmcnt(0)
 pk v71,v78,v79
 mf v[52:55],a[144:147],v[176:179],v[204:207]
 v_exp_f32 v88,v88
 mf v[52:55],a[148:151],v[180:183],v[52:55]
 v_exp_f32 v89,v89
 mf v[52:55],a[152:155],v[184:187],v[52:55]
 rq a[128:131],v208 offset:40960
 mf v[52:55],a[156:159],v[188:191],v[52:55]
 bl v221,s[8:11],s63 offen offset:1024 lds
 mf v[36:39],a[156:159],v[172:175],v[200:203]
 rq a[132:135],v209 offset:40960
 pk v84,v88,v89
 mf v[36:39],a[152:155],v[168:171],v[36:39]
 v_exp_f32 v90,v90
 mf v[36:39],a[148:151],v[164:167],v[36:39]
 rq a[136:139],v210 offset:40960
 mf v[36:39],a[144:147],v[160:163],v[36:39]
 v_exp_f32 v91,v91
 mf v[20:23],a[144:147],v[144:147],v[196:199]
 rq a[140:143],v211 offset:40960
 pk v85,v90,v91
 mf v[20:23],a[148:151],v[148:151],v[20:23]
 v_exp_f32 v92,v92
 mf v[20:23],a[152:155],v[152:155],v[20:23]
 v_exp_f32 v93,v93
 mf v[20:23],a[156:159],v[156:159],v[20:23]
 pk v86,v92,v93
 mf v[4:7],a[156:159],v[140:143],v[192:195]
 v_exp_f32 v94,v94
 mf v[4:7],a[152:155],v[136:139],v[4:7]
 mf v[4:7],a[148:151],v[132:135],v[4:7]
 v_exp_f32 v95,v95
 mf v[4:7],a[144:147],v[128:131],v[4:7]
 s_waitcnt lgkmcnt(0)
 pk v87,v94,v95
 mf v[8:11],a[128:131],v[128:131],v[192:195]
 v_exp_f32 v104,v104
 mf v[8:11],a[132:135],v[132:135],v[8:11]
 v_exp_f32 v105,v105
 mf v[8:11],a[136:139],v[136:139],v[8:11]
 rq a[144:147],v208 offset:45056
 mf v[8:11],a[140:143],v[140:143],v[8:11]
 bl v222,s[8:11],s63 offen offset:2048 lds
 mf v[24:27],a[140:143],v[156:159],v[196:199]
 rq a[148:151],v209 offset:45056
 pk v100,v104,v105
 mf v[24:27],a[136:139],v[152:155],v[24:27]
 v_exp_f32 v106,v106
 mf v[24:27],a[132:135],v[148:151],v[24:27]
 rq a[152:155],v210 offset:45056
 mf v[24:27],a[128:131],v[144:147],v[24:27]
 v_exp_f32 v107,v107
 mf v[40:43],a[128:131],v[160:163],v[200:203]
 rq a[156:159],v211 offset:45056
 pk v101,v106,v107
 mf v[40:43],a[132:135],v[164:167],v[40:43]
 v_exp_f32 v108,v108
 mf v[40:43],a[136:139],v[168:171],v[40:43]
 v_exp_f32 v109,v109
 mf v[40:43],a[140:143],v[172:175],v[40:43]
 pk v102,v108,v109
 mf v[56:59],a[140:143],v[188:191],v[204:207]
 v_exp_f32 v110,v110
 mf v[56:59],a[136:139],v[184:187],v[56:59]
 mf v[56:59],a[132:135],v[180:183],v[56:59]
 v_exp_f32 v111,v111
 mf v[56:59],a[128:131],v[176:179],v[56:59]
 s_waitcnt lgkmcnt(0)
 rt a[130:131],v212 offset:20480
 pk v103,v110,v111
 mf v[60:63],a[144:147],v[176:179],v[204:207]
 v_exp_f32 v120,v120
 mf v[60:63],a[148:151],v[180:183],v[60:63]
 v_exp_f32 v121,v121
 mf v[60:63],a[152:155],v[184:187],v[60:63]
 rt a[128:129],v212 offset:16384
 rt a[132:133],v212 offset:24576
 mf v[60:63],a[156:159],v[188:191],v[60:63]
 bl v223,s[8:11],s63 offen offset:3072 lds
 mf v[44:47],a[156:159],v[172:175],v[200:203]
 rt a[134:135],v212 offset:28672
 pk v116,v120,v121
 mf v[44:47],a[152:155],v[168:171],v[44:47]
 v_exp_f32 v122,v122
 mf v[44:47],a[148:151],v[164:167],v[44:47]
 rt a[136:137],v213 offset:16384
 mf v[44:47],a[144:147],v[160:163],v[44:47]
 v_exp_f32 v123,v123
 mf v[28:31],a[144:147],v[144:147],v[196:199]
 rt a[138:139],v213 offset:20480
 pk v117,v122,v123
 mf v[28:31],a[148:151],v[148:151],v[28:31]
 v_exp_f32 v124,v124
 mf v[28:31],a[152:155],v[152:155],v[28:31]
 v_exp_f32 v125,v125
 mf v[28:31],a[156:159],v[156:159],v[28:31]
 rt a[140:141],v213 offset:24576
 pk v118,v124,v125
 mf v[12:15],a[156:159],v[140:143],v[192:195]
 v_exp_f32 v126,v126
 mf v[12:15],a[152:155],v[136:139],v[12:15]
 rt a[142:143],v213 offset:28672
 buffer_load_dword v241,v242,s[16:19],s71 offen sc1
 mf v[12:15],a[148:151],v[132:135],v[12:15]
 v_exp_f32 v127,v127
 mf v[12:15],a[144:147],v[128:131],v[12:15]
 s_waitcnt lgkmcnt(4)
 rt a[148:149],v214 offset:24576
 pk v119,v126,v127
 mf a[0:3],v[64:67],a[128:131],a[0:3]
 v_exp_f32 v0,v0
 mf a[0:3],v[68:71],a[132:135],a[0:3]
 v_exp_f32 v1,v1
 mf a[4:7],v[84:87],a[132:135],a[4:7]
 rt a[150:151],v214 offset:28672
 pk v0,v0,v1
 mf a[4:7],v[80:83],a[128:131],a[4:7]
 v_exp_f32 v2,v2
 mf a[8:11],v[96:99],a[128:131],a[8:11]
 rt a[146:147],v214 offset:20480
 rt a[152:153],v215 offset:16384
 mf a[8:11],v[100:103],a[132:135],a[8:11]
 v_exp_f32 v3,v3
 mf a[12:15],v[116:119],a[132:135],a[12:15]
 rt a[154:155],v215 offset:20480
 pk v1,v2,v3
 mf a[12:15],v[112:115],a[128:131],a[12:15]
 s_waitcnt lgkmcnt(5)
 v_exp_f32 v4,v4
 mf a[28:31],v[112:115],a[136:139],a[28:31]
 v_exp_f32 v5,v5
 mf a[28:31],v[116:119],a[140:143],a[28:31]
 s_add_u32 m0,s61,65536
 rt a[156:157],v215 offset:24576
 pk v2,v4,v5
 mf a[24:27],v[100:103],a[140:143],a[24:27]
 s_mov_b32 s63,327680
 rt a[144:145],v214 offset:16384
 rt a[158:159],v215 offset:28672
 mf a[24:27],v[96:99],a[136:139],a[24:27]
 bl v224,s[12:15],s63 offen offset:0 lds
 mf a[20:23],v[80:83],a[136:139],a[20:23]
 v_exp_f32 v6,v6
 mf a[20:23],v[84:87],a[140:143],a[20:23]
 rt a[128:129],v216 offset:16384
 global_load_dword a255,v[248:249],off
 mf a[16:19],v[68:71],a[140:143],a[16:19]
 v_exp_f32 v7,v7
 mf a[16:19],v[64:67],a[136:139],a[16:19]
 s_waitcnt lgkmcnt(2)
 rt a[130:131],v216 offset:20480
 pk v3,v6,v7
 mf a[32:35],v[64:67],a[144:147],a[32:35]
 v_exp_f32 v16,v16
 mf a[32:35],v[68:71],a[148:151],a[32:35]
 rt a[132:133],v216 offset:24576
 mf a[36:39],v[84:87],a[148:151],a[36:39]
 v_exp_f32 v17,v17
 mf a[36:39],v[80:83],a[144:147],a[36:39]
 v_exp_f32 v18,v18
 mf a[40:43],v[96:99],a[144:147],a[40:43]
 rt a[134:135],v216 offset:28672
 pk v16,v16,v17
 mf a[40:43],v[100:103],a[148:151],a[40:43]
 v_exp_f32 v19,v19
 mf a[44:47],v[116:119],a[148:151],a[44:47]
 rt a[136:137],v217 offset:16384
 pk v17,v18,v19
 mf a[44:47],v[112:115],a[144:147],a[44:47]
 s_waitcnt lgkmcnt(5)
 v_exp_f32 v20,v20
 mf a[60:63],v[112:115],a[152:155],a[60:63]
 rt a[138:139],v217 offset:20480
 mf a[60:63],v[116:119],a[156:159],a[60:63]
 v_exp_f32 v21,v21
 mf a[56:59],v[100:103],a[156:159],a[56:59]
 rt a[140:141],v217 offset:24576
 mf a[56:59],v[96:99],a[152:155],a[56:59]
 bl v225,s[12:15],s63 offen offset:1024 lds
 mf a[52:55],v[80:83],a[152:155],a[52:55]
 v_exp_f32 v22,v22
 mf a[52:55],v[84:87],a[156:159],a[52:55]
 rt a[142:143],v217 offset:28672
 pk v18,v20,v21
 mf a[48:51],v[68:71],a[156:159],a[48:51]
 v_exp_f32 v23,v23
 mf a[48:51],v[64:67],a[152:155],a[48:51]
 s_waitcnt lgkmcnt(4)
 rt a[144:145],v218 offset:16384
 pk v19,v22,v23
 mf a[64:67],v[64:67],a[128:131],a[64:67]
 v_exp_f32 v32,v32
 mf a[64:67],v[68:71],a[132:135],a[64:67]
 rt a[146:147],v218 offset:20480
 mf a[68:71],v[84:87],a[132:135],a[68:71]
 v_exp_f32 v33,v33
 mf a[68:71],v[80:83],a[128:131],a[68:71]
 rt a[148:149],v218 offset:24576
 pk v32,v32,v33
 mf a[72:75],v[96:99],a[128:131],a[72:75]
 v_exp_f32 v34,v34
 mf a[72:75],v[100:103],a[132:135],a[72:75]
 v_exp_f32 v35,v35
 mf a[76:79],v[116:119],a[132:135],a[76:79]
 rt a[150:151],v218 offset:28672
 pk v33,v34,v35
 mf a[76:79],v[112:115],a[128:131],a[76:79]
 s_waitcnt lgkmcnt(4)
 v_exp_f32 v36,v36
 mf a[92:95],v[112:115],a[136:139],a[92:95]
 rt a[152:153],v219 offset:16384
 mf a[92:95],v[116:119],a[140:143],a[92:95]
 v_exp_f32 v37,v37
 mf a[88:91],v[100:103],a[140:143],a[88:91]
 rt a[154:155],v219 offset:20480
 mf a[88:91],v[96:99],a[136:139],a[88:91]
 bl v224,s[12:15],s63 offen offset:2048 lds
 mf a[84:87],v[80:83],a[136:139],a[84:87]
 rt a[156:157],v219 offset:24576
 pk v34,v36,v37
 mf a[84:87],v[84:87],a[140:143],a[84:87]
 v_exp_f32 v38,v38
 mf a[80:83],v[68:71],a[140:143],a[80:83]
 v_exp_f32 v39,v39
 mf a[80:83],v[64:67],a[136:139],a[80:83]
 s_waitcnt lgkmcnt(3)
 rt a[158:159],v219 offset:28672
 pk v35,v38,v39
 mf a[96:99],v[64:67],a[144:147],a[96:99]
 v_exp_f32 v48,v48
 mf a[96:99],v[68:71],a[148:151],a[96:99]
 mf a[100:103],v[84:87],a[148:151],a[100:103]
 v_exp_f32 v49,v49
 mf a[100:103],v[80:83],a[144:147],a[100:103]
 pk v48,v48,v49
 mf a[104:107],v[96:99],a[144:147],a[104:107]
 v_exp_f32 v50,v50
 mf a[104:107],v[100:103],a[148:151],a[104:107]
 rq a[128:131],v208 offset:49152
 mf a[108:111],v[116:119],a[148:151],a[108:111]
 v_exp_f32 v51,v51
 mf a[108:111],v[112:115],a[144:147],a[108:111]
 s_waitcnt lgkmcnt(1)
 v_exp_f32 v52,v52
 mf a[124:127],v[112:115],a[152:155],a[124:127]
 rq a[132:135],v209 offset:49152
 pk v49,v50,v51
 mf a[124:127],v[116:119],a[156:159],a[124:127]
 v_exp_f32 v53,v53
 mf a[120:123],v[100:103],a[156:159],a[120:123]
 rq a[136:139],v210 offset:49152
 mf a[120:123],v[96:99],a[152:155],a[120:123]
 bl v225,s[12:15],s63 offen offset:3072 lds
 mf a[116:119],v[80:83],a[152:155],a[116:119]
 rq a[140:143],v211 offset:49152
 pk v50,v52,v53
 mf a[116:119],v[84:87],a[156:159],a[116:119]
 v_exp_f32 v54,v54
 mf a[112:115],v[68:71],a[156:159],a[112:115]
 mf a[112:115],v[64:67],a[152:155],a[112:115]
 v_exp_f32 v55,v55
 v_smfmac_f32_16x16x64_bf16 a[192:195],a[208:211],v[64:71],v250
 pk v51,v54,v55
 v_smfmac_f32_16x16x64_bf16 a[196:199],a[208:211],v[80:87],v250
 s_waitcnt vmcnt(14)
 v_smfmac_f32_16x16x64_bf16 a[200:203],a[208:211],v[96:103],v250
 s_barrier
 v_smfmac_f32_16x16x64_bf16 a[204:207],a[208:211],v[112:119],v250
 s_waitcnt lgkmcnt(0)
 mf v[64:67],a[128:131],v[128:131],v[192:195]
L_pad_pg15:
 s_cbranch_execz L_hop3
 v_exp_f32 v8,v8
 mf v[64:67],a[132:135],v[132:135],v[64:67]
 s_add_u32 m0,s61,81920
 v_exp_f32 v9,v9
 mf v[64:67],a[136:139],v[136:139],v[64:67]
 s_mov_b32 s63,344064
 rq a[144:147],v208 offset:53248
 mf v[64:67],a[140:143],v[140:143],v[64:67]
 bl v224,s[12:15],s63 offen offset:0 lds
 mf v[80:83],a[140:143],v[156:159],v[196:199]
 rq a[148:151],v209 offset:53248
 pk v4,v8,v9
 mf v[80:83],a[136:139],v[152:155],v[80:83]
 v_exp_f32 v10,v10
 mf v[80:83],a[132:135],v[148:151],v[80:83]
 rq a[152:155],v210 offset:53248
 mf v[80:83],a[128:131],v[144:147],v[80:83]
 v_exp_f32 v11,v11
 mf v[96:99],a[128:131],v[160:163],v[200:203]
 rq a[156:159],v211 offset:53248
 pk v5,v10,v11
 mf v[96:99],a[132:135],v[164:167],v[96:99]
 v_exp_f32 v12,v12
 mf v[96:99],a[136:139],v[168:171],v[96:99]
 v_exp_f32 v13,v13
 mf v[96:99],a[140:143],v[172:175],v[96:99]
 bl v225,s[12:15],s63 offen offset:1024 lds
 pk v6,v12,v13
 mf v[112:115],a[140:143],v[188:191],v[204:207]
 v_exp_f32 v14,v14
 mf v[112:115],a[136:139],v[184:187],v[112:115]
 mf v[112:115],a[132:135],v[180:183],v[112:115]
 v_exp_f32 v15,v15
 mf v[112:115],a[128:131],v[176:179],v[112:115]
 s_waitcnt lgkmcnt(0)
 bl v224,s[12:15],s63 offen offset:2048 lds
 pk v7,v14,v15
 mf v[116:119],a[144:147],v[176:179],v[204:207]
 v_exp_f32 v24,v24
 mf v[116:119],a[148:151],v[180:183],v[116:119]
 v_exp_f32 v25,v25
 mf v[116:119],a[152:155],v[184:187],v[116:119]
 rq a[128:131],v208 offset:57344
 mf v[116:119],a[156:159],v[188:191],v[116:119]
 bl v225,s[12:15],s63 offen offset:3072 lds
 mf v[100:103],a[156:159],v[172:175],v[200:203]
 rq a[132:135],v209 offset:57344
 pk v20,v24,v25
 mf v[100:103],a[152:155],v[168:171],v[100:103]
 v_exp_f32 v26,v26
 mf v[100:103],a[148:151],v[164:167],v[100:103]
 rq a[136:139],v210 offset:57344
 mf v[100:103],a[144:147],v[160:163],v[100:103]
 v_exp_f32 v27,v27
 mf v[84:87],a[144:147],v[144:147],v[196:199]
 rq a[140:143],v211 offset:57344
 pk v21,v26,v27
 mf v[84:87],a[148:151],v[148:151],v[84:87]
 v_exp_f32 v28,v28
 mf v[84:87],a[152:155],v[152:155],v[84:87]
 v_exp_f32 v29,v29
 mf v[84:87],a[156:159],v[156:159],v[84:87]
 pk v22,v28,v29
 mf v[68:71],a[156:159],v[140:143],v[192:195]
 v_exp_f32 v30,v30
 mf v[68:71],a[152:155],v[136:139],v[68:71]
 s_add_u32 m0,s62,65536
 mf v[68:71],a[148:151],v[132:135],v[68:71]
 s_mov_b32 s63,917504
 v_exp_f32 v31,v31
 mf v[68:71],a[144:147],v[128:131],v[68:71]
 s_waitcnt lgkmcnt(0)
 bl v243,s[36:39],s63 offen offset:0 lds
 pk v23,v30,v31
 mf v[72:75],a[128:131],v[128:131],v[192:195]
 v_exp_f32 v40,v40
 mf v[72:75],a[132:135],v[132:135],v[72:75]
 v_exp_f32 v41,v41
 mf v[72:75],a[136:139],v[136:139],v[72:75]
 s_mov_b32 s63,945152
 rq a[144:147],v208 offset:61440
 mf v[72:75],a[140:143],v[140:143],v[72:75]
 bl v243,s[36:39],s63 offen offset:1024 lds
 mf v[88:91],a[140:143],v[156:159],v[196:199]
 rq a[148:151],v209 offset:61440
 pk v36,v40,v41
 mf v[88:91],a[136:139],v[152:155],v[88:91]
 v_exp_f32 v42,v42
 mf v[88:91],a[132:135],v[148:151],v[88:91]
 rq a[152:155],v210 offset:61440
 mf v[88:91],a[128:131],v[144:147],v[88:91]
 v_exp_f32 v43,v43
 mf v[104:107],a[128:131],v[160:163],v[200:203]
 rq a[156:159],v211 offset:61440
 pk v37,v42,v43
 mf v[104:107],a[132:135],v[164:167],v[104:107]
 v_exp_f32 v44,v44
 mf v[104:107],a[136:139],v[168:171],v[104:107]
 v_exp_f32 v45,v45
 mf v[104:107],a[140:143],v[172:175],v[104:107]
 pk v38,v44,v45
 mf v[120:123],a[140:143],v[188:191],v[204:207]
 s_mov_b32 s63,972800
 v_exp_f32 v46,v46
 mf v[120:123],a[136:139],v[184:187],v[120:123]
 bl v243,s[36:39],s63 offen offset:2048 lds
 mf v[120:123],a[132:135],v[180:183],v[120:123]
 s_mov_b32 s63,1000448
 v_exp_f32 v47,v47
 mf v[120:123],a[128:131],v[176:179],v[120:123]
 s_waitcnt lgkmcnt(0)
 rt a[130:131],v212 offset:36864
 pk v39,v46,v47
 mf v[124:127],a[144:147],v[176:179],v[204:207]
 v_exp_f32 v56,v56
 mf v[124:127],a[148:151],v[180:183],v[124:127]
 v_exp_f32 v57,v57
 mf v[124:127],a[152:155],v[184:187],v[124:127]
 rt a[128:129],v212 offset:32768
 rt a[132:133],v212 offset:40960
 mf v[124:127],a[156:159],v[188:191],v[124:127]
 bl v243,s[36:39],s63 offen offset:3072 lds
 mf v[108:111],a[156:159],v[172:175],v[200:203]
 rt a[134:135],v212 offset:45056
 pk v52,v56,v57
 mf v[108:111],a[152:155],v[168:171],v[108:111]
 v_exp_f32 v58,v58
 mf v[108:111],a[148:151],v[164:167],v[108:111]
 rt a[136:137],v213 offset:32768
 mf v[108:111],a[144:147],v[160:163],v[108:111]
 v_exp_f32 v59,v59
 mf v[92:95],a[144:147],v[144:147],v[196:199]
 rt a[138:139],v213 offset:36864
 pk v53,v58,v59
 mf v[92:95],a[148:151],v[148:151],v[92:95]
 v_exp_f32 v60,v60
 mf v[92:95],a[152:155],v[152:155],v[92:95]
 v_exp_f32 v61,v61
 mf v[92:95],a[156:159],v[156:159],v[92:95]
 rt a[140:141],v213 offset:40960
 pk v54,v60,v61
 mf v[76:79],a[156:159],v[140:143],v[192:195]
 v_exp_f32 v62,v62
 mf v[76:79],a[152:155],v[136:139],v[76:79]
 rt a[142:143],v213 offset:45056
 s_waitcnt vmcnt(13)
 v_cmp_gt_u32 vcc,1,v241
 mf v[76:79],a[148:151],v[132:135],v[76:79]
 v_exp_f32 v63,v63
 mf v[76:79],a[144:147],v[128:131],v[76:79]
 s_waitcnt lgkmcnt(4)
 rt a[148:149],v214 offset:40960
 pk v55,v62,v63
 mf a[0:3],v[0:3],a[128:131],a[0:3]
 v_exp_f32 v64,v64
 mf a[0:3],v[4:7],a[132:135],a[0:3]
 v_exp_f32 v65,v65
 mf a[4:7],v[20:23],a[132:135],a[4:7]
 rt a[150:151],v214 offset:45056
 pk v64,v64,v65
 mf a[4:7],v[16:19],a[128:131],a[4:7]
 v_exp_f32 v66,v66
 mf a[8:11],v[32:35],a[128:131],a[8:11]
 rt a[146:147],v214 offset:36864
 rt a[152:153],v215 offset:32768
 mf a[8:11],v[36:39],a[132:135],a[8:11]
 v_exp_f32 v67,v67
 mf a[12:15],v[52:55],a[132:135],a[12:15]
 rt a[154:155],v215 offset:36864
 pk v65,v66,v67
 mf a[12:15],v[48:51],a[128:131],a[12:15]
 s_waitcnt lgkmcnt(5)
 v_exp_f32 v68,v68
 mf a[28:31],v[48:51],a[136:139],a[28:31]
 v_exp_f32 v69,v69
 mf a[28:31],v[52:55],a[140:143],a[28:31]
 s_add_u32 m0,s62,69632
 rt a[156:157],v215 offset:40960
 pk v66,v68,v69
 mf a[24:27],v[36:39],a[140:143],a[24:27]
 s_mov_b32 s63,1032192
 rt a[144:145],v214 offset:32768
 rt a[158:159],v215 offset:45056
 mf a[24:27],v[32:35],a[136:139],a[24:27]
 bl v243,s[36:39],s63 offen offset:0 lds
 mf a[20:23],v[16:19],a[136:139],a[20:23]
 v_exp_f32 v70,v70
 mf a[20:23],v[20:23],a[140:143],a[20:23]
 rt a[128:129],v216 offset:32768
 s_cbranch_vccnz L_slow_x1
L_back_x1:
 mf a[16:19],v[4:7],a[140:143],a[16:19]
 s_mov_b32 s64,2621440
 v_exp_f32 v71,v71
 mf a[16:19],v[0:3],a[136:139],a[16:19]
 s_waitcnt lgkmcnt(2)
 rt a[130:131],v216 offset:36864
 pk v67,v70,v71
 mf a[32:35],v[0:3],a[144:147],a[32:35]
 v_exp_f32 v80,v80
 mf a[32:35],v[4:7],a[148:151],a[32:35]
 rt a[132:133],v216 offset:40960
 bl a[212:215],v254,s[16:19],s64 offen sc1
 mf a[36:39],v[20:23],a[148:151],a[36:39]
 v_exp_f32 v81,v81
 mf a[36:39],v[16:19],a[144:147],a[36:39]
 v_exp_f32 v82,v82
 mf a[40:43],v[32:35],a[144:147],a[40:43]
 s_mov_b32 s64,2752512
 rt a[134:135],v216 offset:45056
 pk v80,v80,v81
 mf a[40:43],v[36:39],a[148:151],a[40:43]
 v_exp_f32 v83,v83
 mf a[44:47],v[52:55],a[148:151],a[44:47]
 rt a[136:137],v217 offset:32768
 pk v81,v82,v83
 mf a[44:47],v[48:51],a[144:147],a[44:47]
 s_waitcnt lgkmcnt(5)
 v_exp_f32 v84,v84
 mf a[60:63],v[48:51],a[152:155],a[60:63]
 rt a[138:139],v217 offset:36864
 bl a[216:219],v254,s[16:19],s64 offen sc1
 mf a[60:63],v[52:55],a[156:159],a[60:63]
 v_exp_f32 v85,v85
 mf a[56:59],v[36:39],a[156:159],a[56:59]
 s_mov_b32 s63,1059840
 rt a[140:141],v217 offset:40960
 mf a[56:59],v[32:35],a[152:155],a[56:59]
 bl v243,s[36:39],s63 offen offset:1024 lds
 mf a[52:55],v[16:19],a[152:155],a[52:55]
 v_exp_f32 v86,v86
 mf a[52:55],v[20:23],a[156:159],a[52:55]
 rt a[142:143],v217 offset:45056
 pk v82,v84,v85
 mf a[48:51],v[4:7],a[156:159],a[48:51]
 v_exp_f32 v87,v87
 mf a[48:51],v[0:3],a[152:155],a[48:51]
 s_waitcnt lgkmcnt(4)
 rt a[144:145],v218 offset:32768
 pk v83,v86,v87
 mf a[64:67],v[0:3],a[128:131],a[64:67]
 v_exp_f32 v96,v96
 mf a[64:67],v[4:7],a[132:135],a[64:67]
 rt a[146:147],v218 offset:36864
 mf a[68:71],v[20:23],a[132:135],a[68:71]
 s_mov_b32 s64,2883584
 v_exp_f32 v97,v97
 mf a[68:71],v[16:19],a[128:131],a[68:71]
 rt a[148:149],v218 offset:40960
 pk v96,v96,v97
 mf a[72:75],v[32:35],a[128:131],a[72:75]
 v_exp_f32 v98,v98
 mf a[72:75],v[36:39],a[132:135],a[72:75]
 v_exp_f32 v99,v99
 mf a[76:79],v[52:55],a[132:135],a[76:79]
 rt a[150:151],v218 offset:45056
 pk v97,v98,v99
 mf a[76:79],v[48:51],a[128:131],a[76:79]
 s_waitcnt lgkmcnt(4)
 v_exp_f32 v100,v100
 mf a[92:95],v[48:51],a[136:139],a[92:95]
 rt a[152:153],v219 offset:32768
 bl a[220:223],v254,s[16:19],s64 offen sc1
 mf a[92:95],v[52:55],a[140:143],a[92:95]
 v_exp_f32 v101,v101
 mf a[88:91],v[36:39],a[140:143],a[88:91]
 s_mov_b32 s63,1087488
 rt a[154:155],v219 offset:36864
 mf a[88:91],v[32:35],a[136:139],a[88:91]
 bl v243,s[36:39],s63 offen offset:2048 lds
 mf a[84:87],v[16:19],a[136:139],a[84:87]
 rt a[156:157],v219 offset:40960
 pk v98,v100,v101
 mf a[84:87],v[20:23],a[140:143],a[84:87]
 v_exp_f32 v102,v102
 mf a[80:83],v[4:7],a[140:143],a[80:83]
 v_exp_f32 v103,v103
 mf a[80:83],v[0:3],a[136:139],a[80:83]
 s_waitcnt lgkmcnt(3)
 rt a[158:159],v219 offset:45056
 pk v99,v102,v103
 mf a[96:99],v[0:3],a[144:147],a[96:99]
 s_mov_b32 s64,3014656
 v_exp_f32 v112,v112
 mf a[96:99],v[4:7],a[148:151],a[96:99]
 bl a[224:227],v254,s[16:19],s64 offen sc1
 mf a[100:103],v[20:23],a[148:151],a[100:103]
 v_exp_f32 v113,v113
 mf a[100:103],v[16:19],a[144:147],a[100:103]
 pk v112,v112,v113
 mf a[104:107],v[32:35],a[144:147],a[104:107]
 v_exp_f32 v114,v114
 mf a[104:107],v[36:39],a[148:151],a[104:107]
 rq a[128:131],v208 offset:0
 mf a[108:111],v[52:55],a[148:151],a[108:111]
 v_exp_f32 v115,v115
 mf a[108:111],v[48:51],a[144:147],a[108:111]
 s_waitcnt lgkmcnt(1)
 v_exp_f32 v116,v116
 mf a[124:127],v[48:51],a[152:155],a[124:127]
 rq a[132:135],v209 offset:0
 pk v113,v114,v115
 mf a[124:127],v[52:55],a[156:159],a[124:127]
 v_exp_f32 v117,v117
 mf a[120:123],v[36:39],a[156:159],a[120:123]
 s_mov_b32 s63,1115136
 rq a[136:139],v210 offset:0
 mf a[120:123],v[32:35],a[152:155],a[120:123]
 bl v243,s[36:39],s63 offen offset:3072 lds
 mf a[116:119],v[16:19],a[152:155],a[116:119]
 rq a[140:143],v211 offset:0
 pk v114,v116,v117
 mf a[116:119],v[20:23],a[156:159],a[116:119]
 v_exp_f32 v118,v118
 mf a[112:115],v[4:7],a[156:159],a[112:115]
 mf a[112:115],v[0:3],a[152:155],a[112:115]
 v_exp_f32 v119,v119
 v_smfmac_f32_16x16x64_bf16 a[192:195],a[208:211],v[0:7],v250
 pk v115,v118,v119
 v_smfmac_f32_16x16x64_bf16 a[196:199],a[208:211],v[16:23],v250
 v_smfmac_f32_16x16x64_bf16 a[200:203],a[208:211],v[32:39],v250
 s_barrier
 v_smfmac_f32_16x16x64_bf16 a[204:207],a[208:211],v[48:55],v250
 s_waitcnt lgkmcnt(0)
 mf v[0:3],a[128:131],v[128:131],v[192:195]
 v_exp_f32 v72,v72
 mf v[0:3],a[132:135],v[132:135],v[0:3]
 s_add_u32 m0,s60,32768
 v_exp_f32 v73,v73
 mf v[0:3],a[136:139],v[136:139],v[0:3]
 s_mov_b32 s63,3145728
 rq a[144:147],v208 offset:4096
 mf v[0:3],a[140:143],v[140:143],v[0:3]
 bl v254,s[16:19],s63 offen sc1 lds
 mf v[16:19],a[140:143],v[156:159],v[196:199]
 rq a[148:151],v209 offset:4096
 pk v68,v72,v73
 mf v[16:19],a[136:139],v[152:155],v[16:19]
 v_exp_f32 v74,v74
 mf v[16:19],a[132:135],v[148:151],v[16:19]
 rq a[152:155],v210 offset:4096
 v_lshrrev_b32 v234,7,v251
 mf v[16:19],a[128:131],v[144:147],v[16:19]
 v_exp_f32 v75,v75
 mf v[32:35],a[128:131],v[160:163],v[200:203]
 rq a[156:159],v211 offset:4096
 pk v69,v74,v75
 mf v[32:35],a[132:135],v[164:167],v[32:35]
 v_exp_f32 v76,v76
 mf v[32:35],a[136:139],v[168:171],v[32:35]
 v_exp_f32 v77,v77
 mf v[32:35],a[140:143],v[172:175],v[32:35]
 pk v70,v76,v77
 v_min_u32 v234,9,v234
 mf v[48:51],a[140:143],v[188:191],v[204:207]
 s_mul_i32 s55,s91,10
 v_exp_f32 v78,v78
 mf v[48:51],a[136:139],v[184:187],v[48:51]
 s_add_u32 m0,s60,36864
 v_add_u32 v234,s55,v234
 v_mul_u32_u24 v234,128,v234
 mf v[48:51],a[132:135],v[180:183],v[48:51]
 s_mov_b32 s63,3276800
 v_exp_f32 v79,v79
 mf v[48:51],a[128:131],v[176:179],v[48:51]
 s_waitcnt lgkmcnt(0)
 s_mov_b32 s55,0
 pk v71,v78,v79
 mf v[52:55],a[144:147],v[176:179],v[204:207]
 s_add_u32 s55,s55,360448
 v_exp_f32 v88,v88
 mf v[52:55],a[148:151],v[180:183],v[52:55]
 v_exp_f32 v89,v89
 mf v[52:55],a[152:155],v[184:187],v[52:55]
 rq a[128:131],v208 offset:8192
 mf v[52:55],a[156:159],v[188:191],v[52:55]
 bl v254,s[16:19],s63 offen sc1 lds
 mf v[36:39],a[156:159],v[172:175],v[200:203]
 rq a[132:135],v209 offset:8192
 pk v84,v88,v89
 mf v[36:39],a[152:155],v[168:171],v[36:39]
 v_exp_f32 v90,v90
 mf v[36:39],a[148:151],v[164:167],v[36:39]
 rq a[136:139],v210 offset:8192
 v_add_u32 v234,s55,v234
 mf v[36:39],a[144:147],v[160:163],v[36:39]
 v_exp_f32 v91,v91
 mf v[20:23],a[144:147],v[144:147],v[196:199]
 rq a[140:143],v211 offset:8192
 pk v85,v90,v91
 mf v[20:23],a[148:151],v[148:151],v[20:23]
 v_exp_f32 v92,v92
 mf v[20:23],a[152:155],v[152:155],v[20:23]
 v_exp_f32 v93,v93
 mf v[20:23],a[156:159],v[156:159],v[20:23]
 buffer_load_dword a255,v234,s[8:11],0 offen
 pk v86,v92,v93
 mf v[4:7],a[156:159],v[140:143],v[192:195]
 v_exp_f32 v94,v94
 mf v[4:7],a[152:155],v[136:139],v[4:7]
 s_add_u32 m0,s60,40960
 buffer_load_dword a255,v234,s[12:15],0 offen
 mf v[4:7],a[148:151],v[132:135],v[4:7]
 s_mov_b32 s63,3407872
 v_exp_f32 v95,v95
 mf v[4:7],a[144:147],v[128:131],v[4:7]
 s_waitcnt lgkmcnt(0)
 pk v87,v94,v95
 v_add_u32 v235,s60,v255
 mf v[8:11],a[128:131],v[128:131],v[192:195]
 v_exp_f32 v104,v104
 mf v[8:11],a[132:135],v[132:135],v[8:11]
 v_exp_f32 v105,v105
 mf v[8:11],a[136:139],v[136:139],v[8:11]
 rq a[144:147],v208 offset:12288
 mf v[8:11],a[140:143],v[140:143],v[8:11]
 bl v254,s[16:19],s63 offen sc1 lds
 mf v[24:27],a[140:143],v[156:159],v[196:199]
 rq a[148:151],v209 offset:12288
 pk v100,v104,v105
 mf v[24:27],a[136:139],v[152:155],v[24:27]
 v_exp_f32 v106,v106
 mf v[24:27],a[132:135],v[148:151],v[24:27]
 rq a[152:155],v210 offset:12288
 mf v[24:27],a[128:131],v[144:147],v[24:27]
 v_exp_f32 v107,v107
 mf v[40:43],a[128:131],v[160:163],v[200:203]
 rq a[156:159],v211 offset:12288
 pk v101,v106,v107
 mf v[40:43],a[132:135],v[164:167],v[40:43]
 v_exp_f32 v108,v108
 mf v[40:43],a[136:139],v[168:171],v[40:43]
 v_exp_f32 v109,v109
 mf v[40:43],a[140:143],v[172:175],v[40:43]
 pk v102,v108,v109
 mf v[56:59],a[140:143],v[188:191],v[204:207]
 v_exp_f32 v110,v110
 mf v[56:59],a[136:139],v[184:187],v[56:59]
 s_add_u32 m0,s60,45056
 mf v[56:59],a[132:135],v[180:183],v[56:59]
 s_mov_b32 s63,3538944
 v_exp_f32 v111,v111
 mf v[56:59],a[128:131],v[176:179],v[56:59]
 s_waitcnt lgkmcnt(0)
 rt a[130:131],v212 offset:53248
 pk v103,v110,v111
 mf v[60:63],a[144:147],v[176:179],v[204:207]
 v_exp_f32 v120,v120
 mf v[60:63],a[148:151],v[180:183],v[60:63]
 v_exp_f32 v121,v121
 mf v[60:63],a[152:155],v[184:187],v[60:63]
 rt a[128:129],v212 offset:49152
 rt a[132:133],v212 offset:57344
 mf v[60:63],a[156:159],v[188:191],v[60:63]
 bl v254,s[16:19],s63 offen sc1 lds
 mf v[44:47],a[156:159],v[172:175],v[200:203]
 rt a[134:135],v212 offset:61440
 pk v116,v120,v121
 mf v[44:47],a[152:155],v[168:171],v[44:47]
 v_exp_f32 v122,v122
 mf v[44:47],a[148:151],v[164:167],v[44:47]
 rt a[136:137],v213 offset:49152
 mf v[44:47],a[144:147],v[160:163],v[44:47]
 v_exp_f32 v123,v123
 mf v[28:31],a[144:147],v[144:147],v[196:199]
 rt a[138:139],v213 offset:53248
 pk v117,v122,v123
 mf v[28:31],a[148:151],v[148:151],v[28:31]
 v_exp_f32 v124,v124
 mf v[28:31],a[152:155],v[152:155],v[28:31]
 v_exp_f32 v125,v125
 mf v[28:31],a[156:159],v[156:159],v[28:31]
 rt a[140:141],v213 offset:57344
 pk v118,v124,v125
 mf v[12:15],a[156:159],v[140:143],v[192:195]
 v_exp_f32 v126,v126
 mf v[12:15],a[152:155],v[136:139],v[12:15]
 rt a[142:143],v213 offset:61440
 mf v[12:15],a[148:151],v[132:135],v[12:15]
 v_exp_f32 v127,v127
 mf v[12:15],a[144:147],v[128:131],v[12:15]
 s_waitcnt lgkmcnt(4)
 rt a[148:149],v214 offset:57344
 pk v119,v126,v127
 mf a[0:3],v[64:67],a[128:131],a[0:3]
 v_exp_f32 v0,v0
 mf a[0:3],v[68:71],a[132:135],a[0:3]
 v_exp_f32 v1,v1
 mf a[4:7],v[84:87],a[132:135],a[4:7]
 rt a[150:151],v214 offset:61440
 pk v0,v0,v1
 mf a[4:7],v[80:83],a[128:131],a[4:7]
 v_exp_f32 v2,v2
 mf a[8:11],v[96:99],a[128:131],a[8:11]
 rt a[146:147],v214 offset:53248
 rt a[152:153],v215 offset:49152
 mf a[8:11],v[100:103],a[132:135],a[8:11]
 v_exp_f32 v3,v3
 mf a[12:15],v[116:119],a[132:135],a[12:15]
 rt a[154:155],v215 offset:53248
 pk v1,v2,v3
 mf a[12:15],v[112:115],a[128:131],a[12:15]
 s_waitcnt lgkmcnt(5)
 v_exp_f32 v4,v4
 mf a[28:31],v[112:115],a[136:139],a[28:31]
 v_exp_f32 v5,v5
 mf a[28:31],v[116:119],a[140:143],a[28:31]
 s_add_u32 m0,s60,49152
 rt a[156:157],v215 offset:57344
 pk v2,v4,v5
 mf a[24:27],v[100:103],a[140:143],a[24:27]
 s_mov_b32 s63,3670016
 rt a[144:145],v214 offset:49152
 rt a[158:159],v215 offset:61440
 mf a[24:27],v[96:99],a[136:139],a[24:27]
 bl v254,s[16:19],s63 offen sc1 lds
 mf a[20:23],v[80:83],a[136:139],a[20:23]
 v_exp_f32 v6,v6
 mf a[20:23],v[84:87],a[140:143],a[20:23]
 rt a[128:129],v216 offset:49152
 mf a[16:19],v[68:71],a[140:143],a[16:19]
 v_exp_f32 v7,v7
 mf a[16:19],v[64:67],a[136:139],a[16:19]
 s_waitcnt lgkmcnt(2)
 rt a[130:131],v216 offset:53248
 pk v3,v6,v7
 mf a[32:35],v[64:67],a[144:147],a[32:35]
 v_exp_f32 v16,v16
 mf a[32:35],v[68:71],a[148:151],a[32:35]
 rt a[132:133],v216 offset:57344
 mf a[36:39],v[84:87],a[148:151],a[36:39]
 v_exp_f32 v17,v17
 mf a[36:39],v[80:83],a[144:147],a[36:39]
 v_exp_f32 v18,v18
 mf a[40:43],v[96:99],a[144:147],a[40:43]
 rt a[134:135],v216 offset:61440
 pk v16,v16,v17
 mf a[40:43],v[100:103],a[148:151],a[40:43]
 v_exp_f32 v19,v19
 mf a[44:47],v[116:119],a[148:151],a[44:47]
 rt a[136:137],v217 offset:49152
 pk v17,v18,v19
 mf a[44:47],v[112:115],a[144:147],a[44:47]
 s_waitcnt lgkmcnt(5)
 v_exp_f32 v20,v20
 mf a[60:63],v[112:115],a[152:155],a[60:63]
 rt a[138:139],v217 offset:53248
 mf a[60:63],v[116:119],a[156:159],a[60:63]
 s_add_u32 m0,s60,53248
 v_exp_f32 v21,v21
 mf a[56:59],v[100:103],a[156:159],a[56:59]
 s_mov_b32 s63,3801088
 rt a[140:141],v217 offset:57344
 mf a[56:59],v[96:99],a[152:155],a[56:59]
 bl v254,s[16:19],s63 offen sc1 lds
 mf a[52:55],v[80:83],a[152:155],a[52:55]
 v_exp_f32 v22,v22
 mf a[52:55],v[84:87],a[156:159],a[52:55]
 rt a[142:143],v217 offset:61440
 pk v18,v20,v21
 mf a[48:51],v[68:71],a[156:159],a[48:51]
 v_exp_f32 v23,v23
 mf a[48:51],v[64:67],a[152:155],a[48:51]
 s_waitcnt lgkmcnt(4)
 rt a[144:145],v218 offset:49152
 pk v19,v22,v23
 mf a[64:67],v[64:67],a[128:131],a[64:67]
 v_exp_f32 v32,v32
 mf a[64:67],v[68:71],a[132:135],a[64:67]
 rt a[146:147],v218 offset:53248
 mf a[68:71],v[84:87],a[132:135],a[68:71]
 v_exp_f32 v33,v33
 mf a[68:71],v[80:83],a[128:131],a[68:71]
 rt a[148:149],v218 offset:57344
 pk v32,v32,v33
 mf a[72:75],v[96:99],a[128:131],a[72:75]
 v_exp_f32 v34,v34
 mf a[72:75],v[100:103],a[132:135],a[72:75]
 v_exp_f32 v35,v35
 mf a[76:79],v[116:119],a[132:135],a[76:79]
 rt a[150:151],v218 offset:61440
 pk v33,v34,v35
 mf a[76:79],v[112:115],a[128:131],a[76:79]
 s_waitcnt lgkmcnt(4)
 v_exp_f32 v36,v36
 mf a[92:95],v[112:115],a[136:139],a[92:95]
L_pad_pg16:
 s_cbranch_execz L_hop3
 rt a[152:153],v219 offset:49152
 mf a[92:95],v[116:119],a[140:143],a[92:95]
 s_add_u32 m0,s60,57344
 v_exp_f32 v37,v37
 mf a[88:91],v[100:103],a[140:143],a[88:91]
 s_mov_b32 s63,3932160
 rt a[154:155],v219 offset:53248
 mf a[88:91],v[96:99],a[136:139],a[88:91]
 bl v254,s[16:19],s63 offen sc1 lds
 mf a[84:87],v[80:83],a[136:139],a[84:87]
 rt a[156:157],v219 offset:57344
 pk v34,v36,v37
 mf a[84:87],v[84:87],a[140:143],a[84:87]
 v_exp_f32 v38,v38
 mf a[80:83],v[68:71],a[140:143],a[80:83]
 v_exp_f32 v39,v39
 mf a[80:83],v[64:67],a[136:139],a[80:83]
 s_waitcnt lgkmcnt(3)
 rt a[158:159],v219 offset:61440
 pk v35,v38,v39
 mf a[96:99],v[64:67],a[144:147],a[96:99]
 v_exp_f32 v48,v48
 mf a[96:99],v[68:71],a[148:151],a[96:99]
 mf a[100:103],v[84:87],a[148:151],a[100:103]
 v_exp_f32 v49,v49
 mf a[100:103],v[80:83],a[144:147],a[100:103]
 pk v48,v48,v49
 mf a[104:107],v[96:99],a[144:147],a[104:107]
 v_exp_f32 v50,v50
 mf a[104:107],v[100:103],a[148:151],a[104:107]
 rq a[128:131],v208 offset:16384
 mf a[108:111],v[116:119],a[148:151],a[108:111]
 v_exp_f32 v51,v51
 mf a[108:111],v[112:115],a[144:147],a[108:111]
 s_waitcnt lgkmcnt(1)
 v_exp_f32 v52,v52
 mf a[124:127],v[112:115],a[152:155],a[124:127]
 rq a[132:135],v209 offset:16384
 pk v49,v50,v51
 mf a[124:127],v[116:119],a[156:159],a[124:127]
 s_add_u32 m0,s60,61440
 v_exp_f32 v53,v53
 mf a[120:123],v[100:103],a[156:159],a[120:123]
 s_mov_b32 s63,4063232
 rq a[136:139],v210 offset:16384
 mf a[120:123],v[96:99],a[152:155],a[120:123]
 bl v254,s[16:19],s63 offen sc1 lds
 mf a[116:119],v[80:83],a[152:155],a[116:119]
 rq a[140:143],v211 offset:16384
 pk v50,v52,v53
 mf a[116:119],v[84:87],a[156:159],a[116:119]
 v_exp_f32 v54,v54
 mf a[112:115],v[68:71],a[156:159],a[112:115]
 mf a[112:115],v[64:67],a[152:155],a[112:115]
 v_exp_f32 v55,v55
 v_smfmac_f32_16x16x64_bf16 a[192:195],a[208:211],v[64:71],v250
 pk v51,v54,v55
 v_smfmac_f32_16x16x64_bf16 a[196:199],a[208:211],v[80:87],v250
 s_waitcnt vmcnt(22)
 v_smfmac_f32_16x16x64_bf16 a[200:203],a[208:211],v[96:103],v250
 s_barrier
 v_smfmac_f32_16x16x64_bf16 a[204:207],a[208:211],v[112:119],v250
 s_waitcnt lgkmcnt(0)
 mf v[64:67],a[128:131],v[128:131],v[192:195]
 v_exp_f32 v8,v8
 mf v[64:67],a[132:135],v[132:135],v[64:67]
 s_add_u32 m0,s60,0
 v_exp_f32 v9,v9
 mf v[64:67],a[136:139],v[136:139],v[64:67]
 s_mov_b32 s63,2097152
 rq a[144:147],v208 offset:20480
 mf v[64:67],a[140:143],v[140:143],v[64:67]
 bl v254,s[16:19],s63 offen sc1 lds
 mf v[80:83],a[140:143],v[156:159],v[196:199]
 rq a[148:151],v209 offset:20480
 pk v4,v8,v9
 mf v[80:83],a[136:139],v[152:155],v[80:83]
 v_exp_f32 v10,v10
 mf v[80:83],a[132:135],v[148:151],v[80:83]
 rq a[152:155],v210 offset:20480
 mf v[80:83],a[128:131],v[144:147],v[80:83]
 v_exp_f32 v11,v11
 mf v[96:99],a[128:131],v[160:163],v[200:203]
 rq a[156:159],v211 offset:20480
 pk v5,v10,v11
 mf v[96:99],a[132:135],v[164:167],v[96:99]
 s_add_u32 m0,s60,4096
 v_exp_f32 v12,v12
 mf v[96:99],a[136:139],v[168:171],v[96:99]
 s_mov_b32 s63,2228224
 v_exp_f32 v13,v13
 mf v[96:99],a[140:143],v[172:175],v[96:99]
 bl v254,s[16:19],s63 offen sc1 lds
 pk v6,v12,v13
 mf v[112:115],a[140:143],v[188:191],v[204:207]
 v_exp_f32 v14,v14
 mf v[112:115],a[136:139],v[184:187],v[112:115]
 s_add_u32 m0,s60,8192
 mf v[112:115],a[132:135],v[180:183],v[112:115]
 s_mov_b32 s63,2359296
 v_exp_f32 v15,v15
 mf v[112:115],a[128:131],v[176:179],v[112:115]
 s_waitcnt lgkmcnt(0)
 bl v254,s[16:19],s63 offen sc1 lds
 pk v7,v14,v15
 mf v[116:119],a[144:147],v[176:179],v[204:207]
 v_exp_f32 v24,v24
 mf v[116:119],a[148:151],v[180:183],v[116:119]
 s_add_u32 m0,s60,12288
 v_exp_f32 v25,v25
 mf v[116:119],a[152:155],v[184:187],v[116:119]
 s_mov_b32 s63,2490368
 rq a[128:131],v208 offset:24576
 mf v[116:119],a[156:159],v[188:191],v[116:119]
 bl v254,s[16:19],s63 offen sc1 lds
 mf v[100:103],a[156:159],v[172:175],v[200:203]
 rq a[132:135],v209 offset:24576
 pk v20,v24,v25
 mf v[100:103],a[152:155],v[168:171],v[100:103]
 v_exp_f32 v26,v26
 mf v[100:103],a[148:151],v[164:167],v[100:103]
 rq a[136:139],v210 offset:24576
 mf v[100:103],a[144:147],v[160:163],v[100:103]
 v_exp_f32 v27,v27
 mf v[84:87],a[144:147],v[144:147],v[196:199]
 rq a[140:143],v211 offset:24576
 pk v21,v26,v27
 mf v[84:87],a[148:151],v[148:151],v[84:87]
 v_exp_f32 v28,v28
 mf v[84:87],a[152:155],v[152:155],v[84:87]
 v_exp_f32 v29,v29
 mf v[84:87],a[156:159],v[156:159],v[84:87]
 pk v22,v28,v29
 mf v[68:71],a[156:159],v[140:143],v[192:195]
 v_exp_f32 v30,v30
 mf v[68:71],a[152:155],v[136:139],v[68:71]
 s_add_u32 m0,s62,32768
 mf v[68:71],a[148:151],v[132:135],v[68:71]
 s_mov_b32 s63,1146880
 v_exp_f32 v31,v31
 mf v[68:71],a[144:147],v[128:131],v[68:71]
 s_waitcnt lgkmcnt(0)
 bl v243,s[36:39],s63 offen offset:0 lds
 pk v23,v30,v31
 mf v[72:75],a[128:131],v[128:131],v[192:195]
 v_exp_f32 v40,v40
 mf v[72:75],a[132:135],v[132:135],v[72:75]
 v_exp_f32 v41,v41
 mf v[72:75],a[136:139],v[136:139],v[72:75]
 s_mov_b32 s63,1174528
 rq a[144:147],v208 offset:28672
 mf v[72:75],a[140:143],v[140:143],v[72:75]
 bl v243,s[36:39],s63 offen offset:1024 lds
 mf v[88:91],a[140:143],v[156:159],v[196:199]
 rq a[148:151],v209 offset:28672
 pk v36,v40,v41
 mf v[88:91],a[136:139],v[152:155],v[88:91]
 v_exp_f32 v42,v42
 mf v[88:91],a[132:135],v[148:151],v[88:91]
 rq a[152:155],v210 offset:28672
 mf v[88:91],a[128:131],v[144:147],v[88:91]
 v_exp_f32 v43,v43
 mf v[104:107],a[128:131],v[160:163],v[200:203]
 rq a[156:159],v211 offset:28672
 pk v37,v42,v43
 mf v[104:107],a[132:135],v[164:167],v[104:107]
 v_exp_f32 v44,v44
 mf v[104:107],a[136:139],v[168:171],v[104:107]
 v_exp_f32 v45,v45
 mf v[104:107],a[140:143],v[172:175],v[104:107]
 pk v38,v44,v45
 mf v[120:123],a[140:143],v[188:191],v[204:207]
 v_exp_f32 v46,v46
 mf v[120:123],a[136:139],v[184:187],v[120:123]
 mf v[120:123],a[132:135],v[180:183],v[120:123]
 s_mov_b32 s63,1202176
 v_exp_f32 v47,v47
 mf v[120:123],a[128:131],v[176:179],v[120:123]
 s_waitcnt lgkmcnt(0)
 rt a[130:131],v212 offset:4096
 pk v39,v46,v47
 mf v[124:127],a[144:147],v[176:179],v[204:207]
 v_exp_f32 v56,v56
 mf v[124:127],a[148:151],v[180:183],v[124:127]
 v_exp_f32 v57,v57
 mf v[124:127],a[152:155],v[184:187],v[124:127]
 rt a[128:129],v212 offset:0
 rt a[132:133],v212 offset:8192
 mf v[124:127],a[156:159],v[188:191],v[124:127]
 bl v243,s[36:39],s63 offen offset:2048 lds
 mf v[108:111],a[156:159],v[172:175],v[200:203]
 rt a[134:135],v212 offset:12288
 pk v52,v56,v57
 mf v[108:111],a[152:155],v[168:171],v[108:111]
 v_exp_f32 v58,v58
 mf v[108:111],a[148:151],v[164:167],v[108:111]
 rt a[136:137],v213 offset:0
 mf v[108:111],a[144:147],v[160:163],v[108:111]
 v_exp_f32 v59,v59
 mf v[92:95],a[144:147],v[144:147],v[196:199]
 rt a[138:139],v213 offset:4096
 pk v53,v58,v59
 mf v[92:95],a[148:151],v[148:151],v[92:95]
 v_exp_f32 v60,v60
 mf v[92:95],a[152:155],v[152:155],v[92:95]
 v_exp_f32 v61,v61
 mf v[92:95],a[156:159],v[156:159],v[92:95]
 rt a[140:141],v213 offset:8192
 pk v54,v60,v61
 mf v[76:79],a[156:159],v[140:143],v[192:195]
 v_exp_f32 v62,v62
 mf v[76:79],a[152:155],v[136:139],v[76:79]
 rt a[142:143],v213 offset:12288
 mf v[76:79],a[148:151],v[132:135],v[76:79]
 v_exp_f32 v63,v63
 mf v[76:79],a[144:147],v[128:131],v[76:79]
 s_waitcnt lgkmcnt(4)
 rt a[148:149],v214 offset:8192
 pk v55,v62,v63
 mf a[0:3],v[0:3],a[128:131],a[0:3]
 v_exp_f32 v64,v64
 mf a[0:3],v[4:7],a[132:135],a[0:3]
 v_exp_f32 v65,v65
 mf a[4:7],v[20:23],a[132:135],a[4:7]
 rt a[150:151],v214 offset:12288
 pk v64,v64,v65
 mf a[4:7],v[16:19],a[128:131],a[4:7]
 v_exp_f32 v66,v66
 mf a[8:11],v[32:35],a[128:131],a[8:11]
 rt a[146:147],v214 offset:4096
 rt a[152:153],v215 offset:0
 mf a[8:11],v[36:39],a[132:135],a[8:11]
 v_exp_f32 v67,v67
 mf a[12:15],v[52:55],a[132:135],a[12:15]
 rt a[154:155],v215 offset:4096
 pk v65,v66,v67
 mf a[12:15],v[48:51],a[128:131],a[12:15]
 s_waitcnt lgkmcnt(5)
 v_exp_f32 v68,v68
 mf a[28:31],v[48:51],a[136:139],a[28:31]
 v_exp_f32 v69,v69
 mf a[28:31],v[52:55],a[140:143],a[28:31]
 rt a[156:157],v215 offset:8192
 pk v66,v68,v69
 mf a[24:27],v[36:39],a[140:143],a[24:27]
 s_mov_b32 s63,1229824
 rt a[144:145],v214 offset:0
 rt a[158:159],v215 offset:12288
 mf a[24:27],v[32:35],a[136:139],a[24:27]
 bl v243,s[36:39],s63 offen offset:3072 lds
 mf a[20:23],v[16:19],a[136:139],a[20:23]
 v_exp_f32 v70,v70
 mf a[20:23],v[20:23],a[140:143],a[20:23]
 rt a[128:129],v216 offset:0
 mf a[16:19],v[4:7],a[140:143],a[16:19]
 v_exp_f32 v71,v71
 mf a[16:19],v[0:3],a[136:139],a[16:19]
 s_waitcnt lgkmcnt(2)
 rt a[130:131],v216 offset:4096
 pk v67,v70,v71
 mf a[32:35],v[0:3],a[144:147],a[32:35]
 v_exp_f32 v80,v80
 mf a[32:35],v[4:7],a[148:151],a[32:35]
 rt a[132:133],v216 offset:8192
 mf a[36:39],v[20:23],a[148:151],a[36:39]
 v_exp_f32 v81,v81
 mf a[36:39],v[16:19],a[144:147],a[36:39]
 v_exp_f32 v82,v82
 mf a[40:43],v[32:35],a[144:147],a[40:43]
 rt a[134:135],v216 offset:12288
 pk v80,v80,v81
 mf a[40:43],v[36:39],a[148:151],a[40:43]
 v_exp_f32 v83,v83
 mf a[44:47],v[52:55],a[148:151],a[44:47]
 rt a[136:137],v217 offset:0
 pk v81,v82,v83
 mf a[44:47],v[48:51],a[144:147],a[44:47]
 s_waitcnt lgkmcnt(5)
 v_exp_f32 v84,v84
 mf a[60:63],v[48:51],a[152:155],a[60:63]
 rt a[138:139],v217 offset:4096
 mf a[60:63],v[52:55],a[156:159],a[60:63]
 s_add_u32 m0,s62,36864
 v_exp_f32 v85,v85
 mf a[56:59],v[36:39],a[156:159],a[56:59]
 s_mov_b32 s63,1261568
 rt a[140:141],v217 offset:8192
 mf a[56:59],v[32:35],a[152:155],a[56:59]
 bl v243,s[36:39],s63 offen offset:0 lds
 mf a[52:55],v[16:19],a[152:155],a[52:55]
 v_exp_f32 v86,v86
 mf a[52:55],v[20:23],a[156:159],a[52:55]
 rt a[142:143],v217 offset:12288
 pk v82,v84,v85
 mf a[48:51],v[4:7],a[156:159],a[48:51]
 v_exp_f32 v87,v87
 mf a[48:51],v[0:3],a[152:155],a[48:51]
 s_waitcnt lgkmcnt(4)
 rt a[144:145],v218 offset:0
 pk v83,v86,v87
 mf a[64:67],v[0:3],a[128:131],a[64:67]
 v_exp_f32 v96,v96
 mf a[64:67],v[4:7],a[132:135],a[64:67]
 rt a[146:147],v218 offset:4096
 mf a[68:71],v[20:23],a[132:135],a[68:71]
 v_exp_f32 v97,v97
 mf a[68:71],v[16:19],a[128:131],a[68:71]
 rt a[148:149],v218 offset:8192
 pk v96,v96,v97
 mf a[72:75],v[32:35],a[128:131],a[72:75]
 v_exp_f32 v98,v98
 mf a[72:75],v[36:39],a[132:135],a[72:75]
 v_exp_f32 v99,v99
 mf a[76:79],v[52:55],a[132:135],a[76:79]
 rt a[150:151],v218 offset:12288
 pk v97,v98,v99
 mf a[76:79],v[48:51],a[128:131],a[76:79]
 s_waitcnt lgkmcnt(4)
 v_exp_f32 v100,v100
 mf a[92:95],v[48:51],a[136:139],a[92:95]
 rt a[152:153],v219 offset:0
 mf a[92:95],v[52:55],a[140:143],a[92:95]
 v_exp_f32 v101,v101
 mf a[88:91],v[36:39],a[140:143],a[88:91]
 s_mov_b32 s63,1289216
 rt a[154:155],v219 offset:4096
 mf a[88:91],v[32:35],a[136:139],a[88:91]
 bl v243,s[36:39],s63 offen offset:1024 lds
 mf a[84:87],v[16:19],a[136:139],a[84:87]
 rt a[156:157],v219 offset:8192
 pk v98,v100,v101
 mf a[84:87],v[20:23],a[140:143],a[84:87]
 v_exp_f32 v102,v102
 mf a[80:83],v[4:7],a[140:143],a[80:83]
 s_mov_b32 s63,1316864
 v_exp_f32 v103,v103
 mf a[80:83],v[0:3],a[136:139],a[80:83]
 s_waitcnt lgkmcnt(3)
 rt a[158:159],v219 offset:12288
 pk v99,v102,v103
 mf a[96:99],v[0:3],a[144:147],a[96:99]
 v_exp_f32 v112,v112
 mf a[96:99],v[4:7],a[148:151],a[96:99]
 bl v243,s[36:39],s63 offen offset:2048 lds
 mf a[100:103],v[20:23],a[148:151],a[100:103]
 v_exp_f32 v113,v113
 mf a[100:103],v[16:19],a[144:147],a[100:103]
 pk v112,v112,v113
 mf a[104:107],v[32:35],a[144:147],a[104:107]
 v_exp_f32 v114,v114
 mf a[104:107],v[36:39],a[148:151],a[104:107]
 mf a[108:111],v[52:55],a[148:151],a[108:111]
 v_exp_f32 v115,v115
 mf a[108:111],v[48:51],a[144:147],a[108:111]
 s_waitcnt lgkmcnt(0)
 v_exp_f32 v116,v116
 mf a[124:127],v[48:51],a[152:155],a[124:127]
 rt a[128:129],v212 offset:16384
 pk v113,v114,v115
 mf a[124:127],v[52:55],a[156:159],a[124:127]
 v_exp_f32 v117,v117
 mf a[120:123],v[36:39],a[156:159],a[120:123]
 s_mov_b32 s63,1344512
 rt a[130:131],v212 offset:20480
 mf a[120:123],v[32:35],a[152:155],a[120:123]
 bl v243,s[36:39],s63 offen offset:3072 lds
 mf a[116:119],v[16:19],a[152:155],a[116:119]
 rt a[132:133],v213 offset:16384
 pk v114,v116,v117
 mf a[116:119],v[20:23],a[156:159],a[116:119]
 v_exp_f32 v118,v118
 mf a[112:115],v[4:7],a[156:159],a[112:115]
 rt a[134:135],v213 offset:20480
 mf a[112:115],v[0:3],a[152:155],a[112:115]
 v_exp_f32 v119,v119
 v_smfmac_f32_16x16x64_bf16 a[192:195],a[208:211],v[0:7],v250
 s_mov_b64 exec,0
 s_cmp_eq_u32 s54,0
 s_cbranch_scc1 L_pad_odd0
 s_cmp_eq_u32 s54,1
 s_cbranch_scc1 L_pad_join
 s_cmp_eq_u32 s54,2
 s_cbranch_scc1 L_pad_pg20
 s_branch L_pad_pg21
L_hop4:
 s_mov_b64 exec,-1
 pk v115,v118,v119
 v_smfmac_f32_16x16x64_bf16 a[196:199],a[208:211],v[16:23],v250
 s_waitcnt vmcnt(12)
 rt a[136:137],v214 offset:16384
 v_smfmac_f32_16x16x64_bf16 a[200:203],a[208:211],v[32:39],v250
 s_barrier
 rt a[138:139],v214 offset:20480
 v_smfmac_f32_16x16x64_bf16 a[204:207],a[208:211],v[48:55],v250
 s_waitcnt lgkmcnt(4)
 mf a[0:3],v[64:67],a[128:131],a[0:3]
 v_exp_f32 v72,v72
 mf a[4:7],v[80:83],a[128:131],a[4:7]
 rt a[140:141],v215 offset:16384
 v_exp_f32 v73,v73
 mf a[8:11],v[96:99],a[128:131],a[8:11]
 rt a[142:143],v215 offset:20480
 v_exp_f32 v74,v74
 pk v68,v72,v73
 mf a[12:15],v[112:115],a[128:131],a[12:15]
 s_waitcnt lgkmcnt(4)
 v_exp_f32 v75,v75
 mf a[28:31],v[112:115],a[132:135],a[28:31]
 v_exp_f32 v76,v76
 pk v69,v74,v75
 mf a[24:27],v[96:99],a[132:135],a[24:27]
 rt a[144:145],v216 offset:16384
 v_exp_f32 v77,v77
 mf a[20:23],v[80:83],a[132:135],a[20:23]
 rt a[146:147],v216 offset:20480
 v_exp_f32 v78,v78
 pk v70,v76,v77
 mf a[16:19],v[64:67],a[132:135],a[16:19]
 s_waitcnt lgkmcnt(4)
 v_exp_f32 v79,v79
 mf a[32:35],v[64:67],a[136:139],a[32:35]
 v_exp_f32 v88,v88
 pk v71,v78,v79
 mf a[36:39],v[80:83],a[136:139],a[36:39]
 rt a[148:149],v217 offset:16384
 v_exp_f32 v89,v89
 mf a[40:43],v[96:99],a[136:139],a[40:43]
 rt a[150:151],v217 offset:20480
 v_exp_f32 v90,v90
 pk v84,v88,v89
 mf a[44:47],v[112:115],a[136:139],a[44:47]
 s_waitcnt lgkmcnt(4)
 v_exp_f32 v91,v91
 mf a[60:63],v[112:115],a[140:143],a[60:63]
 v_exp_f32 v92,v92
 pk v85,v90,v91
 mf a[56:59],v[96:99],a[140:143],a[56:59]
 rt a[152:153],v218 offset:16384
 v_exp_f32 v93,v93
 mf a[52:55],v[80:83],a[140:143],a[52:55]
 rt a[154:155],v218 offset:20480
 v_exp_f32 v94,v94
 pk v86,v92,v93
 mf a[48:51],v[64:67],a[140:143],a[48:51]
 s_waitcnt lgkmcnt(4)
 v_exp_f32 v95,v95
 mf a[64:67],v[64:67],a[144:147],a[64:67]
 v_exp_f32 v104,v104
 pk v87,v94,v95
 mf a[68:71],v[80:83],a[144:147],a[68:71]
 rt a[156:157],v219 offset:16384
 v_exp_f32 v105,v105
 mf a[72:75],v[96:99],a[144:147],a[72:75]
 rt a[158:159],v219 offset:20480
 v_exp_f32 v106,v106
 pk v100,v104,v105
 mf a[76:79],v[112:115],a[144:147],a[76:79]
 s_waitcnt lgkmcnt(4)
 v_exp_f32 v107,v107
 mf a[92:95],v[112:115],a[148:151],a[92:95]
 v_exp_f32 v108,v108
 pk v101,v106,v107
 mf a[88:91],v[96:99],a[148:151],a[88:91]
 v_exp_f32 v109,v109
 mf a[84:87],v[80:83],a[148:151],a[84:87]
 v_exp_f32 v110,v110
 pk v102,v108,v109
 mf a[80:83],v[64:67],a[148:151],a[80:83]
 s_waitcnt lgkmcnt(2)
 v_exp_f32 v111,v111
 mf a[96:99],v[64:67],a[152:155],a[96:99]
 v_exp_f32 v120,v120
 pk v103,v110,v111
 mf a[100:103],v[80:83],a[152:155],a[100:103]
 rt a[128:129],v212 offset:24576
 v_exp_f32 v121,v121
 mf a[104:107],v[96:99],a[152:155],a[104:107]
 rt a[130:131],v212 offset:28672
 v_exp_f32 v122,v122
 pk v116,v120,v121
 mf a[108:111],v[112:115],a[152:155],a[108:111]
 s_waitcnt lgkmcnt(2)
 v_exp_f32 v123,v123
 mf a[124:127],v[112:115],a[156:159],a[124:127]
 v_exp_f32 v124,v124
 pk v117,v122,v123
 mf a[120:123],v[96:99],a[156:159],a[120:123]
 rt a[132:133],v213 offset:24576
 v_exp_f32 v125,v125
 mf a[116:119],v[80:83],a[156:159],a[116:119]
 rt a[134:135],v213 offset:28672
 v_exp_f32 v126,v126
 pk v118,v124,v125
 mf a[112:115],v[64:67],a[156:159],a[112:115]
 v_exp_f32 v127,v127
 v_smfmac_f32_16x16x64_bf16 a[192:195],a[208:211],v[64:71],v250
 pk v119,v126,v127
 v_smfmac_f32_16x16x64_bf16 a[196:199],a[208:211],v[80:87],v250
 rt a[136:137],v214 offset:24576
 v_smfmac_f32_16x16x64_bf16 a[200:203],a[208:211],v[96:103],v250
 rt a[138:139],v214 offset:28672
 v_smfmac_f32_16x16x64_bf16 a[204:207],a[208:211],v[112:119],v250
 s_waitcnt lgkmcnt(4)
 ds_write_b128 v235,a[212:215] offset:16384
 mf a[0:3],v[68:71],a[128:131],a[0:3]
 mf a[4:7],v[84:87],a[128:131],a[4:7]
 rt a[140:141],v215 offset:24576
 mf a[8:11],v[100:103],a[128:131],a[8:11]
 rt a[142:143],v215 offset:28672
 mf a[12:15],v[116:119],a[128:131],a[12:15]
 s_waitcnt lgkmcnt(5)
 mf a[28:31],v[116:119],a[132:135],a[28:31]
 rq a[160:163],v255 offset:32768
 ds_write_b128 v235,a[216:219] offset:20480
 mf a[24:27],v[100:103],a[132:135],a[24:27]
 rt a[144:145],v216 offset:24576
 mf a[20:23],v[84:87],a[132:135],a[20:23]
 rt a[146:147],v216 offset:28672
 rq a[176:179],v255 offset:36864
 mf a[16:19],v[68:71],a[132:135],a[16:19]
 s_waitcnt lgkmcnt(8)
 mf a[32:35],v[68:71],a[136:139],a[32:35]
 rq a[164:167],v255 offset:33792
 mf a[36:39],v[84:87],a[136:139],a[36:39]
 rt a[148:149],v217 offset:24576
 mf a[40:43],v[100:103],a[136:139],a[40:43]
 rt a[150:151],v217 offset:28672
 rq a[180:183],v255 offset:37888
 mf a[44:47],v[116:119],a[136:139],a[44:47]
 s_waitcnt lgkmcnt(9)
 ds_write_b128 v235,a[220:223] offset:24576
 mf a[60:63],v[116:119],a[140:143],a[60:63]
 rq a[168:171],v255 offset:34816
 mf a[56:59],v[100:103],a[140:143],a[56:59]
 rt a[152:153],v218 offset:24576
 mf a[52:55],v[84:87],a[140:143],a[52:55]
 rt a[154:155],v218 offset:28672
 rq a[184:187],v255 offset:38912
 mf a[48:51],v[68:71],a[140:143],a[48:51]
 s_waitcnt lgkmcnt(10)
 mf a[64:67],v[68:71],a[144:147],a[64:67]
 rq a[172:175],v255 offset:35840
 ds_write_b128 v235,a[224:227] offset:28672
 mf a[68:71],v[84:87],a[144:147],a[68:71]
 rt a[156:157],v219 offset:24576
 mf a[72:75],v[100:103],a[144:147],a[72:75]
 rt a[158:159],v219 offset:28672
 rq a[188:191],v255 offset:39936
 mf a[76:79],v[116:119],a[144:147],a[76:79]
 s_waitcnt lgkmcnt(11)
 mf a[92:95],v[116:119],a[148:151],a[92:95]
 mf a[88:91],v[100:103],a[148:151],a[88:91]
 mf a[84:87],v[84:87],a[148:151],a[84:87]
 rt a[128:129],v230 offset:0
 mf a[80:83],v[68:71],a[148:151],a[80:83]
 s_waitcnt lgkmcnt(7)
 rt a[130:131],v230 offset:2048
 mf a[96:99],v[68:71],a[152:155],a[96:99]
 rt a[132:133],v230 offset:4096
 mf a[100:103],v[84:87],a[152:155],a[100:103]
 rt a[134:135],v230 offset:6144
 mf a[104:107],v[100:103],a[152:155],a[104:107]
 rt a[136:137],v231 offset:0
 mf a[108:111],v[116:119],a[152:155],a[108:111]
 s_waitcnt lgkmcnt(6)
 rt a[138:139],v231 offset:2048
 mf a[124:127],v[116:119],a[156:159],a[124:127]
 mf a[120:123],v[100:103],a[156:159],a[120:123]
 mf a[116:119],v[84:87],a[156:159],a[116:119]
 mf a[112:115],v[68:71],a[156:159],a[112:115]
 s_bitcmp1_b32 s52,0
 s_cbranch_scc1 L_odd
L_even:
 s_waitcnt lgkmcnt(2)
 mf v[0:3],a[128:131],a[160:163],0
 rt a[140:141],v231 offset:4096
 rq a[212:215],v255 offset:40960
 mf v[0:3],a[132:135],a[176:179],v[0:3]
 s_barrier
 mf v[16:19],a[132:135],a[180:183],0
 s_add_u32 m0,s62,0
 s_mov_b32 s63,1376256
 rt a[142:143],v231 offset:6144
 rq a[228:231],v255 offset:45056
 mf v[16:19],a[128:131],a[164:167],v[16:19]
 rq a[216:219],v255 offset:41984
 bl v243,s[36:39],s63 offen offset:0 lds
 mf v[32:35],a[128:131],a[168:171],0
 s_mov_b32 s63,1403904
 rt a[144:145],v232 offset:0
 mf v[32:35],a[132:135],a[184:187],v[32:35]
 bl v243,s[36:39],s63 offen offset:1024 lds
 mf v[48:51],a[132:135],a[188:191],0
 s_mov_b32 s63,1431552
 rt a[146:147],v232 offset:2048
 mf v[48:51],a[128:131],a[172:175],v[48:51]
 s_waitcnt lgkmcnt(4)
 rq a[232:235],v255 offset:46080
 bl v243,s[36:39],s63 offen offset:2048 lds
 mf v[52:55],a[136:139],a[172:175],0
 s_mov_b32 s63,1459200
 rt a[148:149],v232 offset:4096
 mf v[52:55],a[140:143],a[188:191],v[52:55]
 bl v243,s[36:39],s63 offen offset:3072 lds
 mf v[36:39],a[140:143],a[184:187],0
 s_add_u32 m0,s62,4096
 s_mov_b32 s63,1490944
 rt a[150:151],v232 offset:6144
 mf v[36:39],a[136:139],a[168:171],v[36:39]
 rq a[220:223],v255 offset:43008
 bl v243,s[36:39],s63 offen offset:0 lds
 mf v[20:23],a[136:139],a[164:167],0
 s_mov_b32 s63,1518592
 rt a[152:153],v233 offset:0
 mf v[20:23],a[140:143],a[180:183],v[20:23]
 bl v243,s[36:39],s63 offen offset:1024 lds
 mf v[4:7],a[140:143],a[176:179],0
 rt a[154:155],v233 offset:2048
 mf v[4:7],a[136:139],a[160:163],v[4:7]
 s_waitcnt lgkmcnt(3)
 rq a[236:239],v255 offset:47104
 mf v[8:11],a[144:147],a[160:163],0
 s_mov_b32 s63,1546240
 rt a[156:157],v233 offset:4096
 mf v[8:11],a[148:151],a[176:179],v[8:11]
 bl v243,s[36:39],s63 offen offset:2048 lds
 mf v[24:27],a[148:151],a[180:183],0
 rt a[158:159],v233 offset:6144
 mf v[24:27],a[144:147],a[164:167],v[24:27]
 rq a[224:227],v255 offset:44032
 mf v[40:43],a[144:147],a[168:171],0
 s_mov_b32 s63,1573888
 s_waitcnt vmcnt(7)
 rt a[128:129],v226 offset:32768
 mf v[40:43],a[148:151],a[184:187],v[40:43]
 bl v243,s[36:39],s63 offen offset:3072 lds
 mf v[56:59],a[148:151],a[188:191],0
 rt a[130:131],v226 offset:34816
 mf v[56:59],a[144:147],a[172:175],v[56:59]
 s_waitcnt lgkmcnt(3)
 s_add_u32 m0,s62,65536
 rq a[240:243],v255 offset:48128
 mf v[60:63],a[152:155],a[172:175],0
 s_mov_b32 s63,1605632
 rt a[132:133],v226 offset:36864
 mf v[60:63],a[156:159],a[188:191],v[60:63]
 bl v243,s[36:39],s63 offen offset:0 lds
 mf v[44:47],a[156:159],a[184:187],0
 rt a[134:135],v226 offset:38912
 mf v[44:47],a[152:155],a[168:171],v[44:47]
 mf v[28:31],a[152:155],a[164:167],0
 s_mov_b32 s63,1633280
 rt a[136:137],v227 offset:32768
 mf v[28:31],a[156:159],a[180:183],v[28:31]
 bl v243,s[36:39],s63 offen offset:1024 lds
 mf v[12:15],a[156:159],a[176:179],0
 rt a[138:139],v227 offset:34816
 mf v[12:15],a[152:155],a[160:163],v[12:15]
 s_waitcnt lgkmcnt(2)
 mf v[0:3],a[128:131],a[212:215],v[0:3]
 s_mov_b32 s63,1660928
 rt a[140:141],v227 offset:36864
 rq a[160:163],v255 offset:49152
 mf v[0:3],a[132:135],a[228:231],v[0:3]
 bl v243,s[36:39],s63 offen offset:2048 lds
 mf v[16:19],a[132:135],a[232:235],v[16:19]
 rt a[142:143],v227 offset:38912
 rq a[176:179],v255 offset:53248
 mf v[16:19],a[128:131],a[216:219],v[16:19]
 rq a[164:167],v255 offset:50176
 mf v[32:35],a[128:131],a[220:223],v[32:35]
 s_mov_b32 s63,1688576
 rt a[144:145],v228 offset:32768
 mf v[32:35],a[132:135],a[236:239],v[32:35]
 bl v243,s[36:39],s63 offen offset:3072 lds
 mf v[48:51],a[132:135],a[240:243],v[48:51]
 rt a[146:147],v228 offset:34816
 mf v[48:51],a[128:131],a[224:227],v[48:51]
 s_waitcnt lgkmcnt(4)
 s_add_u32 m0,s62,69632
 rq a[180:183],v255 offset:54272
 mf v[52:55],a[136:139],a[224:227],v[52:55]
 s_mov_b32 s63,1720320
 rt a[148:149],v228 offset:36864
 mf v[52:55],a[140:143],a[240:243],v[52:55]
 bl v243,s[36:39],s63 offen offset:0 lds
 mf v[36:39],a[140:143],a[236:239],v[36:39]
 rt a[150:151],v228 offset:38912
 mf v[36:39],a[136:139],a[220:223],v[36:39]
 rq a[168:171],v255 offset:51200
 mf v[20:23],a[136:139],a[216:219],v[20:23]
 s_mov_b32 s63,1747968
 rt a[152:153],v229 offset:32768
 mf v[20:23],a[140:143],a[232:235],v[20:23]
 bl v243,s[36:39],s63 offen offset:1024 lds
 mf v[4:7],a[140:143],a[228:231],v[4:7]
 rt a[154:155],v229 offset:34816
 mf v[4:7],a[136:139],a[212:215],v[4:7]
 s_waitcnt lgkmcnt(3)
 rq a[184:187],v255 offset:55296
 mf v[8:11],a[144:147],a[212:215],v[8:11]
 s_mov_b32 s63,1775616
 rt a[156:157],v229 offset:36864
 mf v[8:11],a[148:151],a[228:231],v[8:11]
 bl v243,s[36:39],s63 offen offset:2048 lds
 mf v[24:27],a[148:151],a[232:235],v[24:27]
 rt a[158:159],v229 offset:38912
 mf v[24:27],a[144:147],a[216:219],v[24:27]
 rq a[172:175],v255 offset:52224
 mf v[40:43],a[144:147],a[220:223],v[40:43]
 s_mov_b32 s63,1803264
 s_waitcnt vmcnt(7)
 rt a[128:129],v226 offset:0
 mf v[40:43],a[148:151],a[236:239],v[40:43]
 bl v243,s[36:39],s63 offen offset:3072 lds
 mf v[56:59],a[148:151],a[240:243],v[56:59]
 rt a[130:131],v226 offset:2048
 mf v[56:59],a[144:147],a[224:227],v[56:59]
 s_waitcnt lgkmcnt(3)
 s_add_u32 m0,s62,32768
 rq a[188:191],v255 offset:56320
 mf v[60:63],a[152:155],a[224:227],v[60:63]
 s_mov_b32 s63,0
 rt a[132:133],v226 offset:4096
 mf v[60:63],a[156:159],a[240:243],v[60:63]
 bl v243,s[36:39],s63 offen offset:0 lds
 mf v[44:47],a[156:159],a[236:239],v[44:47]
 rt a[134:135],v226 offset:6144
 mf v[44:47],a[152:155],a[220:223],v[44:47]
 mf v[28:31],a[152:155],a[216:219],v[28:31]
 s_mov_b32 s63,27648
 rt a[136:137],v227 offset:0
 mf v[28:31],a[156:159],a[232:235],v[28:31]
 bl v243,s[36:39],s63 offen offset:1024 lds
 mf v[12:15],a[156:159],a[228:231],v[12:15]
 rt a[138:139],v227 offset:2048
 mf v[12:15],a[152:155],a[212:215],v[12:15]
 s_waitcnt lgkmcnt(2)
 mf v[0:3],a[128:131],a[160:163],v[0:3]
 s_mov_b32 s63,55296
 rt a[140:141],v227 offset:4096
 rq a[212:215],v255 offset:57344
 mf v[0:3],a[132:135],a[176:179],v[0:3]
 bl v243,s[36:39],s63 offen offset:2048 lds
 mf v[16:19],a[132:135],a[180:183],v[16:19]
 rt a[142:143],v227 offset:6144
 rq a[228:231],v255 offset:61440
 mf v[16:19],a[128:131],a[164:167],v[16:19]
 rq a[216:219],v255 offset:58368
 mf v[32:35],a[128:131],a[168:171],v[32:35]
 s_mov_b32 s63,82944
 rt a[144:145],v228 offset:0
 mf v[32:35],a[132:135],a[184:187],v[32:35]
 bl v243,s[36:39],s63 offen offset:3072 lds
 mf v[48:51],a[132:135],a[188:191],v[48:51]
 rt a[146:147],v228 offset:2048
 mf v[48:51],a[128:131],a[172:175],v[48:51]
 s_waitcnt lgkmcnt(4)
 s_add_u32 m0,s62,36864
 rq a[232:235],v255 offset:62464
 mf v[52:55],a[136:139],a[172:175],v[52:55]
 s_mov_b32 s63,114688
 rt a[148:149],v228 offset:4096
 mf v[52:55],a[140:143],a[188:191],v[52:55]
 bl v243,s[36:39],s63 offen offset:0 lds
 mf v[36:39],a[140:143],a[184:187],v[36:39]
 rt a[150:151],v228 offset:6144
 mf v[36:39],a[136:139],a[168:171],v[36:39]
 rq a[220:223],v255 offset:59392
 mf v[20:23],a[136:139],a[164:167],v[20:23]
 s_mov_b32 s63,142336
 rt a[152:153],v229 offset:0
 mf v[20:23],a[140:143],a[180:183],v[20:23]
 bl v243,s[36:39],s63 offen offset:1024 lds
 mf v[4:7],a[140:143],a[176:179],v[4:7]
 rt a[154:155],v229 offset:2048
 mf v[4:7],a[136:139],a[160:163],v[4:7]
 s_waitcnt lgkmcnt(3)
 rq a[236:239],v255 offset:63488
 mf v[8:11],a[144:147],a[160:163],v[8:11]
 s_mov_b32 s63,169984
 rt a[156:157],v229 offset:4096
 mf v[8:11],a[148:151],a[176:179],v[8:11]
 bl v243,s[36:39],s63 offen offset:2048 lds
 mf v[24:27],a[148:151],a[180:183],v[24:27]
 rt a[158:159],v229 offset:6144
 mf v[24:27],a[144:147],a[164:167],v[24:27]
 rq a[224:227],v255 offset:60416
 mf v[40:43],a[144:147],a[168:171],v[40:43]
 s_mov_b32 s63,197632
 s_waitcnt vmcnt(7)
 rt a[128:129],v230 offset:0
 mf v[40:43],a[148:151],a[184:187],v[40:43]
 bl v243,s[36:39],s63 offen offset:3072 lds
 mf v[56:59],a[148:151],a[188:191],v[56:59]
 rt a[130:131],v230 offset:2048
 mf v[56:59],a[144:147],a[172:175],v[56:59]
 s_waitcnt lgkmcnt(3)
 s_add_u32 m0,s62,0
 rq a[240:243],v255 offset:64512
 mf v[60:63],a[152:155],a[172:175],v[60:63]
 s_mov_b32 s63,229376
 rt a[132:133],v230 offset:4096
 mf v[60:63],a[156:159],a[188:191],v[60:63]
 bl v243,s[36:39],s63 offen offset:0 lds
 mf v[44:47],a[156:159],a[184:187],v[44:47]
 rt a[134:135],v230 offset:6144
 mf v[44:47],a[152:155],a[168:171],v[44:47]
 s_barrier
 mf v[28:31],a[152:155],a[164:167],v[28:31]
 s_mov_b32 s63,257024
 rt a[136:137],v231 offset:0
 mf v[28:31],a[156:159],a[180:183],v[28:31]
 bl v243,s[36:39],s63 offen offset:1024 lds
 mf v[12:15],a[156:159],a[176:179],v[12:15]
 rt a[138:139],v231 offset:2048
 mf v[12:15],a[152:155],a[160:163],v[12:15]
 s_waitcnt lgkmcnt(2)
 mf v[0:3],a[128:131],a[212:215],v[0:3]
 s_mov_b32 s63,284672
 rt a[140:141],v231 offset:4096
 rq a[160:163],v255 offset:0
 mf v[0:3],a[132:135],a[228:231],v[0:3]
 bl v243,s[36:39],s63 offen offset:2048 lds
 mf v[16:19],a[132:135],a[232:235],v[16:19]
 rt a[142:143],v231 offset:6144
 rq a[176:179],v255 offset:4096
 mf v[16:19],a[128:131],a[216:219],v[16:19]
 rq a[164:167],v255 offset:1024
 mf v[32:35],a[128:131],a[220:223],v[32:35]
 s_mov_b32 s63,312320
 rt a[144:145],v232 offset:0
 mf v[32:35],a[132:135],a[236:239],v[32:35]
 bl v243,s[36:39],s63 offen offset:3072 lds
 mf v[48:51],a[132:135],a[240:243],v[48:51]
 rt a[146:147],v232 offset:2048
 mf v[48:51],a[128:131],a[224:227],v[48:51]
 s_waitcnt lgkmcnt(4)
 s_add_u32 m0,s62,4096
 rq a[180:183],v255 offset:5120
 mf v[52:55],a[136:139],a[224:227],v[52:55]
 s_mov_b32 s63,344064
 rt a[148:149],v232 offset:4096
 mf v[52:55],a[140:143],a[240:243],v[52:55]
 bl v243,s[36:39],s63 offen offset:0 lds
 mf v[36:39],a[140:143],a[236:239],v[36:39]
 rt a[150:151],v232 offset:6144
 mf v[36:39],a[136:139],a[220:223],v[36:39]
 rq a[168:171],v255 offset:2048
 mf v[20:23],a[136:139],a[216:219],v[20:23]
 s_mov_b32 s63,371712
 rt a[152:153],v233 offset:0
 mf v[20:23],a[140:143],a[232:235],v[20:23]
 bl v243,s[36:39],s63 offen offset:1024 lds
 mf v[4:7],a[140:143],a[228:231],v[4:7]
 rt a[154:155],v233 offset:2048
 mf v[4:7],a[136:139],a[212:215],v[4:7]
 s_waitcnt lgkmcnt(3)
 rq a[184:187],v255 offset:6144
 mf v[8:11],a[144:147],a[212:215],v[8:11]
 s_mov_b32 s63,399360
 rt a[156:157],v233 offset:4096
 mf v[8:11],a[148:151],a[228:231],v[8:11]
 bl v243,s[36:39],s63 offen offset:2048 lds
 mf v[24:27],a[148:151],a[232:235],v[24:27]
 rt a[158:159],v233 offset:6144
 mf v[24:27],a[144:147],a[216:219],v[24:27]
 rq a[172:175],v255 offset:3072
 mf v[40:43],a[144:147],a[220:223],v[40:43]
 s_mov_b32 s63,427008
 s_waitcnt vmcnt(7)
 rt a[128:129],v226 offset:32768
 mf v[40:43],a[148:151],a[236:239],v[40:43]
 bl v243,s[36:39],s63 offen offset:3072 lds
 mf v[56:59],a[148:151],a[240:243],v[56:59]
 rt a[130:131],v226 offset:34816
 mf v[56:59],a[144:147],a[224:227],v[56:59]
 s_waitcnt lgkmcnt(3)
 s_add_u32 m0,s62,65536
 rq a[188:191],v255 offset:7168
 mf v[60:63],a[152:155],a[224:227],v[60:63]
 s_mov_b32 s63,458752
 rt a[132:133],v226 offset:36864
 mf v[60:63],a[156:159],a[240:243],v[60:63]
 bl v243,s[36:39],s63 offen offset:0 lds
 mf v[44:47],a[156:159],a[236:239],v[44:47]
 rt a[134:135],v226 offset:38912
 mf v[44:47],a[152:155],a[220:223],v[44:47]
 mf v[28:31],a[152:155],a[216:219],v[28:31]
 s_mov_b32 s63,486400
 rt a[136:137],v227 offset:32768
 mf v[28:31],a[156:159],a[232:235],v[28:31]
 bl v243,s[36:39],s63 offen offset:1024 lds
 mf v[12:15],a[156:159],a[228:231],v[12:15]
 rt a[138:139],v227 offset:34816
 mf v[12:15],a[152:155],a[212:215],v[12:15]
 s_waitcnt lgkmcnt(2)
 mf v[0:3],a[128:131],a[160:163],v[0:3]
 s_mov_b32 s63,514048
 rt a[140:141],v227 offset:36864
 rq a[212:215],v255 offset:8192
 mf v[0:3],a[132:135],a[176:179],v[0:3]
 bl v243,s[36:39],s63 offen offset:2048 lds
 mf v[16:19],a[132:135],a[180:183],v[16:19]
 s_lshl2_add_u32 s55,s83,s85
 rt a[142:143],v227 offset:38912
 rq a[228:231],v255 offset:12288
 mf v[16:19],a[128:131],a[164:167],v[16:19]
 rq a[216:219],v255 offset:9216
 mf v[32:35],a[128:131],a[168:171],v[32:35]
 s_mov_b32 s63,541696
 rt a[144:145],v228 offset:32768
 mf v[32:35],a[132:135],a[184:187],v[32:35]
 bl v243,s[36:39],s63 offen offset:3072 lds
 mf v[48:51],a[132:135],a[188:191],v[48:51]
 s_lshl_b32 s55,s55,10
 rt a[146:147],v228 offset:34816
 v_add_u32 v235,s55,v255
 mf v[48:51],a[128:131],a[172:175],v[48:51]
 s_waitcnt lgkmcnt(4)
 s_add_u32 m0,s62,69632
 rq a[232:235],v255 offset:13312
 mf v[52:55],a[136:139],a[172:175],v[52:55]
 s_mov_b32 s63,573440
 rt a[148:149],v228 offset:36864
 mf v[52:55],a[140:143],a[188:191],v[52:55]
 bl v243,s[36:39],s63 offen offset:0 lds
 mf v[36:39],a[140:143],a[184:187],v[36:39]
 rt a[150:151],v228 offset:38912
 mf v[36:39],a[136:139],a[168:171],v[36:39]
 rq a[220:223],v255 offset:10240
 mf v[20:23],a[136:139],a[164:167],v[20:23]
 s_mov_b32 s63,601088
 rt a[152:153],v229 offset:32768
 mf v[20:23],a[140:143],a[180:183],v[20:23]
 bl v243,s[36:39],s63 offen offset:1024 lds
 mf v[4:7],a[140:143],a[176:179],v[4:7]
 rt a[154:155],v229 offset:34816
 mf v[4:7],a[136:139],a[160:163],v[4:7]
 s_waitcnt lgkmcnt(3)
 rq a[236:239],v255 offset:14336
 mf v[8:11],a[144:147],a[160:163],v[8:11]
 s_mov_b32 s63,628736
 rt a[156:157],v229 offset:36864
 mf v[8:11],a[148:151],a[176:179],v[8:11]
 bl v243,s[36:39],s63 offen offset:2048 lds
 mf v[24:27],a[148:151],a[180:183],v[24:27]
 rt a[158:159],v229 offset:38912
 mf v[24:27],a[144:147],a[164:167],v[24:27]
 rq a[224:227],v255 offset:11264
 mf v[40:43],a[144:147],a[168:171],v[40:43]
 s_mov_b32 s63,656384
 s_waitcnt vmcnt(7)
 rt a[128:129],v226 offset:0
 mf v[40:43],a[148:151],a[184:187],v[40:43]
 bl v243,s[36:39],s63 offen offset:3072 lds
 mf v[56:59],a[148:151],a[188:191],v[56:59]
 rt a[130:131],v226 offset:2048
 mf v[56:59],a[144:147],a[172:175],v[56:59]
 s_waitcnt lgkmcnt(3)
 s_add_u32 m0,s62,32768
 rq a[240:243],v255 offset:15360
 mf v[60:63],a[152:155],a[172:175],v[60:63]
 s_mov_b32 s63,688128
 rt a[132:133],v226 offset:4096
 mf v[60:63],a[156:159],a[188:191],v[60:63]
 bl v243,s[36:39],s63 offen offset:0 lds
 mf v[44:47],a[156:159],a[184:187],v[44:47]
 rt a[134:135],v226 offset:6144
 mf v[44:47],a[152:155],a[168:171],v[44:47]
 mf v[28:31],a[152:155],a[164:167],v[28:31]
 s_mov_b32 s63,715776
 rt a[136:137],v227 offset:0
 mf v[28:31],a[156:159],a[180:183],v[28:31]
 bl v243,s[36:39],s63 offen offset:1024 lds
 mf v[12:15],a[156:159],a[176:179],v[12:15]
 rt a[138:139],v227 offset:2048
 mf v[12:15],a[152:155],a[160:163],v[12:15]
 s_waitcnt lgkmcnt(2)
 mf v[0:3],a[128:131],a[212:215],v[0:3]
 s_mov_b32 s63,743424
 rt a[140:141],v227 offset:4096
 rq a[160:163],v255 offset:16384
 mf v[0:3],a[132:135],a[228:231],v[0:3]
 bl v243,s[36:39],s63 offen offset:2048 lds
 mf v[16:19],a[132:135],a[232:235],v[16:19]
 rt a[142:143],v227 offset:6144
 rq a[176:179],v255 offset:20480
 mf v[16:19],a[128:131],a[216:219],v[16:19]
 rq a[164:167],v255 offset:17408
 mf v[32:35],a[128:131],a[220:223],v[32:35]
 s_mov_b32 s63,771072
 rt a[144:145],v228 offset:0
 mf v[32:35],a[132:135],a[236:239],v[32:35]
 bl v243,s[36:39],s63 offen offset:3072 lds
 mf v[48:51],a[132:135],a[240:243],v[48:51]
 rt a[146:147],v228 offset:2048
 mf v[48:51],a[128:131],a[224:227],v[48:51]
 s_waitcnt lgkmcnt(4)
 s_add_u32 m0,s62,36864
 rq a[180:183],v255 offset:21504
 mf v[52:55],a[136:139],a[224:227],v[52:55]
 s_mov_b32 s63,802816
 rt a[148:149],v228 offset:4096
 mf v[52:55],a[140:143],a[240:243],v[52:55]
 bl v243,s[36:39],s63 offen offset:0 lds
 mf v[36:39],a[140:143],a[236:239],v[36:39]
 rt a[150:151],v228 offset:6144
 mf v[36:39],a[136:139],a[220:223],v[36:39]
 rq a[168:171],v255 offset:18432
 mf v[20:23],a[136:139],a[216:219],v[20:23]
 s_mov_b32 s63,830464
 rt a[152:153],v229 offset:0
 mf v[20:23],a[140:143],a[232:235],v[20:23]
 bl v243,s[36:39],s63 offen offset:1024 lds
 mf v[4:7],a[140:143],a[228:231],v[4:7]
 rt a[154:155],v229 offset:2048
 mf v[4:7],a[136:139],a[212:215],v[4:7]
 s_waitcnt lgkmcnt(3)
 rq a[184:187],v255 offset:22528
 mf v[8:11],a[144:147],a[212:215],v[8:11]
 s_mov_b32 s63,858112
 rt a[156:157],v229 offset:4096
 mf v[8:11],a[148:151],a[228:231],v[8:11]
 bl v243,s[36:39],s63 offen offset:2048 lds
 mf v[24:27],a[148:151],a[232:235],v[24:27]
 rt a[158:159],v229 offset:6144
 mf v[24:27],a[144:147],a[216:219],v[24:27]
 rq a[172:175],v255 offset:19456
 mf v[40:43],a[144:147],a[220:223],v[40:43]
 s_mov_b32 s63,885760
 s_waitcnt vmcnt(7)
 rt a[128:129],v230 offset:0
 mf v[40:43],a[148:151],a[236:239],v[40:43]
 bl v243,s[36:39],s63 offen offset:3072 lds
 mf v[56:59],a[148:151],a[240:243],v[56:59]
 rt a[130:131],v230 offset:2048
 mf v[56:59],a[144:147],a[224:227],v[56:59]
 s_waitcnt lgkmcnt(3)
 s_add_u32 m0,s62,0
 rq a[188:191],v255 offset:23552
 mf v[60:63],a[152:155],a[224:227],v[60:63]
 s_mov_b32 s63,0
 rt a[132:133],v230 offset:4096
 mf v[60:63],a[156:159],a[240:243],v[60:63]
 bl v239,s[40:43],s63 offen offset:0 lds
 mf v[44:47],a[156:159],a[236:239],v[44:47]
 rt a[134:135],v230 offset:6144
 mf v[44:47],a[152:155],a[220:223],v[44:47]
 mf v[28:31],a[152:155],a[216:219],v[28:31]
 s_mov_b32 s63,7168
 rt a[136:137],v231 offset:0
 mf v[28:31],a[156:159],a[232:235],v[28:31]
 bl v239,s[40:43],s63 offen offset:1024 lds
 mf v[12:15],a[156:159],a[228:231],v[12:15]
 rt a[138:139],v231 offset:2048
 mf v[12:15],a[152:155],a[212:215],v[12:15]
 s_waitcnt lgkmcnt(2)
 mf v[0:3],a[128:131],a[160:163],v[0:3]
 s_mov_b32 s63,14336
 rt a[140:141],v231 offset:4096
 rq a[212:215],v255 offset:24576
 mf v[0:3],a[132:135],a[176:179],v[0:3]
 bl v239,s[40:43],s63 offen offset:2048 lds
 mf v[16:19],a[132:135],a[180:183],v[16:19]
 rt a[142:143],v231 offset:6144
 rq a[228:231],v255 offset:28672
 mf v[16:19],a[128:131],a[164:167],v[16:19]
 rq a[216:219],v255 offset:25600
 mf v[32:35],a[128:131],a[168:171],v[32:35]
 s_mov_b32 s63,21504
 rt a[144:145],v232 offset:0
 mf v[32:35],a[132:135],a[184:187],v[32:35]
 bl v239,s[40:43],s63 offen offset:3072 lds
 mf v[48:51],a[132:135],a[188:191],v[48:51]
 rt a[146:147],v232 offset:2048
 mf v[48:51],a[128:131],a[172:175],v[48:51]
 s_waitcnt lgkmcnt(4)
 s_add_u32 m0,s62,4096
 rq a[232:235],v255 offset:29696
 mf v[52:55],a[136:139],a[172:175],v[52:55]
 s_mov_b32 s63,32768
 rt a[148:149],v232 offset:4096
 mf v[52:55],a[140:143],a[188:191],v[52:55]
 bl v239,s[40:43],s63 offen offset:0 lds
 mf v[36:39],a[140:143],a[184:187],v[36:39]
 s_mov_b64 exec,0
 s_cmp_eq_u32 s54,0
 s_cbranch_scc1 L_pad_pg18
 s_cmp_eq_u32 s54,1
 s_cbranch_scc1 L_pad_pg19
L_hop5:
 s_mov_b64 exec,-1
 rt a[150:151],v232 offset:6144
 mf v[36:39],a[136:139],a[168:171],v[36:39]
 rq a[220:223],v255 offset:26624
 mf v[20:23],a[136:139],a[164:167],v[20:23]
 s_mov_b32 s63,39936
 rt a[152:153],v233 offset:0
 mf v[20:23],a[140:143],a[180:183],v[20:23]
 bl v239,s[40:43],s63 offen offset:1024 lds
 mf v[4:7],a[140:143],a[176:179],v[4:7]
 rt a[154:155],v233 offset:2048
 mf v[4:7],a[136:139],a[160:163],v[4:7]
 s_waitcnt lgkmcnt(3)
 rq a[236:239],v255 offset:30720
 mf v[8:11],a[144:147],a[160:163],v[8:11]
 s_mov_b32 s63,47104
 rt a[156:157],v233 offset:4096
 mf v[8:11],a[148:151],a[176:179],v[8:11]
 bl v239,s[40:43],s63 offen offset:2048 lds
 mf v[24:27],a[148:151],a[180:183],v[24:27]
 rt a[158:159],v233 offset:6144
 mf v[24:27],a[144:147],a[164:167],v[24:27]
 rq a[224:227],v255 offset:27648
 mf v[40:43],a[144:147],a[168:171],v[40:43]
 s_mov_b32 s63,54272
 s_waitcnt vmcnt(7)
 rt a[128:129],v226 offset:32768
 mf v[40:43],a[148:151],a[184:187],v[40:43]
 bl v239,s[40:43],s63 offen offset:3072 lds
 mf v[56:59],a[148:151],a[188:191],v[56:59]
 rt a[130:131],v226 offset:34816
 mf v[56:59],a[144:147],a[172:175],v[56:59]
 s_waitcnt lgkmcnt(3)
 s_add_u32 m0,s62,65536
 rq a[240:243],v255 offset:31744
 mf v[60:63],a[152:155],a[172:175],v[60:63]
 s_mov_b32 s63,128
 rt a[132:133],v226 offset:36864
 mf v[60:63],a[156:159],a[188:191],v[60:63]
L_pad_pg18:
 s_cbranch_execz L_hop5
 bl v239,s[40:43],s63 offen offset:0 lds
 mf v[44:47],a[156:159],a[184:187],v[44:47]
 rt a[134:135],v226 offset:38912
 mf v[44:47],a[152:155],a[168:171],v[44:47]
 mf v[28:31],a[152:155],a[164:167],v[28:31]
 s_mov_b32 s63,7296
 rt a[136:137],v227 offset:32768
 mf v[28:31],a[156:159],a[180:183],v[28:31]
 bl v239,s[40:43],s63 offen offset:1024 lds
 mf v[12:15],a[156:159],a[176:179],v[12:15]
 rt a[138:139],v227 offset:34816
 mf v[12:15],a[152:155],a[160:163],v[12:15]
 s_waitcnt lgkmcnt(2)
 mf v[0:3],a[128:131],a[212:215],v[0:3]
 s_mov_b32 s63,14464
 rt a[140:141],v227 offset:36864
 mf v[0:3],a[132:135],a[228:231],v[0:3]
 bl v239,s[40:43],s63 offen offset:2048 lds
 mf v[16:19],a[132:135],a[232:235],v[16:19]
 rt a[142:143],v227 offset:38912
 mf v[16:19],a[128:131],a[216:219],v[16:19]
 rq a[244:247],v235
 mf v[32:35],a[128:131],a[220:223],v[32:35]
 s_mov_b32 s63,21632
 rt a[144:145],v228 offset:32768
 mf v[32:35],a[132:135],a[236:239],v[32:35]
 bl v239,s[40:43],s63 offen offset:3072 lds
 mf v[48:51],a[132:135],a[240:243],v[48:51]
 rt a[146:147],v228 offset:34816
 mf v[48:51],a[128:131],a[224:227],v[48:51]
 s_waitcnt lgkmcnt(3)
 s_add_u32 m0,s62,69632
 rq a[248:251],v235 offset:8192
 mf v[52:55],a[136:139],a[224:227],v[52:55]
 s_mov_b32 s63,32896
 rt a[148:149],v228 offset:36864
 mf v[52:55],a[140:143],a[240:243],v[52:55]
 bl v239,s[40:43],s63 offen offset:0 lds
 mf v[36:39],a[140:143],a[236:239],v[36:39]
 s_lshl_b32 s55,s54,13
 rt a[150:151],v228 offset:38912
 v_add_u32 v234,s55,v255
 mf v[36:39],a[136:139],a[220:223],v[36:39]
 mf v[20:23],a[136:139],a[216:219],v[20:23]
 s_mov_b32 s63,40064
 rt a[152:153],v229 offset:32768
 mf v[20:23],a[140:143],a[232:235],v[20:23]
 bl v239,s[40:43],s63 offen offset:1024 lds
 mf v[4:7],a[140:143],a[228:231],v[4:7]
 rt a[154:155],v229 offset:34816
 mf v[4:7],a[136:139],a[212:215],v[4:7]
 s_waitcnt lgkmcnt(2)
 mf v[8:11],a[144:147],a[212:215],v[8:11]
 s_mov_b32 s63,47232
 rt a[156:157],v229 offset:36864
 mf v[8:11],a[148:151],a[228:231],v[8:11]
 bl v239,s[40:43],s63 offen offset:2048 lds
 mf v[24:27],a[148:151],a[232:235],v[24:27]
 rt a[158:159],v229 offset:38912
 mf v[24:27],a[144:147],a[216:219],v[24:27]
 mf v[40:43],a[144:147],a[220:223],v[40:43]
 s_mov_b32 s63,54400
 mf v[40:43],a[148:151],a[236:239],v[40:43]
 bl v239,s[40:43],s63 offen offset:3072 lds
 mf v[56:59],a[148:151],a[240:243],v[56:59]
 mf v[56:59],a[144:147],a[224:227],v[56:59]
 s_waitcnt lgkmcnt(0)
 s_add_u32 m0,s62,32768
 mf v[60:63],a[152:155],a[224:227],v[60:63]
 s_mov_b32 s63,65536
 mf v[60:63],a[156:159],a[240:243],v[60:63]
 bl v239,s[40:43],s63 offen offset:0 lds
 mf v[44:47],a[156:159],a[236:239],v[44:47]
 mf v[44:47],a[152:155],a[220:223],v[44:47]
 mf v[28:31],a[152:155],a[216:219],v[28:31]
 s_mov_b32 s63,72704
 mf v[28:31],a[156:159],a[232:235],v[28:31]
 bl v239,s[40:43],s63 offen offset:1024 lds
 mf v[12:15],a[156:159],a[228:231],v[12:15]
 mf v[12:15],a[152:155],a[212:215],v[12:15]
 s_barrier
 s_mov_b32 s63,79872
 bl v239,s[40:43],s63 offen offset:2048 lds
 v_mov_b32 v236,s78
 v_pk_fma_f32 v[64:65],v[0:1],v[0:1],v[236:237] op_sel_hi:[1,1,0]
 v_pk_fma_f32 v[66:67],v[2:3],v[2:3],v[236:237] op_sel_hi:[1,1,0]
 v_pk_fma_f32 v[68:69],v[4:5],v[4:5],v[236:237] op_sel_hi:[1,1,0]
 v_pk_fma_f32 v[70:71],v[6:7],v[6:7],v[236:237] op_sel_hi:[1,1,0]
 v_pk_fma_f32 v[72:73],v[8:9],v[8:9],v[236:237] op_sel_hi:[1,1,0]
 v_pk_fma_f32 v[74:75],v[10:11],v[10:11],v[236:237] op_sel_hi:[1,1,0]
 v_pk_fma_f32 v[76:77],v[12:13],v[12:13],v[236:237] op_sel_hi:[1,1,0]
 v_pk_fma_f32 v[78:79],v[14:15],v[14:15],v[236:237] op_sel_hi:[1,1,0]
 v_pk_mul_f32 v[64:65],v[64:65],v[0:1] neg_lo:[0,1] neg_hi:[0,1]
 v_pk_mul_f32 v[66:67],v[66:67],v[2:3] neg_lo:[0,1] neg_hi:[0,1]
 v_pk_mul_f32 v[68:69],v[68:69],v[4:5] neg_lo:[0,1] neg_hi:[0,1]
 v_pk_mul_f32 v[70:71],v[70:71],v[6:7] neg_lo:[0,1] neg_hi:[0,1]
 v_pk_mul_f32 v[72:73],v[72:73],v[8:9] neg_lo:[0,1] neg_hi:[0,1]
 v_pk_mul_f32 v[74:75],v[74:75],v[10:11] neg_lo:[0,1] neg_hi:[0,1]
 v_pk_mul_f32 v[76:77],v[76:77],v[12:13] neg_lo:[0,1] neg_hi:[0,1]
 s_mov_b32 s63,87040
 bl v239,s[40:43],s63 offen offset:3072 lds
 v_pk_mul_f32 v[78:79],v[78:79],v[14:15] neg_lo:[0,1] neg_hi:[0,1]
 v_exp_f32 v64,v64
 v_exp_f32 v65,v65
 v_exp_f32 v66,v66
 v_exp_f32 v67,v67
 v_exp_f32 v68,v68
 v_exp_f32 v69,v69
 v_exp_f32 v70,v70
 v_exp_f32 v71,v71
 v_exp_f32 v72,v72
 v_exp_f32 v73,v73
 v_exp_f32 v74,v74
 v_exp_f32 v75,v75
 v_exp_f32 v76,v76
 v_exp_f32 v77,v77
 v_exp_f32 v78,v78
 s_add_u32 m0,s62,36864
 s_mov_b32 s63,98304
 bl v239,s[40:43],s63 offen offset:0 lds
 v_exp_f32 v79,v79
 v_pk_add_f32 v[64:65],v[64:65],1.0 op_sel_hi:[1,0]
 v_pk_add_f32 v[66:67],v[66:67],1.0 op_sel_hi:[1,0]
 v_pk_add_f32 v[68:69],v[68:69],1.0 op_sel_hi:[1,0]
 v_pk_add_f32 v[70:71],v[70:71],1.0 op_sel_hi:[1,0]
 v_pk_add_f32 v[72:73],v[72:73],1.0 op_sel_hi:[1,0]
 v_pk_add_f32 v[74:75],v[74:75],1.0 op_sel_hi:[1,0]
 v_pk_add_f32 v[76:77],v[76:77],1.0 op_sel_hi:[1,0]
 v_pk_add_f32 v[78:79],v[78:79],1.0 op_sel_hi:[1,0]
 v_rcp_f32 v64,v64
 v_rcp_f32 v65,v65
 v_rcp_f32 v66,v66
 v_rcp_f32 v67,v67
 v_rcp_f32 v68,v68
 v_rcp_f32 v69,v69
 v_rcp_f32 v70,v70
 s_mov_b32 s63,105472
 bl v239,s[40:43],s63 offen offset:1024 lds
 v_rcp_f32 v71,v71
 v_rcp_f32 v72,v72
 v_rcp_f32 v73,v73
 v_rcp_f32 v74,v74
 v_rcp_f32 v75,v75
 v_rcp_f32 v76,v76
 v_rcp_f32 v77,v77
 v_rcp_f32 v78,v78
 v_rcp_f32 v79,v79
 v_pk_mul_f32 v[64:65],v[64:65],v[0:1]
 v_pk_mul_f32 v[66:67],v[66:67],v[2:3]
 v_pk_mul_f32 v[68:69],v[68:69],v[4:5]
 v_pk_mul_f32 v[70:71],v[70:71],v[6:7]
 v_pk_mul_f32 v[72:73],v[72:73],v[8:9]
 v_pk_mul_f32 v[74:75],v[74:75],v[10:11]
 v_pk_mul_f32 v[76:77],v[76:77],v[12:13]
 s_mov_b32 s63,112640
 bl v239,s[40:43],s63 offen offset:2048 lds
 v_pk_mul_f32 v[78:79],v[78:79],v[14:15]
 pk v0,v64,v65
 pk v1,v66,v67
 pk v2,v68,v69
 pk v3,v70,v71
 pk v4,v72,v73
 pk v5,v74,v75
 pk v6,v76,v77
 pk v7,v78,v79
 ds_write_b128 v234,v[0:3] offset:0
 ds_write_b128 v234,v[4:7] offset:4096
 v_pk_fma_f32 v[80:81],v[16:17],v[16:17],v[236:237] op_sel_hi:[1,1,0]
 v_pk_fma_f32 v[82:83],v[18:19],v[18:19],v[236:237] op_sel_hi:[1,1,0]
 v_pk_fma_f32 v[84:85],v[20:21],v[20:21],v[236:237] op_sel_hi:[1,1,0]
 v_pk_fma_f32 v[86:87],v[22:23],v[22:23],v[236:237] op_sel_hi:[1,1,0]
 v_pk_fma_f32 v[88:89],v[24:25],v[24:25],v[236:237] op_sel_hi:[1,1,0]
 s_mov_b32 s63,119808
 bl v239,s[40:43],s63 offen offset:3072 lds
 v_pk_fma_f32 v[90:91],v[26:27],v[26:27],v[236:237] op_sel_hi:[1,1,0]
 v_pk_fma_f32 v[92:93],v[28:29],v[28:29],v[236:237] op_sel_hi:[1,1,0]
 v_pk_fma_f32 v[94:95],v[30:31],v[30:31],v[236:237] op_sel_hi:[1,1,0]
 v_pk_mul_f32 v[80:81],v[80:81],v[16:17] neg_lo:[0,1] neg_hi:[0,1]
 v_pk_mul_f32 v[82:83],v[82:83],v[18:19] neg_lo:[0,1] neg_hi:[0,1]
 v_pk_mul_f32 v[84:85],v[84:85],v[20:21] neg_lo:[0,1] neg_hi:[0,1]
 v_pk_mul_f32 v[86:87],v[86:87],v[22:23] neg_lo:[0,1] neg_hi:[0,1]
 v_pk_mul_f32 v[88:89],v[88:89],v[24:25] neg_lo:[0,1] neg_hi:[0,1]
 v_pk_mul_f32 v[90:91],v[90:91],v[26:27] neg_lo:[0,1] neg_hi:[0,1]
 v_pk_mul_f32 v[92:93],v[92:93],v[28:29] neg_lo:[0,1] neg_hi:[0,1]
 v_pk_mul_f32 v[94:95],v[94:95],v[30:31] neg_lo:[0,1] neg_hi:[0,1]
 v_exp_f32 v80,v80
 v_exp_f32 v81,v81
 v_exp_f32 v82,v82
 v_exp_f32 v83,v83
 v_exp_f32 v84,v84
 v_exp_f32 v85,v85
 v_exp_f32 v86,v86
 v_exp_f32 v87,v87
 v_exp_f32 v88,v88
 v_exp_f32 v89,v89
 v_exp_f32 v90,v90
 v_exp_f32 v91,v91
 v_exp_f32 v92,v92
 v_exp_f32 v93,v93
 v_exp_f32 v94,v94
 v_exp_f32 v95,v95
 v_pk_add_f32 v[80:81],v[80:81],1.0 op_sel_hi:[1,0]
 v_pk_add_f32 v[82:83],v[82:83],1.0 op_sel_hi:[1,0]
 v_pk_add_f32 v[84:85],v[84:85],1.0 op_sel_hi:[1,0]
 v_pk_add_f32 v[86:87],v[86:87],1.0 op_sel_hi:[1,0]
 v_pk_add_f32 v[88:89],v[88:89],1.0 op_sel_hi:[1,0]
 v_pk_add_f32 v[90:91],v[90:91],1.0 op_sel_hi:[1,0]
 v_pk_add_f32 v[92:93],v[92:93],1.0 op_sel_hi:[1,0]
 v_pk_add_f32 v[94:95],v[94:95],1.0 op_sel_hi:[1,0]
 v_rcp_f32 v80,v80
 v_rcp_f32 v81,v81
 v_rcp_f32 v82,v82
 v_rcp_f32 v83,v83
 v_rcp_f32 v84,v84
 v_rcp_f32 v85,v85
 v_rcp_f32 v86,v86
 v_rcp_f32 v87,v87
 v_rcp_f32 v88,v88
 v_rcp_f32 v89,v89
 v_rcp_f32 v90,v90
 v_rcp_f32 v91,v91
 v_rcp_f32 v92,v92
 v_rcp_f32 v93,v93
 v_rcp_f32 v94,v94
 v_rcp_f32 v95,v95
 v_pk_mul_f32 v[80:81],v[80:81],v[16:17]
 v_pk_mul_f32 v[82:83],v[82:83],v[18:19]
 v_pk_mul_f32 v[84:85],v[84:85],v[20:21]
 v_pk_mul_f32 v[86:87],v[86:87],v[22:23]
 v_pk_mul_f32 v[88:89],v[88:89],v[24:25]
 v_pk_mul_f32 v[90:91],v[90:91],v[26:27]
 v_pk_mul_f32 v[92:93],v[92:93],v[28:29]
 v_pk_mul_f32 v[94:95],v[94:95],v[30:31]
 pk v16,v80,v81
 pk v17,v82,v83
 pk v18,v84,v85
 pk v19,v86,v87
 pk v20,v88,v89
 pk v21,v90,v91
 pk v22,v92,v93
 pk v23,v94,v95
 ds_write_b128 v234,v[16:19] offset:1024
 ds_write_b128 v234,v[20:23] offset:5120
 v_pk_fma_f32 v[96:97],v[32:33],v[32:33],v[236:237] op_sel_hi:[1,1,0]
 v_pk_fma_f32 v[98:99],v[34:35],v[34:35],v[236:237] op_sel_hi:[1,1,0]
 v_pk_fma_f32 v[100:101],v[36:37],v[36:37],v[236:237] op_sel_hi:[1,1,0]
 v_pk_fma_f32 v[102:103],v[38:39],v[38:39],v[236:237] op_sel_hi:[1,1,0]
 v_pk_fma_f32 v[104:105],v[40:41],v[40:41],v[236:237] op_sel_hi:[1,1,0]
 v_pk_fma_f32 v[106:107],v[42:43],v[42:43],v[236:237] op_sel_hi:[1,1,0]
 v_pk_fma_f32 v[108:109],v[44:45],v[44:45],v[236:237] op_sel_hi:[1,1,0]
 v_pk_fma_f32 v[110:111],v[46:47],v[46:47],v[236:237] op_sel_hi:[1,1,0]
 v_pk_mul_f32 v[96:97],v[96:97],v[32:33] neg_lo:[0,1] neg_hi:[0,1]
 v_pk_mul_f32 v[98:99],v[98:99],v[34:35] neg_lo:[0,1] neg_hi:[0,1]
 v_pk_mul_f32 v[100:101],v[100:101],v[36:37] neg_lo:[0,1] neg_hi:[0,1]
 v_pk_mul_f32 v[102:103],v[102:103],v[38:39] neg_lo:[0,1] neg_hi:[0,1]
 v_pk_mul_f32 v[104:105],v[104:105],v[40:41] neg_lo:[0,1] neg_hi:[0,1]
 v_pk_mul_f32 v[106:107],v[106:107],v[42:43] neg_lo:[0,1] neg_hi:[0,1]
 v_pk_mul_f32 v[108:109],v[108:109],v[44:45] neg_lo:[0,1] neg_hi:[0,1]
 v_pk_mul_f32 v[110:111],v[110:111],v[46:47] neg_lo:[0,1] neg_hi:[0,1]
 v_exp_f32 v96,v96
 v_exp_f32 v97,v97
 v_exp_f32 v98,v98
 v_exp_f32 v99,v99
 v_exp_f32 v100,v100
 v_exp_f32 v101,v101
 v_exp_f32 v102,v102
 v_exp_f32 v103,v103
 v_exp_f32 v104,v104
 v_exp_f32 v105,v105
 v_exp_f32 v106,v106
 v_exp_f32 v107,v107
 v_exp_f32 v108,v108
 v_exp_f32 v109,v109
 v_exp_f32 v110,v110
 v_exp_f32 v111,v111
 v_pk_add_f32 v[96:97],v[96:97],1.0 op_sel_hi:[1,0]
 v_pk_add_f32 v[98:99],v[98:99],1.0 op_sel_hi:[1,0]
 v_pk_add_f32 v[100:101],v[100:101],1.0 op_sel_hi:[1,0]
 v_pk_add_f32 v[102:103],v[102:103],1.0 op_sel_hi:[1,0]
 v_pk_add_f32 v[104:105],v[104:105],1.0 op_sel_hi:[1,0]
 v_pk_add_f32 v[106:107],v[106:107],1.0 op_sel_hi:[1,0]
 v_pk_add_f32 v[108:109],v[108:109],1.0 op_sel_hi:[1,0]
 v_pk_add_f32 v[110:111],v[110:111],1.0 op_sel_hi:[1,0]
 v_rcp_f32 v96,v96
 v_rcp_f32 v97,v97
 v_rcp_f32 v98,v98
 v_rcp_f32 v99,v99
 v_rcp_f32 v100,v100
 v_rcp_f32 v101,v101
 v_rcp_f32 v102,v102
 v_rcp_f32 v103,v103
 v_rcp_f32 v104,v104
 v_rcp_f32 v105,v105
 v_rcp_f32 v106,v106
 v_rcp_f32 v107,v107
 v_rcp_f32 v108,v108
 v_rcp_f32 v109,v109
 v_rcp_f32 v110,v110
 v_rcp_f32 v111,v111
 v_pk_mul_f32 v[96:97],v[96:97],v[32:33]
 v_pk_mul_f32 v[98:99],v[98:99],v[34:35]
 v_pk_mul_f32 v[100:101],v[100:101],v[36:37]
 v_pk_mul_f32 v[102:103],v[102:103],v[38:39]
 v_pk_mul_f32 v[104:105],v[104:105],v[40:41]
 v_pk_mul_f32 v[106:107],v[106:107],v[42:43]
 v_pk_mul_f32 v[108:109],v[108:109],v[44:45]
 v_pk_mul_f32 v[110:111],v[110:111],v[46:47]
 pk v32,v96,v97
 pk v33,v98,v99
 pk v34,v100,v101
 pk v35,v102,v103
 pk v36,v104,v105
 pk v37,v106,v107
 pk v38,v108,v109
 pk v39,v110,v111
 ds_write_b128 v234,v[32:35] offset:2048
 ds_write_b128 v234,v[36:39] offset:6144
 v_pk_fma_f32 v[112:113],v[48:49],v[48:49],v[236:237] op_sel_hi:[1,1,0]
 v_pk_fma_f32 v[114:115],v[50:51],v[50:51],v[236:237] op_sel_hi:[1,1,0]
 v_pk_fma_f32 v[116:117],v[52:53],v[52:53],v[236:237] op_sel_hi:[1,1,0]
 v_pk_fma_f32 v[118:119],v[54:55],v[54:55],v[236:237] op_sel_hi:[1,1,0]
 v_pk_fma_f32 v[120:121],v[56:57],v[56:57],v[236:237] op_sel_hi:[1,1,0]
 v_pk_fma_f32 v[122:123],v[58:59],v[58:59],v[236:237] op_sel_hi:[1,1,0]
 v_pk_fma_f32 v[124:125],v[60:61],v[60:61],v[236:237] op_sel_hi:[1,1,0]
 v_pk_fma_f32 v[126:127],v[62:63],v[62:63],v[236:237] op_sel_hi:[1,1,0]
 v_pk_mul_f32 v[112:113],v[112:113],v[48:49] neg_lo:[0,1] neg_hi:[0,1]
 v_pk_mul_f32 v[114:115],v[114:115],v[50:51] neg_lo:[0,1] neg_hi:[0,1]
 v_pk_mul_f32 v[116:117],v[116:117],v[52:53] neg_lo:[0,1] neg_hi:[0,1]
 v_pk_mul_f32 v[118:119],v[118:119],v[54:55] neg_lo:[0,1] neg_hi:[0,1]
 v_pk_mul_f32 v[120:121],v[120:121],v[56:57] neg_lo:[0,1] neg_hi:[0,1]
 v_pk_mul_f32 v[122:123],v[122:123],v[58:59] neg_lo:[0,1] neg_hi:[0,1]
 v_pk_mul_f32 v[124:125],v[124:125],v[60:61] neg_lo:[0,1] neg_hi:[0,1]
 v_pk_mul_f32 v[126:127],v[126:127],v[62:63] neg_lo:[0,1] neg_hi:[0,1]
 v_exp_f32 v112,v112
 v_exp_f32 v113,v113
 v_exp_f32 v114,v114
 v_exp_f32 v115,v115
 v_exp_f32 v116,v116
 v_exp_f32 v117,v117
 v_exp_f32 v118,v118
 v_exp_f32 v119,v119
 v_exp_f32 v120,v120
 v_exp_f32 v121,v121
 v_exp_f32 v122,v122
 v_exp_f32 v123,v123
 v_exp_f32 v124,v124
 v_exp_f32 v125,v125
 v_exp_f32 v126,v126
 v_exp_f32 v127,v127
 v_pk_add_f32 v[112:113],v[112:113],1.0 op_sel_hi:[1,0]
 v_pk_add_f32 v[114:115],v[114:115],1.0 op_sel_hi:[1,0]
 v_pk_add_f32 v[116:117],v[116:117],1.0 op_sel_hi:[1,0]
 v_pk_add_f32 v[118:119],v[118:119],1.0 op_sel_hi:[1,0]
 v_pk_add_f32 v[120:121],v[120:121],1.0 op_sel_hi:[1,0]
 v_pk_add_f32 v[122:123],v[122:123],1.0 op_sel_hi:[1,0]
 v_pk_add_f32 v[124:125],v[124:125],1.0 op_sel_hi:[1,0]
 v_pk_add_f32 v[126:127],v[126:127],1.0 op_sel_hi:[1,0]
 v_rcp_f32 v112,v112
 v_rcp_f32 v113,v113
 v_rcp_f32 v114,v114
 v_rcp_f32 v115,v115
 v_rcp_f32 v116,v116
 v_rcp_f32 v117,v117
 v_rcp_f32 v118,v118
 v_rcp_f32 v119,v119
 v_rcp_f32 v120,v120
 v_rcp_f32 v121,v121
 v_rcp_f32 v122,v122
 v_rcp_f32 v123,v123
 v_rcp_f32 v124,v124
 v_rcp_f32 v125,v125
 v_rcp_f32 v126,v126
 v_rcp_f32 v127,v127
 v_pk_mul_f32 v[112:113],v[112:113],v[48:49]
 v_pk_mul_f32 v[114:115],v[114:115],v[50:51]
 v_pk_mul_f32 v[116:117],v[116:117],v[52:53]
 v_pk_mul_f32 v[118:119],v[118:119],v[54:55]
 v_pk_mul_f32 v[120:121],v[120:121],v[56:57]
 v_pk_mul_f32 v[122:123],v[122:123],v[58:59]
 v_pk_mul_f32 v[124:125],v[124:125],v[60:61]
 v_pk_mul_f32 v[126:127],v[126:127],v[62:63]
 pk v48,v112,v113
 pk v49,v114,v115
 pk v50,v116,v117
 pk v51,v118,v119
 pk v52,v120,v121
 pk v53,v122,v123
 pk v54,v124,v125
 pk v55,v126,v127
 ds_write_b128 v234,v[48:51] offset:3072
 ds_write_b128 v234,v[52:55] offset:7168
 s_waitcnt vmcnt(16)
 rt a[128:129],v226 offset:0
 rt a[130:131],v226 offset:2048
 rt a[132:133],v226 offset:4096
 rt a[134:135],v226 offset:6144
 s_waitcnt lgkmcnt(4)
 s_barrier
 rq a[160:163],v255 offset:0
 rq a[176:179],v255 offset:4096
 rq a[164:167],v255 offset:1024
 rq a[180:183],v255 offset:5120
 rq a[168:171],v255 offset:2048
 rq a[184:187],v255 offset:6144
 rq a[172:175],v255 offset:3072
 rq a[188:191],v255 offset:7168
 rt a[136:137],v227 offset:0
 rt a[138:139],v227 offset:2048
 s_waitcnt lgkmcnt(8)
 mf v[0:3],a[128:131],a[160:163],0
 rt a[140:141],v227 offset:4096
 mf v[0:3],a[132:135],a[176:179],v[0:3]
 s_waitcnt lgkmcnt(7)
 mf v[16:19],a[132:135],a[180:183],0
 rt a[142:143],v227 offset:6144
 mf v[16:19],a[128:131],a[164:167],v[16:19]
 s_waitcnt lgkmcnt(6)
 rq a[212:215],v255 offset:8192
 mf v[32:35],a[128:131],a[168:171],0
 rt a[144:145],v228 offset:0
 mf v[32:35],a[132:135],a[184:187],v[32:35]
 s_waitcnt lgkmcnt(6)
 mf v[48:51],a[132:135],a[188:191],0
 rt a[146:147],v228 offset:2048
 mf v[48:51],a[128:131],a[172:175],v[48:51]
 s_waitcnt lgkmcnt(3)
 rq a[228:231],v255 offset:12288
 mf v[52:55],a[136:139],a[172:175],0
 rt a[148:149],v228 offset:4096
 mf v[52:55],a[140:143],a[188:191],v[52:55]
 mf v[36:39],a[140:143],a[184:187],0
 rt a[150:151],v228 offset:6144
 mf v[36:39],a[136:139],a[168:171],v[36:39]
 mf v[20:23],a[136:139],a[164:167],0
 rt a[152:153],v229 offset:0
 mf v[20:23],a[140:143],a[180:183],v[20:23]
 mf v[4:7],a[140:143],a[176:179],0
 rt a[154:155],v229 offset:2048
 mf v[4:7],a[136:139],a[160:163],v[4:7]
 s_waitcnt lgkmcnt(2)
 rq a[216:219],v255 offset:9216
 mf v[8:11],a[144:147],a[160:163],0
 rt a[156:157],v229 offset:4096
 mf v[8:11],a[148:151],a[176:179],v[8:11]
 mf v[24:27],a[148:151],a[180:183],0
 rt a[158:159],v229 offset:6144
 mf v[24:27],a[144:147],a[164:167],v[24:27]
 mf v[40:43],a[144:147],a[168:171],0
 s_waitcnt vmcnt(8)
 rt a[128:129],v230 offset:0
 mf v[40:43],a[148:151],a[184:187],v[40:43]
 mf v[56:59],a[148:151],a[188:191],0
 rt a[130:131],v230 offset:2048
 mf v[56:59],a[144:147],a[172:175],v[56:59]
 s_waitcnt lgkmcnt(2)
 s_add_u32 m0,s62,0
 rq a[232:235],v255 offset:13312
 mf v[60:63],a[152:155],a[172:175],0
 s_mov_b32 s63,65664
 rt a[132:133],v230 offset:4096
 mf v[60:63],a[156:159],a[188:191],v[60:63]
 bl v239,s[40:43],s63 offen offset:0 lds
 mf v[44:47],a[156:159],a[184:187],0
 rt a[134:135],v230 offset:6144
 mf v[44:47],a[152:155],a[168:171],v[44:47]
 mf v[28:31],a[152:155],a[164:167],0
 s_mov_b32 s63,72832
 rt a[136:137],v231 offset:0
 mf v[28:31],a[156:159],a[180:183],v[28:31]
 bl v239,s[40:43],s63 offen offset:1024 lds
 mf v[12:15],a[156:159],a[176:179],0
 rt a[138:139],v231 offset:2048
 mf v[12:15],a[152:155],a[160:163],v[12:15]
 s_waitcnt lgkmcnt(2)
 rq a[220:223],v255 offset:10240
 mf v[64:67],a[128:131],a[160:163],0
 s_mov_b32 s63,80000
 rt a[140:141],v231 offset:4096
 mf v[64:67],a[132:135],a[176:179],v[64:67]
 bl v239,s[40:43],s63 offen offset:2048 lds
 mf v[80:83],a[132:135],a[180:183],0
 rt a[142:143],v231 offset:6144
 mf v[80:83],a[128:131],a[164:167],v[80:83]
 rq a[236:239],v255 offset:14336
 mf v[96:99],a[128:131],a[168:171],0
 s_mov_b32 s63,87168
 rt a[144:145],v232 offset:0
 mf v[96:99],a[132:135],a[184:187],v[96:99]
 bl v239,s[40:43],s63 offen offset:3072 lds
 mf v[112:115],a[132:135],a[188:191],0
 rt a[146:147],v232 offset:2048
 mf v[112:115],a[128:131],a[172:175],v[112:115]
 s_waitcnt lgkmcnt(3)
 s_add_u32 m0,s62,4096
 mf v[116:119],a[136:139],a[172:175],0
 s_mov_b32 s63,98432
 rt a[148:149],v232 offset:4096
 mf v[116:119],a[140:143],a[188:191],v[116:119]
 bl v239,s[40:43],s63 offen offset:0 lds
 mf v[100:103],a[140:143],a[184:187],0
 rt a[150:151],v232 offset:6144
 mf v[100:103],a[136:139],a[168:171],v[100:103]
 rq a[224:227],v255 offset:11264
 mf v[84:87],a[136:139],a[164:167],0
 s_mov_b32 s63,105600
 rt a[152:153],v233 offset:0
 mf v[84:87],a[140:143],a[180:183],v[84:87]
 bl v239,s[40:43],s63 offen offset:1024 lds
 mf v[68:71],a[140:143],a[176:179],0
 rt a[154:155],v233 offset:2048
 mf v[68:71],a[136:139],a[160:163],v[68:71]
 s_waitcnt lgkmcnt(3)
 mf v[72:75],a[144:147],a[160:163],0
 s_mov_b32 s63,112768
 rt a[156:157],v233 offset:4096
 mf v[72:75],a[148:151],a[176:179],v[72:75]
 bl v239,s[40:43],s63 offen offset:2048 lds
 mf v[88:91],a[148:151],a[180:183],0
 rt a[158:159],v233 offset:6144
 mf v[88:91],a[144:147],a[164:167],v[88:91]
 rq a[240:243],v255 offset:15360
 mf v[104:107],a[144:147],a[168:171],0
 s_mov_b32 s63,119936
 s_waitcnt vmcnt(7)
 rt a[128:129],v226 offset:32768
 mf v[104:107],a[148:151],a[184:187],v[104:107]
 bl v239,s[40:43],s63 offen offset:3072 lds
 mf v[120:123],a[148:151],a[188:191],0
 rt a[130:131],v226 offset:34816
 mf v[120:123],a[144:147],a[172:175],v[120:123]
 s_waitcnt lgkmcnt(3)
 s_add_u32 m0,s62,65536
 mf v[124:127],a[152:155],a[172:175],0
 s_mov_b32 s63,131072
 rt a[132:133],v226 offset:36864
 mf v[124:127],a[156:159],a[188:191],v[124:127]
 bl v239,s[40:43],s63 offen offset:0 lds
 mf v[108:111],a[156:159],a[184:187],0
 rt a[134:135],v226 offset:38912
 mf v[108:111],a[152:155],a[168:171],v[108:111]
 mf v[92:95],a[152:155],a[164:167],0
 s_mov_b32 s63,138240
 rt a[136:137],v227 offset:32768
 mf v[92:95],a[156:159],a[180:183],v[92:95]
 bl v239,s[40:43],s63 offen offset:1024 lds
 mf v[76:79],a[156:159],a[176:179],0
 rt a[138:139],v227 offset:34816
 mf v[76:79],a[152:155],a[160:163],v[76:79]
 s_waitcnt lgkmcnt(2)
 mf v[0:3],a[128:131],a[212:215],v[0:3]
 s_mov_b32 s63,145408
 rt a[140:141],v227 offset:36864
 mf v[0:3],a[132:135],a[228:231],v[0:3]
 bl v239,s[40:43],s63 offen offset:2048 lds
 mf v[16:19],a[132:135],a[232:235],v[16:19]
 rt a[142:143],v227 offset:38912
 mf v[16:19],a[128:131],a[216:219],v[16:19]
 rq a[160:163],v255 offset:16384
 mf v[32:35],a[128:131],a[220:223],v[32:35]
 s_mov_b32 s63,152576
 rt a[144:145],v228 offset:32768
 mf v[32:35],a[132:135],a[236:239],v[32:35]
 bl v239,s[40:43],s63 offen offset:3072 lds
 mf v[48:51],a[132:135],a[240:243],v[48:51]
 rt a[146:147],v228 offset:34816
 mf v[48:51],a[128:131],a[224:227],v[48:51]
 s_waitcnt lgkmcnt(3)
 s_add_u32 m0,s62,69632
 rq a[176:179],v255 offset:20480
 mf v[52:55],a[136:139],a[224:227],v[52:55]
 s_mov_b32 s63,163840
 rt a[148:149],v228 offset:36864
 mf v[52:55],a[140:143],a[240:243],v[52:55]
 bl v239,s[40:43],s63 offen offset:0 lds
 mf v[36:39],a[140:143],a[236:239],v[36:39]
 rt a[150:151],v228 offset:38912
 mf v[36:39],a[136:139],a[220:223],v[36:39]
 mf v[20:23],a[136:139],a[216:219],v[20:23]
 s_mov_b32 s63,171008
 rt a[152:153],v229 offset:32768
 mf v[20:23],a[140:143],a[232:235],v[20:23]
 bl v239,s[40:43],s63 offen offset:1024 lds
 mf v[4:7],a[140:143],a[228:231],v[4:7]
 rt a[154:155],v229 offset:34816
 mf v[4:7],a[136:139],a[212:215],v[4:7]
 s_waitcnt lgkmcnt(2)
 rq a[164:167],v255 offset:17408
 mf v[8:11],a[144:147],a[212:215],v[8:11]
 s_mov_b32 s63,178176
 rt a[156:157],v229 offset:36864
 mf v[8:11],a[148:151],a[228:231],v[8:11]
L_pad_pg19:
 s_cbranch_execz L_hop5
 bl v239,s[40:43],s63 offen offset:2048 lds
 mf v[24:27],a[148:151],a[232:235],v[24:27]
 rt a[158:159],v229 offset:38912
 mf v[24:27],a[144:147],a[216:219],v[24:27]
 mf v[40:43],a[144:147],a[220:223],v[40:43]
 s_mov_b32 s63,185344
 s_waitcnt vmcnt(7)
 rt a[128:129],v226 offset:0
 mf v[40:43],a[148:151],a[236:239],v[40:43]
 bl v239,s[40:43],s63 offen offset:3072 lds
 mf v[56:59],a[148:151],a[240:243],v[56:59]
 rt a[130:131],v226 offset:2048
 mf v[56:59],a[144:147],a[224:227],v[56:59]
 s_waitcnt lgkmcnt(2)
 s_add_u32 m0,s62,32768
 rq a[180:183],v255 offset:21504
 mf v[60:63],a[152:155],a[224:227],v[60:63]
 s_mov_b32 s63,131200
 rt a[132:133],v226 offset:4096
 mf v[60:63],a[156:159],a[240:243],v[60:63]
 bl v239,s[40:43],s63 offen offset:0 lds
 mf v[44:47],a[156:159],a[236:239],v[44:47]
 rt a[134:135],v226 offset:6144
 mf v[44:47],a[152:155],a[220:223],v[44:47]
 mf v[28:31],a[152:155],a[216:219],v[28:31]
 s_mov_b32 s63,138368
 rt a[136:137],v227 offset:0
 mf v[28:31],a[156:159],a[232:235],v[28:31]
 bl v239,s[40:43],s63 offen offset:1024 lds
 mf v[12:15],a[156:159],a[228:231],v[12:15]
 rt a[138:139],v227 offset:2048
 mf v[12:15],a[152:155],a[212:215],v[12:15]
 s_waitcnt lgkmcnt(2)
 rq a[168:171],v255 offset:18432
 mf v[64:67],a[128:131],a[212:215],v[64:67]
 s_mov_b32 s63,145536
 rt a[140:141],v227 offset:4096
 mf v[64:67],a[132:135],a[228:231],v[64:67]
 bl v239,s[40:43],s63 offen offset:2048 lds
 mf v[80:83],a[132:135],a[232:235],v[80:83]
 rt a[142:143],v227 offset:6144
 mf v[80:83],a[128:131],a[216:219],v[80:83]
 rq a[184:187],v255 offset:22528
 mf v[96:99],a[128:131],a[220:223],v[96:99]
 s_mov_b32 s63,152704
 rt a[144:145],v228 offset:0
 mf v[96:99],a[132:135],a[236:239],v[96:99]
 bl v239,s[40:43],s63 offen offset:3072 lds
 mf v[112:115],a[132:135],a[240:243],v[112:115]
 rt a[146:147],v228 offset:2048
 mf v[112:115],a[128:131],a[224:227],v[112:115]
 s_waitcnt lgkmcnt(3)
 s_add_u32 m0,s62,36864
 mf v[116:119],a[136:139],a[224:227],v[116:119]
 s_mov_b32 s63,163968
 rt a[148:149],v228 offset:4096
 mf v[116:119],a[140:143],a[240:243],v[116:119]
 bl v239,s[40:43],s63 offen offset:0 lds
 mf v[100:103],a[140:143],a[236:239],v[100:103]
 rt a[150:151],v228 offset:6144
 mf v[100:103],a[136:139],a[220:223],v[100:103]
 rq a[172:175],v255 offset:19456
 mf v[84:87],a[136:139],a[216:219],v[84:87]
 s_mov_b32 s63,171136
 rt a[152:153],v229 offset:0
 mf v[84:87],a[140:143],a[232:235],v[84:87]
 bl v239,s[40:43],s63 offen offset:1024 lds
 mf v[68:71],a[140:143],a[228:231],v[68:71]
 rt a[154:155],v229 offset:2048
 mf v[68:71],a[136:139],a[212:215],v[68:71]
 s_waitcnt lgkmcnt(3)
 mf v[72:75],a[144:147],a[212:215],v[72:75]
 s_mov_b32 s63,178304
 rt a[156:157],v229 offset:4096
 mf v[72:75],a[148:151],a[228:231],v[72:75]
 bl v239,s[40:43],s63 offen offset:2048 lds
 mf v[88:91],a[148:151],a[232:235],v[88:91]
 rt a[158:159],v229 offset:6144
 mf v[88:91],a[144:147],a[216:219],v[88:91]
 rq a[188:191],v255 offset:23552
 mf v[104:107],a[144:147],a[220:223],v[104:107]
 s_mov_b32 s63,185472
 s_waitcnt vmcnt(7)
 rt a[128:129],v230 offset:0
 mf v[104:107],a[148:151],a[236:239],v[104:107]
 bl v239,s[40:43],s63 offen offset:3072 lds
 mf v[120:123],a[148:151],a[240:243],v[120:123]
 rt a[130:131],v230 offset:2048
 mf v[120:123],a[144:147],a[224:227],v[120:123]
 s_waitcnt lgkmcnt(3)
 s_add_u32 m0,s62,0
 mf v[124:127],a[152:155],a[224:227],v[124:127]
 s_mov_b32 s63,196608
 rt a[132:133],v230 offset:4096
 mf v[124:127],a[156:159],a[240:243],v[124:127]
 bl v239,s[40:43],s63 offen offset:0 lds
 mf v[108:111],a[156:159],a[236:239],v[108:111]
 rt a[134:135],v230 offset:6144
 mf v[108:111],a[152:155],a[220:223],v[108:111]
 mf v[92:95],a[152:155],a[216:219],v[92:95]
 s_mov_b32 s63,203776
 rt a[136:137],v231 offset:0
 mf v[92:95],a[156:159],a[232:235],v[92:95]
 bl v239,s[40:43],s63 offen offset:1024 lds
 mf v[76:79],a[156:159],a[228:231],v[76:79]
 rt a[138:139],v231 offset:2048
 mf v[76:79],a[152:155],a[212:215],v[76:79]
 s_waitcnt lgkmcnt(2)
 mf v[0:3],a[128:131],a[160:163],v[0:3]
 s_mov_b32 s63,210944
 rt a[140:141],v231 offset:4096
 mf v[0:3],a[132:135],a[176:179],v[0:3]
 bl v239,s[40:43],s63 offen offset:2048 lds
 mf v[16:19],a[132:135],a[180:183],v[16:19]
 rt a[142:143],v231 offset:6144
 mf v[16:19],a[128:131],a[164:167],v[16:19]
 rq a[212:215],v255 offset:24576
 mf v[32:35],a[128:131],a[168:171],v[32:35]
 s_mov_b32 s63,218112
 rt a[144:145],v232 offset:0
 mf v[32:35],a[132:135],a[184:187],v[32:35]
 bl v239,s[40:43],s63 offen offset:3072 lds
 mf v[48:51],a[132:135],a[188:191],v[48:51]
 rt a[146:147],v232 offset:2048
 mf v[48:51],a[128:131],a[172:175],v[48:51]
 s_waitcnt lgkmcnt(3)
 s_add_u32 m0,s62,4096
 rq a[228:231],v255 offset:28672
 mf v[52:55],a[136:139],a[172:175],v[52:55]
 s_mov_b32 s63,229376
 rt a[148:149],v232 offset:4096
 mf v[52:55],a[140:143],a[188:191],v[52:55]
 bl v239,s[40:43],s63 offen offset:0 lds
 mf v[36:39],a[140:143],a[184:187],v[36:39]
 rt a[150:151],v232 offset:6144
 mf v[36:39],a[136:139],a[168:171],v[36:39]
 mf v[20:23],a[136:139],a[164:167],v[20:23]
 s_mov_b32 s63,236544
 rt a[152:153],v233 offset:0
 mf v[20:23],a[140:143],a[180:183],v[20:23]
 bl v239,s[40:43],s63 offen offset:1024 lds
 mf v[4:7],a[140:143],a[176:179],v[4:7]
 rt a[154:155],v233 offset:2048
 mf v[4:7],a[136:139],a[160:163],v[4:7]
 s_waitcnt lgkmcnt(2)
 rq a[216:219],v255 offset:25600
 mf v[8:11],a[144:147],a[160:163],v[8:11]
 s_mov_b32 s63,243712
 rt a[156:157],v233 offset:4096
 mf v[8:11],a[148:151],a[176:179],v[8:11]
 bl v239,s[40:43],s63 offen offset:2048 lds
 mf v[24:27],a[148:151],a[180:183],v[24:27]
 rt a[158:159],v233 offset:6144
 mf v[24:27],a[144:147],a[164:167],v[24:27]
 mf v[40:43],a[144:147],a[168:171],v[40:43]
 s_mov_b32 s63,250880
 s_waitcnt vmcnt(7)
 rt a[128:129],v226 offset:32768
 mf v[40:43],a[148:151],a[184:187],v[40:43]
 bl v239,s[40:43],s63 offen offset:3072 lds
 mf v[56:59],a[148:151],a[188:191],v[56:59]
 rt a[130:131],v226 offset:34816
 mf v[56:59],a[144:147],a[172:175],v[56:59]
 s_waitcnt lgkmcnt(2)
 s_add_u32 m0,s62,65536
 rq a[232:235],v255 offset:29696
 mf v[60:63],a[152:155],a[172:175],v[60:63]
 s_mov_b32 s63,196736
 rt a[132:133],v226 offset:36864
 mf v[60:63],a[156:159],a[188:191],v[60:63]
 bl v239,s[40:43],s63 offen offset:0 lds
 mf v[44:47],a[156:159],a[184:187],v[44:47]
 rt a[134:135],v226 offset:38912
 mf v[44:47],a[152:155],a[168:171],v[44:47]
 mf v[28:31],a[152:155],a[164:167],v[28:31]
 s_mov_b32 s63,203904
 rt a[136:137],v227 offset:32768
 mf v[28:31],a[156:159],a[180:183],v[28:31]
 bl v239,s[40:43],s63 offen offset:1024 lds
 mf v[12:15],a[156:159],a[176:179],v[12:15]
 rt a[138:139],v227 offset:34816
 mf v[12:15],a[152:155],a[160:163],v[12:15]
 s_waitcnt lgkmcnt(2)
 rq a[220:223],v255 offset:26624
 mf v[64:67],a[128:131],a[160:163],v[64:67]
 s_mov_b32 s63,211072
 rt a[140:141],v227 offset:36864
 mf v[64:67],a[132:135],a[176:179],v[64:67]
 bl v239,s[40:43],s63 offen offset:2048 lds
 mf v[80:83],a[132:135],a[180:183],v[80:83]
 rt a[142:143],v227 offset:38912
 mf v[80:83],a[128:131],a[164:167],v[80:83]
 rq a[236:239],v255 offset:30720
 mf v[96:99],a[128:131],a[168:171],v[96:99]
 s_mov_b32 s63,218240
 rt a[144:145],v228 offset:32768
 mf v[96:99],a[132:135],a[184:187],v[96:99]
 bl v239,s[40:43],s63 offen offset:3072 lds
 mf v[112:115],a[132:135],a[188:191],v[112:115]
 rt a[146:147],v228 offset:34816
 mf v[112:115],a[128:131],a[172:175],v[112:115]
 s_waitcnt lgkmcnt(3)
 s_add_u32 m0,s62,69632
 mf v[116:119],a[136:139],a[172:175],v[116:119]
 s_mov_b32 s63,229504
 rt a[148:149],v228 offset:36864
 mf v[116:119],a[140:143],a[188:191],v[116:119]
 bl v239,s[40:43],s63 offen offset:0 lds
 mf v[100:103],a[140:143],a[184:187],v[100:103]
 rt a[150:151],v228 offset:38912
 mf v[100:103],a[136:139],a[168:171],v[100:103]
 rq a[224:227],v255 offset:27648
 mf v[84:87],a[136:139],a[164:167],v[84:87]
 s_mov_b32 s63,236672
 rt a[152:153],v229 offset:32768
 mf v[84:87],a[140:143],a[180:183],v[84:87]
 bl v239,s[40:43],s63 offen offset:1024 lds
 mf v[68:71],a[140:143],a[176:179],v[68:71]
 rt a[154:155],v229 offset:34816
 mf v[68:71],a[136:139],a[160:163],v[68:71]
 s_waitcnt lgkmcnt(3)
 mf v[72:75],a[144:147],a[160:163],v[72:75]
 s_mov_b32 s63,243840
 rt a[156:157],v229 offset:36864
 mf v[72:75],a[148:151],a[176:179],v[72:75]
 bl v239,s[40:43],s63 offen offset:2048 lds
 mf v[88:91],a[148:151],a[180:183],v[88:91]
 rt a[158:159],v229 offset:38912
 mf v[88:91],a[144:147],a[164:167],v[88:91]
 rq a[240:243],v255 offset:31744
 mf v[104:107],a[144:147],a[168:171],v[104:107]
 s_mov_b32 s63,251008
 s_waitcnt vmcnt(7)
 rt a[128:129],v226 offset:0
 mf v[104:107],a[148:151],a[184:187],v[104:107]
 bl v239,s[40:43],s63 offen offset:3072 lds
 mf v[120:123],a[148:151],a[188:191],v[120:123]
 rt a[130:131],v226 offset:2048
 mf v[120:123],a[144:147],a[172:175],v[120:123]
 s_waitcnt lgkmcnt(3)
 s_add_u32 m0,s61,32768
 mf v[124:127],a[152:155],a[172:175],v[124:127]
 s_mov_b32 s63,360448
 rt a[132:133],v226 offset:4096
 mf v[124:127],a[156:159],a[188:191],v[124:127]
 bl v220,s[8:11],s63 offen offset:0 lds
 mf v[108:111],a[156:159],a[184:187],v[108:111]
 rt a[134:135],v226 offset:6144
 mf v[108:111],a[152:155],a[168:171],v[108:111]
 mf v[92:95],a[152:155],a[164:167],v[92:95]
 rt a[136:137],v227 offset:0
 mf v[92:95],a[156:159],a[180:183],v[92:95]
 bl v221,s[8:11],s63 offen offset:1024 lds
 mf v[76:79],a[156:159],a[176:179],v[76:79]
 rt a[138:139],v227 offset:2048
 mf v[76:79],a[152:155],a[160:163],v[76:79]
 s_waitcnt lgkmcnt(2)
 mf v[0:3],a[128:131],a[212:215],v[0:3]
 rt a[140:141],v227 offset:4096
 mf v[0:3],a[132:135],a[228:231],v[0:3]
 bl v222,s[8:11],s63 offen offset:2048 lds
 mf v[16:19],a[132:135],a[232:235],v[16:19]
 rt a[142:143],v227 offset:6144
 mf v[16:19],a[128:131],a[216:219],v[16:19]
 mf v[32:35],a[128:131],a[220:223],v[32:35]
 rt a[144:145],v228 offset:0
 mf v[32:35],a[132:135],a[236:239],v[32:35]
 bl v223,s[8:11],s63 offen offset:3072 lds
 mf v[48:51],a[132:135],a[240:243],v[48:51]
 rt a[146:147],v228 offset:2048
 mf v[48:51],a[128:131],a[224:227],v[48:51]
 s_waitcnt lgkmcnt(2)
 s_add_u32 m0,s61,49152
 mf v[52:55],a[136:139],a[224:227],v[52:55]
 s_mov_b32 s63,376832
 rt a[148:149],v228 offset:4096
 mf v[52:55],a[140:143],a[240:243],v[52:55]
 bl v220,s[8:11],s63 offen offset:0 lds
 mf v[36:39],a[140:143],a[236:239],v[36:39]
 rt a[150:151],v228 offset:6144
 mf v[36:39],a[136:139],a[220:223],v[36:39]
 mf v[20:23],a[136:139],a[216:219],v[20:23]
 rt a[152:153],v229 offset:0
 mf v[20:23],a[140:143],a[232:235],v[20:23]
 bl v221,s[8:11],s63 offen offset:1024 lds
 mf v[4:7],a[140:143],a[228:231],v[4:7]
 rt a[154:155],v229 offset:2048
 mf v[4:7],a[136:139],a[212:215],v[4:7]
 s_waitcnt lgkmcnt(2)
 mf v[8:11],a[144:147],a[212:215],v[8:11]
 rt a[156:157],v229 offset:4096
 mf v[8:11],a[148:151],a[228:231],v[8:11]
 bl v222,s[8:11],s63 offen offset:2048 lds
 mf v[24:27],a[148:151],a[232:235],v[24:27]
 rt a[158:159],v229 offset:6144
 mf v[24:27],a[144:147],a[216:219],v[24:27]
 mf v[40:43],a[144:147],a[220:223],v[40:43]
 s_waitcnt vmcnt(7)
 rt a[128:129],v230 offset:0
 pk v0,v0,v1
 mf v[40:43],a[148:151],a[236:239],v[40:43]
 bl v223,s[8:11],s63 offen offset:3072 lds
 mf v[56:59],a[148:151],a[240:243],v[56:59]
 rt a[130:131],v230 offset:2048
 pk v1,v2,v3
 mf v[56:59],a[144:147],a[224:227],v[56:59]
 s_waitcnt lgkmcnt(2)
 pk v2,v4,v5
 pk v3,v6,v7
 mf v[60:63],a[152:155],a[224:227],v[60:63]
 rt a[132:133],v230 offset:4096
 v_accvgpr_write_b32 a160,v0
 mf v[60:63],a[156:159],a[240:243],v[60:63]
 v_accvgpr_write_b32 a161,v1
 v_accvgpr_write_b32 a162,v2
 mf v[44:47],a[156:159],a[236:239],v[44:47]
 rt a[134:135],v230 offset:6144
 v_accvgpr_write_b32 a163,v3
 mf v[44:47],a[152:155],a[220:223],v[44:47]
 pk v16,v16,v17
 pk v17,v18,v19
 mf v[28:31],a[152:155],a[216:219],v[28:31]
 rt a[136:137],v231 offset:0
 pk v18,v20,v21
 mf v[28:31],a[156:159],a[232:235],v[28:31]
 pk v19,v22,v23
 v_accvgpr_write_b32 a168,v16
 mf v[12:15],a[156:159],a[228:231],v[12:15]
 rt a[138:139],v231 offset:2048
 v_accvgpr_write_b32 a169,v17
 mf v[12:15],a[152:155],a[212:215],v[12:15]
 s_waitcnt lgkmcnt(2)
 v_accvgpr_write_b32 a170,v18
 v_accvgpr_write_b32 a171,v19
 mf v[64:67],a[128:131],a[212:215],v[64:67]
 rt a[140:141],v231 offset:4096
 pk v32,v32,v33
 mf v[64:67],a[132:135],a[228:231],v[64:67]
 pk v33,v34,v35
 pk v34,v36,v37
 mf v[80:83],a[132:135],a[232:235],v[80:83]
 rt a[142:143],v231 offset:6144
 pk v35,v38,v39
 mf v[80:83],a[128:131],a[216:219],v[80:83]
 v_accvgpr_write_b32 a176,v32
 v_accvgpr_write_b32 a177,v33
 mf v[96:99],a[128:131],a[220:223],v[96:99]
 rt a[144:145],v232 offset:0
 v_accvgpr_write_b32 a178,v34
 mf v[96:99],a[132:135],a[236:239],v[96:99]
 v_accvgpr_write_b32 a179,v35
 pk v48,v48,v49
 mf v[112:115],a[132:135],a[240:243],v[112:115]
 rt a[146:147],v232 offset:2048
 pk v49,v50,v51
 mf v[112:115],a[128:131],a[224:227],v[112:115]
 s_waitcnt lgkmcnt(2)
 pk v50,v52,v53
 pk v51,v54,v55
 mf v[116:119],a[136:139],a[224:227],v[116:119]
 rt a[148:149],v232 offset:4096
 v_accvgpr_write_b32 a184,v48
 mf v[116:119],a[140:143],a[240:243],v[116:119]
 v_accvgpr_write_b32 a185,v49
 v_accvgpr_write_b32 a186,v50
 mf v[100:103],a[140:143],a[236:239],v[100:103]
 rt a[150:151],v232 offset:6144
 v_accvgpr_write_b32 a187,v51
 mf v[100:103],a[136:139],a[220:223],v[100:103]
 pk v8,v8,v9
 pk v9,v10,v11
 mf v[84:87],a[136:139],a[216:219],v[84:87]
 rt a[152:153],v233 offset:0
 pk v10,v12,v13
 mf v[84:87],a[140:143],a[232:235],v[84:87]
 pk v11,v14,v15
 v_accvgpr_write_b32 a164,v8
 mf v[68:71],a[140:143],a[228:231],v[68:71]
 rt a[154:155],v233 offset:2048
 v_accvgpr_write_b32 a165,v9
 mf v[68:71],a[136:139],a[212:215],v[68:71]
 s_waitcnt lgkmcnt(2)
 v_accvgpr_write_b32 a166,v10
 v_accvgpr_write_b32 a167,v11
 mf v[72:75],a[144:147],a[212:215],v[72:75]
 rt a[156:157],v233 offset:4096
 pk v24,v24,v25
 mf v[72:75],a[148:151],a[228:231],v[72:75]
 pk v25,v26,v27
 pk v26,v28,v29
 mf v[88:91],a[148:151],a[232:235],v[88:91]
 rt a[158:159],v233 offset:6144
 pk v27,v30,v31
 mf v[88:91],a[144:147],a[216:219],v[88:91]
 v_accvgpr_write_b32 a172,v24
 v_accvgpr_write_b32 a173,v25
 mf v[104:107],a[144:147],a[220:223],v[104:107]
 v_accvgpr_write_b32 a174,v26
 v_accvgpr_write_b32 a175,v27
 mf v[104:107],a[148:151],a[236:239],v[104:107]
 pk v40,v40,v41
 pk v41,v42,v43
 mf v[120:123],a[148:151],a[240:243],v[120:123]
 pk v42,v44,v45
 pk v43,v46,v47
 mf v[120:123],a[144:147],a[224:227],v[120:123]
 s_waitcnt lgkmcnt(0)
 v_accvgpr_write_b32 a180,v40
 v_accvgpr_write_b32 a181,v41
 mf v[124:127],a[152:155],a[224:227],v[124:127]
 v_accvgpr_write_b32 a182,v42
 v_accvgpr_write_b32 a183,v43
 mf v[124:127],a[156:159],a[240:243],v[124:127]
 pk v56,v56,v57
 pk v57,v58,v59
 mf v[108:111],a[156:159],a[236:239],v[108:111]
 pk v58,v60,v61
 pk v59,v62,v63
 mf v[108:111],a[152:155],a[220:223],v[108:111]
 v_accvgpr_write_b32 a188,v56
 v_accvgpr_write_b32 a189,v57
 mf v[92:95],a[152:155],a[216:219],v[92:95]
 v_accvgpr_write_b32 a190,v58
 v_accvgpr_write_b32 a191,v59
 mf v[92:95],a[156:159],a[232:235],v[92:95]
 mf v[76:79],a[156:159],a[228:231],v[76:79]
 mf v[76:79],a[152:155],a[212:215],v[76:79]
 s_waitcnt vmcnt(0)
 s_barrier
 rq a[128:131],v208 offset:32768
 rq a[132:135],v209 offset:32768
 rq a[136:139],v210 offset:32768
 rq a[140:143],v211 offset:32768
 rq a[144:147],v208 offset:36864
 rq a[148:151],v209 offset:36864
 rq a[152:155],v210 offset:36864
 rq a[156:159],v211 offset:36864
L_join:
L_pad_join:
 s_cbranch_execz L_hop4
 pk v64,v64,v65
 pk v65,v66,v67
 pk v66,v68,v69
 pk v67,v70,v71
 v_accvgpr_write_b32 a212,v64
 v_accvgpr_write_b32 a213,v65
 v_accvgpr_write_b32 a214,v66
 v_accvgpr_write_b32 a215,v67
 pk v72,v72,v73
 pk v73,v74,v75
 pk v74,v76,v77
 pk v75,v78,v79
 v_accvgpr_write_b32 a216,v72
 v_accvgpr_write_b32 a217,v73
 v_accvgpr_write_b32 a218,v74
 v_accvgpr_write_b32 a219,v75
 s_waitcnt lgkmcnt(4)
 mf v[0:3],a[128:131],v[128:131],v[192:195]
 s_add_u32 m0,s61,98304
 pk v80,v80,v81
 pk v81,v82,v83
 mf v[0:3],a[132:135],v[132:135],v[0:3]
 s_mov_b32 s63,360448
 pk v82,v84,v85
 pk v83,v86,v87
 mf v[0:3],a[136:139],v[136:139],v[0:3]
 bl v224,s[12:15],s63 offen offset:0 lds
 mf v[0:3],a[140:143],v[140:143],v[0:3]
 v_accvgpr_write_b32 a220,v80
 v_accvgpr_write_b32 a221,v81
 mf v[16:19],a[140:143],v[156:159],v[196:199]
 v_accvgpr_write_b32 a222,v82
 v_accvgpr_write_b32 a223,v83
 mf v[16:19],a[136:139],v[152:155],v[16:19]
 pk v88,v88,v89
 pk v89,v90,v91
 mf v[16:19],a[132:135],v[148:151],v[16:19]
 bl v225,s[12:15],s63 offen offset:1024 lds
 mf v[16:19],a[128:131],v[144:147],v[16:19]
 pk v90,v92,v93
 pk v91,v94,v95
 mf v[32:35],a[128:131],v[160:163],v[200:203]
 v_accvgpr_write_b32 a224,v88
 v_accvgpr_write_b32 a225,v89
 mf v[32:35],a[132:135],v[164:167],v[32:35]
 v_accvgpr_write_b32 a226,v90
 v_accvgpr_write_b32 a227,v91
 mf v[32:35],a[136:139],v[168:171],v[32:35]
 bl v224,s[12:15],s63 offen offset:2048 lds
 mf v[32:35],a[140:143],v[172:175],v[32:35]
 pk v96,v96,v97
 pk v97,v98,v99
 mf v[48:51],a[140:143],v[188:191],v[204:207]
 pk v98,v100,v101
 pk v99,v102,v103
 mf v[48:51],a[136:139],v[184:187],v[48:51]
 v_accvgpr_write_b32 a228,v96
 v_accvgpr_write_b32 a229,v97
 mf v[48:51],a[132:135],v[180:183],v[48:51]
 bl v225,s[12:15],s63 offen offset:3072 lds
 mf v[48:51],a[128:131],v[176:179],v[48:51]
 s_waitcnt lgkmcnt(0)
 v_accvgpr_write_b32 a230,v98
 v_accvgpr_write_b32 a231,v99
 mf v[52:55],a[144:147],v[176:179],v[204:207]
 s_add_u32 m0,s61,0
 rq a[128:131],v208 offset:40960
 pk v104,v104,v105
 mf v[52:55],a[148:151],v[180:183],v[52:55]
 s_mov_b32 s63,393216
 rq a[132:135],v209 offset:40960
 pk v105,v106,v107
 mf v[52:55],a[152:155],v[184:187],v[52:55]
 rq a[136:139],v210 offset:40960
 bl v220,s[8:11],s63 offen offset:0 lds
 mf v[52:55],a[156:159],v[188:191],v[52:55]
 rq a[140:143],v211 offset:40960
 pk v106,v108,v109
 mf v[36:39],a[156:159],v[172:175],v[200:203]
 pk v107,v110,v111
 v_accvgpr_write_b32 a232,v104
 mf v[36:39],a[152:155],v[168:171],v[36:39]
 v_accvgpr_write_b32 a233,v105
 v_accvgpr_write_b32 a234,v106
 mf v[36:39],a[148:151],v[164:167],v[36:39]
L_pad_pg20:
 s_cbranch_execz L_hop4
 bl v221,s[8:11],s63 offen offset:1024 lds
 mf v[36:39],a[144:147],v[160:163],v[36:39]
 v_accvgpr_write_b32 a235,v107
 mf v[20:23],a[144:147],v[144:147],v[196:199]
 v_exp_f32 v0,v0
 mf v[20:23],a[148:151],v[148:151],v[20:23]
 v_exp_f32 v1,v1
 mf v[20:23],a[152:155],v[152:155],v[20:23]
 bl v222,s[8:11],s63 offen offset:2048 lds
 mf v[20:23],a[156:159],v[156:159],v[20:23]
 v_exp_f32 v2,v2
 mf v[4:7],a[156:159],v[140:143],v[192:195]
 v_exp_f32 v3,v3
 mf v[4:7],a[152:155],v[136:139],v[4:7]
 v_exp_f32 v16,v16
 mf v[4:7],a[148:151],v[132:135],v[4:7]
 bl v223,s[8:11],s63 offen offset:3072 lds
 mf v[4:7],a[144:147],v[128:131],v[4:7]
 s_waitcnt lgkmcnt(0)
 v_exp_f32 v17,v17
 mf v[8:11],a[128:131],v[128:131],v[192:195]
 rq a[144:147],v208 offset:45056
 mf v[8:11],a[132:135],v[132:135],v[8:11]
 rq a[148:151],v209 offset:45056
 mf v[8:11],a[136:139],v[136:139],v[8:11]
 rq a[152:155],v210 offset:45056
 mf v[8:11],a[140:143],v[140:143],v[8:11]
 rq a[156:159],v211 offset:45056
 mf v[24:27],a[140:143],v[156:159],v[196:199]
 v_exp_f32 v18,v18
 mf v[24:27],a[136:139],v[152:155],v[24:27]
 v_exp_f32 v19,v19
 mf v[24:27],a[132:135],v[148:151],v[24:27]
 v_exp_f32 v32,v32
 mf v[24:27],a[128:131],v[144:147],v[24:27]
 v_exp_f32 v33,v33
 mf v[40:43],a[128:131],v[160:163],v[200:203]
 v_exp_f32 v34,v34
 mf v[40:43],a[132:135],v[164:167],v[40:43]
 v_exp_f32 v35,v35
 mf v[40:43],a[136:139],v[168:171],v[40:43]
 v_exp_f32 v48,v48
 mf v[40:43],a[140:143],v[172:175],v[40:43]
 v_exp_f32 v49,v49
 mf v[56:59],a[140:143],v[188:191],v[204:207]
 v_exp_f32 v50,v50
 mf v[56:59],a[136:139],v[184:187],v[56:59]
 v_exp_f32 v51,v51
 mf v[56:59],a[132:135],v[180:183],v[56:59]
 pk v0,v0,v1
 pk v1,v2,v3
 mf v[56:59],a[128:131],v[176:179],v[56:59]
 s_waitcnt lgkmcnt(0)
 pk v16,v16,v17
 pk v17,v18,v19
 mf v[60:63],a[144:147],v[176:179],v[204:207]
 rq a[128:131],v208 offset:49152
 pk v32,v32,v33
 mf v[60:63],a[148:151],v[180:183],v[60:63]
 rq a[132:135],v209 offset:49152
 pk v33,v34,v35
 mf v[60:63],a[152:155],v[184:187],v[60:63]
 rq a[136:139],v210 offset:49152
 pk v48,v48,v49
 mf v[60:63],a[156:159],v[188:191],v[60:63]
 rq a[140:143],v211 offset:49152
 pk v49,v50,v51
 mf v[44:47],a[156:159],v[172:175],v[200:203]
 v_exp_f32 v4,v4
 mf v[44:47],a[152:155],v[168:171],v[44:47]
 v_exp_f32 v5,v5
 mf v[44:47],a[148:151],v[164:167],v[44:47]
 v_exp_f32 v6,v6
 mf v[44:47],a[144:147],v[160:163],v[44:47]
 v_exp_f32 v7,v7
 mf v[28:31],a[144:147],v[144:147],v[196:199]
 v_exp_f32 v20,v20
 mf v[28:31],a[148:151],v[148:151],v[28:31]
 v_exp_f32 v21,v21
 mf v[28:31],a[152:155],v[152:155],v[28:31]
 v_exp_f32 v22,v22
 mf v[28:31],a[156:159],v[156:159],v[28:31]
 v_exp_f32 v23,v23
 mf v[12:15],a[156:159],v[140:143],v[192:195]
 v_exp_f32 v36,v36
 mf v[12:15],a[152:155],v[136:139],v[12:15]
 v_exp_f32 v37,v37
 mf v[12:15],a[148:151],v[132:135],v[12:15]
 v_exp_f32 v38,v38
 mf v[12:15],a[144:147],v[128:131],v[12:15]
 v_exp_f32 v39,v39
 v_exp_f32 v52,v52
 v_exp_f32 v53,v53
 v_exp_f32 v54,v54
 v_exp_f32 v55,v55
 pk v2,v4,v5
 pk v3,v6,v7
 pk v18,v20,v21
 pk v19,v22,v23
 pk v34,v36,v37
 pk v35,v38,v39
 pk v50,v52,v53
 pk v51,v54,v55
 pk v112,v112,v113
 pk v113,v114,v115
 pk v114,v116,v117
 pk v115,v118,v119
 v_accvgpr_write_b32 a236,v112
 v_accvgpr_write_b32 a237,v113
 v_accvgpr_write_b32 a238,v114
 v_accvgpr_write_b32 a239,v115
 pk v120,v120,v121
 pk v121,v122,v123
 pk v122,v124,v125
 pk v123,v126,v127
 v_accvgpr_write_b32 a240,v120
 v_accvgpr_write_b32 a241,v121
 v_accvgpr_write_b32 a242,v122
 v_accvgpr_write_b32 a243,v123
 s_waitcnt vmcnt(0) lgkmcnt(0)
 s_barrier
 mf v[64:67],a[128:131],v[128:131],v[192:195]
 v_exp_f32 v8,v8
 mf v[64:67],a[132:135],v[132:135],v[64:67]
 s_add_u32 m0,s61,114688
 v_exp_f32 v9,v9
 mf v[64:67],a[136:139],v[136:139],v[64:67]
 s_mov_b32 s63,376832
 rq a[144:147],v208 offset:53248
 mf v[64:67],a[140:143],v[140:143],v[64:67]
 bl v224,s[12:15],s63 offen offset:0 lds
 mf v[80:83],a[140:143],v[156:159],v[196:199]
 rq a[148:151],v209 offset:53248
 pk v4,v8,v9
 mf v[80:83],a[136:139],v[152:155],v[80:83]
 v_exp_f32 v10,v10
 mf v[80:83],a[132:135],v[148:151],v[80:83]
 rq a[152:155],v210 offset:53248
 mf v[80:83],a[128:131],v[144:147],v[80:83]
 v_exp_f32 v11,v11
 mf v[96:99],a[128:131],v[160:163],v[200:203]
 rq a[156:159],v211 offset:53248
 pk v5,v10,v11
 mf v[96:99],a[132:135],v[164:167],v[96:99]
 v_exp_f32 v12,v12
 mf v[96:99],a[136:139],v[168:171],v[96:99]
 v_exp_f32 v13,v13
 mf v[96:99],a[140:143],v[172:175],v[96:99]
 bl v225,s[12:15],s63 offen offset:1024 lds
 pk v6,v12,v13
 mf v[112:115],a[140:143],v[188:191],v[204:207]
 v_exp_f32 v14,v14
 mf v[112:115],a[136:139],v[184:187],v[112:115]
 bl v224,s[12:15],s63 offen offset:2048 lds
 mf v[112:115],a[132:135],v[180:183],v[112:115]
 v_exp_f32 v15,v15
 mf v[112:115],a[128:131],v[176:179],v[112:115]
 s_waitcnt lgkmcnt(0)
 bl v225,s[12:15],s63 offen offset:3072 lds
 pk v7,v14,v15
 mf v[116:119],a[144:147],v[176:179],v[204:207]
 v_exp_f32 v24,v24
 mf v[116:119],a[148:151],v[180:183],v[116:119]
 s_add_u32 m0,s61,16384
 v_exp_f32 v25,v25
 mf v[116:119],a[152:155],v[184:187],v[116:119]
 s_mov_b32 s63,409600
 rq a[128:131],v208 offset:57344
 mf v[116:119],a[156:159],v[188:191],v[116:119]
 bl v220,s[8:11],s63 offen offset:0 lds
 mf v[100:103],a[156:159],v[172:175],v[200:203]
 rq a[132:135],v209 offset:57344
 pk v20,v24,v25
 mf v[100:103],a[152:155],v[168:171],v[100:103]
 v_exp_f32 v26,v26
 mf v[100:103],a[148:151],v[164:167],v[100:103]
 rq a[136:139],v210 offset:57344
 mf v[100:103],a[144:147],v[160:163],v[100:103]
 v_exp_f32 v27,v27
 mf v[84:87],a[144:147],v[144:147],v[196:199]
 rq a[140:143],v211 offset:57344
 pk v21,v26,v27
 mf v[84:87],a[148:151],v[148:151],v[84:87]
 v_exp_f32 v28,v28
 mf v[84:87],a[152:155],v[152:155],v[84:87]
 v_exp_f32 v29,v29
 mf v[84:87],a[156:159],v[156:159],v[84:87]
 bl v221,s[8:11],s63 offen offset:1024 lds
 pk v22,v28,v29
 mf v[68:71],a[156:159],v[140:143],v[192:195]
 v_exp_f32 v30,v30
 mf v[68:71],a[152:155],v[136:139],v[68:71]
 mf v[68:71],a[148:151],v[132:135],v[68:71]
 v_exp_f32 v31,v31
 mf v[68:71],a[144:147],v[128:131],v[68:71]
 s_waitcnt lgkmcnt(0)
 bl v222,s[8:11],s63 offen offset:2048 lds
 pk v23,v30,v31
 mf v[72:75],a[128:131],v[128:131],v[192:195]
 v_exp_f32 v40,v40
 mf v[72:75],a[132:135],v[132:135],v[72:75]
 v_exp_f32 v41,v41
 mf v[72:75],a[136:139],v[136:139],v[72:75]
 rq a[144:147],v208 offset:61440
 mf v[72:75],a[140:143],v[140:143],v[72:75]
 bl v223,s[8:11],s63 offen offset:3072 lds
 mf v[88:91],a[140:143],v[156:159],v[196:199]
 rq a[148:151],v209 offset:61440
 pk v36,v40,v41
 mf v[88:91],a[136:139],v[152:155],v[88:91]
 v_exp_f32 v42,v42
 mf v[88:91],a[132:135],v[148:151],v[88:91]
 rq a[152:155],v210 offset:61440
 mf v[88:91],a[128:131],v[144:147],v[88:91]
 v_exp_f32 v43,v43
 mf v[104:107],a[128:131],v[160:163],v[200:203]
 rq a[156:159],v211 offset:61440
 pk v37,v42,v43
 mf v[104:107],a[132:135],v[164:167],v[104:107]
 s_add_u32 m0,s61,32768
 v_exp_f32 v44,v44
 mf v[104:107],a[136:139],v[168:171],v[104:107]
 s_mov_b32 s63,425984
 v_exp_f32 v45,v45
 mf v[104:107],a[140:143],v[172:175],v[104:107]
 bl v220,s[8:11],s63 offen offset:0 lds
 pk v38,v44,v45
 mf v[120:123],a[140:143],v[188:191],v[204:207]
 v_exp_f32 v46,v46
 mf v[120:123],a[136:139],v[184:187],v[120:123]
 bl v221,s[8:11],s63 offen offset:1024 lds
 mf v[120:123],a[132:135],v[180:183],v[120:123]
 v_exp_f32 v47,v47
 mf v[120:123],a[128:131],v[176:179],v[120:123]
 s_waitcnt lgkmcnt(0)
 rt a[130:131],v212 offset:36864
 pk v39,v46,v47
 mf v[124:127],a[144:147],v[176:179],v[204:207]
 v_exp_f32 v56,v56
 mf v[124:127],a[148:151],v[180:183],v[124:127]
 v_exp_f32 v57,v57
 mf v[124:127],a[152:155],v[184:187],v[124:127]
 rt a[128:129],v212 offset:32768
 rt a[132:133],v212 offset:40960
 mf v[124:127],a[156:159],v[188:191],v[124:127]
 bl v222,s[8:11],s63 offen offset:2048 lds
 mf v[108:111],a[156:159],v[172:175],v[200:203]
 rt a[134:135],v212 offset:45056
 pk v52,v56,v57
 mf v[108:111],a[152:155],v[168:171],v[108:111]
 v_exp_f32 v58,v58
 mf v[108:111],a[148:151],v[164:167],v[108:111]
 rt a[136:137],v213 offset:32768
 mf v[108:111],a[144:147],v[160:163],v[108:111]
 v_exp_f32 v59,v59
 mf v[92:95],a[144:147],v[144:147],v[196:199]
 rt a[138:139],v213 offset:36864
 pk v53,v58,v59
 mf v[92:95],a[148:151],v[148:151],v[92:95]
 v_exp_f32 v60,v60
 mf v[92:95],a[152:155],v[152:155],v[92:95]
 v_exp_f32 v61,v61
 mf v[92:95],a[156:159],v[156:159],v[92:95]
 rt a[140:141],v213 offset:40960
 pk v54,v60,v61
 mf v[76:79],a[156:159],v[140:143],v[192:195]
 s_add_u32 s64,s68,20971520
 v_exp_f32 v62,v62
 mf v[76:79],a[152:155],v[136:139],v[76:79]
 rt a[142:143],v213 offset:45056
 buffer_store_dwordx4 a[160:163],v255,s[16:19],s64 offen offset:0 sc1
 mf v[76:79],a[148:151],v[132:135],v[76:79]
 v_exp_f32 v63,v63
 mf v[76:79],a[144:147],v[128:131],v[76:79]
 s_waitcnt lgkmcnt(4)
 rt a[148:149],v214 offset:40960
 pk v55,v62,v63
 mf a[0:3],v[0:3],a[128:131],a[0:3]
 v_exp_f32 v64,v64
 mf a[0:3],v[4:7],a[132:135],a[0:3]
 v_exp_f32 v65,v65
 mf a[4:7],v[20:23],a[132:135],a[4:7]
 rt a[150:151],v214 offset:45056
 pk v64,v64,v65
 mf a[4:7],v[16:19],a[128:131],a[4:7]
 v_exp_f32 v66,v66
 mf a[8:11],v[32:35],a[128:131],a[8:11]
 rt a[146:147],v214 offset:36864
 rt a[152:153],v215 offset:32768
 mf a[8:11],v[36:39],a[132:135],a[8:11]
 v_exp_f32 v67,v67
 mf a[12:15],v[52:55],a[132:135],a[12:15]
 rt a[154:155],v215 offset:36864
 pk v65,v66,v67
 mf a[12:15],v[48:51],a[128:131],a[12:15]
 s_waitcnt lgkmcnt(5)
 v_exp_f32 v68,v68
 mf a[28:31],v[48:51],a[136:139],a[28:31]
 v_exp_f32 v69,v69
 mf a[28:31],v[52:55],a[140:143],a[28:31]
 rt a[156:157],v215 offset:40960
 pk v66,v68,v69
 mf a[24:27],v[36:39],a[140:143],a[24:27]
 rt a[144:145],v214 offset:32768
 rt a[158:159],v215 offset:45056
 mf a[24:27],v[32:35],a[136:139],a[24:27]
 bl v223,s[8:11],s63 offen offset:3072 lds
 mf a[20:23],v[16:19],a[136:139],a[20:23]
 v_exp_f32 v70,v70
 mf a[20:23],v[20:23],a[140:143],a[20:23]
 rt a[128:129],v216 offset:32768
 mf a[16:19],v[4:7],a[140:143],a[16:19]
 v_exp_f32 v71,v71
 mf a[16:19],v[0:3],a[136:139],a[16:19]
 s_waitcnt lgkmcnt(2)
 rt a[130:131],v216 offset:36864
 pk v67,v70,v71
 mf a[32:35],v[0:3],a[144:147],a[32:35]
 v_exp_f32 v80,v80
 mf a[32:35],v[4:7],a[148:151],a[32:35]
 rt a[132:133],v216 offset:40960
 mf a[36:39],v[20:23],a[148:151],a[36:39]
 s_add_u32 s64,s68,20975616
 v_exp_f32 v81,v81
 mf a[36:39],v[16:19],a[144:147],a[36:39]
 v_exp_f32 v82,v82
 mf a[40:43],v[32:35],a[144:147],a[40:43]
 rt a[134:135],v216 offset:45056
 pk v80,v80,v81
 mf a[40:43],v[36:39],a[148:151],a[40:43]
 v_exp_f32 v83,v83
 mf a[44:47],v[52:55],a[148:151],a[44:47]
 rt a[136:137],v217 offset:32768
 pk v81,v82,v83
 mf a[44:47],v[48:51],a[144:147],a[44:47]
 s_waitcnt lgkmcnt(5)
 v_exp_f32 v84,v84
 mf a[60:63],v[48:51],a[152:155],a[60:63]
 rt a[138:139],v217 offset:36864
 buffer_store_dwordx4 a[164:167],v255,s[16:19],s64 offen offset:0 sc1
 mf a[60:63],v[52:55],a[156:159],a[60:63]
 s_add_u32 m0,s61,65536
 v_exp_f32 v85,v85
 mf a[56:59],v[36:39],a[156:159],a[56:59]
 s_mov_b32 s63,393216
 rt a[140:141],v217 offset:40960
 mf a[56:59],v[32:35],a[152:155],a[56:59]
 bl v224,s[12:15],s63 offen offset:0 lds
 mf a[52:55],v[16:19],a[152:155],a[52:55]
 v_exp_f32 v86,v86
 mf a[52:55],v[20:23],a[156:159],a[52:55]
 rt a[142:143],v217 offset:45056
 pk v82,v84,v85
 mf a[48:51],v[4:7],a[156:159],a[48:51]
 v_exp_f32 v87,v87
 mf a[48:51],v[0:3],a[152:155],a[48:51]
 s_waitcnt lgkmcnt(4)
 rt a[144:145],v218 offset:32768
 pk v83,v86,v87
 mf a[64:67],v[0:3],a[128:131],a[64:67]
 v_exp_f32 v96,v96
 mf a[64:67],v[4:7],a[132:135],a[64:67]
 rt a[146:147],v218 offset:36864
 mf a[68:71],v[20:23],a[132:135],a[68:71]
 v_exp_f32 v97,v97
 mf a[68:71],v[16:19],a[128:131],a[68:71]
 rt a[148:149],v218 offset:40960
 pk v96,v96,v97
 mf a[72:75],v[32:35],a[128:131],a[72:75]
 v_exp_f32 v98,v98
 mf a[72:75],v[36:39],a[132:135],a[72:75]
 v_exp_f32 v99,v99
 mf a[76:79],v[52:55],a[132:135],a[76:79]
 rt a[150:151],v218 offset:45056
 pk v97,v98,v99
 mf a[76:79],v[48:51],a[128:131],a[76:79]
 s_waitcnt lgkmcnt(4)
 v_exp_f32 v100,v100
 mf a[92:95],v[48:51],a[136:139],a[92:95]
 s_add_u32 s64,s68,20973568
 rt a[152:153],v219 offset:32768
 mf a[92:95],v[52:55],a[140:143],a[92:95]
 v_exp_f32 v101,v101
 mf a[88:91],v[36:39],a[140:143],a[88:91]
 rt a[154:155],v219 offset:36864
 mf a[88:91],v[32:35],a[136:139],a[88:91]
 bl v225,s[12:15],s63 offen offset:1024 lds
 mf a[84:87],v[16:19],a[136:139],a[84:87]
 rt a[156:157],v219 offset:40960
 pk v98,v100,v101
 mf a[84:87],v[20:23],a[140:143],a[84:87]
 v_exp_f32 v102,v102
 mf a[80:83],v[4:7],a[140:143],a[80:83]
 v_exp_f32 v103,v103
 mf a[80:83],v[0:3],a[136:139],a[80:83]
 s_waitcnt lgkmcnt(3)
 rt a[158:159],v219 offset:45056
 pk v99,v102,v103
 mf a[96:99],v[0:3],a[144:147],a[96:99]
 v_exp_f32 v112,v112
 mf a[96:99],v[4:7],a[148:151],a[96:99]
 bl v224,s[12:15],s63 offen offset:2048 lds
 mf a[100:103],v[20:23],a[148:151],a[100:103]
 v_exp_f32 v113,v113
 mf a[100:103],v[16:19],a[144:147],a[100:103]
 buffer_store_dwordx4 a[168:171],v255,s[16:19],s64 offen offset:0 sc1
 pk v112,v112,v113
 mf a[104:107],v[32:35],a[144:147],a[104:107]
 v_exp_f32 v114,v114
 mf a[104:107],v[36:39],a[148:151],a[104:107]
 rq a[128:131],v208 offset:0
 mf a[108:111],v[52:55],a[148:151],a[108:111]
 v_exp_f32 v115,v115
 mf a[108:111],v[48:51],a[144:147],a[108:111]
 s_waitcnt lgkmcnt(1)
 v_exp_f32 v116,v116
 mf a[124:127],v[48:51],a[152:155],a[124:127]
 rq a[132:135],v209 offset:0
 pk v113,v114,v115
 mf a[124:127],v[52:55],a[156:159],a[124:127]
 v_exp_f32 v117,v117
 mf a[120:123],v[36:39],a[156:159],a[120:123]
 rq a[136:139],v210 offset:0
 mf a[120:123],v[32:35],a[152:155],a[120:123]
 bl v225,s[12:15],s63 offen offset:3072 lds
 mf a[116:119],v[16:19],a[152:155],a[116:119]
 rq a[140:143],v211 offset:0
 pk v114,v116,v117
 mf a[116:119],v[20:23],a[156:159],a[116:119]
 v_exp_f32 v118,v118
 mf a[112:115],v[4:7],a[156:159],a[112:115]
 s_add_u32 s64,s68,20977664
 mf a[112:115],v[0:3],a[152:155],a[112:115]
 v_exp_f32 v119,v119
 v_smfmac_f32_16x16x64_bf16 a[192:195],a[208:211],v[0:7],v250
 pk v115,v118,v119
 v_smfmac_f32_16x16x64_bf16 a[196:199],a[208:211],v[16:23],v250
 s_waitcnt vmcnt(11)
 buffer_store_dwordx4 a[172:175],v255,s[16:19],s64 offen offset:0 sc1
 v_smfmac_f32_16x16x64_bf16 a[200:203],a[208:211],v[32:39],v250
 s_barrier
 v_smfmac_f32_16x16x64_bf16 a[204:207],a[208:211],v[48:55],v250
 s_waitcnt lgkmcnt(0)
 mf v[0:3],a[128:131],v[128:131],v[192:195]
 v_exp_f32 v72,v72
 mf v[0:3],a[132:135],v[132:135],v[0:3]
 s_add_u32 m0,s61,49152
 v_exp_f32 v73,v73
 mf v[0:3],a[136:139],v[136:139],v[0:3]
 s_mov_b32 s63,442368
 rq a[144:147],v208 offset:4096
 mf v[0:3],a[140:143],v[140:143],v[0:3]
 bl v220,s[8:11],s63 offen offset:0 lds
 mf v[16:19],a[140:143],v[156:159],v[196:199]
 rq a[148:151],v209 offset:4096
 pk v68,v72,v73
 mf v[16:19],a[136:139],v[152:155],v[16:19]
 v_exp_f32 v74,v74
 mf v[16:19],a[132:135],v[148:151],v[16:19]
 rq a[152:155],v210 offset:4096
 mf v[16:19],a[128:131],v[144:147],v[16:19]
 v_exp_f32 v75,v75
 mf v[32:35],a[128:131],v[160:163],v[200:203]
 rq a[156:159],v211 offset:4096
 pk v69,v74,v75
 mf v[32:35],a[132:135],v[164:167],v[32:35]
 v_exp_f32 v76,v76
 mf v[32:35],a[136:139],v[168:171],v[32:35]
 v_exp_f32 v77,v77
 mf v[32:35],a[140:143],v[172:175],v[32:35]
 bl v221,s[8:11],s63 offen offset:1024 lds
 pk v70,v76,v77
 mf v[48:51],a[140:143],v[188:191],v[204:207]
 v_exp_f32 v78,v78
 mf v[48:51],a[136:139],v[184:187],v[48:51]
 mf v[48:51],a[132:135],v[180:183],v[48:51]
 v_exp_f32 v79,v79
 mf v[48:51],a[128:131],v[176:179],v[48:51]
 s_waitcnt lgkmcnt(0)
 bl v222,s[8:11],s63 offen offset:2048 lds
 pk v71,v78,v79
 mf v[52:55],a[144:147],v[176:179],v[204:207]
 s_add_u32 s64,s68,21037056
 v_exp_f32 v88,v88
 mf v[52:55],a[148:151],v[180:183],v[52:55]
 v_exp_f32 v89,v89
 mf v[52:55],a[152:155],v[184:187],v[52:55]
 rq a[128:131],v208 offset:8192
 mf v[52:55],a[156:159],v[188:191],v[52:55]
 bl v223,s[8:11],s63 offen offset:3072 lds
 mf v[36:39],a[156:159],v[172:175],v[200:203]
 rq a[132:135],v209 offset:8192
 pk v84,v88,v89
 mf v[36:39],a[152:155],v[168:171],v[36:39]
 v_exp_f32 v90,v90
 mf v[36:39],a[148:151],v[164:167],v[36:39]
 rq a[136:139],v210 offset:8192
 buffer_store_dwordx4 a[176:179],v255,s[16:19],s64 offen offset:0 sc1
 mf v[36:39],a[144:147],v[160:163],v[36:39]
 v_exp_f32 v91,v91
 mf v[20:23],a[144:147],v[144:147],v[196:199]
 rq a[140:143],v211 offset:8192
 pk v85,v90,v91
 mf v[20:23],a[148:151],v[148:151],v[20:23]
 v_exp_f32 v92,v92
 mf v[20:23],a[152:155],v[152:155],v[20:23]
 v_exp_f32 v93,v93
 mf v[20:23],a[156:159],v[156:159],v[20:23]
 pk v86,v92,v93
 mf v[4:7],a[156:159],v[140:143],v[192:195]
 v_exp_f32 v94,v94
 mf v[4:7],a[152:155],v[136:139],v[4:7]
 s_add_u32 m0,s61,81920
 mf v[4:7],a[148:151],v[132:135],v[4:7]
 s_mov_b32 s63,409600
 v_exp_f32 v95,v95
 mf v[4:7],a[144:147],v[128:131],v[4:7]
 s_waitcnt lgkmcnt(0)
 bl v224,s[12:15],s63 offen offset:0 lds
 pk v87,v94,v95
 mf v[8:11],a[128:131],v[128:131],v[192:195]
 v_exp_f32 v104,v104
 mf v[8:11],a[132:135],v[132:135],v[8:11]
 v_exp_f32 v105,v105
 mf v[8:11],a[136:139],v[136:139],v[8:11]
 rq a[144:147],v208 offset:12288
 mf v[8:11],a[140:143],v[140:143],v[8:11]
 bl v225,s[12:15],s63 offen offset:1024 lds
 mf v[24:27],a[140:143],v[156:159],v[196:199]
 rq a[148:151],v209 offset:12288
 pk v100,v104,v105
 mf v[24:27],a[136:139],v[152:155],v[24:27]
 v_exp_f32 v106,v106
 mf v[24:27],a[132:135],v[148:151],v[24:27]
 s_add_u32 s64,s68,21041152
 rq a[152:155],v210 offset:12288
 mf v[24:27],a[128:131],v[144:147],v[24:27]
 v_exp_f32 v107,v107
 mf v[40:43],a[128:131],v[160:163],v[200:203]
 rq a[156:159],v211 offset:12288
 pk v101,v106,v107
 mf v[40:43],a[132:135],v[164:167],v[40:43]
 v_exp_f32 v108,v108
 mf v[40:43],a[136:139],v[168:171],v[40:43]
 v_exp_f32 v109,v109
 mf v[40:43],a[140:143],v[172:175],v[40:43]
 buffer_store_dwordx4 a[180:183],v255,s[16:19],s64 offen offset:0 sc1
 pk v102,v108,v109
 mf v[56:59],a[140:143],v[188:191],v[204:207]
 v_exp_f32 v110,v110
 mf v[56:59],a[136:139],v[184:187],v[56:59]
 bl v224,s[12:15],s63 offen offset:2048 lds
 mf v[56:59],a[132:135],v[180:183],v[56:59]
 v_exp_f32 v111,v111
 mf v[56:59],a[128:131],v[176:179],v[56:59]
 s_waitcnt lgkmcnt(0)
 rt a[130:131],v212 offset:53248
 pk v103,v110,v111
 mf v[60:63],a[144:147],v[176:179],v[204:207]
 v_exp_f32 v120,v120
 mf v[60:63],a[148:151],v[180:183],v[60:63]
 v_exp_f32 v121,v121
 mf v[60:63],a[152:155],v[184:187],v[60:63]
 rt a[128:129],v212 offset:49152
 rt a[132:133],v212 offset:57344
 mf v[60:63],a[156:159],v[188:191],v[60:63]
 bl v225,s[12:15],s63 offen offset:3072 lds
 mf v[44:47],a[156:159],v[172:175],v[200:203]
 rt a[134:135],v212 offset:61440
 pk v116,v120,v121
 mf v[44:47],a[152:155],v[168:171],v[44:47]
 v_exp_f32 v122,v122
 mf v[44:47],a[148:151],v[164:167],v[44:47]
 rt a[136:137],v213 offset:49152
 mf v[44:47],a[144:147],v[160:163],v[44:47]
 v_exp_f32 v123,v123
 mf v[28:31],a[144:147],v[144:147],v[196:199]
 rt a[138:139],v213 offset:53248
 pk v117,v122,v123
 mf v[28:31],a[148:151],v[148:151],v[28:31]
 v_exp_f32 v124,v124
 mf v[28:31],a[152:155],v[152:155],v[28:31]
 v_exp_f32 v125,v125
 mf v[28:31],a[156:159],v[156:159],v[28:31]
L_pad_pg21:
 s_cbranch_execz L_hop4
 rt a[140:141],v213 offset:57344
 pk v118,v124,v125
 mf v[12:15],a[156:159],v[140:143],v[192:195]
 s_add_u32 s64,s68,21039104
 v_exp_f32 v126,v126
 mf v[12:15],a[152:155],v[136:139],v[12:15]
 rt a[142:143],v213 offset:61440
 buffer_store_dwordx4 a[184:187],v255,s[16:19],s64 offen offset:0 sc1
 mf v[12:15],a[148:151],v[132:135],v[12:15]
 v_exp_f32 v127,v127
 mf v[12:15],a[144:147],v[128:131],v[12:15]
 s_waitcnt lgkmcnt(4)
 rt a[148:149],v214 offset:57344
 pk v119,v126,v127
 mf a[0:3],v[64:67],a[128:131],a[0:3]
 v_exp_f32 v0,v0
 mf a[0:3],v[68:71],a[132:135],a[0:3]
 v_exp_f32 v1,v1
 mf a[4:7],v[84:87],a[132:135],a[4:7]
 rt a[150:151],v214 offset:61440
 pk v0,v0,v1
 mf a[4:7],v[80:83],a[128:131],a[4:7]
 v_exp_f32 v2,v2
 mf a[8:11],v[96:99],a[128:131],a[8:11]
 rt a[146:147],v214 offset:53248
 rt a[152:153],v215 offset:49152
 mf a[8:11],v[100:103],a[132:135],a[8:11]
 v_exp_f32 v3,v3
 mf a[12:15],v[116:119],a[132:135],a[12:15]
 rt a[154:155],v215 offset:53248
 pk v1,v2,v3
 mf a[12:15],v[112:115],a[128:131],a[12:15]
 s_waitcnt lgkmcnt(5)
 v_exp_f32 v4,v4
 mf a[28:31],v[112:115],a[136:139],a[28:31]
 v_exp_f32 v5,v5
 mf a[28:31],v[116:119],a[140:143],a[28:31]
 s_add_u32 m0,s61,98304
 rt a[156:157],v215 offset:57344
 pk v2,v4,v5
 mf a[24:27],v[100:103],a[140:143],a[24:27]
 s_mov_b32 s63,425984
 rt a[144:145],v214 offset:49152
 rt a[158:159],v215 offset:61440
 mf a[24:27],v[96:99],a[136:139],a[24:27]
 bl v224,s[12:15],s63 offen offset:0 lds
 mf a[20:23],v[80:83],a[136:139],a[20:23]
 v_exp_f32 v6,v6
 mf a[20:23],v[84:87],a[140:143],a[20:23]
 rt a[128:129],v216 offset:49152
 mf a[16:19],v[68:71],a[140:143],a[16:19]
 v_exp_f32 v7,v7
 mf a[16:19],v[64:67],a[136:139],a[16:19]
 s_waitcnt lgkmcnt(2)
 rt a[130:131],v216 offset:53248
 pk v3,v6,v7
 mf a[32:35],v[64:67],a[144:147],a[32:35]
 v_exp_f32 v16,v16
 mf a[32:35],v[68:71],a[148:151],a[32:35]
 rt a[132:133],v216 offset:57344
 mf a[36:39],v[84:87],a[148:151],a[36:39]
 s_add_u32 s64,s68,21043200
 v_exp_f32 v17,v17
 mf a[36:39],v[80:83],a[144:147],a[36:39]
 v_exp_f32 v18,v18
 mf a[40:43],v[96:99],a[144:147],a[40:43]
 rt a[134:135],v216 offset:61440
 pk v16,v16,v17
 mf a[40:43],v[100:103],a[148:151],a[40:43]
 v_exp_f32 v19,v19
 mf a[44:47],v[116:119],a[148:151],a[44:47]
 rt a[136:137],v217 offset:49152
 pk v17,v18,v19
 mf a[44:47],v[112:115],a[144:147],a[44:47]
 s_waitcnt lgkmcnt(5)
 v_exp_f32 v20,v20
 mf a[60:63],v[112:115],a[152:155],a[60:63]
 rt a[138:139],v217 offset:53248
 buffer_store_dwordx4 a[188:191],v255,s[16:19],s64 offen offset:0 sc1
 mf a[60:63],v[116:119],a[156:159],a[60:63]
 v_exp_f32 v21,v21
 mf a[56:59],v[100:103],a[156:159],a[56:59]
 rt a[140:141],v217 offset:57344
 mf a[56:59],v[96:99],a[152:155],a[56:59]
 bl v225,s[12:15],s63 offen offset:1024 lds
 mf a[52:55],v[80:83],a[152:155],a[52:55]
 v_exp_f32 v22,v22
 mf a[52:55],v[84:87],a[156:159],a[52:55]
 rt a[142:143],v217 offset:61440
 pk v18,v20,v21
 mf a[48:51],v[68:71],a[156:159],a[48:51]
 v_exp_f32 v23,v23
 mf a[48:51],v[64:67],a[152:155],a[48:51]
 s_waitcnt lgkmcnt(4)
 rt a[144:145],v218 offset:49152
 pk v19,v22,v23
 mf a[64:67],v[64:67],a[128:131],a[64:67]
 v_exp_f32 v32,v32
 mf a[64:67],v[68:71],a[132:135],a[64:67]
 rt a[146:147],v218 offset:53248
 mf a[68:71],v[84:87],a[132:135],a[68:71]
 v_exp_f32 v33,v33
 mf a[68:71],v[80:83],a[128:131],a[68:71]
 rt a[148:149],v218 offset:57344
 pk v32,v32,v33
 mf a[72:75],v[96:99],a[128:131],a[72:75]
 v_exp_f32 v34,v34
 mf a[72:75],v[100:103],a[132:135],a[72:75]
 v_exp_f32 v35,v35
 mf a[76:79],v[116:119],a[132:135],a[76:79]
 rt a[150:151],v218 offset:61440
 pk v33,v34,v35
 mf a[76:79],v[112:115],a[128:131],a[76:79]
 s_waitcnt lgkmcnt(4)
 v_exp_f32 v36,v36
 mf a[92:95],v[112:115],a[136:139],a[92:95]
 s_add_u32 s64,s68,20971520
 rt a[152:153],v219 offset:49152
 mf a[92:95],v[116:119],a[140:143],a[92:95]
 v_exp_f32 v37,v37
 mf a[88:91],v[100:103],a[140:143],a[88:91]
 rt a[154:155],v219 offset:53248
 mf a[88:91],v[96:99],a[136:139],a[88:91]
 bl v224,s[12:15],s63 offen offset:2048 lds
 mf a[84:87],v[80:83],a[136:139],a[84:87]
 rt a[156:157],v219 offset:57344
 pk v34,v36,v37
 mf a[84:87],v[84:87],a[140:143],a[84:87]
 v_exp_f32 v38,v38
 mf a[80:83],v[68:71],a[140:143],a[80:83]
 v_exp_f32 v39,v39
 mf a[80:83],v[64:67],a[136:139],a[80:83]
 s_waitcnt lgkmcnt(3)
 rt a[158:159],v219 offset:61440
 pk v35,v38,v39
 mf a[96:99],v[64:67],a[144:147],a[96:99]
 v_exp_f32 v48,v48
 mf a[96:99],v[68:71],a[148:151],a[96:99]
 buffer_store_dwordx4 a[212:215],v255,s[16:19],s64 offen offset:1024 sc1
 mf a[100:103],v[84:87],a[148:151],a[100:103]
 v_exp_f32 v49,v49
 mf a[100:103],v[80:83],a[144:147],a[100:103]
 pk v48,v48,v49
 mf a[104:107],v[96:99],a[144:147],a[104:107]
 v_exp_f32 v50,v50
 mf a[104:107],v[100:103],a[148:151],a[104:107]
 rq a[128:131],v208 offset:16384
 mf a[108:111],v[116:119],a[148:151],a[108:111]
 v_exp_f32 v51,v51
 mf a[108:111],v[112:115],a[144:147],a[108:111]
 s_waitcnt lgkmcnt(1)
 v_exp_f32 v52,v52
 mf a[124:127],v[112:115],a[152:155],a[124:127]
 rq a[132:135],v209 offset:16384
 pk v49,v50,v51
 mf a[124:127],v[116:119],a[156:159],a[124:127]
 v_exp_f32 v53,v53
 mf a[120:123],v[100:103],a[156:159],a[120:123]
 rq a[136:139],v210 offset:16384
 mf a[120:123],v[96:99],a[152:155],a[120:123]
 bl v225,s[12:15],s63 offen offset:3072 lds
 mf a[116:119],v[80:83],a[152:155],a[116:119]
 rq a[140:143],v211 offset:16384
 pk v50,v52,v53
 mf a[116:119],v[84:87],a[156:159],a[116:119]
 v_exp_f32 v54,v54
 mf a[112:115],v[68:71],a[156:159],a[112:115]
 s_add_u32 s64,s68,20975616
 mf a[112:115],v[64:67],a[152:155],a[112:115]
 v_exp_f32 v55,v55
 v_smfmac_f32_16x16x64_bf16 a[192:195],a[208:211],v[64:71],v250
 pk v51,v54,v55
 v_smfmac_f32_16x16x64_bf16 a[196:199],a[208:211],v[80:87],v250
 s_waitcnt vmcnt(18)
 buffer_store_dwordx4 a[216:219],v255,s[16:19],s64 offen offset:1024 sc1
 v_smfmac_f32_16x16x64_bf16 a[200:203],a[208:211],v[96:103],v250
 s_barrier
 v_smfmac_f32_16x16x64_bf16 a[204:207],a[208:211],v[112:119],v250
 s_waitcnt lgkmcnt(0)
 mf v[64:67],a[128:131],v[128:131],v[192:195]
 v_exp_f32 v8,v8
 mf v[64:67],a[132:135],v[132:135],v[64:67]
 s_add_u32 m0,s61,0
 v_exp_f32 v9,v9
 mf v[64:67],a[136:139],v[136:139],v[64:67]
 s_mov_b32 s63,458752
 rq a[144:147],v208 offset:20480
 mf v[64:67],a[140:143],v[140:143],v[64:67]
 bl v220,s[8:11],s63 offen offset:0 lds
 mf v[80:83],a[140:143],v[156:159],v[196:199]
 rq a[148:151],v209 offset:20480
 pk v4,v8,v9
 mf v[80:83],a[136:139],v[152:155],v[80:83]
 v_exp_f32 v10,v10
 mf v[80:83],a[132:135],v[148:151],v[80:83]
 rq a[152:155],v210 offset:20480
 mf v[80:83],a[128:131],v[144:147],v[80:83]
 v_exp_f32 v11,v11
 mf v[96:99],a[128:131],v[160:163],v[200:203]
 rq a[156:159],v211 offset:20480
 pk v5,v10,v11
 mf v[96:99],a[132:135],v[164:167],v[96:99]
 v_exp_f32 v12,v12
 mf v[96:99],a[136:139],v[168:171],v[96:99]
 v_exp_f32 v13,v13
 mf v[96:99],a[140:143],v[172:175],v[96:99]
 pk v6,v12,v13
 mf v[112:115],a[140:143],v[188:191],v[204:207]
 v_exp_f32 v14,v14
 mf v[112:115],a[136:139],v[184:187],v[112:115]
 mf v[112:115],a[132:135],v[180:183],v[112:115]
 v_exp_f32 v15,v15
 mf v[112:115],a[128:131],v[176:179],v[112:115]
 s_waitcnt lgkmcnt(0)
 pk v7,v14,v15
 mf v[116:119],a[144:147],v[176:179],v[204:207]
 s_add_u32 s64,s68,20973568
 v_exp_f32 v24,v24
 mf v[116:119],a[148:151],v[180:183],v[116:119]
 v_exp_f32 v25,v25
 mf v[116:119],a[152:155],v[184:187],v[116:119]
 rq a[128:131],v208 offset:24576
 mf v[116:119],a[156:159],v[188:191],v[116:119]
 bl v221,s[8:11],s63 offen offset:1024 lds
 mf v[100:103],a[156:159],v[172:175],v[200:203]
 rq a[132:135],v209 offset:24576
 pk v20,v24,v25
 mf v[100:103],a[152:155],v[168:171],v[100:103]
 v_exp_f32 v26,v26
 mf v[100:103],a[148:151],v[164:167],v[100:103]
 rq a[136:139],v210 offset:24576
 buffer_store_dwordx4 a[220:223],v255,s[16:19],s64 offen offset:1024 sc1
 mf v[100:103],a[144:147],v[160:163],v[100:103]
 v_exp_f32 v27,v27
 mf v[84:87],a[144:147],v[144:147],v[196:199]
 rq a[140:143],v211 offset:24576
 pk v21,v26,v27
 mf v[84:87],a[148:151],v[148:151],v[84:87]
 v_exp_f32 v28,v28
 mf v[84:87],a[152:155],v[152:155],v[84:87]
 v_exp_f32 v29,v29
 mf v[84:87],a[156:159],v[156:159],v[84:87]
 pk v22,v28,v29
 mf v[68:71],a[156:159],v[140:143],v[192:195]
 v_exp_f32 v30,v30
 mf v[68:71],a[152:155],v[136:139],v[68:71]
 mf v[68:71],a[148:151],v[132:135],v[68:71]
 v_exp_f32 v31,v31
 mf v[68:71],a[144:147],v[128:131],v[68:71]
 s_waitcnt lgkmcnt(0)
 pk v23,v30,v31
 mf v[72:75],a[128:131],v[128:131],v[192:195]
 v_exp_f32 v40,v40
 mf v[72:75],a[132:135],v[132:135],v[72:75]
 v_exp_f32 v41,v41
 mf v[72:75],a[136:139],v[136:139],v[72:75]
 rq a[144:147],v208 offset:28672
 mf v[72:75],a[140:143],v[140:143],v[72:75]
 bl v222,s[8:11],s63 offen offset:2048 lds
 mf v[88:91],a[140:143],v[156:159],v[196:199]
 rq a[148:151],v209 offset:28672
 pk v36,v40,v41
 mf v[88:91],a[136:139],v[152:155],v[88:91]
 v_exp_f32 v42,v42
 mf v[88:91],a[132:135],v[148:151],v[88:91]
 s_add_u32 s64,s68,20977664
 rq a[152:155],v210 offset:28672
 mf v[88:91],a[128:131],v[144:147],v[88:91]
 v_exp_f32 v43,v43
 mf v[104:107],a[128:131],v[160:163],v[200:203]
 rq a[156:159],v211 offset:28672
 pk v37,v42,v43
 mf v[104:107],a[132:135],v[164:167],v[104:107]
 v_exp_f32 v44,v44
 mf v[104:107],a[136:139],v[168:171],v[104:107]
 v_exp_f32 v45,v45
 mf v[104:107],a[140:143],v[172:175],v[104:107]
 buffer_store_dwordx4 a[224:227],v255,s[16:19],s64 offen offset:1024 sc1
 pk v38,v44,v45
 mf v[120:123],a[140:143],v[188:191],v[204:207]
 v_exp_f32 v46,v46
 mf v[120:123],a[136:139],v[184:187],v[120:123]
 mf v[120:123],a[132:135],v[180:183],v[120:123]
 v_exp_f32 v47,v47
 mf v[120:123],a[128:131],v[176:179],v[120:123]
 s_waitcnt lgkmcnt(0)
 rt a[130:131],v212 offset:4096
 pk v39,v46,v47
 mf v[124:127],a[144:147],v[176:179],v[204:207]
 v_exp_f32 v56,v56
 mf v[124:127],a[148:151],v[180:183],v[124:127]
 v_exp_f32 v57,v57
 mf v[124:127],a[152:155],v[184:187],v[124:127]
 rt a[128:129],v212 offset:0
 rt a[132:133],v212 offset:8192
 mf v[124:127],a[156:159],v[188:191],v[124:127]
 bl v223,s[8:11],s63 offen offset:3072 lds
 mf v[108:111],a[156:159],v[172:175],v[200:203]
 rt a[134:135],v212 offset:12288
 pk v52,v56,v57
 mf v[108:111],a[152:155],v[168:171],v[108:111]
 v_exp_f32 v58,v58
 mf v[108:111],a[148:151],v[164:167],v[108:111]
 rt a[136:137],v213 offset:0
 mf v[108:111],a[144:147],v[160:163],v[108:111]
 v_exp_f32 v59,v59
 mf v[92:95],a[144:147],v[144:147],v[196:199]
 rt a[138:139],v213 offset:4096
 pk v53,v58,v59
 mf v[92:95],a[148:151],v[148:151],v[92:95]
 v_exp_f32 v60,v60
 mf v[92:95],a[152:155],v[152:155],v[92:95]
 v_exp_f32 v61,v61
 mf v[92:95],a[156:159],v[156:159],v[92:95]
 rt a[140:141],v213 offset:8192
 pk v54,v60,v61
 mf v[76:79],a[156:159],v[140:143],v[192:195]
 s_add_u32 s64,s68,21037056
 v_exp_f32 v62,v62
 mf v[76:79],a[152:155],v[136:139],v[76:79]
 rt a[142:143],v213 offset:12288
 buffer_store_dwordx4 a[228:231],v255,s[16:19],s64 offen offset:1024 sc1
 mf v[76:79],a[148:151],v[132:135],v[76:79]
 v_exp_f32 v63,v63
 mf v[76:79],a[144:147],v[128:131],v[76:79]
 s_waitcnt lgkmcnt(4)
 rt a[148:149],v214 offset:8192
 pk v55,v62,v63
 mf a[0:3],v[0:3],a[128:131],a[0:3]
 v_exp_f32 v64,v64
 mf a[0:3],v[4:7],a[132:135],a[0:3]
 v_exp_f32 v65,v65
 mf a[4:7],v[20:23],a[132:135],a[4:7]
 rt a[150:151],v214 offset:12288
 pk v64,v64,v65
 mf a[4:7],v[16:19],a[128:131],a[4:7]
 v_exp_f32 v66,v66
 mf a[8:11],v[32:35],a[128:131],a[8:11]
 rt a[146:147],v214 offset:4096
 rt a[152:153],v215 offset:0
 mf a[8:11],v[36:39],a[132:135],a[8:11]
 v_exp_f32 v67,v67
 mf a[12:15],v[52:55],a[132:135],a[12:15]
 rt a[154:155],v215 offset:4096
 pk v65,v66,v67
 mf a[12:15],v[48:51],a[128:131],a[12:15]
 s_waitcnt lgkmcnt(5)
 v_exp_f32 v68,v68
 mf a[28:31],v[48:51],a[136:139],a[28:31]
 v_exp_f32 v69,v69
 mf a[28:31],v[52:55],a[140:143],a[28:31]
 s_add_u32 m0,s61,114688
 rt a[156:157],v215 offset:8192
 pk v66,v68,v69
 mf a[24:27],v[36:39],a[140:143],a[24:27]
 s_mov_b32 s63,442368
 rt a[144:145],v214 offset:0
 rt a[158:159],v215 offset:12288
 mf a[24:27],v[32:35],a[136:139],a[24:27]
 bl v224,s[12:15],s63 offen offset:0 lds
 mf a[20:23],v[16:19],a[136:139],a[20:23]
 v_exp_f32 v70,v70
 mf a[20:23],v[20:23],a[140:143],a[20:23]
 rt a[128:129],v216 offset:0
 mf a[16:19],v[4:7],a[140:143],a[16:19]
 v_exp_f32 v71,v71
 mf a[16:19],v[0:3],a[136:139],a[16:19]
 s_waitcnt lgkmcnt(2)
 rt a[130:131],v216 offset:4096
 pk v67,v70,v71
 mf a[32:35],v[0:3],a[144:147],a[32:35]
 v_exp_f32 v80,v80
 mf a[32:35],v[4:7],a[148:151],a[32:35]
 rt a[132:133],v216 offset:8192
 mf a[36:39],v[20:23],a[148:151],a[36:39]
 s_add_u32 s64,s68,21041152
 v_exp_f32 v81,v81
 mf a[36:39],v[16:19],a[144:147],a[36:39]
 v_exp_f32 v82,v82
 mf a[40:43],v[32:35],a[144:147],a[40:43]
 rt a[134:135],v216 offset:12288
 pk v80,v80,v81
 mf a[40:43],v[36:39],a[148:151],a[40:43]
 v_exp_f32 v83,v83
 mf a[44:47],v[52:55],a[148:151],a[44:47]
 rt a[136:137],v217 offset:0
 pk v81,v82,v83
 mf a[44:47],v[48:51],a[144:147],a[44:47]
 s_waitcnt lgkmcnt(5)
 v_exp_f32 v84,v84
 mf a[60:63],v[48:51],a[152:155],a[60:63]
 rt a[138:139],v217 offset:4096
 buffer_store_dwordx4 a[232:235],v255,s[16:19],s64 offen offset:1024 sc1
 mf a[60:63],v[52:55],a[156:159],a[60:63]
 v_exp_f32 v85,v85
 mf a[56:59],v[36:39],a[156:159],a[56:59]
 rt a[140:141],v217 offset:8192
 mf a[56:59],v[32:35],a[152:155],a[56:59]
 bl v225,s[12:15],s63 offen offset:1024 lds
 mf a[52:55],v[16:19],a[152:155],a[52:55]
 v_exp_f32 v86,v86
 mf a[52:55],v[20:23],a[156:159],a[52:55]
 rt a[142:143],v217 offset:12288
 pk v82,v84,v85
 mf a[48:51],v[4:7],a[156:159],a[48:51]
 v_exp_f32 v87,v87
 mf a[48:51],v[0:3],a[152:155],a[48:51]
 s_waitcnt lgkmcnt(4)
 rt a[144:145],v218 offset:0
 pk v83,v86,v87
 mf a[64:67],v[0:3],a[128:131],a[64:67]
 v_exp_f32 v96,v96
 mf a[64:67],v[4:7],a[132:135],a[64:67]
 rt a[146:147],v218 offset:4096
 mf a[68:71],v[20:23],a[132:135],a[68:71]
 v_exp_f32 v97,v97
 mf a[68:71],v[16:19],a[128:131],a[68:71]
 rt a[148:149],v218 offset:8192
 pk v96,v96,v97
 mf a[72:75],v[32:35],a[128:131],a[72:75]
 v_exp_f32 v98,v98
 mf a[72:75],v[36:39],a[132:135],a[72:75]
 v_exp_f32 v99,v99
 mf a[76:79],v[52:55],a[132:135],a[76:79]
 rt a[150:151],v218 offset:12288
 pk v97,v98,v99
 mf a[76:79],v[48:51],a[128:131],a[76:79]
 s_waitcnt lgkmcnt(4)
 v_exp_f32 v100,v100
 mf a[92:95],v[48:51],a[136:139],a[92:95]
 s_add_u32 s64,s68,21039104
 rt a[152:153],v219 offset:0
 mf a[92:95],v[52:55],a[140:143],a[92:95]
 v_exp_f32 v101,v101
 mf a[88:91],v[36:39],a[140:143],a[88:91]
 rt a[154:155],v219 offset:4096
 mf a[88:91],v[32:35],a[136:139],a[88:91]
 bl v224,s[12:15],s63 offen offset:2048 lds
 mf a[84:87],v[16:19],a[136:139],a[84:87]
 rt a[156:157],v219 offset:8192
 pk v98,v100,v101
 mf a[84:87],v[20:23],a[140:143],a[84:87]
 v_exp_f32 v102,v102
 mf a[80:83],v[4:7],a[140:143],a[80:83]
 v_exp_f32 v103,v103
 mf a[80:83],v[0:3],a[136:139],a[80:83]
 s_waitcnt lgkmcnt(3)
 rt a[158:159],v219 offset:12288
 pk v99,v102,v103
 mf a[96:99],v[0:3],a[144:147],a[96:99]
 v_exp_f32 v112,v112
 mf a[96:99],v[4:7],a[148:151],a[96:99]
 buffer_store_dwordx4 a[236:239],v255,s[16:19],s64 offen offset:1024 sc1
 mf a[100:103],v[20:23],a[148:151],a[100:103]
 v_exp_f32 v113,v113
 mf a[100:103],v[16:19],a[144:147],a[100:103]
 pk v112,v112,v113
 mf a[104:107],v[32:35],a[144:147],a[104:107]
 v_exp_f32 v114,v114
 mf a[104:107],v[36:39],a[148:151],a[104:107]
 rq a[128:131],v208 offset:32768
 mf a[108:111],v[52:55],a[148:151],a[108:111]
 v_exp_f32 v115,v115
 mf a[108:111],v[48:51],a[144:147],a[108:111]
 s_waitcnt lgkmcnt(1)
 v_exp_f32 v116,v116
 mf a[124:127],v[48:51],a[152:155],a[124:127]
 rq a[132:135],v209 offset:32768
 pk v113,v114,v115
 mf a[124:127],v[52:55],a[156:159],a[124:127]
 v_exp_f32 v117,v117
 mf a[120:123],v[36:39],a[156:159],a[120:123]
 rq a[136:139],v210 offset:32768
 mf a[120:123],v[32:35],a[152:155],a[120:123]
 bl v225,s[12:15],s63 offen offset:3072 lds
 mf a[116:119],v[16:19],a[152:155],a[116:119]
 rq a[140:143],v211 offset:32768
 pk v114,v116,v117
 mf a[116:119],v[20:23],a[156:159],a[116:119]
 v_exp_f32 v118,v118
 mf a[112:115],v[4:7],a[156:159],a[112:115]
 s_add_u32 s64,s68,21043200
 mf a[112:115],v[0:3],a[152:155],a[112:115]
 v_exp_f32 v119,v119
 v_smfmac_f32_16x16x64_bf16 a[192:195],a[208:211],v[0:7],v250
 s_mov_b64 exec,0
 s_cmp_eq_u32 s54,0
 s_cbranch_scc1 L_pad_pg22
 s_cmp_eq_u32 s54,1
 s_cbranch_scc1 L_pad_pg23
 s_cmp_eq_u32 s54,2
 s_cbranch_scc1 L_pad_pg24
 s_branch L_pad_pg25
L_hop6:
 s_mov_b64 exec,-1
 pk v115,v118,v119
 v_smfmac_f32_16x16x64_bf16 a[196:199],a[208:211],v[16:23],v250
 s_waitcnt vmcnt(21)
 buffer_store_dwordx4 a[240:243],v255,s[16:19],s64 offen offset:1024 sc1
 v_smfmac_f32_16x16x64_bf16 a[200:203],a[208:211],v[32:39],v250
 s_barrier
 v_lshrrev_b32 v234,7,v251
 v_smfmac_f32_16x16x64_bf16 a[204:207],a[208:211],v[48:55],v250
 s_waitcnt lgkmcnt(0)
 v_min_u32 v234,31,v234
 mf v[0:3],a[128:131],v[128:131],v[192:195]
 s_mul_i32 s55,s91,32
 v_exp_f32 v72,v72
 mf v[0:3],a[132:135],v[132:135],v[0:3]
 s_add_u32 m0,s61,16384
 v_exp_f32 v73,v73
 mf v[0:3],a[136:139],v[136:139],v[0:3]
 s_mov_b32 s63,475136
 rq a[144:147],v208 offset:36864
 mf v[0:3],a[140:143],v[140:143],v[0:3]
 bl v220,s[8:11],s63 offen offset:0 lds
 mf v[16:19],a[140:143],v[156:159],v[196:199]
 rq a[148:151],v209 offset:36864
 pk v68,v72,v73
 mf v[16:19],a[136:139],v[152:155],v[16:19]
 v_exp_f32 v74,v74
 mf v[16:19],a[132:135],v[148:151],v[16:19]
 rq a[152:155],v210 offset:36864
 v_add_u32 v234,s55,v234
 mf v[16:19],a[128:131],v[144:147],v[16:19]
 v_exp_f32 v75,v75
 mf v[32:35],a[128:131],v[160:163],v[200:203]
 rq a[156:159],v211 offset:36864
 pk v69,v74,v75
 mf v[32:35],a[132:135],v[164:167],v[32:35]
 v_exp_f32 v76,v76
 mf v[32:35],a[136:139],v[168:171],v[32:35]
 v_exp_f32 v77,v77
 mf v[32:35],a[140:143],v[172:175],v[32:35]
 pk v70,v76,v77
 v_mul_u32_u24 v234,128,v234
 mf v[48:51],a[140:143],v[188:191],v[204:207]
 s_lshl_b32 s55,s52,19
 v_exp_f32 v78,v78
 mf v[48:51],a[136:139],v[184:187],v[48:51]
 v_add_u32 v234,s55,v234
 mf v[48:51],a[132:135],v[180:183],v[48:51]
 v_exp_f32 v79,v79
 mf v[48:51],a[128:131],v[176:179],v[48:51]
 s_waitcnt lgkmcnt(0)
 buffer_load_dword a255,v234,s[24:27],0 offen
 pk v71,v78,v79
 mf v[52:55],a[144:147],v[176:179],v[204:207]
 v_exp_f32 v88,v88
 mf v[52:55],a[148:151],v[180:183],v[52:55]
 v_exp_f32 v89,v89
 mf v[52:55],a[152:155],v[184:187],v[52:55]
 rq a[128:131],v208 offset:40960
 mf v[52:55],a[156:159],v[188:191],v[52:55]
 bl v221,s[8:11],s63 offen offset:1024 lds
 mf v[36:39],a[156:159],v[172:175],v[200:203]
 rq a[132:135],v209 offset:40960
 pk v84,v88,v89
 mf v[36:39],a[152:155],v[168:171],v[36:39]
 v_exp_f32 v90,v90
 mf v[36:39],a[148:151],v[164:167],v[36:39]
 rq a[136:139],v210 offset:40960
 global_load_dword a255,v[248:249],off
 mf v[36:39],a[144:147],v[160:163],v[36:39]
 v_exp_f32 v91,v91
 mf v[20:23],a[144:147],v[144:147],v[196:199]
 rq a[140:143],v211 offset:40960
 pk v85,v90,v91
 mf v[20:23],a[148:151],v[148:151],v[20:23]
 v_exp_f32 v92,v92
 mf v[20:23],a[152:155],v[152:155],v[20:23]
 v_exp_f32 v93,v93
 mf v[20:23],a[156:159],v[156:159],v[20:23]
 pk v86,v92,v93
 mf v[4:7],a[156:159],v[140:143],v[192:195]
 v_exp_f32 v94,v94
 mf v[4:7],a[152:155],v[136:139],v[4:7]
 mf v[4:7],a[148:151],v[132:135],v[4:7]
 v_exp_f32 v95,v95
 mf v[4:7],a[144:147],v[128:131],v[4:7]
 s_waitcnt lgkmcnt(0)
 pk v87,v94,v95
 mf v[8:11],a[128:131],v[128:131],v[192:195]
 v_exp_f32 v104,v104
 mf v[8:11],a[132:135],v[132:135],v[8:11]
 v_exp_f32 v105,v105
 mf v[8:11],a[136:139],v[136:139],v[8:11]
 rq a[144:147],v208 offset:45056
 mf v[8:11],a[140:143],v[140:143],v[8:11]
 bl v222,s[8:11],s63 offen offset:2048 lds
 mf v[24:27],a[140:143],v[156:159],v[196:199]
 rq a[148:151],v209 offset:45056
 pk v100,v104,v105
 mf v[24:27],a[136:139],v[152:155],v[24:27]
L_pad_pg22:
 s_cbranch_execz L_hop6
 v_exp_f32 v106,v106
 mf v[24:27],a[132:135],v[148:151],v[24:27]
 rq a[152:155],v210 offset:45056
 mf v[24:27],a[128:131],v[144:147],v[24:27]
 v_exp_f32 v107,v107
 mf v[40:43],a[128:131],v[160:163],v[200:203]
 rq a[156:159],v211 offset:45056
 pk v101,v106,v107
 mf v[40:43],a[132:135],v[164:167],v[40:43]
 v_exp_f32 v108,v108
 mf v[40:43],a[136:139],v[168:171],v[40:43]
 v_exp_f32 v109,v109
 mf v[40:43],a[140:143],v[172:175],v[40:43]
 pk v102,v108,v109
 mf v[56:59],a[140:143],v[188:191],v[204:207]
 v_exp_f32 v110,v110
 mf v[56:59],a[136:139],v[184:187],v[56:59]
 mf v[56:59],a[132:135],v[180:183],v[56:59]
 v_exp_f32 v111,v111
 mf v[56:59],a[128:131],v[176:179],v[56:59]
 s_waitcnt lgkmcnt(0)
 rt a[130:131],v212 offset:20480
 pk v103,v110,v111
 mf v[60:63],a[144:147],v[176:179],v[204:207]
 v_exp_f32 v120,v120
 mf v[60:63],a[148:151],v[180:183],v[60:63]
 v_exp_f32 v121,v121
 mf v[60:63],a[152:155],v[184:187],v[60:63]
 rt a[128:129],v212 offset:16384
 rt a[132:133],v212 offset:24576
 mf v[60:63],a[156:159],v[188:191],v[60:63]
 bl v223,s[8:11],s63 offen offset:3072 lds
 mf v[44:47],a[156:159],v[172:175],v[200:203]
 rt a[134:135],v212 offset:28672
 pk v116,v120,v121
 mf v[44:47],a[152:155],v[168:171],v[44:47]
 v_exp_f32 v122,v122
 mf v[44:47],a[148:151],v[164:167],v[44:47]
 rt a[136:137],v213 offset:16384
 mf v[44:47],a[144:147],v[160:163],v[44:47]
 v_exp_f32 v123,v123
 mf v[28:31],a[144:147],v[144:147],v[196:199]
 rt a[138:139],v213 offset:20480
 pk v117,v122,v123
 mf v[28:31],a[148:151],v[148:151],v[28:31]
 v_exp_f32 v124,v124
 mf v[28:31],a[152:155],v[152:155],v[28:31]
 v_exp_f32 v125,v125
 mf v[28:31],a[156:159],v[156:159],v[28:31]
 rt a[140:141],v213 offset:24576
 pk v118,v124,v125
 mf v[12:15],a[156:159],v[140:143],v[192:195]
 v_exp_f32 v126,v126
 mf v[12:15],a[152:155],v[136:139],v[12:15]
 rt a[142:143],v213 offset:28672
 mf v[12:15],a[148:151],v[132:135],v[12:15]
 v_exp_f32 v127,v127
 mf v[12:15],a[144:147],v[128:131],v[12:15]
 s_waitcnt lgkmcnt(4)
 rt a[148:149],v214 offset:24576
 pk v119,v126,v127
 mf a[0:3],v[64:67],a[128:131],a[0:3]
 v_exp_f32 v0,v0
 mf a[0:3],v[68:71],a[132:135],a[0:3]
 v_exp_f32 v1,v1
 mf a[4:7],v[84:87],a[132:135],a[4:7]
 rt a[150:151],v214 offset:28672
 pk v0,v0,v1
 mf a[4:7],v[80:83],a[128:131],a[4:7]
 v_exp_f32 v2,v2
 mf a[8:11],v[96:99],a[128:131],a[8:11]
 rt a[146:147],v214 offset:20480
 rt a[152:153],v215 offset:16384
 mf a[8:11],v[100:103],a[132:135],a[8:11]
 v_exp_f32 v3,v3
 mf a[12:15],v[116:119],a[132:135],a[12:15]
 rt a[154:155],v215 offset:20480
 pk v1,v2,v3
 mf a[12:15],v[112:115],a[128:131],a[12:15]
 s_waitcnt lgkmcnt(5)
 v_exp_f32 v4,v4
 mf a[28:31],v[112:115],a[136:139],a[28:31]
 v_exp_f32 v5,v5
 mf a[28:31],v[116:119],a[140:143],a[28:31]
 s_add_u32 m0,s61,65536
 rt a[156:157],v215 offset:24576
 pk v2,v4,v5
 mf a[24:27],v[100:103],a[140:143],a[24:27]
 s_mov_b32 s63,458752
 rt a[144:145],v214 offset:16384
 rt a[158:159],v215 offset:28672
 mf a[24:27],v[96:99],a[136:139],a[24:27]
 bl v224,s[12:15],s63 offen offset:0 lds
 mf a[20:23],v[80:83],a[136:139],a[20:23]
 v_exp_f32 v6,v6
 mf a[20:23],v[84:87],a[140:143],a[20:23]
 rt a[128:129],v216 offset:16384
 mf a[16:19],v[68:71],a[140:143],a[16:19]
 v_exp_f32 v7,v7
 mf a[16:19],v[64:67],a[136:139],a[16:19]
 s_waitcnt lgkmcnt(2)
 rt a[130:131],v216 offset:20480
 pk v3,v6,v7
 mf a[32:35],v[64:67],a[144:147],a[32:35]
 v_exp_f32 v16,v16
 mf a[32:35],v[68:71],a[148:151],a[32:35]
 rt a[132:133],v216 offset:24576
 mf a[36:39],v[84:87],a[148:151],a[36:39]
 v_exp_f32 v17,v17
 mf a[36:39],v[80:83],a[144:147],a[36:39]
 v_exp_f32 v18,v18
 mf a[40:43],v[96:99],a[144:147],a[40:43]
 rt a[134:135],v216 offset:28672
 pk v16,v16,v17
 mf a[40:43],v[100:103],a[148:151],a[40:43]
 v_exp_f32 v19,v19
 mf a[44:47],v[116:119],a[148:151],a[44:47]
 rt a[136:137],v217 offset:16384
 pk v17,v18,v19
 mf a[44:47],v[112:115],a[144:147],a[44:47]
 s_waitcnt lgkmcnt(5)
 v_exp_f32 v20,v20
 mf a[60:63],v[112:115],a[152:155],a[60:63]
 rt a[138:139],v217 offset:20480
 mf a[60:63],v[116:119],a[156:159],a[60:63]
 v_exp_f32 v21,v21
 mf a[56:59],v[100:103],a[156:159],a[56:59]
 rt a[140:141],v217 offset:24576
 mf a[56:59],v[96:99],a[152:155],a[56:59]
 bl v225,s[12:15],s63 offen offset:1024 lds
 mf a[52:55],v[80:83],a[152:155],a[52:55]
 v_exp_f32 v22,v22
 mf a[52:55],v[84:87],a[156:159],a[52:55]
 rt a[142:143],v217 offset:28672
 pk v18,v20,v21
 mf a[48:51],v[68:71],a[156:159],a[48:51]
 v_exp_f32 v23,v23
 mf a[48:51],v[64:67],a[152:155],a[48:51]
 s_waitcnt lgkmcnt(4)
 rt a[144:145],v218 offset:16384
 pk v19,v22,v23
 mf a[64:67],v[64:67],a[128:131],a[64:67]
 v_exp_f32 v32,v32
 mf a[64:67],v[68:71],a[132:135],a[64:67]
 rt a[146:147],v218 offset:20480
 mf a[68:71],v[84:87],a[132:135],a[68:71]
 v_exp_f32 v33,v33
 mf a[68:71],v[80:83],a[128:131],a[68:71]
 rt a[148:149],v218 offset:24576
 pk v32,v32,v33
 mf a[72:75],v[96:99],a[128:131],a[72:75]
 v_exp_f32 v34,v34
 mf a[72:75],v[100:103],a[132:135],a[72:75]
 v_exp_f32 v35,v35
 mf a[76:79],v[116:119],a[132:135],a[76:79]
 rt a[150:151],v218 offset:28672
 pk v33,v34,v35
 mf a[76:79],v[112:115],a[128:131],a[76:79]
 s_waitcnt lgkmcnt(4)
 v_exp_f32 v36,v36
 mf a[92:95],v[112:115],a[136:139],a[92:95]
 rt a[152:153],v219 offset:16384
 mf a[92:95],v[116:119],a[140:143],a[92:95]
 v_exp_f32 v37,v37
 mf a[88:91],v[100:103],a[140:143],a[88:91]
 rt a[154:155],v219 offset:20480
 mf a[88:91],v[96:99],a[136:139],a[88:91]
 bl v224,s[12:15],s63 offen offset:2048 lds
 mf a[84:87],v[80:83],a[136:139],a[84:87]
 rt a[156:157],v219 offset:24576
 pk v34,v36,v37
 mf a[84:87],v[84:87],a[140:143],a[84:87]
 v_exp_f32 v38,v38
 mf a[80:83],v[68:71],a[140:143],a[80:83]
 v_exp_f32 v39,v39
 mf a[80:83],v[64:67],a[136:139],a[80:83]
 s_waitcnt lgkmcnt(3)
 rt a[158:159],v219 offset:28672
 pk v35,v38,v39
 mf a[96:99],v[64:67],a[144:147],a[96:99]
 v_exp_f32 v48,v48
 mf a[96:99],v[68:71],a[148:151],a[96:99]
 mf a[100:103],v[84:87],a[148:151],a[100:103]
 v_exp_f32 v49,v49
 mf a[100:103],v[80:83],a[144:147],a[100:103]
 pk v48,v48,v49
 mf a[104:107],v[96:99],a[144:147],a[104:107]
 v_exp_f32 v50,v50
 mf a[104:107],v[100:103],a[148:151],a[104:107]
 rq a[128:131],v208 offset:49152
 mf a[108:111],v[116:119],a[148:151],a[108:111]
 v_exp_f32 v51,v51
 mf a[108:111],v[112:115],a[144:147],a[108:111]
 s_waitcnt lgkmcnt(1)
 v_exp_f32 v52,v52
 mf a[124:127],v[112:115],a[152:155],a[124:127]
 rq a[132:135],v209 offset:49152
 pk v49,v50,v51
 mf a[124:127],v[116:119],a[156:159],a[124:127]
 v_exp_f32 v53,v53
 mf a[120:123],v[100:103],a[156:159],a[120:123]
 rq a[136:139],v210 offset:49152
 mf a[120:123],v[96:99],a[152:155],a[120:123]
 bl v225,s[12:15],s63 offen offset:3072 lds
 mf a[116:119],v[80:83],a[152:155],a[116:119]
 rq a[140:143],v211 offset:49152
 pk v50,v52,v53
 mf a[116:119],v[84:87],a[156:159],a[116:119]
 v_exp_f32 v54,v54
 mf a[112:115],v[68:71],a[156:159],a[112:115]
 mf a[112:115],v[64:67],a[152:155],a[112:115]
 v_exp_f32 v55,v55
 v_smfmac_f32_16x16x64_bf16 a[192:195],a[208:211],v[64:71],v250
 pk v51,v54,v55
 v_smfmac_f32_16x16x64_bf16 a[196:199],a[208:211],v[80:87],v250
 s_waitcnt vmcnt(18)
 v_smfmac_f32_16x16x64_bf16 a[200:203],a[208:211],v[96:103],v250
 s_barrier
 v_smfmac_f32_16x16x64_bf16 a[204:207],a[208:211],v[112:119],v250
 s_waitcnt lgkmcnt(0)
 v_mov_b32 v240,1
 mf v[64:67],a[128:131],v[128:131],v[192:195]
 s_add_u32 s64,s70,1024
 v_exp_f32 v8,v8
 mf v[64:67],a[132:135],v[132:135],v[64:67]
 s_add_u32 m0,s61,32768
 v_exp_f32 v9,v9
 mf v[64:67],a[136:139],v[136:139],v[64:67]
 s_mov_b32 s63,491520
 rq a[144:147],v208 offset:53248
 mf v[64:67],a[140:143],v[140:143],v[64:67]
 bl v220,s[8:11],s63 offen offset:0 lds
 mf v[80:83],a[140:143],v[156:159],v[196:199]
 s_waitcnt vmcnt(11)
 rq a[148:151],v209 offset:53248
 pk v4,v8,v9
 mf v[80:83],a[136:139],v[152:155],v[80:83]
 v_exp_f32 v10,v10
 mf v[80:83],a[132:135],v[148:151],v[80:83]
 rq a[152:155],v210 offset:53248
 s_mov_b64 exec,3
 buffer_store_dword v240,v251,s[16:19],s64 offen sc1
 s_mov_b64 exec,-1
 mf v[80:83],a[128:131],v[144:147],v[80:83]
 v_exp_f32 v11,v11
 mf v[96:99],a[128:131],v[160:163],v[200:203]
 rq a[156:159],v211 offset:53248
 pk v5,v10,v11
 mf v[96:99],a[132:135],v[164:167],v[96:99]
 v_exp_f32 v12,v12
 mf v[96:99],a[136:139],v[168:171],v[96:99]
 v_exp_f32 v13,v13
 mf v[96:99],a[140:143],v[172:175],v[96:99]
 pk v6,v12,v13
 v_bfe_u32 v234,v254,4,4
 mf v[112:115],a[140:143],v[188:191],v[204:207]
 v_exp_f32 v14,v14
 mf v[112:115],a[136:139],v[184:187],v[112:115]
 v_lshlrev_b32 v234,10,v234
 v_bfe_u32 v235,v255,8,2
 mf v[112:115],a[132:135],v[180:183],v[112:115]
 v_exp_f32 v15,v15
 mf v[112:115],a[128:131],v[176:179],v[112:115]
 s_waitcnt lgkmcnt(0)
 pk v7,v14,v15
 v_lshl_add_u32 v234,v235,3,v234
 mf v[116:119],a[144:147],v[176:179],v[204:207]
 v_exp_f32 v24,v24
 mf v[116:119],a[148:151],v[180:183],v[116:119]
 v_exp_f32 v25,v25
 mf v[116:119],a[152:155],v[184:187],v[116:119]
 rq a[128:131],v208 offset:57344
 mf v[116:119],a[156:159],v[188:191],v[116:119]
 bl v221,s[8:11],s63 offen offset:1024 lds
 mf v[100:103],a[156:159],v[172:175],v[200:203]
 rq a[132:135],v209 offset:57344
 pk v20,v24,v25
 mf v[100:103],a[152:155],v[168:171],v[100:103]
 v_exp_f32 v26,v26
 mf v[100:103],a[148:151],v[164:167],v[100:103]
 rq a[136:139],v210 offset:57344
 mf v[100:103],a[144:147],v[160:163],v[100:103]
 v_exp_f32 v27,v27
 mf v[84:87],a[144:147],v[144:147],v[196:199]
 rq a[140:143],v211 offset:57344
 pk v21,v26,v27
 mf v[84:87],a[148:151],v[148:151],v[84:87]
 v_exp_f32 v28,v28
 mf v[84:87],a[152:155],v[152:155],v[84:87]
 v_exp_f32 v29,v29
 mf v[84:87],a[156:159],v[156:159],v[84:87]
 pk v22,v28,v29
 mf v[68:71],a[156:159],v[140:143],v[192:195]
 v_exp_f32 v30,v30
 mf v[68:71],a[152:155],v[136:139],v[68:71]
 mf v[68:71],a[148:151],v[132:135],v[68:71]
 v_exp_f32 v31,v31
 mf v[68:71],a[144:147],v[128:131],v[68:71]
 s_waitcnt lgkmcnt(0)
 pk v23,v30,v31
 mf v[72:75],a[128:131],v[128:131],v[192:195]
 v_exp_f32 v40,v40
 mf v[72:75],a[132:135],v[132:135],v[72:75]
 v_exp_f32 v41,v41
 mf v[72:75],a[136:139],v[136:139],v[72:75]
 rq a[144:147],v208 offset:61440
 mf v[72:75],a[140:143],v[140:143],v[72:75]
 bl v222,s[8:11],s63 offen offset:2048 lds
 mf v[88:91],a[140:143],v[156:159],v[196:199]
 rq a[148:151],v209 offset:61440
 pk v36,v40,v41
 mf v[88:91],a[136:139],v[152:155],v[88:91]
 v_exp_f32 v42,v42
 mf v[88:91],a[132:135],v[148:151],v[88:91]
 rq a[152:155],v210 offset:61440
 mf v[88:91],a[128:131],v[144:147],v[88:91]
 v_exp_f32 v43,v43
 mf v[104:107],a[128:131],v[160:163],v[200:203]
 rq a[156:159],v211 offset:61440
 pk v37,v42,v43
 mf v[104:107],a[132:135],v[164:167],v[104:107]
 v_exp_f32 v44,v44
 mf v[104:107],a[136:139],v[168:171],v[104:107]
 v_exp_f32 v45,v45
 mf v[104:107],a[140:143],v[172:175],v[104:107]
 pk v38,v44,v45
 mf v[120:123],a[140:143],v[188:191],v[204:207]
 v_exp_f32 v46,v46
 mf v[120:123],a[136:139],v[184:187],v[120:123]
 mf v[120:123],a[132:135],v[180:183],v[120:123]
 v_exp_f32 v47,v47
 mf v[120:123],a[128:131],v[176:179],v[120:123]
 s_waitcnt lgkmcnt(0)
 rt a[130:131],v212 offset:36864
 pk v39,v46,v47
 mf v[124:127],a[144:147],v[176:179],v[204:207]
 v_exp_f32 v56,v56
 mf v[124:127],a[148:151],v[180:183],v[124:127]
 v_exp_f32 v57,v57
 mf v[124:127],a[152:155],v[184:187],v[124:127]
 rt a[128:129],v212 offset:32768
 rt a[132:133],v212 offset:40960
 mf v[124:127],a[156:159],v[188:191],v[124:127]
 bl v223,s[8:11],s63 offen offset:3072 lds
 mf v[108:111],a[156:159],v[172:175],v[200:203]
 rt a[134:135],v212 offset:45056
 pk v52,v56,v57
 mf v[108:111],a[152:155],v[168:171],v[108:111]
 v_exp_f32 v58,v58
 mf v[108:111],a[148:151],v[164:167],v[108:111]
 rt a[136:137],v213 offset:32768
 buffer_load_dwordx2 v[244:245],v234,s[4:7],s87 offen offset:0
 mf v[108:111],a[144:147],v[160:163],v[108:111]
 v_exp_f32 v59,v59
 mf v[92:95],a[144:147],v[144:147],v[196:199]
 rt a[138:139],v213 offset:36864
 pk v53,v58,v59
 mf v[92:95],a[148:151],v[148:151],v[92:95]
 v_exp_f32 v60,v60
 mf v[92:95],a[152:155],v[152:155],v[92:95]
 v_exp_f32 v61,v61
 mf v[92:95],a[156:159],v[156:159],v[92:95]
 rt a[140:141],v213 offset:40960
 pk v54,v60,v61
 mf v[76:79],a[156:159],v[140:143],v[192:195]
 v_exp_f32 v62,v62
 mf v[76:79],a[152:155],v[136:139],v[76:79]
 rt a[142:143],v213 offset:45056
 mf v[76:79],a[148:151],v[132:135],v[76:79]
 v_exp_f32 v63,v63
 mf v[76:79],a[144:147],v[128:131],v[76:79]
 s_waitcnt lgkmcnt(4)
 rt a[148:149],v214 offset:40960
 pk v55,v62,v63
 mf a[0:3],v[0:3],a[128:131],a[0:3]
 v_exp_f32 v64,v64
 mf a[0:3],v[4:7],a[132:135],a[0:3]
 v_exp_f32 v65,v65
 mf a[4:7],v[20:23],a[132:135],a[4:7]
 rt a[150:151],v214 offset:45056
 pk v64,v64,v65
 mf a[4:7],v[16:19],a[128:131],a[4:7]
 v_exp_f32 v66,v66
 mf a[8:11],v[32:35],a[128:131],a[8:11]
 rt a[146:147],v214 offset:36864
 rt a[152:153],v215 offset:32768
 mf a[8:11],v[36:39],a[132:135],a[8:11]
 v_exp_f32 v67,v67
 mf a[12:15],v[52:55],a[132:135],a[12:15]
 rt a[154:155],v215 offset:36864
 pk v65,v66,v67
 mf a[12:15],v[48:51],a[128:131],a[12:15]
 s_waitcnt lgkmcnt(5)
 v_exp_f32 v68,v68
 mf a[28:31],v[48:51],a[136:139],a[28:31]
 v_exp_f32 v69,v69
 mf a[28:31],v[52:55],a[140:143],a[28:31]
 s_add_u32 m0,s61,81920
 rt a[156:157],v215 offset:40960
 pk v66,v68,v69
 mf a[24:27],v[36:39],a[140:143],a[24:27]
 s_mov_b32 s63,475136
 rt a[144:145],v214 offset:32768
 rt a[158:159],v215 offset:45056
 mf a[24:27],v[32:35],a[136:139],a[24:27]
 bl v224,s[12:15],s63 offen offset:0 lds
 mf a[20:23],v[16:19],a[136:139],a[20:23]
 v_exp_f32 v70,v70
 mf a[20:23],v[20:23],a[140:143],a[20:23]
 rt a[128:129],v216 offset:32768
 buffer_load_dwordx2 v[246:247],v234,s[4:7],s87 offen offset:32
 mf a[16:19],v[4:7],a[140:143],a[16:19]
 v_exp_f32 v71,v71
 mf a[16:19],v[0:3],a[136:139],a[16:19]
 s_waitcnt lgkmcnt(2)
 rt a[130:131],v216 offset:36864
 pk v67,v70,v71
 mf a[32:35],v[0:3],a[144:147],a[32:35]
 v_exp_f32 v80,v80
 mf a[32:35],v[4:7],a[148:151],a[32:35]
 rt a[132:133],v216 offset:40960
 mf a[36:39],v[20:23],a[148:151],a[36:39]
 v_exp_f32 v81,v81
 mf a[36:39],v[16:19],a[144:147],a[36:39]
 v_exp_f32 v82,v82
 mf a[40:43],v[32:35],a[144:147],a[40:43]
 rt a[134:135],v216 offset:45056
 pk v80,v80,v81
 mf a[40:43],v[36:39],a[148:151],a[40:43]
 v_exp_f32 v83,v83
 mf a[44:47],v[52:55],a[148:151],a[44:47]
 rt a[136:137],v217 offset:32768
 pk v81,v82,v83
 mf a[44:47],v[48:51],a[144:147],a[44:47]
 s_waitcnt lgkmcnt(5)
 v_exp_f32 v84,v84
 mf a[60:63],v[48:51],a[152:155],a[60:63]
 rt a[138:139],v217 offset:36864
 mf a[60:63],v[52:55],a[156:159],a[60:63]
 v_exp_f32 v85,v85
 mf a[56:59],v[36:39],a[156:159],a[56:59]
 rt a[140:141],v217 offset:40960
 mf a[56:59],v[32:35],a[152:155],a[56:59]
 bl v225,s[12:15],s63 offen offset:1024 lds
 mf a[52:55],v[16:19],a[152:155],a[52:55]
 v_exp_f32 v86,v86
 mf a[52:55],v[20:23],a[156:159],a[52:55]
 rt a[142:143],v217 offset:45056
 pk v82,v84,v85
 mf a[48:51],v[4:7],a[156:159],a[48:51]
 v_exp_f32 v87,v87
 mf a[48:51],v[0:3],a[152:155],a[48:51]
 s_waitcnt lgkmcnt(4)
 rt a[144:145],v218 offset:32768
 pk v83,v86,v87
 mf a[64:67],v[0:3],a[128:131],a[64:67]
 v_exp_f32 v96,v96
 mf a[64:67],v[4:7],a[132:135],a[64:67]
 rt a[146:147],v218 offset:36864
 buffer_load_dwordx2 v[248:249],v234,s[4:7],s87 offen offset:128
 mf a[68:71],v[20:23],a[132:135],a[68:71]
 v_exp_f32 v97,v97
 mf a[68:71],v[16:19],a[128:131],a[68:71]
 rt a[148:149],v218 offset:40960
 pk v96,v96,v97
 mf a[72:75],v[32:35],a[128:131],a[72:75]
 v_exp_f32 v98,v98
 mf a[72:75],v[36:39],a[132:135],a[72:75]
 v_exp_f32 v99,v99
 mf a[76:79],v[52:55],a[132:135],a[76:79]
 rt a[150:151],v218 offset:45056
 pk v97,v98,v99
 mf a[76:79],v[48:51],a[128:131],a[76:79]
 s_waitcnt lgkmcnt(4)
 v_exp_f32 v100,v100
 mf a[92:95],v[48:51],a[136:139],a[92:95]
 rt a[152:153],v219 offset:32768
 mf a[92:95],v[52:55],a[140:143],a[92:95]
 v_exp_f32 v101,v101
 mf a[88:91],v[36:39],a[140:143],a[88:91]
 rt a[154:155],v219 offset:36864
 mf a[88:91],v[32:35],a[136:139],a[88:91]
 bl v224,s[12:15],s63 offen offset:2048 lds
 mf a[84:87],v[16:19],a[136:139],a[84:87]
 rt a[156:157],v219 offset:40960
 pk v98,v100,v101
 mf a[84:87],v[20:23],a[140:143],a[84:87]
 v_exp_f32 v102,v102
 mf a[80:83],v[4:7],a[140:143],a[80:83]
 v_exp_f32 v103,v103
 mf a[80:83],v[0:3],a[136:139],a[80:83]
 s_waitcnt lgkmcnt(3)
 rt a[158:159],v219 offset:45056
 pk v99,v102,v103
 mf a[96:99],v[0:3],a[144:147],a[96:99]
 v_exp_f32 v112,v112
 mf a[96:99],v[4:7],a[148:151],a[96:99]
 buffer_load_dwordx2 v[236:237],v234,s[4:7],s87 offen offset:160
 mf a[100:103],v[20:23],a[148:151],a[100:103]
 v_exp_f32 v113,v113
 mf a[100:103],v[16:19],a[144:147],a[100:103]
 pk v112,v112,v113
 v_bfe_u32 v243,v255,4,4
 mf a[104:107],v[32:35],a[144:147],a[104:107]
 v_exp_f32 v114,v114
 mf a[104:107],v[36:39],a[148:151],a[104:107]
 rq a[128:131],v208 offset:0
 v_bfe_u32 v234,v255,8,2
 mf a[108:111],v[52:55],a[148:151],a[108:111]
 v_exp_f32 v115,v115
 mf a[108:111],v[48:51],a[144:147],a[108:111]
 s_waitcnt lgkmcnt(1)
 v_exp_f32 v116,v116
 mf a[124:127],v[48:51],a[152:155],a[124:127]
 rq a[132:135],v209 offset:0
 pk v113,v114,v115
 mf a[124:127],v[52:55],a[156:159],a[124:127]
 v_exp_f32 v117,v117
 mf a[120:123],v[36:39],a[156:159],a[120:123]
 rq a[136:139],v210 offset:0
 mf a[120:123],v[32:35],a[152:155],a[120:123]
 bl v225,s[12:15],s63 offen offset:3072 lds
 mf a[116:119],v[16:19],a[152:155],a[116:119]
 rq a[140:143],v211 offset:0
 pk v114,v116,v117
 mf a[116:119],v[20:23],a[156:159],a[116:119]
 v_exp_f32 v118,v118
 mf a[112:115],v[4:7],a[156:159],a[112:115]
 v_and_b32 v239,1,v243
 v_xor_b32 v234,v234,v239
 mf a[112:115],v[0:3],a[152:155],a[112:115]
 v_exp_f32 v119,v119
 v_smfmac_f32_16x16x64_bf16 a[192:195],a[208:211],v[0:7],v250
 pk v115,v118,v119
 v_smfmac_f32_16x16x64_bf16 a[196:199],a[208:211],v[16:23],v250
 s_waitcnt vmcnt(17)
 v_lshrrev_b32 v239,3,v243
 v_smfmac_f32_16x16x64_bf16 a[200:203],a[208:211],v[32:39],v250
 s_barrier
 v_lshlrev_b32 v239,1,v239
 v_smfmac_f32_16x16x64_bf16 a[204:207],a[208:211],v[48:55],v250
 s_waitcnt lgkmcnt(0)
 v_xor_b32 v234,v234,v239
 mf v[0:3],a[128:131],v[128:131],v[192:195]
 v_exp_f32 v72,v72
 mf v[0:3],a[132:135],v[132:135],v[0:3]
 s_add_u32 m0,s61,49152
 v_exp_f32 v73,v73
 mf v[0:3],a[136:139],v[136:139],v[0:3]
 s_mov_b32 s63,507904
 rq a[144:147],v208 offset:4096
 mf v[0:3],a[140:143],v[140:143],v[0:3]
 bl v220,s[8:11],s63 offen offset:0 lds
 mf v[16:19],a[140:143],v[156:159],v[196:199]
 rq a[148:151],v209 offset:4096
 pk v68,v72,v73
 mf v[16:19],a[136:139],v[152:155],v[16:19]
 v_exp_f32 v74,v74
 mf v[16:19],a[132:135],v[148:151],v[16:19]
 rq a[152:155],v210 offset:4096
 v_and_b32 v239,6,v243
 mf v[16:19],a[128:131],v[144:147],v[16:19]
 v_exp_f32 v75,v75
 mf v[32:35],a[128:131],v[160:163],v[200:203]
 rq a[156:159],v211 offset:4096
 pk v69,v74,v75
 mf v[32:35],a[132:135],v[164:167],v[32:35]
 v_exp_f32 v76,v76
 mf v[32:35],a[136:139],v[168:171],v[32:35]
 v_exp_f32 v77,v77
 mf v[32:35],a[140:143],v[172:175],v[32:35]
 pk v70,v76,v77
 v_lshl_add_u32 v234,v239,1,v234
 mf v[48:51],a[140:143],v[188:191],v[204:207]
 v_exp_f32 v78,v78
 mf v[48:51],a[136:139],v[184:187],v[48:51]
 v_lshlrev_b32 v234,3,v234
 v_lshl_add_u32 v234,v243,7,v234
 mf v[48:51],a[132:135],v[180:183],v[48:51]
 v_exp_f32 v79,v79
 mf v[48:51],a[128:131],v[176:179],v[48:51]
 s_waitcnt lgkmcnt(0)
 pk v71,v78,v79
 v_bfe_u32 v243,v255,6,4
 mf v[52:55],a[144:147],v[176:179],v[204:207]
 v_exp_f32 v88,v88
 mf v[52:55],a[148:151],v[180:183],v[52:55]
 v_exp_f32 v89,v89
 mf v[52:55],a[152:155],v[184:187],v[52:55]
L_pad_pg23:
 s_cbranch_execz L_hop6
 rq a[128:131],v208 offset:8192
 mf v[52:55],a[156:159],v[188:191],v[52:55]
 bl v221,s[8:11],s63 offen offset:1024 lds
 mf v[36:39],a[156:159],v[172:175],v[200:203]
 rq a[132:135],v209 offset:8192
 pk v84,v88,v89
 mf v[36:39],a[152:155],v[168:171],v[36:39]
 v_exp_f32 v90,v90
 mf v[36:39],a[148:151],v[164:167],v[36:39]
 rq a[136:139],v210 offset:8192
 v_bfe_u32 v235,v255,4,2
 mf v[36:39],a[144:147],v[160:163],v[36:39]
 v_exp_f32 v91,v91
 mf v[20:23],a[144:147],v[144:147],v[196:199]
 rq a[140:143],v211 offset:8192
 pk v85,v90,v91
 mf v[20:23],a[148:151],v[148:151],v[20:23]
 v_exp_f32 v92,v92
 mf v[20:23],a[152:155],v[152:155],v[20:23]
 v_exp_f32 v93,v93
 mf v[20:23],a[156:159],v[156:159],v[20:23]
 pk v86,v92,v93
 v_and_b32 v239,1,v243
 mf v[4:7],a[156:159],v[140:143],v[192:195]
 v_exp_f32 v94,v94
 mf v[4:7],a[152:155],v[136:139],v[4:7]
 v_xor_b32 v235,v235,v239
 v_lshrrev_b32 v239,3,v243
 mf v[4:7],a[148:151],v[132:135],v[4:7]
 v_exp_f32 v95,v95
 mf v[4:7],a[144:147],v[128:131],v[4:7]
 s_waitcnt lgkmcnt(0)
 pk v87,v94,v95
 v_lshlrev_b32 v239,1,v239
 mf v[8:11],a[128:131],v[128:131],v[192:195]
 v_exp_f32 v104,v104
 mf v[8:11],a[132:135],v[132:135],v[8:11]
 v_exp_f32 v105,v105
 mf v[8:11],a[136:139],v[136:139],v[8:11]
 rq a[144:147],v208 offset:12288
 mf v[8:11],a[140:143],v[140:143],v[8:11]
 bl v222,s[8:11],s63 offen offset:2048 lds
 mf v[24:27],a[140:143],v[156:159],v[196:199]
 rq a[148:151],v209 offset:12288
 pk v100,v104,v105
 mf v[24:27],a[136:139],v[152:155],v[24:27]
 v_exp_f32 v106,v106
 mf v[24:27],a[132:135],v[148:151],v[24:27]
 rq a[152:155],v210 offset:12288
 v_xor_b32 v235,v235,v239
 mf v[24:27],a[128:131],v[144:147],v[24:27]
 v_exp_f32 v107,v107
 mf v[40:43],a[128:131],v[160:163],v[200:203]
 rq a[156:159],v211 offset:12288
 pk v101,v106,v107
 mf v[40:43],a[132:135],v[164:167],v[40:43]
 v_exp_f32 v108,v108
 mf v[40:43],a[136:139],v[168:171],v[40:43]
 v_exp_f32 v109,v109
 mf v[40:43],a[140:143],v[172:175],v[40:43]
 pk v102,v108,v109
 v_and_b32 v239,6,v243
 mf v[56:59],a[140:143],v[188:191],v[204:207]
 v_exp_f32 v110,v110
 mf v[56:59],a[136:139],v[184:187],v[56:59]
 v_lshl_add_u32 v235,v239,1,v235
 v_lshlrev_b32 v235,3,v235
 mf v[56:59],a[132:135],v[180:183],v[56:59]
 v_exp_f32 v111,v111
 mf v[56:59],a[128:131],v[176:179],v[56:59]
 s_waitcnt lgkmcnt(0)
 rt a[130:131],v212 offset:53248
 pk v103,v110,v111
 mf v[60:63],a[144:147],v[176:179],v[204:207]
 v_exp_f32 v120,v120
 mf v[60:63],a[148:151],v[180:183],v[60:63]
 v_exp_f32 v121,v121
 mf v[60:63],a[152:155],v[184:187],v[60:63]
 rt a[128:129],v212 offset:49152
 rt a[132:133],v212 offset:57344
 mf v[60:63],a[156:159],v[188:191],v[60:63]
 bl v223,s[8:11],s63 offen offset:3072 lds
 mf v[44:47],a[156:159],v[172:175],v[200:203]
 rt a[134:135],v212 offset:61440
 pk v116,v120,v121
 mf v[44:47],a[152:155],v[168:171],v[44:47]
 v_exp_f32 v122,v122
 mf v[44:47],a[148:151],v[164:167],v[44:47]
 rt a[136:137],v213 offset:49152
 v_lshl_add_u32 v235,v243,7,v235
 mf v[44:47],a[144:147],v[160:163],v[44:47]
 v_exp_f32 v123,v123
 mf v[28:31],a[144:147],v[144:147],v[196:199]
 rt a[138:139],v213 offset:53248
 pk v117,v122,v123
 mf v[28:31],a[148:151],v[148:151],v[28:31]
 v_exp_f32 v124,v124
 mf v[28:31],a[152:155],v[152:155],v[28:31]
 v_exp_f32 v125,v125
 mf v[28:31],a[156:159],v[156:159],v[28:31]
 rt a[140:141],v213 offset:57344
 pk v118,v124,v125
 mf v[12:15],a[156:159],v[140:143],v[192:195]
 v_exp_f32 v126,v126
 mf v[12:15],a[152:155],v[136:139],v[12:15]
 rt a[142:143],v213 offset:61440
 v_add_u32 v234,s61,v234
 mf v[12:15],a[148:151],v[132:135],v[12:15]
 v_exp_f32 v127,v127
 mf v[12:15],a[144:147],v[128:131],v[12:15]
 s_waitcnt lgkmcnt(4)
 rt a[148:149],v214 offset:57344
 pk v119,v126,v127
 mf a[0:3],v[64:67],a[128:131],a[0:3]
 v_exp_f32 v0,v0
 mf a[0:3],v[68:71],a[132:135],a[0:3]
 v_exp_f32 v1,v1
 mf a[4:7],v[84:87],a[132:135],a[4:7]
 rt a[150:151],v214 offset:61440
 pk v0,v0,v1
 mf a[4:7],v[80:83],a[128:131],a[4:7]
 v_exp_f32 v2,v2
 mf a[8:11],v[96:99],a[128:131],a[8:11]
 rt a[146:147],v214 offset:53248
 rt a[152:153],v215 offset:49152
 mf a[8:11],v[100:103],a[132:135],a[8:11]
 v_exp_f32 v3,v3
 mf a[12:15],v[116:119],a[132:135],a[12:15]
 rt a[154:155],v215 offset:53248
 pk v1,v2,v3
 mf a[12:15],v[112:115],a[128:131],a[12:15]
 s_waitcnt lgkmcnt(5)
 v_exp_f32 v4,v4
 mf a[28:31],v[112:115],a[136:139],a[28:31]
 v_exp_f32 v5,v5
 mf a[28:31],v[116:119],a[140:143],a[28:31]
 s_add_u32 m0,s61,98304
 rt a[156:157],v215 offset:57344
 pk v2,v4,v5
 mf a[24:27],v[100:103],a[140:143],a[24:27]
 s_mov_b32 s63,491520
 rt a[144:145],v214 offset:49152
 rt a[158:159],v215 offset:61440
 mf a[24:27],v[96:99],a[136:139],a[24:27]
 bl v224,s[12:15],s63 offen offset:0 lds
 mf a[20:23],v[80:83],a[136:139],a[20:23]
 v_exp_f32 v6,v6
 mf a[20:23],v[84:87],a[140:143],a[20:23]
 rt a[128:129],v216 offset:49152
 buffer_load_dword v241,v242,s[16:19],s72 offen sc1
 mf a[16:19],v[68:71],a[140:143],a[16:19]
 v_exp_f32 v7,v7
 mf a[16:19],v[64:67],a[136:139],a[16:19]
 s_waitcnt lgkmcnt(2)
 rt a[130:131],v216 offset:53248
 pk v3,v6,v7
 mf a[32:35],v[64:67],a[144:147],a[32:35]
 v_exp_f32 v16,v16
 mf a[32:35],v[68:71],a[148:151],a[32:35]
 rt a[132:133],v216 offset:57344
 mf a[36:39],v[84:87],a[148:151],a[36:39]
 v_exp_f32 v17,v17
 mf a[36:39],v[80:83],a[144:147],a[36:39]
 v_exp_f32 v18,v18
 mf a[40:43],v[96:99],a[144:147],a[40:43]
 rt a[134:135],v216 offset:61440
 pk v16,v16,v17
 mf a[40:43],v[100:103],a[148:151],a[40:43]
 v_exp_f32 v19,v19
 mf a[44:47],v[116:119],a[148:151],a[44:47]
 rt a[136:137],v217 offset:49152
 pk v17,v18,v19
 mf a[44:47],v[112:115],a[144:147],a[44:47]
 s_waitcnt lgkmcnt(5)
 v_exp_f32 v20,v20
 mf a[60:63],v[112:115],a[152:155],a[60:63]
 rt a[138:139],v217 offset:53248
 mf a[60:63],v[116:119],a[156:159],a[60:63]
 v_exp_f32 v21,v21
 mf a[56:59],v[100:103],a[156:159],a[56:59]
 rt a[140:141],v217 offset:57344
 mf a[56:59],v[96:99],a[152:155],a[56:59]
 bl v225,s[12:15],s63 offen offset:1024 lds
 mf a[52:55],v[80:83],a[152:155],a[52:55]
 v_exp_f32 v22,v22
 mf a[52:55],v[84:87],a[156:159],a[52:55]
 rt a[142:143],v217 offset:61440
 pk v18,v20,v21
 mf a[48:51],v[68:71],a[156:159],a[48:51]
 v_exp_f32 v23,v23
 mf a[48:51],v[64:67],a[152:155],a[48:51]
 s_waitcnt lgkmcnt(4)
 rt a[144:145],v218 offset:49152
 pk v19,v22,v23
 mf a[64:67],v[64:67],a[128:131],a[64:67]
 v_exp_f32 v32,v32
 mf a[64:67],v[68:71],a[132:135],a[64:67]
 rt a[146:147],v218 offset:53248
 mf a[68:71],v[84:87],a[132:135],a[68:71]
 v_exp_f32 v33,v33
 mf a[68:71],v[80:83],a[128:131],a[68:71]
 rt a[148:149],v218 offset:57344
 pk v32,v32,v33
 mf a[72:75],v[96:99],a[128:131],a[72:75]
 v_exp_f32 v34,v34
 mf a[72:75],v[100:103],a[132:135],a[72:75]
 v_exp_f32 v35,v35
 mf a[76:79],v[116:119],a[132:135],a[76:79]
 rt a[150:151],v218 offset:61440
 pk v33,v34,v35
 mf a[76:79],v[112:115],a[128:131],a[76:79]
 s_waitcnt lgkmcnt(4)
 v_exp_f32 v36,v36
 mf a[92:95],v[112:115],a[136:139],a[92:95]
 rt a[152:153],v219 offset:49152
 mf a[92:95],v[116:119],a[140:143],a[92:95]
 v_exp_f32 v37,v37
 mf a[88:91],v[100:103],a[140:143],a[88:91]
 rt a[154:155],v219 offset:53248
 mf a[88:91],v[96:99],a[136:139],a[88:91]
 bl v224,s[12:15],s63 offen offset:2048 lds
 mf a[84:87],v[80:83],a[136:139],a[84:87]
 rt a[156:157],v219 offset:57344
 pk v34,v36,v37
 mf a[84:87],v[84:87],a[140:143],a[84:87]
 v_exp_f32 v38,v38
 mf a[80:83],v[68:71],a[140:143],a[80:83]
 v_exp_f32 v39,v39
 mf a[80:83],v[64:67],a[136:139],a[80:83]
 s_waitcnt lgkmcnt(3)
 rt a[158:159],v219 offset:61440
 pk v35,v38,v39
 mf a[96:99],v[64:67],a[144:147],a[96:99]
 v_exp_f32 v48,v48
 mf a[96:99],v[68:71],a[148:151],a[96:99]
 mf a[100:103],v[84:87],a[148:151],a[100:103]
 v_exp_f32 v49,v49
 mf a[100:103],v[80:83],a[144:147],a[100:103]
 pk v48,v48,v49
 mf a[104:107],v[96:99],a[144:147],a[104:107]
 v_exp_f32 v50,v50
 mf a[104:107],v[100:103],a[148:151],a[104:107]
 rq a[128:131],v208 offset:16384
 mf a[108:111],v[116:119],a[148:151],a[108:111]
 v_exp_f32 v51,v51
 mf a[108:111],v[112:115],a[144:147],a[108:111]
 s_waitcnt lgkmcnt(1)
 v_exp_f32 v52,v52
 mf a[124:127],v[112:115],a[152:155],a[124:127]
 rq a[132:135],v209 offset:16384
 pk v49,v50,v51
 mf a[124:127],v[116:119],a[156:159],a[124:127]
 v_exp_f32 v53,v53
 mf a[120:123],v[100:103],a[156:159],a[120:123]
 rq a[136:139],v210 offset:16384
 mf a[120:123],v[96:99],a[152:155],a[120:123]
 bl v225,s[12:15],s63 offen offset:3072 lds
 mf a[116:119],v[80:83],a[152:155],a[116:119]
 rq a[140:143],v211 offset:16384
 pk v50,v52,v53
 mf a[116:119],v[84:87],a[156:159],a[116:119]
 v_exp_f32 v54,v54
 mf a[112:115],v[68:71],a[156:159],a[112:115]
 mf a[112:115],v[64:67],a[152:155],a[112:115]
 v_exp_f32 v55,v55
 v_smfmac_f32_16x16x64_bf16 a[192:195],a[208:211],v[64:71],v250
 pk v51,v54,v55
 v_smfmac_f32_16x16x64_bf16 a[196:199],a[208:211],v[80:87],v250
 s_waitcnt vmcnt(17)
 v_smfmac_f32_16x16x64_bf16 a[200:203],a[208:211],v[96:103],v250
 s_barrier
 v_smfmac_f32_16x16x64_bf16 a[204:207],a[208:211],v[112:119],v250
 s_waitcnt lgkmcnt(0)
 mf v[64:67],a[128:131],v[128:131],v[192:195]
 v_exp_f32 v8,v8
 mf v[64:67],a[132:135],v[132:135],v[64:67]
 s_add_u32 m0,s61,114688
 v_exp_f32 v9,v9
 mf v[64:67],a[136:139],v[136:139],v[64:67]
 s_mov_b32 s63,507904
 rq a[144:147],v208 offset:20480
 mf v[64:67],a[140:143],v[140:143],v[64:67]
 bl v224,s[12:15],s63 offen offset:0 lds
 mf v[80:83],a[140:143],v[156:159],v[196:199]
 rq a[148:151],v209 offset:20480
 pk v4,v8,v9
 mf v[80:83],a[136:139],v[152:155],v[80:83]
 v_exp_f32 v10,v10
 mf v[80:83],a[132:135],v[148:151],v[80:83]
 rq a[152:155],v210 offset:20480
 mf v[80:83],a[128:131],v[144:147],v[80:83]
 v_exp_f32 v11,v11
 mf v[96:99],a[128:131],v[160:163],v[200:203]
 rq a[156:159],v211 offset:20480
 pk v5,v10,v11
 mf v[96:99],a[132:135],v[164:167],v[96:99]
 v_exp_f32 v12,v12
 mf v[96:99],a[136:139],v[168:171],v[96:99]
 v_exp_f32 v13,v13
 mf v[96:99],a[140:143],v[172:175],v[96:99]
 pk v6,v12,v13
 mf v[112:115],a[140:143],v[188:191],v[204:207]
 v_exp_f32 v14,v14
 mf v[112:115],a[136:139],v[184:187],v[112:115]
 mf v[112:115],a[132:135],v[180:183],v[112:115]
 v_exp_f32 v15,v15
 mf v[112:115],a[128:131],v[176:179],v[112:115]
 s_waitcnt lgkmcnt(0)
 pk v7,v14,v15
 mf v[116:119],a[144:147],v[176:179],v[204:207]
 v_exp_f32 v24,v24
 mf v[116:119],a[148:151],v[180:183],v[116:119]
 v_exp_f32 v25,v25
 mf v[116:119],a[152:155],v[184:187],v[116:119]
 rq a[128:131],v208 offset:24576
 mf v[116:119],a[156:159],v[188:191],v[116:119]
 bl v225,s[12:15],s63 offen offset:1024 lds
 mf v[100:103],a[156:159],v[172:175],v[200:203]
 rq a[132:135],v209 offset:24576
 pk v20,v24,v25
 mf v[100:103],a[152:155],v[168:171],v[100:103]
 v_exp_f32 v26,v26
 mf v[100:103],a[148:151],v[164:167],v[100:103]
 rq a[136:139],v210 offset:24576
 s_waitcnt vmcnt(5)
 v_cmp_gt_u32 vcc,1,v241
 mf v[100:103],a[144:147],v[160:163],v[100:103]
 v_exp_f32 v27,v27
 mf v[84:87],a[144:147],v[144:147],v[196:199]
 rq a[140:143],v211 offset:24576
 pk v21,v26,v27
 mf v[84:87],a[148:151],v[148:151],v[84:87]
 v_exp_f32 v28,v28
 mf v[84:87],a[152:155],v[152:155],v[84:87]
 v_exp_f32 v29,v29
 mf v[84:87],a[156:159],v[156:159],v[84:87]
 pk v22,v28,v29
 s_cbranch_vccnz L_slow_ph
L_back_ph:
 mf v[68:71],a[156:159],v[140:143],v[192:195]
 s_add_u32 s64,s69,20971520
 v_exp_f32 v30,v30
 mf v[68:71],a[152:155],v[136:139],v[68:71]
 bl a[160:163],v255,s[16:19],s64 offen offset:0 sc1
 mf v[68:71],a[148:151],v[132:135],v[68:71]
 v_exp_f32 v31,v31
 mf v[68:71],a[144:147],v[128:131],v[68:71]
 s_waitcnt lgkmcnt(0)
 pk v23,v30,v31
 mf v[72:75],a[128:131],v[128:131],v[192:195]
 v_exp_f32 v40,v40
 mf v[72:75],a[132:135],v[132:135],v[72:75]
 v_exp_f32 v41,v41
 mf v[72:75],a[136:139],v[136:139],v[72:75]
 rq a[144:147],v208 offset:28672
 mf v[72:75],a[140:143],v[140:143],v[72:75]
 bl v224,s[12:15],s63 offen offset:2048 lds
 mf v[88:91],a[140:143],v[156:159],v[196:199]
 rq a[148:151],v209 offset:28672
 pk v36,v40,v41
 mf v[88:91],a[136:139],v[152:155],v[88:91]
 v_exp_f32 v42,v42
 mf v[88:91],a[132:135],v[148:151],v[88:91]
 rq a[152:155],v210 offset:28672
 mf v[88:91],a[128:131],v[144:147],v[88:91]
 v_exp_f32 v43,v43
 mf v[104:107],a[128:131],v[160:163],v[200:203]
 rq a[156:159],v211 offset:28672
 pk v37,v42,v43
 mf v[104:107],a[132:135],v[164:167],v[104:107]
 v_exp_f32 v44,v44
 mf v[104:107],a[136:139],v[168:171],v[104:107]
 v_exp_f32 v45,v45
 mf v[104:107],a[140:143],v[172:175],v[104:107]
 pk v38,v44,v45
 mf v[120:123],a[140:143],v[188:191],v[204:207]
 v_exp_f32 v46,v46
 mf v[120:123],a[136:139],v[184:187],v[120:123]
 mf v[120:123],a[132:135],v[180:183],v[120:123]
 v_exp_f32 v47,v47
 mf v[120:123],a[128:131],v[176:179],v[120:123]
 s_waitcnt lgkmcnt(0)
 rt a[128:129],v212 offset:0
 pk v39,v46,v47
 mf v[124:127],a[144:147],v[176:179],v[204:207]
 v_exp_f32 v56,v56
 mf v[124:127],a[148:151],v[180:183],v[124:127]
 v_exp_f32 v57,v57
 mf v[124:127],a[152:155],v[184:187],v[124:127]
 rt a[130:131],v212 offset:4096
 mf v[124:127],a[156:159],v[188:191],v[124:127]
 bl v225,s[12:15],s63 offen offset:3072 lds
 mf v[108:111],a[156:159],v[172:175],v[200:203]
 s_add_u32 s64,s69,20971520
 rt a[132:133],v212 offset:8192
 pk v52,v56,v57
 mf v[108:111],a[152:155],v[168:171],v[108:111]
 v_exp_f32 v58,v58
 mf v[108:111],a[148:151],v[164:167],v[108:111]
 rt a[134:135],v212 offset:12288
 bl a[164:167],v255,s[16:19],s64 offen offset:1024 sc1
 mf v[108:111],a[144:147],v[160:163],v[108:111]
 v_exp_f32 v59,v59
 mf v[92:95],a[144:147],v[144:147],v[196:199]
 rt a[136:137],v213 offset:0
 pk v53,v58,v59
 mf v[92:95],a[148:151],v[148:151],v[92:95]
 v_exp_f32 v60,v60
 mf v[92:95],a[152:155],v[152:155],v[92:95]
 v_exp_f32 v61,v61
 mf v[92:95],a[156:159],v[156:159],v[92:95]
 rt a[138:139],v213 offset:4096
 pk v54,v60,v61
 mf v[76:79],a[156:159],v[140:143],v[192:195]
 v_exp_f32 v62,v62
 mf v[76:79],a[152:155],v[136:139],v[76:79]
 rt a[140:141],v213 offset:8192
 mf v[76:79],a[148:151],v[132:135],v[76:79]
 v_exp_f32 v63,v63
 mf v[76:79],a[144:147],v[128:131],v[76:79]
 s_waitcnt lgkmcnt(3)
 rt a[142:143],v213 offset:12288
 pk v55,v62,v63
 mf a[0:3],v[0:3],a[128:131],a[0:3]
 v_exp_f32 v64,v64
 mf a[0:3],v[4:7],a[132:135],a[0:3]
 rt a[144:145],v214 offset:0
 mf a[4:7],v[20:23],a[132:135],a[4:7]
 v_exp_f32 v65,v65
 mf a[4:7],v[16:19],a[128:131],a[4:7]
 rt a[146:147],v214 offset:4096
 pk v64,v64,v65
 mf a[8:11],v[32:35],a[128:131],a[8:11]
 v_exp_f32 v66,v66
 mf a[8:11],v[36:39],a[132:135],a[8:11]
 rt a[148:149],v214 offset:8192
 mf a[12:15],v[52:55],a[132:135],a[12:15]
 v_exp_f32 v67,v67
 mf a[12:15],v[48:51],a[128:131],a[12:15]
 s_waitcnt lgkmcnt(3)
 rt a[150:151],v214 offset:12288
 pk v65,v66,v67
 mf a[28:31],v[48:51],a[136:139],a[28:31]
 s_add_u32 s64,s69,20979712
 v_exp_f32 v68,v68
 mf a[28:31],v[52:55],a[140:143],a[28:31]
 rt a[152:153],v215 offset:0
 bl a[168:171],v255,s[16:19],s64 offen offset:0 sc1
 mf a[24:27],v[36:39],a[140:143],a[24:27]
 v_exp_f32 v69,v69
 mf a[24:27],v[32:35],a[136:139],a[24:27]
 rt a[154:155],v215 offset:4096
 pk v66,v68,v69
 mf a[20:23],v[16:19],a[136:139],a[20:23]
 v_exp_f32 v70,v70
 mf a[20:23],v[20:23],a[140:143],a[20:23]
 rt a[156:157],v215 offset:8192
 mf a[16:19],v[4:7],a[140:143],a[16:19]
 v_exp_f32 v71,v71
 mf a[16:19],v[0:3],a[136:139],a[16:19]
 s_waitcnt lgkmcnt(3)
 rt a[158:159],v215 offset:12288
 pk v67,v70,v71
 mf a[32:35],v[0:3],a[144:147],a[32:35]
 v_exp_f32 v80,v80
 mf a[32:35],v[4:7],a[148:151],a[32:35]
 rt a[128:129],v216 offset:0
 mf a[36:39],v[20:23],a[148:151],a[36:39]
 v_exp_f32 v81,v81
 mf a[36:39],v[16:19],a[144:147],a[36:39]
 rt a[130:131],v216 offset:4096
 pk v80,v80,v81
 mf a[40:43],v[32:35],a[144:147],a[40:43]
 v_exp_f32 v82,v82
 mf a[40:43],v[36:39],a[148:151],a[40:43]
 rt a[132:133],v216 offset:8192
 mf a[44:47],v[52:55],a[148:151],a[44:47]
 v_exp_f32 v83,v83
 mf a[44:47],v[48:51],a[144:147],a[44:47]
 s_waitcnt lgkmcnt(3)
 rt a[134:135],v216 offset:12288
 pk v81,v82,v83
 mf a[60:63],v[48:51],a[152:155],a[60:63]
 v_exp_f32 v84,v84
 mf a[60:63],v[52:55],a[156:159],a[60:63]
 rt a[136:137],v217 offset:0
 mf a[56:59],v[36:39],a[156:159],a[56:59]
 v_exp_f32 v85,v85
 mf a[56:59],v[32:35],a[152:155],a[56:59]
 rt a[138:139],v217 offset:4096
 pk v82,v84,v85
 mf a[52:55],v[16:19],a[152:155],a[52:55]
 v_exp_f32 v86,v86
 mf a[52:55],v[20:23],a[156:159],a[52:55]
 rt a[140:141],v217 offset:8192
 mf a[48:51],v[4:7],a[156:159],a[48:51]
 s_add_u32 s64,s69,20979712
 v_exp_f32 v87,v87
 mf a[48:51],v[0:3],a[152:155],a[48:51]
 s_waitcnt lgkmcnt(3)
 rt a[142:143],v217 offset:12288
 pk v83,v86,v87
 mf a[64:67],v[0:3],a[128:131],a[64:67]
 v_exp_f32 v96,v96
 mf a[64:67],v[4:7],a[132:135],a[64:67]
 rt a[144:145],v218 offset:0
 bl a[172:175],v255,s[16:19],s64 offen offset:1024 sc1
 mf a[68:71],v[20:23],a[132:135],a[68:71]
 v_exp_f32 v97,v97
 mf a[68:71],v[16:19],a[128:131],a[68:71]
 rt a[146:147],v218 offset:4096
 pk v96,v96,v97
 mf a[72:75],v[32:35],a[128:131],a[72:75]
 v_exp_f32 v98,v98
 mf a[72:75],v[36:39],a[132:135],a[72:75]
 rt a[148:149],v218 offset:8192
 mf a[76:79],v[52:55],a[132:135],a[76:79]
 v_exp_f32 v99,v99
 mf a[76:79],v[48:51],a[128:131],a[76:79]
 s_waitcnt lgkmcnt(3)
 rt a[150:151],v218 offset:12288
 pk v97,v98,v99
 mf a[92:95],v[48:51],a[136:139],a[92:95]
 v_exp_f32 v100,v100
 mf a[92:95],v[52:55],a[140:143],a[92:95]
 rt a[152:153],v219 offset:0
 mf a[88:91],v[36:39],a[140:143],a[88:91]
 v_exp_f32 v101,v101
 mf a[88:91],v[32:35],a[136:139],a[88:91]
 rt a[154:155],v219 offset:4096
 pk v98,v100,v101
 mf a[84:87],v[16:19],a[136:139],a[84:87]
 v_exp_f32 v102,v102
 mf a[84:87],v[20:23],a[140:143],a[84:87]
 rt a[156:157],v219 offset:8192
 mf a[80:83],v[4:7],a[140:143],a[80:83]
 v_exp_f32 v103,v103
 mf a[80:83],v[0:3],a[136:139],a[80:83]
 s_waitcnt lgkmcnt(3)
 rt a[158:159],v219 offset:12288
 pk v99,v102,v103
 mf a[96:99],v[0:3],a[144:147],a[96:99]
 v_exp_f32 v112,v112
 mf a[96:99],v[4:7],a[148:151],a[96:99]
 mf a[100:103],v[20:23],a[148:151],a[100:103]
 v_exp_f32 v113,v113
 mf a[100:103],v[16:19],a[144:147],a[100:103]
 pk v112,v112,v113
 mf a[104:107],v[32:35],a[144:147],a[104:107]
 s_add_u32 s64,s69,20987904
 v_exp_f32 v114,v114
 mf a[104:107],v[36:39],a[148:151],a[104:107]
 bl a[176:179],v255,s[16:19],s64 offen offset:0 sc1
 mf a[108:111],v[52:55],a[148:151],a[108:111]
 v_exp_f32 v115,v115
 mf a[108:111],v[48:51],a[144:147],a[108:111]
 s_waitcnt lgkmcnt(0)
 rq a[128:131],v208 offset:32768
 pk v113,v114,v115
 mf a[124:127],v[48:51],a[152:155],a[124:127]
 v_exp_f32 v116,v116
 mf a[124:127],v[52:55],a[156:159],a[124:127]
 rq a[132:135],v209 offset:32768
 mf a[120:123],v[36:39],a[156:159],a[120:123]
 v_exp_f32 v117,v117
 mf a[120:123],v[32:35],a[152:155],a[120:123]
 rq a[136:139],v210 offset:32768
 pk v114,v116,v117
 mf a[116:119],v[16:19],a[152:155],a[116:119]
 v_exp_f32 v118,v118
 mf a[116:119],v[20:23],a[156:159],a[116:119]
 rq a[140:143],v211 offset:32768
 mf a[112:115],v[4:7],a[156:159],a[112:115]
 v_exp_f32 v119,v119
 mf a[112:115],v[0:3],a[152:155],a[112:115]
 pk v115,v118,v119
 v_smfmac_f32_16x16x64_bf16 a[192:195],a[208:211],v[0:7],v250
 v_smfmac_f32_16x16x64_bf16 a[196:199],a[208:211],v[16:23],v250
 v_smfmac_f32_16x16x64_bf16 a[200:203],a[208:211],v[32:39],v250
 s_barrier
 v_smfmac_f32_16x16x64_bf16 a[204:207],a[208:211],v[48:55],v250
 s_waitcnt lgkmcnt(0)
 mf v[0:3],a[128:131],v[128:131],v[192:195]
 v_exp_f32 v72,v72
 mf v[0:3],a[132:135],v[132:135],v[0:3]
 s_add_u32 m0,s62,65536
 v_exp_f32 v73,v73
 mf v[0:3],a[136:139],v[136:139],v[0:3]
 s_mov_b32 s63,0
 rq a[144:147],v208 offset:36864
 mf v[0:3],a[140:143],v[140:143],v[0:3]
 bl v238,s[24:27],s63 offen offset:0 lds
 mf v[16:19],a[140:143],v[156:159],v[196:199]
L_pad_pg24:
 s_cbranch_execz L_hop6
 rq a[148:151],v209 offset:36864
 pk v68,v72,v73
 mf v[16:19],a[136:139],v[152:155],v[16:19]
 v_exp_f32 v74,v74
 mf v[16:19],a[132:135],v[148:151],v[16:19]
 s_add_u32 s64,s69,20987904
 rq a[152:155],v210 offset:36864
 mf v[16:19],a[128:131],v[144:147],v[16:19]
 v_exp_f32 v75,v75
 mf v[32:35],a[128:131],v[160:163],v[200:203]
 rq a[156:159],v211 offset:36864
 pk v69,v74,v75
 mf v[32:35],a[132:135],v[164:167],v[32:35]
 v_exp_f32 v76,v76
 mf v[32:35],a[136:139],v[168:171],v[32:35]
 v_exp_f32 v77,v77
 mf v[32:35],a[140:143],v[172:175],v[32:35]
 bl a[180:183],v255,s[16:19],s64 offen offset:1024 sc1
 pk v70,v76,v77
 mf v[48:51],a[140:143],v[188:191],v[204:207]
 v_exp_f32 v78,v78
 mf v[48:51],a[136:139],v[184:187],v[48:51]
 mf v[48:51],a[132:135],v[180:183],v[48:51]
 s_mov_b32 s63,7168
 v_exp_f32 v79,v79
 mf v[48:51],a[128:131],v[176:179],v[48:51]
 s_waitcnt lgkmcnt(0)
 pk v71,v78,v79
 mf v[52:55],a[144:147],v[176:179],v[204:207]
 v_exp_f32 v88,v88
 mf v[52:55],a[148:151],v[180:183],v[52:55]
 v_exp_f32 v89,v89
 mf v[52:55],a[152:155],v[184:187],v[52:55]
 rq a[128:131],v208 offset:40960
 mf v[52:55],a[156:159],v[188:191],v[52:55]
 bl v238,s[24:27],s63 offen offset:1024 lds
 mf v[36:39],a[156:159],v[172:175],v[200:203]
 rq a[132:135],v209 offset:40960
 pk v84,v88,v89
 mf v[36:39],a[152:155],v[168:171],v[36:39]
 v_exp_f32 v90,v90
 mf v[36:39],a[148:151],v[164:167],v[36:39]
 rq a[136:139],v210 offset:40960
 mf v[36:39],a[144:147],v[160:163],v[36:39]
 v_exp_f32 v91,v91
 mf v[20:23],a[144:147],v[144:147],v[196:199]
 rq a[140:143],v211 offset:40960
 pk v85,v90,v91
 mf v[20:23],a[148:151],v[148:151],v[20:23]
 v_exp_f32 v92,v92
 mf v[20:23],a[152:155],v[152:155],v[20:23]
 v_exp_f32 v93,v93
 mf v[20:23],a[156:159],v[156:159],v[20:23]
 pk v86,v92,v93
 mf v[4:7],a[156:159],v[140:143],v[192:195]
 s_add_u32 s64,s69,20996096
 v_exp_f32 v94,v94
 mf v[4:7],a[152:155],v[136:139],v[4:7]
 bl a[184:187],v255,s[16:19],s64 offen offset:0 sc1
 mf v[4:7],a[148:151],v[132:135],v[4:7]
 s_mov_b32 s63,14336
 v_exp_f32 v95,v95
 mf v[4:7],a[144:147],v[128:131],v[4:7]
 s_waitcnt lgkmcnt(0)
 pk v87,v94,v95
 mf v[8:11],a[128:131],v[128:131],v[192:195]
 v_exp_f32 v104,v104
 mf v[8:11],a[132:135],v[132:135],v[8:11]
 v_exp_f32 v105,v105
 mf v[8:11],a[136:139],v[136:139],v[8:11]
 rq a[144:147],v208 offset:45056
 mf v[8:11],a[140:143],v[140:143],v[8:11]
 bl v238,s[24:27],s63 offen offset:2048 lds
 mf v[24:27],a[140:143],v[156:159],v[196:199]
 rq a[148:151],v209 offset:45056
 pk v100,v104,v105
 mf v[24:27],a[136:139],v[152:155],v[24:27]
 v_exp_f32 v106,v106
 mf v[24:27],a[132:135],v[148:151],v[24:27]
 rq a[152:155],v210 offset:45056
 mf v[24:27],a[128:131],v[144:147],v[24:27]
 v_exp_f32 v107,v107
 mf v[40:43],a[128:131],v[160:163],v[200:203]
 rq a[156:159],v211 offset:45056
 pk v101,v106,v107
 mf v[40:43],a[132:135],v[164:167],v[40:43]
 v_exp_f32 v108,v108
 mf v[40:43],a[136:139],v[168:171],v[40:43]
 v_exp_f32 v109,v109
 mf v[40:43],a[140:143],v[172:175],v[40:43]
 pk v102,v108,v109
 mf v[56:59],a[140:143],v[188:191],v[204:207]
 v_exp_f32 v110,v110
 mf v[56:59],a[136:139],v[184:187],v[56:59]
 mf v[56:59],a[132:135],v[180:183],v[56:59]
 s_mov_b32 s63,21504
 v_exp_f32 v111,v111
 mf v[56:59],a[128:131],v[176:179],v[56:59]
 s_waitcnt lgkmcnt(0)
 rt a[130:131],v212 offset:20480
 pk v103,v110,v111
 mf v[60:63],a[144:147],v[176:179],v[204:207]
 v_exp_f32 v120,v120
 mf v[60:63],a[148:151],v[180:183],v[60:63]
 v_exp_f32 v121,v121
 mf v[60:63],a[152:155],v[184:187],v[60:63]
 rt a[128:129],v212 offset:16384
 rt a[132:133],v212 offset:24576
 mf v[60:63],a[156:159],v[188:191],v[60:63]
 bl v238,s[24:27],s63 offen offset:3072 lds
 mf v[44:47],a[156:159],v[172:175],v[200:203]
 s_add_u32 s64,s69,20996096
 rt a[134:135],v212 offset:28672
 pk v116,v120,v121
 mf v[44:47],a[152:155],v[168:171],v[44:47]
 v_exp_f32 v122,v122
 mf v[44:47],a[148:151],v[164:167],v[44:47]
 rt a[136:137],v213 offset:16384
 bl a[188:191],v255,s[16:19],s64 offen offset:1024 sc1
 mf v[44:47],a[144:147],v[160:163],v[44:47]
 v_exp_f32 v123,v123
 mf v[28:31],a[144:147],v[144:147],v[196:199]
 rt a[138:139],v213 offset:20480
 pk v117,v122,v123
 mf v[28:31],a[148:151],v[148:151],v[28:31]
 v_exp_f32 v124,v124
 mf v[28:31],a[152:155],v[152:155],v[28:31]
 v_exp_f32 v125,v125
 mf v[28:31],a[156:159],v[156:159],v[28:31]
 rt a[140:141],v213 offset:24576
 pk v118,v124,v125
 mf v[12:15],a[156:159],v[140:143],v[192:195]
 v_exp_f32 v126,v126
 mf v[12:15],a[152:155],v[136:139],v[12:15]
 rt a[142:143],v213 offset:28672
 mf v[12:15],a[148:151],v[132:135],v[12:15]
 v_exp_f32 v127,v127
 mf v[12:15],a[144:147],v[128:131],v[12:15]
 s_waitcnt lgkmcnt(4)
 rt a[148:149],v214 offset:24576
 pk v119,v126,v127
 mf a[0:3],v[64:67],a[128:131],a[0:3]
 v_exp_f32 v0,v0
 mf a[0:3],v[68:71],a[132:135],a[0:3]
 v_exp_f32 v1,v1
 mf a[4:7],v[84:87],a[132:135],a[4:7]
 rt a[150:151],v214 offset:28672
 pk v0,v0,v1
 mf a[4:7],v[80:83],a[128:131],a[4:7]
 v_exp_f32 v2,v2
 mf a[8:11],v[96:99],a[128:131],a[8:11]
 rt a[146:147],v214 offset:20480
 rt a[152:153],v215 offset:16384
 mf a[8:11],v[100:103],a[132:135],a[8:11]
 v_exp_f32 v3,v3
 mf a[12:15],v[116:119],a[132:135],a[12:15]
 rt a[154:155],v215 offset:20480
 pk v1,v2,v3
 mf a[12:15],v[112:115],a[128:131],a[12:15]
 s_waitcnt lgkmcnt(5)
 v_exp_f32 v4,v4
 mf a[28:31],v[112:115],a[136:139],a[28:31]
 s_add_u32 s64,s69,21004288
 v_exp_f32 v5,v5
 mf a[28:31],v[116:119],a[140:143],a[28:31]
 s_add_u32 m0,s62,69632
 rt a[156:157],v215 offset:24576
 pk v2,v4,v5
 mf a[24:27],v[100:103],a[140:143],a[24:27]
 s_mov_b32 s63,131072
 rt a[144:145],v214 offset:16384
 rt a[158:159],v215 offset:28672
 mf a[24:27],v[96:99],a[136:139],a[24:27]
 bl v238,s[24:27],s63 offen offset:0 lds
 mf a[20:23],v[80:83],a[136:139],a[20:23]
 v_exp_f32 v6,v6
 mf a[20:23],v[84:87],a[140:143],a[20:23]
 rt a[128:129],v216 offset:16384
 bl a[212:215],v255,s[16:19],s64 offen offset:0 sc1
 mf a[16:19],v[68:71],a[140:143],a[16:19]
 v_exp_f32 v7,v7
 mf a[16:19],v[64:67],a[136:139],a[16:19]
 s_waitcnt lgkmcnt(2)
 rt a[130:131],v216 offset:20480
 pk v3,v6,v7
 mf a[32:35],v[64:67],a[144:147],a[32:35]
 v_exp_f32 v16,v16
 mf a[32:35],v[68:71],a[148:151],a[32:35]
 rt a[132:133],v216 offset:24576
 mf a[36:39],v[84:87],a[148:151],a[36:39]
 v_exp_f32 v17,v17
 mf a[36:39],v[80:83],a[144:147],a[36:39]
 v_exp_f32 v18,v18
 mf a[40:43],v[96:99],a[144:147],a[40:43]
 rt a[134:135],v216 offset:28672
 pk v16,v16,v17
 mf a[40:43],v[100:103],a[148:151],a[40:43]
 v_exp_f32 v19,v19
 mf a[44:47],v[116:119],a[148:151],a[44:47]
 rt a[136:137],v217 offset:16384
 pk v17,v18,v19
 mf a[44:47],v[112:115],a[144:147],a[44:47]
 s_waitcnt lgkmcnt(5)
 v_exp_f32 v20,v20
 mf a[60:63],v[112:115],a[152:155],a[60:63]
 rt a[138:139],v217 offset:20480
 mf a[60:63],v[116:119],a[156:159],a[60:63]
 v_exp_f32 v21,v21
 mf a[56:59],v[100:103],a[156:159],a[56:59]
 s_mov_b32 s63,138240
 rt a[140:141],v217 offset:24576
 mf a[56:59],v[96:99],a[152:155],a[56:59]
 bl v238,s[24:27],s63 offen offset:1024 lds
 mf a[52:55],v[80:83],a[152:155],a[52:55]
 v_exp_f32 v22,v22
 mf a[52:55],v[84:87],a[156:159],a[52:55]
 rt a[142:143],v217 offset:28672
 pk v18,v20,v21
 mf a[48:51],v[68:71],a[156:159],a[48:51]
 s_add_u32 s64,s69,21004288
 v_exp_f32 v23,v23
 mf a[48:51],v[64:67],a[152:155],a[48:51]
 s_waitcnt lgkmcnt(4)
 rt a[144:145],v218 offset:16384
 pk v19,v22,v23
 mf a[64:67],v[64:67],a[128:131],a[64:67]
 v_exp_f32 v32,v32
 mf a[64:67],v[68:71],a[132:135],a[64:67]
 rt a[146:147],v218 offset:20480
 bl a[216:219],v255,s[16:19],s64 offen offset:1024 sc1
 mf a[68:71],v[84:87],a[132:135],a[68:71]
 v_exp_f32 v33,v33
 mf a[68:71],v[80:83],a[128:131],a[68:71]
 rt a[148:149],v218 offset:24576
 pk v32,v32,v33
 mf a[72:75],v[96:99],a[128:131],a[72:75]
 v_exp_f32 v34,v34
 mf a[72:75],v[100:103],a[132:135],a[72:75]
 v_exp_f32 v35,v35
 mf a[76:79],v[116:119],a[132:135],a[76:79]
 rt a[150:151],v218 offset:28672
 pk v33,v34,v35
 mf a[76:79],v[112:115],a[128:131],a[76:79]
 s_waitcnt lgkmcnt(4)
 v_exp_f32 v36,v36
 mf a[92:95],v[112:115],a[136:139],a[92:95]
 rt a[152:153],v219 offset:16384
 mf a[92:95],v[116:119],a[140:143],a[92:95]
 v_exp_f32 v37,v37
 mf a[88:91],v[100:103],a[140:143],a[88:91]
 s_mov_b32 s63,145408
 rt a[154:155],v219 offset:20480
 mf a[88:91],v[96:99],a[136:139],a[88:91]
 bl v238,s[24:27],s63 offen offset:2048 lds
 mf a[84:87],v[80:83],a[136:139],a[84:87]
 rt a[156:157],v219 offset:24576
 pk v34,v36,v37
 mf a[84:87],v[84:87],a[140:143],a[84:87]
 v_exp_f32 v38,v38
 mf a[80:83],v[68:71],a[140:143],a[80:83]
 v_exp_f32 v39,v39
 mf a[80:83],v[64:67],a[136:139],a[80:83]
 s_waitcnt lgkmcnt(3)
 rt a[158:159],v219 offset:28672
 pk v35,v38,v39
 mf a[96:99],v[64:67],a[144:147],a[96:99]
 v_exp_f32 v48,v48
 mf a[96:99],v[68:71],a[148:151],a[96:99]
 mf a[100:103],v[84:87],a[148:151],a[100:103]
 v_exp_f32 v49,v49
 mf a[100:103],v[80:83],a[144:147],a[100:103]
 pk v48,v48,v49
 mf a[104:107],v[96:99],a[144:147],a[104:107]
 s_add_u32 s64,s69,21012480
 v_exp_f32 v50,v50
 mf a[104:107],v[100:103],a[148:151],a[104:107]
 rq a[128:131],v208 offset:49152
 bl a[220:223],v255,s[16:19],s64 offen offset:0 sc1
 mf a[108:111],v[116:119],a[148:151],a[108:111]
 v_exp_f32 v51,v51
 mf a[108:111],v[112:115],a[144:147],a[108:111]
 s_waitcnt lgkmcnt(1)
 v_exp_f32 v52,v52
 mf a[124:127],v[112:115],a[152:155],a[124:127]
 rq a[132:135],v209 offset:49152
 pk v49,v50,v51
 mf a[124:127],v[116:119],a[156:159],a[124:127]
 v_exp_f32 v53,v53
 mf a[120:123],v[100:103],a[156:159],a[120:123]
 s_mov_b32 s63,152576
 rq a[136:139],v210 offset:49152
 mf a[120:123],v[96:99],a[152:155],a[120:123]
 bl v238,s[24:27],s63 offen offset:3072 lds
 mf a[116:119],v[80:83],a[152:155],a[116:119]
 rq a[140:143],v211 offset:49152
 pk v50,v52,v53
 mf a[116:119],v[84:87],a[156:159],a[116:119]
 v_exp_f32 v54,v54
 mf a[112:115],v[68:71],a[156:159],a[112:115]
 mf a[112:115],v[64:67],a[152:155],a[112:115]
 v_exp_f32 v55,v55
 v_smfmac_f32_16x16x64_bf16 a[192:195],a[208:211],v[64:71],v250
 pk v51,v54,v55
 v_smfmac_f32_16x16x64_bf16 a[196:199],a[208:211],v[80:87],v250
 s_waitcnt vmcnt(18)
 v_smfmac_f32_16x16x64_bf16 a[200:203],a[208:211],v[96:103],v250
 s_barrier
 v_smfmac_f32_16x16x64_bf16 a[204:207],a[208:211],v[112:119],v250
 s_waitcnt lgkmcnt(0)
 mf v[64:67],a[128:131],v[128:131],v[192:195]
 v_exp_f32 v8,v8
 mf v[64:67],a[132:135],v[132:135],v[64:67]
 s_add_u32 m0,s62,0
 v_exp_f32 v9,v9
 mf v[64:67],a[136:139],v[136:139],v[64:67]
 s_mov_b32 s63,262144
 rq a[144:147],v208 offset:53248
 mf v[64:67],a[140:143],v[140:143],v[64:67]
 bl v238,s[24:27],s63 offen offset:0 lds
 mf v[80:83],a[140:143],v[156:159],v[196:199]
 rq a[148:151],v209 offset:53248
 pk v4,v8,v9
 mf v[80:83],a[136:139],v[152:155],v[80:83]
 v_exp_f32 v10,v10
 mf v[80:83],a[132:135],v[148:151],v[80:83]
 s_add_u32 s64,s69,21012480
 rq a[152:155],v210 offset:53248
 mf v[80:83],a[128:131],v[144:147],v[80:83]
 v_exp_f32 v11,v11
 mf v[96:99],a[128:131],v[160:163],v[200:203]
 rq a[156:159],v211 offset:53248
 pk v5,v10,v11
 mf v[96:99],a[132:135],v[164:167],v[96:99]
 v_exp_f32 v12,v12
 mf v[96:99],a[136:139],v[168:171],v[96:99]
 v_exp_f32 v13,v13
 mf v[96:99],a[140:143],v[172:175],v[96:99]
 bl a[224:227],v255,s[16:19],s64 offen offset:1024 sc1
 pk v6,v12,v13
 mf v[112:115],a[140:143],v[188:191],v[204:207]
 v_exp_f32 v14,v14
 mf v[112:115],a[136:139],v[184:187],v[112:115]
 mf v[112:115],a[132:135],v[180:183],v[112:115]
 s_mov_b32 s63,269312
 v_exp_f32 v15,v15
 mf v[112:115],a[128:131],v[176:179],v[112:115]
 s_waitcnt lgkmcnt(0)
 pk v7,v14,v15
 mf v[116:119],a[144:147],v[176:179],v[204:207]
 v_exp_f32 v24,v24
 mf v[116:119],a[148:151],v[180:183],v[116:119]
 v_exp_f32 v25,v25
 mf v[116:119],a[152:155],v[184:187],v[116:119]
 rq a[128:131],v208 offset:57344
 mf v[116:119],a[156:159],v[188:191],v[116:119]
 bl v238,s[24:27],s63 offen offset:1024 lds
 mf v[100:103],a[156:159],v[172:175],v[200:203]
 rq a[132:135],v209 offset:57344
 pk v20,v24,v25
 mf v[100:103],a[152:155],v[168:171],v[100:103]
 v_exp_f32 v26,v26
 mf v[100:103],a[148:151],v[164:167],v[100:103]
 rq a[136:139],v210 offset:57344
 mf v[100:103],a[144:147],v[160:163],v[100:103]
 v_exp_f32 v27,v27
 mf v[84:87],a[144:147],v[144:147],v[196:199]
 rq a[140:143],v211 offset:57344
 pk v21,v26,v27
 mf v[84:87],a[148:151],v[148:151],v[84:87]
 v_exp_f32 v28,v28
 mf v[84:87],a[152:155],v[152:155],v[84:87]
 v_exp_f32 v29,v29
 mf v[84:87],a[156:159],v[156:159],v[84:87]
 pk v22,v28,v29
 mf v[68:71],a[156:159],v[140:143],v[192:195]
 s_add_u32 s64,s69,21020672
 v_exp_f32 v30,v30
 mf v[68:71],a[152:155],v[136:139],v[68:71]
 bl a[228:231],v255,s[16:19],s64 offen offset:0 sc1
 mf v[68:71],a[148:151],v[132:135],v[68:71]
 s_mov_b32 s63,276480
 v_exp_f32 v31,v31
 mf v[68:71],a[144:147],v[128:131],v[68:71]
 s_waitcnt lgkmcnt(0)
 pk v23,v30,v31
 mf v[72:75],a[128:131],v[128:131],v[192:195]
 v_exp_f32 v40,v40
 mf v[72:75],a[132:135],v[132:135],v[72:75]
 v_exp_f32 v41,v41
 mf v[72:75],a[136:139],v[136:139],v[72:75]
 rq a[144:147],v208 offset:61440
 mf v[72:75],a[140:143],v[140:143],v[72:75]
 bl v238,s[24:27],s63 offen offset:2048 lds
 mf v[88:91],a[140:143],v[156:159],v[196:199]
 rq a[148:151],v209 offset:61440
 pk v36,v40,v41
 mf v[88:91],a[136:139],v[152:155],v[88:91]
 v_exp_f32 v42,v42
 mf v[88:91],a[132:135],v[148:151],v[88:91]
 rq a[152:155],v210 offset:61440
 mf v[88:91],a[128:131],v[144:147],v[88:91]
 v_exp_f32 v43,v43
 mf v[104:107],a[128:131],v[160:163],v[200:203]
 rq a[156:159],v211 offset:61440
 pk v37,v42,v43
 mf v[104:107],a[132:135],v[164:167],v[104:107]
 v_exp_f32 v44,v44
 mf v[104:107],a[136:139],v[168:171],v[104:107]
 v_exp_f32 v45,v45
 mf v[104:107],a[140:143],v[172:175],v[104:107]
 pk v38,v44,v45
 mf v[120:123],a[140:143],v[188:191],v[204:207]
 v_exp_f32 v46,v46
 mf v[120:123],a[136:139],v[184:187],v[120:123]
 mf v[120:123],a[132:135],v[180:183],v[120:123]
 s_mov_b32 s63,283648
 v_exp_f32 v47,v47
 mf v[120:123],a[128:131],v[176:179],v[120:123]
 s_waitcnt lgkmcnt(0)
 rt a[130:131],v212 offset:36864
 pk v39,v46,v47
 mf v[124:127],a[144:147],v[176:179],v[204:207]
 v_exp_f32 v56,v56
 mf v[124:127],a[148:151],v[180:183],v[124:127]
 v_exp_f32 v57,v57
 mf v[124:127],a[152:155],v[184:187],v[124:127]
 rt a[128:129],v212 offset:32768
 rt a[132:133],v212 offset:40960
 mf v[124:127],a[156:159],v[188:191],v[124:127]
 bl v238,s[24:27],s63 offen offset:3072 lds
 mf v[108:111],a[156:159],v[172:175],v[200:203]
 s_add_u32 s64,s69,21020672
 rt a[134:135],v212 offset:45056
 pk v52,v56,v57
 mf v[108:111],a[152:155],v[168:171],v[108:111]
 v_exp_f32 v58,v58
 mf v[108:111],a[148:151],v[164:167],v[108:111]
 rt a[136:137],v213 offset:32768
 bl a[232:235],v255,s[16:19],s64 offen offset:1024 sc1
 mf v[108:111],a[144:147],v[160:163],v[108:111]
 v_exp_f32 v59,v59
 mf v[92:95],a[144:147],v[144:147],v[196:199]
 rt a[138:139],v213 offset:36864
 pk v53,v58,v59
 mf v[92:95],a[148:151],v[148:151],v[92:95]
 v_exp_f32 v60,v60
 mf v[92:95],a[152:155],v[152:155],v[92:95]
 v_exp_f32 v61,v61
 mf v[92:95],a[156:159],v[156:159],v[92:95]
 rt a[140:141],v213 offset:40960
 pk v54,v60,v61
 mf v[76:79],a[156:159],v[140:143],v[192:195]
 v_exp_f32 v62,v62
 mf v[76:79],a[152:155],v[136:139],v[76:79]
 rt a[142:143],v213 offset:45056
 mf v[76:79],a[148:151],v[132:135],v[76:79]
 v_exp_f32 v63,v63
 mf v[76:79],a[144:147],v[128:131],v[76:79]
 s_waitcnt lgkmcnt(4)
 rt a[148:149],v214 offset:40960
 pk v55,v62,v63
 mf a[0:3],v[0:3],a[128:131],a[0:3]
 v_exp_f32 v64,v64
 mf a[0:3],v[4:7],a[132:135],a[0:3]
 v_exp_f32 v65,v65
 mf a[4:7],v[20:23],a[132:135],a[4:7]
 rt a[150:151],v214 offset:45056
 pk v64,v64,v65
 mf a[4:7],v[16:19],a[128:131],a[4:7]
 v_exp_f32 v66,v66
 mf a[8:11],v[32:35],a[128:131],a[8:11]
 rt a[146:147],v214 offset:36864
 rt a[152:153],v215 offset:32768
 mf a[8:11],v[36:39],a[132:135],a[8:11]
 v_exp_f32 v67,v67
 mf a[12:15],v[52:55],a[132:135],a[12:15]
 rt a[154:155],v215 offset:36864
 pk v65,v66,v67
 mf a[12:15],v[48:51],a[128:131],a[12:15]
 s_waitcnt lgkmcnt(5)
 v_exp_f32 v68,v68
 mf a[28:31],v[48:51],a[136:139],a[28:31]
 s_add_u32 s64,s69,21028864
 v_exp_f32 v69,v69
 mf a[28:31],v[52:55],a[140:143],a[28:31]
 s_add_u32 m0,s62,4096
 rt a[156:157],v215 offset:40960
 pk v66,v68,v69
 mf a[24:27],v[36:39],a[140:143],a[24:27]
 s_mov_b32 s63,393216
 rt a[144:145],v214 offset:32768
 rt a[158:159],v215 offset:45056
 mf a[24:27],v[32:35],a[136:139],a[24:27]
 bl v238,s[24:27],s63 offen offset:0 lds
 mf a[20:23],v[16:19],a[136:139],a[20:23]
 v_exp_f32 v70,v70
 mf a[20:23],v[20:23],a[140:143],a[20:23]
 rt a[128:129],v216 offset:32768
 bl a[236:239],v255,s[16:19],s64 offen offset:0 sc1
 mf a[16:19],v[4:7],a[140:143],a[16:19]
 v_exp_f32 v71,v71
 mf a[16:19],v[0:3],a[136:139],a[16:19]
 s_waitcnt lgkmcnt(2)
 rt a[130:131],v216 offset:36864
 pk v67,v70,v71
 mf a[32:35],v[0:3],a[144:147],a[32:35]
 v_exp_f32 v80,v80
 mf a[32:35],v[4:7],a[148:151],a[32:35]
 rt a[132:133],v216 offset:40960
 mf a[36:39],v[20:23],a[148:151],a[36:39]
 v_exp_f32 v81,v81
 mf a[36:39],v[16:19],a[144:147],a[36:39]
 v_exp_f32 v82,v82
 mf a[40:43],v[32:35],a[144:147],a[40:43]
 rt a[134:135],v216 offset:45056
 pk v80,v80,v81
 mf a[40:43],v[36:39],a[148:151],a[40:43]
 v_exp_f32 v83,v83
 mf a[44:47],v[52:55],a[148:151],a[44:47]
 rt a[136:137],v217 offset:32768
 pk v81,v82,v83
 mf a[44:47],v[48:51],a[144:147],a[44:47]
 s_waitcnt lgkmcnt(5)
 v_exp_f32 v84,v84
 mf a[60:63],v[48:51],a[152:155],a[60:63]
 rt a[138:139],v217 offset:36864
 mf a[60:63],v[52:55],a[156:159],a[60:63]
 v_exp_f32 v85,v85
 mf a[56:59],v[36:39],a[156:159],a[56:59]
 s_mov_b32 s63,400384
 rt a[140:141],v217 offset:40960
 mf a[56:59],v[32:35],a[152:155],a[56:59]
 bl v238,s[24:27],s63 offen offset:1024 lds
 mf a[52:55],v[16:19],a[152:155],a[52:55]
 v_exp_f32 v86,v86
 mf a[52:55],v[20:23],a[156:159],a[52:55]
 rt a[142:143],v217 offset:45056
 pk v82,v84,v85
 mf a[48:51],v[4:7],a[156:159],a[48:51]
 s_add_u32 s64,s69,21028864
 v_exp_f32 v87,v87
 mf a[48:51],v[0:3],a[152:155],a[48:51]
 s_waitcnt lgkmcnt(4)
 rt a[144:145],v218 offset:32768
 pk v83,v86,v87
 mf a[64:67],v[0:3],a[128:131],a[64:67]
 v_exp_f32 v96,v96
 mf a[64:67],v[4:7],a[132:135],a[64:67]
 rt a[146:147],v218 offset:36864
 bl a[240:243],v255,s[16:19],s64 offen offset:1024 sc1
 mf a[68:71],v[20:23],a[132:135],a[68:71]
 v_exp_f32 v97,v97
 mf a[68:71],v[16:19],a[128:131],a[68:71]
 rt a[148:149],v218 offset:40960
 pk v96,v96,v97
 mf a[72:75],v[32:35],a[128:131],a[72:75]
 v_exp_f32 v98,v98
 mf a[72:75],v[36:39],a[132:135],a[72:75]
 v_exp_f32 v99,v99
 mf a[76:79],v[52:55],a[132:135],a[76:79]
 rt a[150:151],v218 offset:45056
 pk v97,v98,v99
 mf a[76:79],v[48:51],a[128:131],a[76:79]
 s_waitcnt lgkmcnt(4)
 v_exp_f32 v100,v100
 mf a[92:95],v[48:51],a[136:139],a[92:95]
 rt a[152:153],v219 offset:32768
 mf a[92:95],v[52:55],a[140:143],a[92:95]
 v_exp_f32 v101,v101
 mf a[88:91],v[36:39],a[140:143],a[88:91]
 s_mov_b32 s63,407552
 rt a[154:155],v219 offset:36864
 mf a[88:91],v[32:35],a[136:139],a[88:91]
 bl v238,s[24:27],s63 offen offset:2048 lds
 mf a[84:87],v[16:19],a[136:139],a[84:87]
 rt a[156:157],v219 offset:40960
 pk v98,v100,v101
 mf a[84:87],v[20:23],a[140:143],a[84:87]
 v_exp_f32 v102,v102
 mf a[80:83],v[4:7],a[140:143],a[80:83]
 v_exp_f32 v103,v103
 mf a[80:83],v[0:3],a[136:139],a[80:83]
 s_waitcnt lgkmcnt(3)
 rt a[158:159],v219 offset:45056
 pk v99,v102,v103
 mf a[96:99],v[0:3],a[144:147],a[96:99]
L_pad_pg25:
 s_cbranch_execz L_hop6
 v_exp_f32 v112,v112
 mf a[96:99],v[4:7],a[148:151],a[96:99]
 mf a[100:103],v[20:23],a[148:151],a[100:103]
 v_exp_f32 v113,v113
 mf a[100:103],v[16:19],a[144:147],a[100:103]
 pk v112,v112,v113
 mf a[104:107],v[32:35],a[144:147],a[104:107]
 v_exp_f32 v114,v114
 mf a[104:107],v[36:39],a[148:151],a[104:107]
 mf a[108:111],v[52:55],a[148:151],a[108:111]
 v_exp_f32 v115,v115
 mf a[108:111],v[48:51],a[144:147],a[108:111]
 s_waitcnt lgkmcnt(0)
 v_exp_f32 v116,v116
 mf a[124:127],v[48:51],a[152:155],a[124:127]
 rt a[128:129],v212 offset:49152
 pk v113,v114,v115
 mf a[124:127],v[52:55],a[156:159],a[124:127]
 v_exp_f32 v117,v117
 mf a[120:123],v[36:39],a[156:159],a[120:123]
 s_mov_b32 s63,414720
 rt a[130:131],v212 offset:53248
 mf a[120:123],v[32:35],a[152:155],a[120:123]
 bl v238,s[24:27],s63 offen offset:3072 lds
 mf a[116:119],v[16:19],a[152:155],a[116:119]
 rt a[132:133],v213 offset:49152
 pk v114,v116,v117
 mf a[116:119],v[20:23],a[156:159],a[116:119]
 v_exp_f32 v118,v118
 mf a[112:115],v[4:7],a[156:159],a[112:115]
 rt a[134:135],v213 offset:53248
 mf a[112:115],v[0:3],a[152:155],a[112:115]
 v_exp_f32 v119,v119
 v_smfmac_f32_16x16x64_bf16 a[192:195],a[208:211],v[0:7],v250
 s_mov_b64 exec,0
 s_cmp_eq_u32 s54,0
 s_cbranch_scc1 L_pad_pg26
 s_cmp_eq_u32 s54,1
 s_cbranch_scc1 L_pad_pg27
 s_cmp_eq_u32 s54,2
 s_cbranch_scc1 L_pad_pg28
 s_branch L_pad_pg29
L_hop7:
 s_mov_b64 exec,-1
 pk v115,v118,v119
 v_smfmac_f32_16x16x64_bf16 a[196:199],a[208:211],v[16:23],v250
 rt a[136:137],v214 offset:49152
 v_smfmac_f32_16x16x64_bf16 a[200:203],a[208:211],v[32:39],v250
 s_barrier
 rt a[138:139],v214 offset:53248
 v_smfmac_f32_16x16x64_bf16 a[204:207],a[208:211],v[48:55],v250
 s_waitcnt lgkmcnt(4)
 mf a[0:3],v[64:67],a[128:131],a[0:3]
 v_exp_f32 v72,v72
 mf a[4:7],v[80:83],a[128:131],a[4:7]
 rt a[140:141],v215 offset:49152
 v_exp_f32 v73,v73
 mf a[8:11],v[96:99],a[128:131],a[8:11]
 rt a[142:143],v215 offset:53248
 v_exp_f32 v74,v74
 pk v68,v72,v73
 mf a[12:15],v[112:115],a[128:131],a[12:15]
 s_waitcnt lgkmcnt(4)
 v_exp_f32 v75,v75
 mf a[28:31],v[112:115],a[132:135],a[28:31]
 v_exp_f32 v76,v76
 pk v69,v74,v75
 mf a[24:27],v[96:99],a[132:135],a[24:27]
 rt a[144:145],v216 offset:49152
 v_exp_f32 v77,v77
 mf a[20:23],v[80:83],a[132:135],a[20:23]
 rt a[146:147],v216 offset:53248
 v_exp_f32 v78,v78
 pk v70,v76,v77
 mf a[16:19],v[64:67],a[132:135],a[16:19]
 s_waitcnt lgkmcnt(4)
 v_exp_f32 v79,v79
 mf a[32:35],v[64:67],a[136:139],a[32:35]
 v_exp_f32 v88,v88
 pk v71,v78,v79
 mf a[36:39],v[80:83],a[136:139],a[36:39]
 rt a[148:149],v217 offset:49152
 v_exp_f32 v89,v89
 mf a[40:43],v[96:99],a[136:139],a[40:43]
 rt a[150:151],v217 offset:53248
 v_exp_f32 v90,v90
 pk v84,v88,v89
 mf a[44:47],v[112:115],a[136:139],a[44:47]
 s_waitcnt lgkmcnt(4)
 v_exp_f32 v91,v91
 mf a[60:63],v[112:115],a[140:143],a[60:63]
 v_exp_f32 v92,v92
 pk v85,v90,v91
 mf a[56:59],v[96:99],a[140:143],a[56:59]
 rt a[152:153],v218 offset:49152
 v_exp_f32 v93,v93
 mf a[52:55],v[80:83],a[140:143],a[52:55]
 rt a[154:155],v218 offset:53248
 v_exp_f32 v94,v94
 pk v86,v92,v93
 mf a[48:51],v[64:67],a[140:143],a[48:51]
 s_waitcnt lgkmcnt(4)
 v_exp_f32 v95,v95
 mf a[64:67],v[64:67],a[144:147],a[64:67]
 v_exp_f32 v104,v104
 pk v87,v94,v95
 mf a[68:71],v[80:83],a[144:147],a[68:71]
 rt a[156:157],v219 offset:49152
 v_exp_f32 v105,v105
 mf a[72:75],v[96:99],a[144:147],a[72:75]
 rt a[158:159],v219 offset:53248
 v_exp_f32 v106,v106
 pk v100,v104,v105
 mf a[76:79],v[112:115],a[144:147],a[76:79]
 s_waitcnt lgkmcnt(4)
 v_exp_f32 v107,v107
 mf a[92:95],v[112:115],a[148:151],a[92:95]
 v_exp_f32 v108,v108
 pk v101,v106,v107
 mf a[88:91],v[96:99],a[148:151],a[88:91]
 v_exp_f32 v109,v109
 mf a[84:87],v[80:83],a[148:151],a[84:87]
 v_exp_f32 v110,v110
 pk v102,v108,v109
 mf a[80:83],v[64:67],a[148:151],a[80:83]
 s_waitcnt lgkmcnt(2)
 v_exp_f32 v111,v111
 mf a[96:99],v[64:67],a[152:155],a[96:99]
 v_exp_f32 v120,v120
 pk v103,v110,v111
 mf a[100:103],v[80:83],a[152:155],a[100:103]
 rt a[128:129],v212 offset:57344
 v_exp_f32 v121,v121
 mf a[104:107],v[96:99],a[152:155],a[104:107]
 rt a[130:131],v212 offset:61440
 v_exp_f32 v122,v122
 pk v116,v120,v121
 mf a[108:111],v[112:115],a[152:155],a[108:111]
 s_waitcnt lgkmcnt(2)
 v_exp_f32 v123,v123
 mf a[124:127],v[112:115],a[156:159],a[124:127]
 v_exp_f32 v124,v124
 pk v117,v122,v123
 mf a[120:123],v[96:99],a[156:159],a[120:123]
 rt a[132:133],v213 offset:57344
 v_exp_f32 v125,v125
 mf a[116:119],v[80:83],a[156:159],a[116:119]
 rt a[134:135],v213 offset:61440
 v_exp_f32 v126,v126
 pk v118,v124,v125
 mf a[112:115],v[64:67],a[156:159],a[112:115]
 v_exp_f32 v127,v127
 v_smfmac_f32_16x16x64_bf16 a[192:195],a[208:211],v[64:71],v250
 pk v119,v126,v127
 v_smfmac_f32_16x16x64_bf16 a[196:199],a[208:211],v[80:87],v250
 s_lshl_b32 s56,s54,2
 rt a[136:137],v214 offset:57344
 v_smfmac_f32_16x16x64_bf16 a[200:203],a[208:211],v[96:103],v250
 s_add_u32 s56,s56,98304
 rt a[138:139],v214 offset:61440
 v_smfmac_f32_16x16x64_bf16 a[204:207],a[208:211],v[112:119],v250
 s_waitcnt lgkmcnt(4)
 v_mov_b32 v60,0x5f800000
 mf a[0:3],v[68:71],a[128:131],a[0:3]
 v_mov_b32 v61,s56
 v_mov_b32 v62,98304
 mf a[4:7],v[84:87],a[128:131],a[4:7]
 rt a[140:141],v215 offset:57344
 mf a[8:11],v[100:103],a[128:131],a[8:11]
 rt a[142:143],v215 offset:61440
 v_accvgpr_read_b32 v40,a192
 mf a[12:15],v[116:119],a[128:131],a[12:15]
 s_waitcnt lgkmcnt(4)
 v_accvgpr_read_b32 v41,a193
 v_accvgpr_read_b32 v42,a196
 mf a[28:31],v[116:119],a[132:135],a[28:31]
 v_accvgpr_read_b32 v43,a197
 v_accvgpr_read_b32 v44,a200
 mf a[24:27],v[100:103],a[132:135],a[24:27]
 rt a[144:145],v216 offset:57344
 v_accvgpr_read_b32 v45,a201
 mf a[20:23],v[84:87],a[132:135],a[20:23]
 rt a[146:147],v216 offset:61440
 v_accvgpr_read_b32 v46,a204
 mf a[16:19],v[68:71],a[132:135],a[16:19]
 s_waitcnt lgkmcnt(4)
 v_accvgpr_read_b32 v47,a205
 v_add_f32 v40,v40,v41
 mf a[32:35],v[68:71],a[136:139],a[32:35]
 v_add_f32 v42,v42,v43
 v_add_f32 v44,v44,v45
 mf a[36:39],v[84:87],a[136:139],a[36:39]
 rt a[148:149],v217 offset:57344
 v_add_f32 v46,v46,v47
 mf a[40:43],v[100:103],a[136:139],a[40:43]
 rt a[150:151],v217 offset:61440
 v_maximum3_f32 v56,v40,v42,v44
 mf a[44:47],v[116:119],a[136:139],a[44:47]
 s_waitcnt lgkmcnt(4)
 v_maximum3_f32 v56,v56,v46,v46
 v_cmp_nle_f32 vcc,v56,v60
 mf a[60:63],v[116:119],a[140:143],a[60:63]
 s_nop 0
 s_cmp_lg_u64 vcc,0
 s_cselect_b32 s55,1,0
 v_mov_b32 v56,s55
 mf a[56:59],v[100:103],a[140:143],a[56:59]
 rt a[152:153],v218 offset:57344
 ds_write_b32 v61,v56
 mf a[52:55],v[84:87],a[140:143],a[52:55]
 rt a[154:155],v218 offset:61440
 v_bfe_u32 v48,v255,8,2
 mf a[48:51],v[68:71],a[140:143],a[48:51]
 s_waitcnt lgkmcnt(5)
 v_lshlrev_b32 v48,4,v48
 mf a[64:67],v[68:71],a[144:147],a[64:67]
 v_rcp_f32 v40,v40
 mf a[68:71],v[84:87],a[144:147],a[68:71]
 rt a[156:157],v219 offset:57344
 mf a[72:75],v[100:103],a[144:147],a[72:75]
 rt a[158:159],v219 offset:61440
 mf a[76:79],v[116:119],a[144:147],a[76:79]
 s_waitcnt lgkmcnt(5)
 v_rcp_f32 v42,v42
 mf a[92:95],v[116:119],a[148:151],a[92:95]
 v_rcp_f32 v44,v44
 mf a[88:91],v[100:103],a[148:151],a[88:91]
 v_rcp_f32 v46,v46
 mf a[84:87],v[84:87],a[148:151],a[84:87]
 s_waitcnt lgkmcnt(3)
 s_barrier
 rq v[56:59],v62
 mf a[80:83],v[68:71],a[148:151],a[80:83]
 s_waitcnt lgkmcnt(3)
 ds_bpermute_b32 v192,v48,v40 offset:0
 ds_bpermute_b32 v193,v48,v40 offset:4
 mf a[96:99],v[68:71],a[152:155],a[96:99]
 ds_bpermute_b32 v194,v48,v40 offset:8
 ds_bpermute_b32 v195,v48,v40 offset:12
 mf a[100:103],v[84:87],a[152:155],a[100:103]
 ds_bpermute_b32 v196,v48,v42 offset:0
 ds_bpermute_b32 v197,v48,v42 offset:4
 mf a[104:107],v[100:103],a[152:155],a[104:107]
 ds_bpermute_b32 v198,v48,v42 offset:8
 ds_bpermute_b32 v199,v48,v42 offset:12
 mf a[108:111],v[116:119],a[152:155],a[108:111]
 s_waitcnt lgkmcnt(9)
 ds_bpermute_b32 v200,v48,v44 offset:0
 ds_bpermute_b32 v201,v48,v44 offset:4
 mf a[124:127],v[116:119],a[156:159],a[124:127]
 ds_bpermute_b32 v202,v48,v44 offset:8
 ds_bpermute_b32 v203,v48,v44 offset:12
 mf a[120:123],v[100:103],a[156:159],a[120:123]
 ds_bpermute_b32 v204,v48,v46 offset:0
 ds_bpermute_b32 v205,v48,v46 offset:4
 mf a[116:119],v[84:87],a[156:159],a[116:119]
 ds_bpermute_b32 v206,v48,v46 offset:8
 ds_bpermute_b32 v207,v48,v46 offset:12
 mf a[112:115],v[68:71],a[156:159],a[112:115]
 s_waitcnt lgkmcnt(15)
 v_or3_b32 v56,v56,v57,v58
 v_or_b32 v56,v56,v59
 s_nop 0
 v_readfirstlane_b32 s55,v56
 s_nop 1
 s_cmp_lg_u32 s55,0
 s_cbranch_scc1 L_redo
L_att_done:
 v_xor_b32 v208,0,v234
 v_xor_b32 v212,0,v235
 v_xor_b32 v209,32,v234
 v_xor_b32 v213,32,v235
 v_xor_b32 v210,64,v234
 v_xor_b32 v214,64,v235
 v_xor_b32 v211,96,v234
 v_xor_b32 v215,96,v235
 v_accvgpr_read_b32 v0,a0
 v_accvgpr_read_b32 v1,a1
 v_accvgpr_read_b32 v2,a2
 v_accvgpr_read_b32 v3,a3
 v_accvgpr_read_b32 v4,a16
 v_accvgpr_read_b32 v5,a17
 v_accvgpr_read_b32 v6,a18
 v_accvgpr_read_b32 v7,a19
 s_waitcnt lgkmcnt(0)
 v_accvgpr_read_b32 v8,a4
 v_accvgpr_read_b32 v9,a5
 v_accvgpr_read_b32 v10,a6
 v_accvgpr_read_b32 v11,a7
 v_accvgpr_read_b32 v12,a20
 v_accvgpr_read_b32 v13,a21
 v_accvgpr_read_b32 v14,a22
 v_accvgpr_read_b32 v15,a23
 v_pk_mul_f32 v[0:1],v[0:1],v[192:193]
 v_pk_mul_f32 v[2:3],v[2:3],v[194:195]
 v_pk_mul_f32 v[4:5],v[4:5],v[192:193]
 v_pk_mul_f32 v[6:7],v[6:7],v[194:195]
 v_accvgpr_read_b32 v16,a8
 v_accvgpr_read_b32 v17,a9
 v_accvgpr_read_b32 v18,a10
 v_accvgpr_read_b32 v19,a11
 v_accvgpr_read_b32 v20,a24
 v_accvgpr_read_b32 v21,a25
 v_accvgpr_read_b32 v22,a26
 v_accvgpr_read_b32 v23,a27
 v_pk_mul_f32 v[8:9],v[8:9],v[196:197]
 v_pk_mul_f32 v[10:11],v[10:11],v[198:199]
 v_pk_mul_f32 v[12:13],v[12:13],v[196:197]
 v_pk_mul_f32 v[14:15],v[14:15],v[198:199]
 pk v0,v0,v1
 pk v1,v2,v3
 pk v2,v4,v5
 pk v3,v6,v7
 v_accvgpr_read_b32 v24,a12
 v_accvgpr_read_b32 v25,a13
 v_accvgpr_read_b32 v26,a14
 v_accvgpr_read_b32 v27,a15
 v_accvgpr_read_b32 v28,a28
 v_accvgpr_read_b32 v29,a29
 v_accvgpr_read_b32 v30,a30
 v_accvgpr_read_b32 v31,a31
 v_pk_mul_f32 v[16:17],v[16:17],v[200:201]
 v_pk_mul_f32 v[18:19],v[18:19],v[202:203]
 v_pk_mul_f32 v[20:21],v[20:21],v[200:201]
 v_pk_mul_f32 v[22:23],v[22:23],v[202:203]
 pk v8,v8,v9
 pk v9,v10,v11
 pk v10,v12,v13
 pk v11,v14,v15
 ds_write2st64_b64 v208,v[0:1],v[2:3] offset0:0 offset1:4
 v_accvgpr_read_b32 v32,a32
 v_accvgpr_read_b32 v33,a33
 v_accvgpr_read_b32 v34,a34
 v_accvgpr_read_b32 v35,a35
 v_accvgpr_read_b32 v36,a48
 v_accvgpr_read_b32 v37,a49
 v_accvgpr_read_b32 v38,a50
 v_accvgpr_read_b32 v39,a51
 v_pk_mul_f32 v[24:25],v[24:25],v[204:205]
 v_pk_mul_f32 v[26:27],v[26:27],v[206:207]
 v_pk_mul_f32 v[28:29],v[28:29],v[204:205]
 v_pk_mul_f32 v[30:31],v[30:31],v[206:207]
 pk v16,v16,v17
 pk v17,v18,v19
 pk v18,v20,v21
 pk v19,v22,v23
 ds_write2st64_b64 v209,v[8:9],v[10:11] offset0:0 offset1:4
 v_accvgpr_read_b32 v40,a36
 v_accvgpr_read_b32 v41,a37
 v_accvgpr_read_b32 v42,a38
 v_accvgpr_read_b32 v43,a39
 v_accvgpr_read_b32 v44,a52
 v_accvgpr_read_b32 v45,a53
 v_accvgpr_read_b32 v46,a54
 v_accvgpr_read_b32 v47,a55
 v_pk_mul_f32 v[32:33],v[32:33],v[192:193]
 v_pk_mul_f32 v[34:35],v[34:35],v[194:195]
 v_pk_mul_f32 v[36:37],v[36:37],v[192:193]
 v_pk_mul_f32 v[38:39],v[38:39],v[194:195]
 pk v24,v24,v25
 pk v25,v26,v27
 pk v26,v28,v29
 pk v27,v30,v31
 ds_write2st64_b64 v210,v[16:17],v[18:19] offset0:0 offset1:4
 v_accvgpr_read_b32 v48,a40
 v_accvgpr_read_b32 v49,a41
 v_accvgpr_read_b32 v50,a42
 v_accvgpr_read_b32 v51,a43
 v_accvgpr_read_b32 v52,a56
 v_accvgpr_read_b32 v53,a57
 v_accvgpr_read_b32 v54,a58
 v_accvgpr_read_b32 v55,a59
 v_pk_mul_f32 v[40:41],v[40:41],v[196:197]
 v_pk_mul_f32 v[42:43],v[42:43],v[198:199]
 v_pk_mul_f32 v[44:45],v[44:45],v[196:197]
 v_pk_mul_f32 v[46:47],v[46:47],v[198:199]
 pk v32,v32,v33
 pk v33,v34,v35
 pk v34,v36,v37
 pk v35,v38,v39
 ds_write2st64_b64 v211,v[24:25],v[26:27] offset0:0 offset1:4
 v_accvgpr_read_b32 v56,a44
 v_accvgpr_read_b32 v57,a45
 v_accvgpr_read_b32 v58,a46
 v_accvgpr_read_b32 v59,a47
 v_accvgpr_read_b32 v60,a60
 v_accvgpr_read_b32 v61,a61
 v_accvgpr_read_b32 v62,a62
 v_accvgpr_read_b32 v63,a63
 v_pk_mul_f32 v[48:49],v[48:49],v[200:201]
 v_pk_mul_f32 v[50:51],v[50:51],v[202:203]
 v_pk_mul_f32 v[52:53],v[52:53],v[200:201]
 v_pk_mul_f32 v[54:55],v[54:55],v[202:203]
 pk v40,v40,v41
 pk v41,v42,v43
 pk v42,v44,v45
 pk v43,v46,v47
 ds_write2st64_b64 v208,v[32:33],v[34:35] offset0:32 offset1:36
 v_accvgpr_read_b32 v0,a64
 v_accvgpr_read_b32 v1,a65
 v_accvgpr_read_b32 v2,a66
 v_accvgpr_read_b32 v3,a67
 v_accvgpr_read_b32 v4,a80
 v_accvgpr_read_b32 v5,a81
 v_accvgpr_read_b32 v6,a82
 v_accvgpr_read_b32 v7,a83
 v_pk_mul_f32 v[56:57],v[56:57],v[204:205]
 v_pk_mul_f32 v[58:59],v[58:59],v[206:207]
 v_pk_mul_f32 v[60:61],v[60:61],v[204:205]
 v_pk_mul_f32 v[62:63],v[62:63],v[206:207]
 pk v48,v48,v49
 pk v49,v50,v51
 pk v50,v52,v53
 pk v51,v54,v55
 ds_write2st64_b64 v209,v[40:41],v[42:43] offset0:32 offset1:36
 v_accvgpr_read_b32 v8,a68
 v_accvgpr_read_b32 v9,a69
 v_accvgpr_read_b32 v10,a70
 v_accvgpr_read_b32 v11,a71
 v_accvgpr_read_b32 v12,a84
 v_accvgpr_read_b32 v13,a85
 v_accvgpr_read_b32 v14,a86
 v_accvgpr_read_b32 v15,a87
 v_pk_mul_f32 v[0:1],v[0:1],v[192:193]
 v_pk_mul_f32 v[2:3],v[2:3],v[194:195]
 v_pk_mul_f32 v[4:5],v[4:5],v[192:193]
 v_pk_mul_f32 v[6:7],v[6:7],v[194:195]
 pk v56,v56,v57
 pk v57,v58,v59
 pk v58,v60,v61
 pk v59,v62,v63
 ds_write2st64_b64 v210,v[48:49],v[50:51] offset0:32 offset1:36
 v_accvgpr_read_b32 v16,a72
 v_accvgpr_read_b32 v17,a73
 v_accvgpr_read_b32 v18,a74
 v_accvgpr_read_b32 v19,a75
 v_accvgpr_read_b32 v20,a88
 v_accvgpr_read_b32 v21,a89
 v_accvgpr_read_b32 v22,a90
 v_accvgpr_read_b32 v23,a91
 v_pk_mul_f32 v[8:9],v[8:9],v[196:197]
 v_pk_mul_f32 v[10:11],v[10:11],v[198:199]
 v_pk_mul_f32 v[12:13],v[12:13],v[196:197]
 v_pk_mul_f32 v[14:15],v[14:15],v[198:199]
 pk v0,v0,v1
 pk v1,v2,v3
 pk v2,v4,v5
 pk v3,v6,v7
 ds_write2st64_b64 v211,v[56:57],v[58:59] offset0:32 offset1:36
 v_accvgpr_read_b32 v24,a76
 v_accvgpr_read_b32 v25,a77
 v_accvgpr_read_b32 v26,a78
 v_accvgpr_read_b32 v27,a79
 v_accvgpr_read_b32 v28,a92
 v_accvgpr_read_b32 v29,a93
 v_accvgpr_read_b32 v30,a94
 v_accvgpr_read_b32 v31,a95
 v_pk_mul_f32 v[16:17],v[16:17],v[200:201]
 v_pk_mul_f32 v[18:19],v[18:19],v[202:203]
 v_pk_mul_f32 v[20:21],v[20:21],v[200:201]
 v_pk_mul_f32 v[22:23],v[22:23],v[202:203]
 pk v8,v8,v9
 pk v9,v10,v11
 pk v10,v12,v13
 pk v11,v14,v15
 ds_write2st64_b64 v208,v[0:1],v[2:3] offset0:64 offset1:68
 v_accvgpr_read_b32 v32,a96
 v_accvgpr_read_b32 v33,a97
 v_accvgpr_read_b32 v34,a98
 v_accvgpr_read_b32 v35,a99
 v_accvgpr_read_b32 v36,a112
 v_accvgpr_read_b32 v37,a113
 v_accvgpr_read_b32 v38,a114
 v_accvgpr_read_b32 v39,a115
 v_pk_mul_f32 v[24:25],v[24:25],v[204:205]
 v_pk_mul_f32 v[26:27],v[26:27],v[206:207]
 v_pk_mul_f32 v[28:29],v[28:29],v[204:205]
 v_pk_mul_f32 v[30:31],v[30:31],v[206:207]
 pk v16,v16,v17
 pk v17,v18,v19
 pk v18,v20,v21
 pk v19,v22,v23
 ds_write2st64_b64 v209,v[8:9],v[10:11] offset0:64 offset1:68
 v_accvgpr_read_b32 v40,a100
 v_accvgpr_read_b32 v41,a101
 v_accvgpr_read_b32 v42,a102
 v_accvgpr_read_b32 v43,a103
 v_accvgpr_read_b32 v44,a116
 v_accvgpr_read_b32 v45,a117
 v_accvgpr_read_b32 v46,a118
 v_accvgpr_read_b32 v47,a119
 v_pk_mul_f32 v[32:33],v[32:33],v[192:193]
 v_pk_mul_f32 v[34:35],v[34:35],v[194:195]
 v_pk_mul_f32 v[36:37],v[36:37],v[192:193]
 v_pk_mul_f32 v[38:39],v[38:39],v[194:195]
 pk v24,v24,v25
 pk v25,v26,v27
 pk v26,v28,v29
 pk v27,v30,v31
 ds_write2st64_b64 v210,v[16:17],v[18:19] offset0:64 offset1:68
 v_accvgpr_read_b32 v48,a104
 v_accvgpr_read_b32 v49,a105
 v_accvgpr_read_b32 v50,a106
 v_accvgpr_read_b32 v51,a107
 v_accvgpr_read_b32 v52,a120
 v_accvgpr_read_b32 v53,a121
 v_accvgpr_read_b32 v54,a122
 v_accvgpr_read_b32 v55,a123
 v_pk_mul_f32 v[40:41],v[40:41],v[196:197]
 v_pk_mul_f32 v[42:43],v[42:43],v[198:199]
 v_pk_mul_f32 v[44:45],v[44:45],v[196:197]
 v_pk_mul_f32 v[46:47],v[46:47],v[198:199]
 pk v32,v32,v33
 pk v33,v34,v35
 pk v34,v36,v37
 pk v35,v38,v39
 ds_write2st64_b64 v211,v[24:25],v[26:27] offset0:64 offset1:68
 v_accvgpr_read_b32 v56,a108
 v_accvgpr_read_b32 v57,a109
 v_accvgpr_read_b32 v58,a110
 v_accvgpr_read_b32 v59,a111
 v_accvgpr_read_b32 v60,a124
 v_accvgpr_read_b32 v61,a125
 v_accvgpr_read_b32 v62,a126
 v_accvgpr_read_b32 v63,a127
 v_pk_mul_f32 v[48:49],v[48:49],v[200:201]
 v_pk_mul_f32 v[50:51],v[50:51],v[202:203]
 v_pk_mul_f32 v[52:53],v[52:53],v[200:201]
 v_pk_mul_f32 v[54:55],v[54:55],v[202:203]
 pk v40,v40,v41
 pk v41,v42,v43
 pk v42,v44,v45
 pk v43,v46,v47
 ds_write2st64_b64 v208,v[32:33],v[34:35] offset0:96 offset1:100
 v_pk_mul_f32 v[56:57],v[56:57],v[204:205]
 v_pk_mul_f32 v[58:59],v[58:59],v[206:207]
 v_pk_mul_f32 v[60:61],v[60:61],v[204:205]
 v_pk_mul_f32 v[62:63],v[62:63],v[206:207]
 pk v48,v48,v49
 pk v49,v50,v51
 pk v50,v52,v53
 pk v51,v54,v55
 ds_write2st64_b64 v209,v[40:41],v[42:43] offset0:96 offset1:100
 pk v56,v56,v57
 pk v57,v58,v59
 pk v58,v60,v61
 pk v59,v62,v63
 ds_write2st64_b64 v210,v[48:49],v[50:51] offset0:96 offset1:100
 ds_write2st64_b64 v211,v[56:57],v[58:59] offset0:96 offset1:100
 s_waitcnt vmcnt(13)
 rt a[128:129],v230 offset:0
 rt a[130:131],v230 offset:2048
 rt a[132:133],v230 offset:4096
 rt a[134:135],v230 offset:6144
 s_waitcnt lgkmcnt(4)
 s_barrier
 rt a[0:1],v212 offset:0
 rt a[2:3],v212 offset:2048
 rt a[16:17],v212 offset:4096
 rt a[18:19],v212 offset:6144
 rt a[4:5],v213 offset:0
 rt a[6:7],v213 offset:2048
 rt a[20:21],v213 offset:4096
 rt a[22:23],v213 offset:6144
 rt a[8:9],v214 offset:0
 rt a[10:11],v214 offset:2048
L_pad_pg26:
 s_cbranch_execz L_hop7
 rt a[24:25],v214 offset:4096
 rt a[26:27],v214 offset:6144
 rt a[12:13],v215 offset:0
 rt a[14:15],v215 offset:2048
 rt a[28:29],v215 offset:4096
 rt a[30:31],v215 offset:6144
 rt a[136:137],v231 offset:0
 rt a[138:139],v231 offset:2048
 s_waitcnt lgkmcnt(14)
 mf v[64:67],a[128:131],a[0:3],0
 s_add_u32 m0,s62,32768
 s_mov_b32 s63,32768
 rt a[140:141],v231 offset:4096
 rt a[32:33],v212 offset:8192
 mf v[64:67],a[132:135],a[16:19],v[64:67]
 s_waitcnt lgkmcnt(12)
 bl v238,s[24:27],s63 offen offset:0 lds
 mf v[80:83],a[132:135],a[20:23],0
 s_mov_b32 s63,39936
 rt a[142:143],v231 offset:6144
 rt a[34:35],v212 offset:10240
 mf v[80:83],a[128:131],a[4:7],v[80:83]
 s_waitcnt lgkmcnt(10)
 rt a[48:49],v212 offset:12288
 rt a[50:51],v212 offset:14336
 bl v238,s[24:27],s63 offen offset:1024 lds
 mf v[96:99],a[128:131],a[8:11],0
 s_mov_b32 s63,47104
 rt a[144:145],v232 offset:0
 rt a[36:37],v213 offset:8192
 mf v[96:99],a[132:135],a[24:27],v[96:99]
 s_waitcnt lgkmcnt(10)
 bl v238,s[24:27],s63 offen offset:2048 lds
 mf v[112:115],a[132:135],a[28:31],0
 s_mov_b32 s63,54272
 rt a[146:147],v232 offset:2048
 rt a[38:39],v213 offset:10240
 mf v[112:115],a[128:131],a[12:15],v[112:115]
 s_waitcnt lgkmcnt(7)
 rt a[52:53],v213 offset:12288
 rt a[54:55],v213 offset:14336
 bl v238,s[24:27],s63 offen offset:3072 lds
 mf v[116:119],a[136:139],a[12:15],0
 s_add_u32 m0,s62,36864
 s_mov_b32 s63,163840
 rt a[148:149],v232 offset:4096
 mf v[116:119],a[140:143],a[28:31],v[116:119]
 bl v238,s[24:27],s63 offen offset:0 lds
 mf v[100:103],a[140:143],a[24:27],0
 rt a[150:151],v232 offset:6144
 mf v[100:103],a[136:139],a[8:11],v[100:103]
 rt a[40:41],v214 offset:8192
 rt a[42:43],v214 offset:10240
 mf v[84:87],a[136:139],a[4:7],0
 s_mov_b32 s63,171008
 rt a[152:153],v233 offset:0
 mf v[84:87],a[140:143],a[20:23],v[84:87]
 bl v238,s[24:27],s63 offen offset:1024 lds
 mf v[68:71],a[140:143],a[16:19],0
 rt a[154:155],v233 offset:2048
 mf v[68:71],a[136:139],a[0:3],v[68:71]
 s_waitcnt lgkmcnt(4)
 rt a[56:57],v214 offset:12288
 rt a[58:59],v214 offset:14336
 mf v[72:75],a[144:147],a[0:3],0
 s_mov_b32 s63,178176
 rt a[156:157],v233 offset:4096
 mf v[72:75],a[148:151],a[16:19],v[72:75]
 bl v238,s[24:27],s63 offen offset:2048 lds
 mf v[88:91],a[148:151],a[20:23],0
 rt a[158:159],v233 offset:6144
 mf v[88:91],a[144:147],a[4:7],v[88:91]
 rt a[44:45],v215 offset:8192
 rt a[46:47],v215 offset:10240
 mf v[104:107],a[144:147],a[8:11],0
 s_mov_b32 s63,185344
 s_waitcnt vmcnt(7)
 rt a[128:129],v226 offset:0
 mf v[104:107],a[148:151],a[24:27],v[104:107]
 bl v238,s[24:27],s63 offen offset:3072 lds
 mf v[120:123],a[148:151],a[28:31],0
 rt a[130:131],v226 offset:2048
 mf v[120:123],a[144:147],a[12:15],v[120:123]
 s_waitcnt lgkmcnt(4)
 s_add_u32 m0,s62,65536
 rt a[60:61],v215 offset:12288
 rt a[62:63],v215 offset:14336
 mf v[124:127],a[152:155],a[12:15],0
 s_mov_b32 s63,294912
 rt a[132:133],v226 offset:4096
 mf v[124:127],a[156:159],a[28:31],v[124:127]
 bl v238,s[24:27],s63 offen offset:0 lds
 mf v[108:111],a[156:159],a[24:27],0
 rt a[134:135],v226 offset:6144
 mf v[108:111],a[152:155],a[8:11],v[108:111]
 mf v[92:95],a[152:155],a[4:7],0
 s_mov_b32 s63,302080
 rt a[136:137],v227 offset:0
 mf v[92:95],a[156:159],a[20:23],v[92:95]
 bl v238,s[24:27],s63 offen offset:1024 lds
 mf v[76:79],a[156:159],a[16:19],0
 rt a[138:139],v227 offset:2048
 mf v[76:79],a[152:155],a[0:3],v[76:79]
 s_waitcnt lgkmcnt(2)
 mf v[64:67],a[128:131],a[32:35],v[64:67]
 s_mov_b32 s63,309248
 rt a[140:141],v227 offset:4096
 rt a[64:65],v212 offset:16384
 mf v[64:67],a[132:135],a[48:51],v[64:67]
 bl v238,s[24:27],s63 offen offset:2048 lds
 mf v[80:83],a[132:135],a[52:55],v[80:83]
 rt a[142:143],v227 offset:6144
 rt a[66:67],v212 offset:18432
 mf v[80:83],a[128:131],a[36:39],v[80:83]
 rt a[80:81],v212 offset:20480
 rt a[82:83],v212 offset:22528
 mf v[96:99],a[128:131],a[40:43],v[96:99]
 s_mov_b32 s63,316416
 rt a[144:145],v228 offset:0
 rt a[68:69],v213 offset:16384
 mf v[96:99],a[132:135],a[56:59],v[96:99]
 bl v238,s[24:27],s63 offen offset:3072 lds
 mf v[112:115],a[132:135],a[60:63],v[112:115]
 rt a[146:147],v228 offset:2048
 rt a[70:71],v213 offset:18432
 mf v[112:115],a[128:131],a[44:47],v[112:115]
 s_waitcnt lgkmcnt(7)
 s_add_u32 m0,s62,69632
 rt a[84:85],v213 offset:20480
 rt a[86:87],v213 offset:22528
 mf v[116:119],a[136:139],a[44:47],v[116:119]
 s_mov_b32 s63,425984
 rt a[148:149],v228 offset:4096
 mf v[116:119],a[140:143],a[60:63],v[116:119]
 bl v238,s[24:27],s63 offen offset:0 lds
 mf v[100:103],a[140:143],a[56:59],v[100:103]
 rt a[150:151],v228 offset:6144
 mf v[100:103],a[136:139],a[40:43],v[100:103]
 rt a[72:73],v214 offset:16384
 rt a[74:75],v214 offset:18432
 mf v[84:87],a[136:139],a[36:39],v[84:87]
 s_mov_b32 s63,433152
 rt a[152:153],v229 offset:0
 mf v[84:87],a[140:143],a[52:55],v[84:87]
 bl v238,s[24:27],s63 offen offset:1024 lds
 mf v[68:71],a[140:143],a[48:51],v[68:71]
 rt a[154:155],v229 offset:2048
 mf v[68:71],a[136:139],a[32:35],v[68:71]
 s_waitcnt lgkmcnt(4)
 rt a[88:89],v214 offset:20480
 rt a[90:91],v214 offset:22528
 mf v[72:75],a[144:147],a[32:35],v[72:75]
 s_mov_b32 s63,440320
 rt a[156:157],v229 offset:4096
 mf v[72:75],a[148:151],a[48:51],v[72:75]
 bl v238,s[24:27],s63 offen offset:2048 lds
 mf v[88:91],a[148:151],a[52:55],v[88:91]
 rt a[158:159],v229 offset:6144
 mf v[88:91],a[144:147],a[36:39],v[88:91]
 rt a[76:77],v215 offset:16384
 rt a[78:79],v215 offset:18432
 mf v[104:107],a[144:147],a[40:43],v[104:107]
 s_mov_b32 s63,447488
 s_waitcnt vmcnt(7)
 rt a[128:129],v226 offset:32768
 mf v[104:107],a[148:151],a[56:59],v[104:107]
 bl v238,s[24:27],s63 offen offset:3072 lds
 mf v[120:123],a[148:151],a[60:63],v[120:123]
 rt a[130:131],v226 offset:34816
 mf v[120:123],a[144:147],a[44:47],v[120:123]
 s_waitcnt lgkmcnt(4)
 s_add_u32 m0,s62,0
 rt a[92:93],v215 offset:20480
 rt a[94:95],v215 offset:22528
 mf v[124:127],a[152:155],a[44:47],v[124:127]
 s_mov_b32 s63,65536
 rt a[132:133],v226 offset:36864
 mf v[124:127],a[156:159],a[60:63],v[124:127]
 bl v238,s[24:27],s63 offen offset:0 lds
 mf v[108:111],a[156:159],a[56:59],v[108:111]
 rt a[134:135],v226 offset:38912
 mf v[108:111],a[152:155],a[40:43],v[108:111]
 mf v[92:95],a[152:155],a[36:39],v[92:95]
 s_mov_b32 s63,72704
 rt a[136:137],v227 offset:32768
 mf v[92:95],a[156:159],a[52:55],v[92:95]
 bl v238,s[24:27],s63 offen offset:1024 lds
 mf v[76:79],a[156:159],a[48:51],v[76:79]
 rt a[138:139],v227 offset:34816
 mf v[76:79],a[152:155],a[32:35],v[76:79]
 s_waitcnt lgkmcnt(2)
 mf v[64:67],a[128:131],a[64:67],v[64:67]
 s_mov_b32 s63,79872
 rt a[140:141],v227 offset:36864
 rt a[96:97],v212 offset:24576
 mf v[64:67],a[132:135],a[80:83],v[64:67]
 bl v238,s[24:27],s63 offen offset:2048 lds
 mf v[80:83],a[132:135],a[84:87],v[80:83]
 rt a[142:143],v227 offset:38912
 rt a[98:99],v212 offset:26624
 mf v[80:83],a[128:131],a[68:71],v[80:83]
 rt a[112:113],v212 offset:28672
 rt a[114:115],v212 offset:30720
 mf v[96:99],a[128:131],a[72:75],v[96:99]
 s_mov_b32 s63,87040
 rt a[144:145],v228 offset:32768
 rt a[100:101],v213 offset:24576
 mf v[96:99],a[132:135],a[88:91],v[96:99]
 bl v238,s[24:27],s63 offen offset:3072 lds
 mf v[112:115],a[132:135],a[92:95],v[112:115]
 rt a[146:147],v228 offset:34816
 rt a[102:103],v213 offset:26624
 mf v[112:115],a[128:131],a[76:79],v[112:115]
 s_waitcnt lgkmcnt(7)
 s_add_u32 m0,s62,4096
 rt a[116:117],v213 offset:28672
 rt a[118:119],v213 offset:30720
 mf v[116:119],a[136:139],a[76:79],v[116:119]
 s_mov_b32 s63,196608
 rt a[148:149],v228 offset:36864
 mf v[116:119],a[140:143],a[92:95],v[116:119]
 bl v238,s[24:27],s63 offen offset:0 lds
 mf v[100:103],a[140:143],a[88:91],v[100:103]
 rt a[150:151],v228 offset:38912
 mf v[100:103],a[136:139],a[72:75],v[100:103]
 rt a[104:105],v214 offset:24576
 rt a[106:107],v214 offset:26624
 mf v[84:87],a[136:139],a[68:71],v[84:87]
 s_mov_b32 s63,203776
 rt a[152:153],v229 offset:32768
 mf v[84:87],a[140:143],a[84:87],v[84:87]
 bl v238,s[24:27],s63 offen offset:1024 lds
 mf v[68:71],a[140:143],a[80:83],v[68:71]
 rt a[154:155],v229 offset:34816
 mf v[68:71],a[136:139],a[64:67],v[68:71]
 s_waitcnt lgkmcnt(4)
 rt a[120:121],v214 offset:28672
 rt a[122:123],v214 offset:30720
 mf v[72:75],a[144:147],a[64:67],v[72:75]
 s_mov_b32 s63,210944
 rt a[156:157],v229 offset:36864
 mf v[72:75],a[148:151],a[80:83],v[72:75]
 bl v238,s[24:27],s63 offen offset:2048 lds
 mf v[88:91],a[148:151],a[84:87],v[88:91]
 rt a[158:159],v229 offset:38912
 mf v[88:91],a[144:147],a[68:71],v[88:91]
 rt a[108:109],v215 offset:24576
 rt a[110:111],v215 offset:26624
 mf v[104:107],a[144:147],a[72:75],v[104:107]
 s_mov_b32 s63,218112
 s_waitcnt vmcnt(7)
 rt a[128:129],v230 offset:0
 mf v[104:107],a[148:151],a[88:91],v[104:107]
 bl v238,s[24:27],s63 offen offset:3072 lds
 mf v[120:123],a[148:151],a[92:95],v[120:123]
 rt a[130:131],v230 offset:2048
 mf v[120:123],a[144:147],a[76:79],v[120:123]
 s_waitcnt lgkmcnt(4)
 s_add_u32 m0,s62,32768
 rt a[124:125],v215 offset:28672
 rt a[126:127],v215 offset:30720
 mf v[124:127],a[152:155],a[76:79],v[124:127]
 s_mov_b32 s63,327680
 rt a[132:133],v230 offset:4096
 mf v[124:127],a[156:159],a[92:95],v[124:127]
 bl v238,s[24:27],s63 offen offset:0 lds
 mf v[108:111],a[156:159],a[88:91],v[108:111]
 rt a[134:135],v230 offset:6144
 mf v[108:111],a[152:155],a[72:75],v[108:111]
 mf v[92:95],a[152:155],a[68:71],v[92:95]
 s_mov_b32 s63,334848
 rt a[136:137],v231 offset:0
 mf v[92:95],a[156:159],a[84:87],v[92:95]
 bl v238,s[24:27],s63 offen offset:1024 lds
 mf v[76:79],a[156:159],a[80:83],v[76:79]
 rt a[138:139],v231 offset:2048
 mf v[76:79],a[152:155],a[64:67],v[76:79]
 s_waitcnt lgkmcnt(2)
 mf v[64:67],a[128:131],a[96:99],v[64:67]
 s_mov_b32 s63,342016
 rt a[140:141],v231 offset:4096
 rt v[0:1],v212 offset:32768
 mf v[64:67],a[132:135],a[112:115],v[64:67]
 bl v238,s[24:27],s63 offen offset:2048 lds
 mf v[80:83],a[132:135],a[116:119],v[80:83]
 rt a[142:143],v231 offset:6144
 rt v[2:3],v212 offset:34816
 mf v[80:83],a[128:131],a[100:103],v[80:83]
 rt v[16:17],v212 offset:36864
 rt v[18:19],v212 offset:38912
 mf v[96:99],a[128:131],a[104:107],v[96:99]
 s_mov_b32 s63,349184
 rt a[144:145],v232 offset:0
 rt v[4:5],v213 offset:32768
 mf v[96:99],a[132:135],a[120:123],v[96:99]
 bl v238,s[24:27],s63 offen offset:3072 lds
 mf v[112:115],a[132:135],a[124:127],v[112:115]
 rt a[146:147],v232 offset:2048
 rt v[6:7],v213 offset:34816
 mf v[112:115],a[128:131],a[108:111],v[112:115]
 s_waitcnt lgkmcnt(7)
 s_add_u32 m0,s62,36864
 rt v[20:21],v213 offset:36864
 rt v[22:23],v213 offset:38912
 mf v[116:119],a[136:139],a[108:111],v[116:119]
 s_mov_b32 s63,458752
 rt a[148:149],v232 offset:4096
 mf v[116:119],a[140:143],a[124:127],v[116:119]
 bl v238,s[24:27],s63 offen offset:0 lds
 mf v[100:103],a[140:143],a[120:123],v[100:103]
 rt a[150:151],v232 offset:6144
 mf v[100:103],a[136:139],a[104:107],v[100:103]
 rt v[8:9],v214 offset:32768
 rt v[10:11],v214 offset:34816
 mf v[84:87],a[136:139],a[100:103],v[84:87]
 s_mov_b32 s63,465920
 rt a[152:153],v233 offset:0
 mf v[84:87],a[140:143],a[116:119],v[84:87]
 bl v238,s[24:27],s63 offen offset:1024 lds
 mf v[68:71],a[140:143],a[112:115],v[68:71]
 rt a[154:155],v233 offset:2048
 mf v[68:71],a[136:139],a[96:99],v[68:71]
 s_waitcnt lgkmcnt(4)
 rt v[24:25],v214 offset:36864
 rt v[26:27],v214 offset:38912
 mf v[72:75],a[144:147],a[96:99],v[72:75]
 s_mov_b32 s63,473088
 rt a[156:157],v233 offset:4096
 mf v[72:75],a[148:151],a[112:115],v[72:75]
 bl v238,s[24:27],s63 offen offset:2048 lds
 mf v[88:91],a[148:151],a[116:119],v[88:91]
 rt a[158:159],v233 offset:6144
 mf v[88:91],a[144:147],a[100:103],v[88:91]
 rt v[12:13],v215 offset:32768
 rt v[14:15],v215 offset:34816
 mf v[104:107],a[144:147],a[104:107],v[104:107]
 s_mov_b32 s63,480256
 s_waitcnt vmcnt(7)
 rt a[128:129],v226 offset:0
 mf v[104:107],a[148:151],a[120:123],v[104:107]
 bl v238,s[24:27],s63 offen offset:3072 lds
 mf v[120:123],a[148:151],a[124:127],v[120:123]
 rt a[130:131],v226 offset:2048
 mf v[120:123],a[144:147],a[108:111],v[120:123]
 s_waitcnt lgkmcnt(4)
 s_add_u32 m0,s62,65536
 rt v[28:29],v215 offset:36864
 rt v[30:31],v215 offset:38912
 mf v[124:127],a[152:155],a[108:111],v[124:127]
 s_mov_b32 s63,98304
 rt a[132:133],v226 offset:4096
 mf v[124:127],a[156:159],a[124:127],v[124:127]
 bl v238,s[24:27],s63 offen offset:0 lds
 mf v[108:111],a[156:159],a[120:123],v[108:111]
 rt a[134:135],v226 offset:6144
 mf v[108:111],a[152:155],a[104:107],v[108:111]
 mf v[92:95],a[152:155],a[100:103],v[92:95]
 s_mov_b32 s63,105472
 rt a[136:137],v227 offset:0
 mf v[92:95],a[156:159],a[116:119],v[92:95]
 bl v238,s[24:27],s63 offen offset:1024 lds
 mf v[76:79],a[156:159],a[112:115],v[76:79]
 rt a[138:139],v227 offset:2048
 mf v[76:79],a[152:155],a[96:99],v[76:79]
 s_waitcnt lgkmcnt(2)
 mf v[64:67],a[128:131],v[0:3],v[64:67]
 s_mov_b32 s63,112640
 rt a[140:141],v227 offset:4096
 rt v[32:33],v212 offset:40960
 mf v[64:67],a[132:135],v[16:19],v[64:67]
 bl v238,s[24:27],s63 offen offset:2048 lds
 mf v[80:83],a[132:135],v[20:23],v[80:83]
 rt a[142:143],v227 offset:6144
 rt v[34:35],v212 offset:43008
 mf v[80:83],a[128:131],v[4:7],v[80:83]
 rt v[48:49],v212 offset:45056
 rt v[50:51],v212 offset:47104
 mf v[96:99],a[128:131],v[8:11],v[96:99]
 s_mov_b32 s63,119808
 rt a[144:145],v228 offset:0
 rt v[36:37],v213 offset:40960
 mf v[96:99],a[132:135],v[24:27],v[96:99]
 bl v238,s[24:27],s63 offen offset:3072 lds
 mf v[112:115],a[132:135],v[28:31],v[112:115]
 rt a[146:147],v228 offset:2048
 rt v[38:39],v213 offset:43008
 mf v[112:115],a[128:131],v[12:15],v[112:115]
 s_waitcnt lgkmcnt(7)
 s_add_u32 m0,s62,69632
 rt v[52:53],v213 offset:45056
 rt v[54:55],v213 offset:47104
 mf v[116:119],a[136:139],v[12:15],v[116:119]
 s_mov_b32 s63,229376
 rt a[148:149],v228 offset:4096
 mf v[116:119],a[140:143],v[28:31],v[116:119]
 bl v238,s[24:27],s63 offen offset:0 lds
 mf v[100:103],a[140:143],v[24:27],v[100:103]
 rt a[150:151],v228 offset:6144
 mf v[100:103],a[136:139],v[8:11],v[100:103]
 rt v[40:41],v214 offset:40960
 rt v[42:43],v214 offset:43008
 mf v[84:87],a[136:139],v[4:7],v[84:87]
 s_mov_b32 s63,236544
 rt a[152:153],v229 offset:0
 mf v[84:87],a[140:143],v[20:23],v[84:87]
 bl v238,s[24:27],s63 offen offset:1024 lds
 mf v[68:71],a[140:143],v[16:19],v[68:71]
 rt a[154:155],v229 offset:2048
 mf v[68:71],a[136:139],v[0:3],v[68:71]
 s_waitcnt lgkmcnt(4)
 rt v[56:57],v214 offset:45056
 rt v[58:59],v214 offset:47104
 mf v[72:75],a[144:147],v[0:3],v[72:75]
 s_mov_b32 s63,243712
 rt a[156:157],v229 offset:4096
 mf v[72:75],a[148:151],v[16:19],v[72:75]
 bl v238,s[24:27],s63 offen offset:2048 lds
 mf v[88:91],a[148:151],v[20:23],v[88:91]
 rt a[158:159],v229 offset:6144
 mf v[88:91],a[144:147],v[4:7],v[88:91]
 rt v[44:45],v215 offset:40960
 rt v[46:47],v215 offset:43008
 mf v[104:107],a[144:147],v[8:11],v[104:107]
 s_mov_b32 s63,250880
 s_waitcnt vmcnt(7)
 rt a[128:129],v226 offset:32768
 mf v[104:107],a[148:151],v[24:27],v[104:107]
 bl v238,s[24:27],s63 offen offset:3072 lds
 mf v[120:123],a[148:151],v[28:31],v[120:123]
 rt a[130:131],v226 offset:34816
 mf v[120:123],a[144:147],v[12:15],v[120:123]
 s_waitcnt lgkmcnt(4)
 s_add_u32 m0,s62,0
 rt v[60:61],v215 offset:45056
 rt v[62:63],v215 offset:47104
 mf v[124:127],a[152:155],v[12:15],v[124:127]
 s_mov_b32 s63,360448
 rt a[132:133],v226 offset:36864
 mf v[124:127],a[156:159],v[28:31],v[124:127]
 bl v238,s[24:27],s63 offen offset:0 lds
 mf v[108:111],a[156:159],v[24:27],v[108:111]
 rt a[134:135],v226 offset:38912
 mf v[108:111],a[152:155],v[8:11],v[108:111]
 mf v[92:95],a[152:155],v[4:7],v[92:95]
 s_mov_b32 s63,367616
 rt a[136:137],v227 offset:32768
 mf v[92:95],a[156:159],v[20:23],v[92:95]
 bl v238,s[24:27],s63 offen offset:1024 lds
 mf v[76:79],a[156:159],v[16:19],v[76:79]
 rt a[138:139],v227 offset:34816
 mf v[76:79],a[152:155],v[0:3],v[76:79]
 s_waitcnt lgkmcnt(2)
 mf v[64:67],a[128:131],v[32:35],v[64:67]
 s_mov_b32 s63,374784
 rt a[140:141],v227 offset:36864
 rt a[0:1],v212 offset:49152
 mf v[64:67],a[132:135],v[48:51],v[64:67]
 bl v238,s[24:27],s63 offen offset:2048 lds
 mf v[80:83],a[132:135],v[52:55],v[80:83]
 rt a[142:143],v227 offset:38912
 rt a[2:3],v212 offset:51200
 mf v[80:83],a[128:131],v[36:39],v[80:83]
 rt a[16:17],v212 offset:53248
 rt a[18:19],v212 offset:55296
 mf v[96:99],a[128:131],v[40:43],v[96:99]
 s_mov_b32 s63,381952
 rt a[144:145],v228 offset:32768
 rt a[4:5],v213 offset:49152
 mf v[96:99],a[132:135],v[56:59],v[96:99]
 bl v238,s[24:27],s63 offen offset:3072 lds
 mf v[112:115],a[132:135],v[60:63],v[112:115]
 rt a[146:147],v228 offset:34816
 rt a[6:7],v213 offset:51200
 mf v[112:115],a[128:131],v[44:47],v[112:115]
 s_waitcnt lgkmcnt(7)
 s_add_u32 m0,s62,4096
 rt a[20:21],v213 offset:53248
 rt a[22:23],v213 offset:55296
 mf v[116:119],a[136:139],v[44:47],v[116:119]
 s_mov_b32 s63,491520
 rt a[148:149],v228 offset:36864
 mf v[116:119],a[140:143],v[60:63],v[116:119]
 bl v238,s[24:27],s63 offen offset:0 lds
 mf v[100:103],a[140:143],v[56:59],v[100:103]
 rt a[150:151],v228 offset:38912
 mf v[100:103],a[136:139],v[40:43],v[100:103]
 rt a[8:9],v214 offset:49152
 rt a[10:11],v214 offset:51200
 mf v[84:87],a[136:139],v[36:39],v[84:87]
 s_mov_b32 s63,498688
 rt a[152:153],v229 offset:32768
 mf v[84:87],a[140:143],v[52:55],v[84:87]
 bl v238,s[24:27],s63 offen offset:1024 lds
 mf v[68:71],a[140:143],v[48:51],v[68:71]
 rt a[154:155],v229 offset:34816
 mf v[68:71],a[136:139],v[32:35],v[68:71]
 s_waitcnt lgkmcnt(4)
 rt a[24:25],v214 offset:53248
 rt a[26:27],v214 offset:55296
 mf v[72:75],a[144:147],v[32:35],v[72:75]
 s_mov_b32 s63,505856
 rt a[156:157],v229 offset:36864
 mf v[72:75],a[148:151],v[48:51],v[72:75]
 bl v238,s[24:27],s63 offen offset:2048 lds
 mf v[88:91],a[148:151],v[52:55],v[88:91]
 rt a[158:159],v229 offset:38912
 mf v[88:91],a[144:147],v[36:39],v[88:91]
 rt a[12:13],v215 offset:49152
 rt a[14:15],v215 offset:51200
 mf v[104:107],a[144:147],v[40:43],v[104:107]
 s_mov_b32 s63,513024
 s_waitcnt vmcnt(7)
 rt a[128:129],v230 offset:0
 mf v[104:107],a[148:151],v[56:59],v[104:107]
 bl v238,s[24:27],s63 offen offset:3072 lds
 mf v[120:123],a[148:151],v[60:63],v[120:123]
 rt a[130:131],v230 offset:2048
 mf v[120:123],a[144:147],v[44:47],v[120:123]
 s_waitcnt lgkmcnt(4)
 s_add_u32 m0,s62,32768
 rt a[28:29],v215 offset:53248
 rt a[30:31],v215 offset:55296
 mf v[124:127],a[152:155],v[44:47],v[124:127]
 s_mov_b32 s63,32896
 rt a[132:133],v230 offset:4096
 mf v[124:127],a[156:159],v[60:63],v[124:127]
L_pad_pg27:
 s_cbranch_execz L_hop7
 bl v238,s[24:27],s63 offen offset:0 lds
 mf v[108:111],a[156:159],v[56:59],v[108:111]
 rt a[134:135],v230 offset:6144
 mf v[108:111],a[152:155],v[40:43],v[108:111]
 mf v[92:95],a[152:155],v[36:39],v[92:95]
 s_mov_b32 s63,40064
 rt a[136:137],v231 offset:0
 mf v[92:95],a[156:159],v[52:55],v[92:95]
 bl v238,s[24:27],s63 offen offset:1024 lds
 mf v[76:79],a[156:159],v[48:51],v[76:79]
 rt a[138:139],v231 offset:2048
 mf v[76:79],a[152:155],v[32:35],v[76:79]
 s_waitcnt lgkmcnt(2)
 mf v[64:67],a[128:131],a[0:3],v[64:67]
 s_mov_b32 s63,47232
 rt a[140:141],v231 offset:4096
 rt a[32:33],v212 offset:57344
 mf v[64:67],a[132:135],a[16:19],v[64:67]
 bl v238,s[24:27],s63 offen offset:2048 lds
 mf v[80:83],a[132:135],a[20:23],v[80:83]
 rt a[142:143],v231 offset:6144
 rt a[34:35],v212 offset:59392
 mf v[80:83],a[128:131],a[4:7],v[80:83]
 rt a[48:49],v212 offset:61440
 rt a[50:51],v212 offset:63488
 mf v[96:99],a[128:131],a[8:11],v[96:99]
 s_mov_b32 s63,54400
 rt a[144:145],v232 offset:0
 rt a[36:37],v213 offset:57344
 mf v[96:99],a[132:135],a[24:27],v[96:99]
 bl v238,s[24:27],s63 offen offset:3072 lds
 mf v[112:115],a[132:135],a[28:31],v[112:115]
 rt a[146:147],v232 offset:2048
 rt a[38:39],v213 offset:59392
 mf v[112:115],a[128:131],a[12:15],v[112:115]
 s_waitcnt lgkmcnt(7)
 s_add_u32 m0,s62,36864
 rt a[52:53],v213 offset:61440
 rt a[54:55],v213 offset:63488
 mf v[116:119],a[136:139],a[12:15],v[116:119]
 s_mov_b32 s63,163968
 rt a[148:149],v232 offset:4096
 mf v[116:119],a[140:143],a[28:31],v[116:119]
 bl v238,s[24:27],s63 offen offset:0 lds
 mf v[100:103],a[140:143],a[24:27],v[100:103]
 rt a[150:151],v232 offset:6144
 mf v[100:103],a[136:139],a[8:11],v[100:103]
 rt a[40:41],v214 offset:57344
 rt a[42:43],v214 offset:59392
 mf v[84:87],a[136:139],a[4:7],v[84:87]
 s_mov_b32 s63,171136
 rt a[152:153],v233 offset:0
 mf v[84:87],a[140:143],a[20:23],v[84:87]
 bl v238,s[24:27],s63 offen offset:1024 lds
 mf v[68:71],a[140:143],a[16:19],v[68:71]
 rt a[154:155],v233 offset:2048
 mf v[68:71],a[136:139],a[0:3],v[68:71]
 s_waitcnt lgkmcnt(4)
 rt a[56:57],v214 offset:61440
 rt a[58:59],v214 offset:63488
 mf v[72:75],a[144:147],a[0:3],v[72:75]
 s_mov_b32 s63,178304
 rt a[156:157],v233 offset:4096
 mf v[72:75],a[148:151],a[16:19],v[72:75]
 bl v238,s[24:27],s63 offen offset:2048 lds
 mf v[88:91],a[148:151],a[20:23],v[88:91]
 rt a[158:159],v233 offset:6144
 mf v[88:91],a[144:147],a[4:7],v[88:91]
 rt a[44:45],v215 offset:57344
 rt a[46:47],v215 offset:59392
 mf v[104:107],a[144:147],a[8:11],v[104:107]
 s_mov_b32 s63,185472
 s_waitcnt vmcnt(7)
 rt a[128:129],v226 offset:0
 mf v[104:107],a[148:151],a[24:27],v[104:107]
 bl v238,s[24:27],s63 offen offset:3072 lds
 mf v[120:123],a[148:151],a[28:31],v[120:123]
 rt a[130:131],v226 offset:2048
 mf v[120:123],a[144:147],a[12:15],v[120:123]
 s_waitcnt lgkmcnt(4)
 s_add_u32 m0,s62,65536
 rt a[60:61],v215 offset:61440
 rt a[62:63],v215 offset:63488
 mf v[124:127],a[152:155],a[12:15],v[124:127]
 s_mov_b32 s63,295040
 rt a[132:133],v226 offset:4096
 mf v[124:127],a[156:159],a[28:31],v[124:127]
 bl v238,s[24:27],s63 offen offset:0 lds
 mf v[108:111],a[156:159],a[24:27],v[108:111]
 rt a[134:135],v226 offset:6144
 mf v[108:111],a[152:155],a[8:11],v[108:111]
 mf v[92:95],a[152:155],a[4:7],v[92:95]
 s_mov_b32 s63,302208
 rt a[136:137],v227 offset:0
 mf v[92:95],a[156:159],a[20:23],v[92:95]
 bl v238,s[24:27],s63 offen offset:1024 lds
 mf v[76:79],a[156:159],a[16:19],v[76:79]
 rt a[138:139],v227 offset:2048
 mf v[76:79],a[152:155],a[0:3],v[76:79]
 s_waitcnt lgkmcnt(2)
 mf v[64:67],a[128:131],a[32:35],v[64:67]
 s_mov_b32 s63,309376
 rt a[140:141],v227 offset:4096
 s_lshl1_add_u32 s55,s54,0
 mf v[64:67],a[132:135],a[48:51],v[64:67]
 s_cmp_eq_u32 s55,s52
 s_cselect_b32 s3,0x7f000000,0
 bl v238,s[24:27],s63 offen offset:2048 lds
 mf v[80:83],a[132:135],a[52:55],v[80:83]
 rt a[142:143],v227 offset:6144
 v_or_b32 v218,s3,v255
 mf v[80:83],a[128:131],a[36:39],v[80:83]
 s_lshl1_add_u32 s55,s54,1
 s_cmp_eq_u32 s55,s52
 s_cselect_b32 s101,0x7f000000,0
 v_or_b32 v219,s101,v255
 mf v[96:99],a[128:131],a[40:43],v[96:99]
 s_mov_b32 s63,316544
 rt a[144:145],v228 offset:0
 s_lshl_b32 s65,s52,13
 mf v[96:99],a[132:135],a[56:59],v[96:99]
 s_lshl_b32 s59,s69,0
 bl v238,s[24:27],s63 offen offset:3072 lds
 mf v[112:115],a[132:135],a[60:63],v[112:115]
 s_add_u32 s65,s65,s59
 rt a[146:147],v228 offset:2048
 s_add_u32 s65,s65,4194304
 mf v[112:115],a[128:131],a[44:47],v[112:115]
 s_waitcnt lgkmcnt(2)
 s_add_u32 m0,s62,69632
 mf v[116:119],a[136:139],a[44:47],v[116:119]
 s_mov_b32 s63,426112
 rt a[148:149],v228 offset:4096
 mf v[116:119],a[140:143],a[60:63],v[116:119]
 bl v238,s[24:27],s63 offen offset:0 lds
 mf v[100:103],a[140:143],a[56:59],v[100:103]
 rt a[150:151],v228 offset:6144
 mf v[100:103],a[136:139],a[40:43],v[100:103]
 mf v[84:87],a[136:139],a[36:39],v[84:87]
 s_mov_b32 s63,433280
 rt a[152:153],v229 offset:0
 mf v[84:87],a[140:143],a[52:55],v[84:87]
 bl v238,s[24:27],s63 offen offset:1024 lds
 mf v[68:71],a[140:143],a[48:51],v[68:71]
 rt a[154:155],v229 offset:2048
 mf v[68:71],a[136:139],a[32:35],v[68:71]
 s_waitcnt lgkmcnt(2)
 mf v[72:75],a[144:147],a[32:35],v[72:75]
 s_mov_b32 s63,440448
 rt a[156:157],v229 offset:4096
 mf v[72:75],a[148:151],a[48:51],v[72:75]
 bl v238,s[24:27],s63 offen offset:2048 lds
 mf v[88:91],a[148:151],a[52:55],v[88:91]
 rt a[158:159],v229 offset:6144
 mf v[88:91],a[144:147],a[36:39],v[88:91]
 mf v[104:107],a[144:147],a[40:43],v[104:107]
 s_mov_b32 s63,447616
 s_waitcnt vmcnt(7)
 rt a[128:129],v226 offset:32768
 mf v[104:107],a[148:151],a[56:59],v[104:107]
 bl v238,s[24:27],s63 offen offset:3072 lds
 mf v[120:123],a[148:151],a[60:63],v[120:123]
 rt a[130:131],v226 offset:34816
 mf v[120:123],a[144:147],a[44:47],v[120:123]
 s_waitcnt lgkmcnt(2)
 s_add_u32 m0,s62,0
 mf v[124:127],a[152:155],a[44:47],v[124:127]
 s_mov_b32 s63,65664
 rt a[132:133],v226 offset:36864
 mf v[124:127],a[156:159],a[60:63],v[124:127]
 bl v238,s[24:27],s63 offen offset:0 lds
 mf v[108:111],a[156:159],a[56:59],v[108:111]
 rt a[134:135],v226 offset:38912
 mf v[108:111],a[152:155],a[40:43],v[108:111]
 mf v[92:95],a[152:155],a[36:39],v[92:95]
 s_mov_b32 s63,72832
 rt a[136:137],v227 offset:32768
 mf v[92:95],a[156:159],a[52:55],v[92:95]
 bl v238,s[24:27],s63 offen offset:1024 lds
 mf v[76:79],a[156:159],a[48:51],v[76:79]
 rt a[138:139],v227 offset:34816
 mf v[76:79],a[152:155],a[32:35],v[76:79]
 s_waitcnt lgkmcnt(2)
 mf v[128:131],a[128:131],a[64:67],0
 s_mov_b32 s63,80000
 rt a[140:141],v227 offset:36864
 mf v[128:131],a[132:135],a[80:83],v[128:131]
 bl v238,s[24:27],s63 offen offset:2048 lds
 mf v[144:147],a[132:135],a[84:87],0
 rt a[142:143],v227 offset:38912
 mf v[144:147],a[128:131],a[68:71],v[144:147]
 mf v[160:163],a[128:131],a[72:75],0
 s_mov_b32 s63,87168
 rt a[144:145],v228 offset:32768
 pk v64,v64,v65
 mf v[160:163],a[132:135],a[88:91],v[160:163]
 bl v238,s[24:27],s63 offen offset:3072 lds
 mf v[176:179],a[132:135],a[92:95],0
 rt a[146:147],v228 offset:34816
 pk v65,v66,v67
 mf v[176:179],a[128:131],a[76:79],v[176:179]
 s_waitcnt lgkmcnt(2)
 s_add_u32 m0,s62,4096
 pk v66,v68,v69
 mf v[180:183],a[136:139],a[76:79],0
 s_mov_b32 s63,196736
 rt a[148:149],v228 offset:36864
 pk v67,v70,v71
 mf v[180:183],a[140:143],a[92:95],v[180:183]
 bl v238,s[24:27],s63 offen offset:0 lds
 mf v[164:167],a[140:143],a[88:91],0
 rt a[150:151],v228 offset:38912
 pk v72,v72,v73
 mf v[164:167],a[136:139],a[72:75],v[164:167]
 pk v73,v74,v75
 pk v74,v76,v77
 mf v[148:151],a[136:139],a[68:71],0
 s_mov_b32 s63,203904
 rt a[152:153],v229 offset:32768
 pk v75,v78,v79
 mf v[148:151],a[140:143],a[84:87],v[148:151]
 bl v238,s[24:27],s63 offen offset:1024 lds
 mf v[132:135],a[140:143],a[80:83],0
 rt a[154:155],v229 offset:34816
 pk v80,v80,v81
 mf v[132:135],a[136:139],a[64:67],v[132:135]
 s_waitcnt lgkmcnt(2)
 pk v81,v82,v83
 pk v82,v84,v85
 mf v[136:139],a[144:147],a[64:67],0
 s_mov_b32 s63,211072
 rt a[156:157],v229 offset:36864
 pk v83,v86,v87
 mf v[136:139],a[148:151],a[80:83],v[136:139]
 bl v238,s[24:27],s63 offen offset:2048 lds
 mf v[152:155],a[148:151],a[84:87],0
 rt a[158:159],v229 offset:38912
 pk v88,v88,v89
 mf v[152:155],a[144:147],a[68:71],v[152:155]
 pk v89,v90,v91
 pk v90,v92,v93
 mf v[168:171],a[144:147],a[72:75],0
 s_mov_b32 s63,218240
 s_waitcnt vmcnt(7)
 rt a[128:129],v230 offset:0
 pk v91,v94,v95
 mf v[168:171],a[148:151],a[88:91],v[168:171]
 bl v238,s[24:27],s63 offen offset:3072 lds
 mf v[184:187],a[148:151],a[92:95],0
 rt a[130:131],v230 offset:2048
 pk v96,v96,v97
 mf v[184:187],a[144:147],a[76:79],v[184:187]
 s_waitcnt lgkmcnt(2)
 s_add_u32 m0,s62,32768
 pk v97,v98,v99
 mf v[188:191],a[152:155],a[76:79],0
 s_mov_b32 s63,128
 rt a[132:133],v230 offset:4096
 pk v98,v100,v101
 mf v[188:191],a[156:159],a[92:95],v[188:191]
 bl v238,s[24:27],s63 offen offset:0 lds
 mf v[172:175],a[156:159],a[88:91],0
 rt a[134:135],v230 offset:6144
 pk v99,v102,v103
 mf v[172:175],a[152:155],a[72:75],v[172:175]
 pk v104,v104,v105
 pk v105,v106,v107
 mf v[156:159],a[152:155],a[68:71],0
 s_mov_b32 s63,7296
 rt a[136:137],v231 offset:0
 pk v106,v108,v109
 mf v[156:159],a[156:159],a[84:87],v[156:159]
 bl v238,s[24:27],s63 offen offset:1024 lds
 mf v[140:143],a[156:159],a[80:83],0
 rt a[138:139],v231 offset:2048
 pk v107,v110,v111
 mf v[140:143],a[152:155],a[64:67],v[140:143]
 s_waitcnt lgkmcnt(2)
 pk v112,v112,v113
 pk v113,v114,v115
 mf v[128:131],a[128:131],a[96:99],v[128:131]
 s_mov_b32 s63,14464
 rt a[140:141],v231 offset:4096
 pk v114,v116,v117
 mf v[128:131],a[132:135],a[112:115],v[128:131]
 bl v238,s[24:27],s63 offen offset:2048 lds
 mf v[144:147],a[132:135],a[116:119],v[144:147]
 rt a[142:143],v231 offset:6144
 pk v115,v118,v119
 mf v[144:147],a[128:131],a[100:103],v[144:147]
 rt a[64:65],v212 offset:0
 rt a[66:67],v212 offset:2048
 mf v[160:163],a[128:131],a[104:107],v[160:163]
 s_mov_b32 s63,21632
 rt a[144:145],v232 offset:0
 pk v120,v120,v121
 mf v[160:163],a[132:135],a[120:123],v[160:163]
 bl v238,s[24:27],s63 offen offset:3072 lds
 mf v[176:179],a[132:135],a[124:127],v[176:179]
 rt a[146:147],v232 offset:2048
 pk v121,v122,v123
 mf v[176:179],a[128:131],a[108:111],v[176:179]
 s_waitcnt lgkmcnt(4)
 s_add_u32 m0,s62,36864
 rt a[80:81],v212 offset:4096
 mf v[180:183],a[136:139],a[108:111],v[180:183]
 s_mov_b32 s63,131200
 rt a[148:149],v232 offset:4096
 pk v122,v124,v125
 mf v[180:183],a[140:143],a[124:127],v[180:183]
 bl v238,s[24:27],s63 offen offset:0 lds
 mf v[164:167],a[140:143],a[120:123],v[164:167]
 rt a[150:151],v232 offset:6144
 pk v123,v126,v127
 mf v[164:167],a[136:139],a[104:107],v[164:167]
 rt a[82:83],v212 offset:6144
 mf v[148:151],a[136:139],a[100:103],v[148:151]
 s_mov_b32 s63,138368
 rt a[152:153],v233 offset:0
 mf v[148:151],a[140:143],a[116:119],v[148:151]
 bl v238,s[24:27],s63 offen offset:1024 lds
 mf v[132:135],a[140:143],a[112:115],v[132:135]
 rt a[154:155],v233 offset:2048
 mf v[132:135],a[136:139],a[96:99],v[132:135]
 s_waitcnt lgkmcnt(3)
 rt a[68:69],v213 offset:0
 mf v[136:139],a[144:147],a[96:99],v[136:139]
 s_mov_b32 s63,145536
 rt a[156:157],v233 offset:4096
 mf v[136:139],a[148:151],a[112:115],v[136:139]
 bl v238,s[24:27],s63 offen offset:2048 lds
 mf v[152:155],a[148:151],a[116:119],v[152:155]
 rt a[158:159],v233 offset:6144
 mf v[152:155],a[144:147],a[100:103],v[152:155]
 rt a[70:71],v213 offset:2048
 mf v[168:171],a[144:147],a[104:107],v[168:171]
 s_mov_b32 s63,152704
 s_waitcnt vmcnt(7)
 rt a[128:129],v226 offset:0
 mf v[168:171],a[148:151],a[120:123],v[168:171]
 bl v238,s[24:27],s63 offen offset:3072 lds
 mf v[184:187],a[148:151],a[124:127],v[184:187]
 rt a[130:131],v226 offset:2048
 mf v[184:187],a[144:147],a[108:111],v[184:187]
 s_waitcnt lgkmcnt(3)
 s_add_u32 m0,s62,65536
 rt a[84:85],v213 offset:4096
 mf v[188:191],a[152:155],a[108:111],v[188:191]
 s_mov_b32 s63,327808
 rt a[132:133],v226 offset:4096
 mf v[188:191],a[156:159],a[124:127],v[188:191]
 bl v238,s[24:27],s63 offen offset:0 lds
 mf v[172:175],a[156:159],a[120:123],v[172:175]
 rt a[134:135],v226 offset:6144
 mf v[172:175],a[152:155],a[104:107],v[172:175]
 rt a[86:87],v213 offset:6144
 mf v[156:159],a[152:155],a[100:103],v[156:159]
 s_mov_b32 s63,334976
 rt a[136:137],v227 offset:0
 mf v[156:159],a[156:159],a[116:119],v[156:159]
 bl v238,s[24:27],s63 offen offset:1024 lds
 mf v[140:143],a[156:159],a[112:115],v[140:143]
 rt a[138:139],v227 offset:2048
 mf v[140:143],a[152:155],a[96:99],v[140:143]
 s_waitcnt lgkmcnt(3)
 rt a[72:73],v214 offset:0
 rt a[74:75],v214 offset:2048
 mf v[128:131],a[128:131],v[0:3],v[128:131]
 s_mov_b32 s63,342144
 rt a[140:141],v227 offset:4096
 mf v[128:131],a[132:135],v[16:19],v[128:131]
 bl v238,s[24:27],s63 offen offset:2048 lds
 mf v[144:147],a[132:135],v[20:23],v[144:147]
 rt a[142:143],v227 offset:6144
 mf v[144:147],a[128:131],v[4:7],v[144:147]
 rt a[88:89],v214 offset:4096
 mf v[160:163],a[128:131],v[8:11],v[160:163]
 s_mov_b32 s63,349312
 rt a[144:145],v228 offset:0
 mf v[160:163],a[132:135],v[24:27],v[160:163]
 bl v238,s[24:27],s63 offen offset:3072 lds
 mf v[176:179],a[132:135],v[28:31],v[176:179]
 rt a[146:147],v228 offset:2048
 mf v[176:179],a[128:131],v[12:15],v[176:179]
 s_waitcnt lgkmcnt(3)
 s_add_u32 m0,s62,69632
 rt a[90:91],v214 offset:6144
 mf v[180:183],a[136:139],v[12:15],v[180:183]
 s_mov_b32 s63,458880
 rt a[148:149],v228 offset:4096
 mf v[180:183],a[140:143],v[28:31],v[180:183]
 bl v238,s[24:27],s63 offen offset:0 lds
 mf v[164:167],a[140:143],v[24:27],v[164:167]
 rt a[150:151],v228 offset:6144
 mf v[164:167],a[136:139],v[8:11],v[164:167]
 rt a[76:77],v215 offset:0
 mf v[148:151],a[136:139],v[4:7],v[148:151]
 s_mov_b32 s63,466048
 rt a[152:153],v229 offset:0
 mf v[148:151],a[140:143],v[20:23],v[148:151]
 bl v238,s[24:27],s63 offen offset:1024 lds
 mf v[132:135],a[140:143],v[16:19],v[132:135]
 rt a[154:155],v229 offset:2048
 mf v[132:135],a[136:139],v[0:3],v[132:135]
 s_waitcnt lgkmcnt(3)
 rt a[78:79],v215 offset:2048
 mf v[136:139],a[144:147],v[0:3],v[136:139]
 s_mov_b32 s63,473216
 rt a[156:157],v229 offset:4096
 mf v[136:139],a[148:151],v[16:19],v[136:139]
 bl v238,s[24:27],s63 offen offset:2048 lds
 mf v[152:155],a[148:151],v[20:23],v[152:155]
 rt a[158:159],v229 offset:6144
 mf v[152:155],a[144:147],v[4:7],v[152:155]
 rt a[92:93],v215 offset:4096
 mf v[168:171],a[144:147],v[8:11],v[168:171]
 s_mov_b32 s63,480384
 s_waitcnt vmcnt(7)
 rt a[128:129],v226 offset:32768
 mf v[168:171],a[148:151],v[24:27],v[168:171]
 bl v238,s[24:27],s63 offen offset:3072 lds
 mf v[184:187],a[148:151],v[28:31],v[184:187]
 rt a[130:131],v226 offset:34816
 mf v[184:187],a[144:147],v[12:15],v[184:187]
 s_waitcnt lgkmcnt(3)
 s_add_u32 m0,s62,0
 rt a[94:95],v215 offset:6144
 mf v[188:191],a[152:155],v[12:15],v[188:191]
 s_mov_b32 s63,262272
 rt a[132:133],v226 offset:36864
 mf v[188:191],a[156:159],v[28:31],v[188:191]
 bl v238,s[24:27],s63 offen offset:0 lds
 mf v[172:175],a[156:159],v[24:27],v[172:175]
 rt a[134:135],v226 offset:38912
 mf v[172:175],a[152:155],v[8:11],v[172:175]
 mf v[156:159],a[152:155],v[4:7],v[156:159]
 s_mov_b32 s63,269440
 rt a[136:137],v227 offset:32768
 mf v[156:159],a[156:159],v[20:23],v[156:159]
 bl v238,s[24:27],s63 offen offset:1024 lds
 mf v[140:143],a[156:159],v[16:19],v[140:143]
 rt a[138:139],v227 offset:34816
 mf v[140:143],a[152:155],v[0:3],v[140:143]
 s_waitcnt lgkmcnt(2)
 mf v[128:131],a[128:131],a[64:67],v[128:131]
 s_mov_b32 s63,276608
 rt a[140:141],v227 offset:36864
 mf v[128:131],a[132:135],a[80:83],v[128:131]
 bl v238,s[24:27],s63 offen offset:2048 lds
 mf v[144:147],a[132:135],a[84:87],v[144:147]
 rt a[142:143],v227 offset:38912
 mf v[144:147],a[128:131],a[68:71],v[144:147]
 rt a[96:97],v212 offset:8192
 rt a[98:99],v212 offset:10240
 mf v[160:163],a[128:131],a[72:75],v[160:163]
 s_mov_b32 s63,283776
 rt a[144:145],v228 offset:32768
 mf v[160:163],a[132:135],a[88:91],v[160:163]
 bl v238,s[24:27],s63 offen offset:3072 lds
 mf v[176:179],a[132:135],a[92:95],v[176:179]
 rt a[146:147],v228 offset:34816
 mf v[176:179],a[128:131],a[76:79],v[176:179]
 s_waitcnt lgkmcnt(4)
 s_add_u32 m0,s62,4096
 rt a[112:113],v212 offset:12288
 mf v[180:183],a[136:139],a[76:79],v[180:183]
 s_mov_b32 s63,393344
 rt a[148:149],v228 offset:36864
 mf v[180:183],a[140:143],a[92:95],v[180:183]
 bl v238,s[24:27],s63 offen offset:0 lds
 mf v[164:167],a[140:143],a[88:91],v[164:167]
 rt a[150:151],v228 offset:38912
 mf v[164:167],a[136:139],a[72:75],v[164:167]
 rt a[114:115],v212 offset:14336
 mf v[148:151],a[136:139],a[68:71],v[148:151]
 s_mov_b32 s63,400512
 rt a[152:153],v229 offset:32768
 mf v[148:151],a[140:143],a[84:87],v[148:151]
 bl v238,s[24:27],s63 offen offset:1024 lds
 mf v[132:135],a[140:143],a[80:83],v[132:135]
 rt a[154:155],v229 offset:34816
 mf v[132:135],a[136:139],a[64:67],v[132:135]
 s_waitcnt lgkmcnt(3)
 rt a[100:101],v213 offset:8192
 mf v[136:139],a[144:147],a[64:67],v[136:139]
 s_mov_b32 s63,407680
 rt a[156:157],v229 offset:36864
 mf v[136:139],a[148:151],a[80:83],v[136:139]
 bl v238,s[24:27],s63 offen offset:2048 lds
 mf v[152:155],a[148:151],a[84:87],v[152:155]
 rt a[158:159],v229 offset:38912
 mf v[152:155],a[144:147],a[68:71],v[152:155]
 rt a[102:103],v213 offset:10240
 mf v[168:171],a[144:147],a[72:75],v[168:171]
 s_mov_b32 s63,414848
 s_waitcnt vmcnt(7)
 rt a[128:129],v230 offset:0
 mf v[168:171],a[148:151],a[88:91],v[168:171]
 bl v238,s[24:27],s63 offen offset:3072 lds
 mf v[184:187],a[148:151],a[92:95],v[184:187]
 rt a[130:131],v230 offset:2048
 mf v[184:187],a[144:147],a[76:79],v[184:187]
 s_waitcnt lgkmcnt(3)
 s_add_u32 m0,s62,32768
 rt a[116:117],v213 offset:12288
 mf v[188:191],a[152:155],a[76:79],v[188:191]
 s_mov_b32 s63,98432
 rt a[132:133],v230 offset:4096
 mf v[188:191],a[156:159],a[92:95],v[188:191]
 bl v238,s[24:27],s63 offen offset:0 lds
 mf v[172:175],a[156:159],a[88:91],v[172:175]
 rt a[134:135],v230 offset:6144
 mf v[172:175],a[152:155],a[72:75],v[172:175]
 rt a[118:119],v213 offset:14336
 mf v[156:159],a[152:155],a[68:71],v[156:159]
 s_mov_b32 s63,105600
 rt a[136:137],v231 offset:0
 mf v[156:159],a[156:159],a[84:87],v[156:159]
 bl v238,s[24:27],s63 offen offset:1024 lds
 mf v[140:143],a[156:159],a[80:83],v[140:143]
 rt a[138:139],v231 offset:2048
 mf v[140:143],a[152:155],a[64:67],v[140:143]
 s_waitcnt lgkmcnt(3)
 rt a[104:105],v214 offset:8192
 rt a[106:107],v214 offset:10240
 mf v[128:131],a[128:131],v[32:35],v[128:131]
 s_mov_b32 s63,112768
 rt a[140:141],v231 offset:4096
 mf v[128:131],a[132:135],v[48:51],v[128:131]
 bl v238,s[24:27],s63 offen offset:2048 lds
 mf v[144:147],a[132:135],v[52:55],v[144:147]
L_pad_pg28:
 s_cbranch_execz L_hop7
 rt a[142:143],v231 offset:6144
 mf v[144:147],a[128:131],v[36:39],v[144:147]
 rt a[120:121],v214 offset:12288
 mf v[160:163],a[128:131],v[40:43],v[160:163]
 s_mov_b32 s63,119936
 rt a[144:145],v232 offset:0
 mf v[160:163],a[132:135],v[56:59],v[160:163]
 bl v238,s[24:27],s63 offen offset:3072 lds
 mf v[176:179],a[132:135],v[60:63],v[176:179]
 rt a[146:147],v232 offset:2048
 mf v[176:179],a[128:131],v[44:47],v[176:179]
 s_waitcnt lgkmcnt(3)
 s_add_u32 m0,s62,36864
 rt a[122:123],v214 offset:14336
 mf v[180:183],a[136:139],v[44:47],v[180:183]
 s_mov_b32 s63,229504
 rt a[148:149],v232 offset:4096
 mf v[180:183],a[140:143],v[60:63],v[180:183]
 bl v238,s[24:27],s63 offen offset:0 lds
 mf v[164:167],a[140:143],v[56:59],v[164:167]
 rt a[150:151],v232 offset:6144
 mf v[164:167],a[136:139],v[40:43],v[164:167]
 rt a[108:109],v215 offset:8192
 mf v[148:151],a[136:139],v[36:39],v[148:151]
 s_mov_b32 s63,236672
 rt a[152:153],v233 offset:0
 mf v[148:151],a[140:143],v[52:55],v[148:151]
 bl v238,s[24:27],s63 offen offset:1024 lds
 mf v[132:135],a[140:143],v[48:51],v[132:135]
 rt a[154:155],v233 offset:2048
 mf v[132:135],a[136:139],v[32:35],v[132:135]
 s_waitcnt lgkmcnt(3)
 rt a[110:111],v215 offset:10240
 mf v[136:139],a[144:147],v[32:35],v[136:139]
 s_mov_b32 s63,243840
 rt a[156:157],v233 offset:4096
 mf v[136:139],a[148:151],v[48:51],v[136:139]
 bl v238,s[24:27],s63 offen offset:2048 lds
 mf v[152:155],a[148:151],v[52:55],v[152:155]
 rt a[158:159],v233 offset:6144
 mf v[152:155],a[144:147],v[36:39],v[152:155]
 rt a[124:125],v215 offset:12288
 mf v[168:171],a[144:147],v[40:43],v[168:171]
 s_mov_b32 s63,251008
 s_waitcnt vmcnt(7)
 rt a[128:129],v226 offset:0
 mf v[168:171],a[148:151],v[56:59],v[168:171]
 bl v238,s[24:27],s63 offen offset:3072 lds
 mf v[184:187],a[148:151],v[60:63],v[184:187]
 rt a[130:131],v226 offset:2048
 mf v[184:187],a[144:147],v[44:47],v[184:187]
 s_waitcnt lgkmcnt(3)
 s_add_u32 m0,s62,65536
 rt a[126:127],v215 offset:14336
 mf v[188:191],a[152:155],v[44:47],v[188:191]
 s_mov_b32 s63,360576
 rt a[132:133],v226 offset:4096
 mf v[188:191],a[156:159],v[60:63],v[188:191]
 bl v238,s[24:27],s63 offen offset:0 lds
 mf v[172:175],a[156:159],v[56:59],v[172:175]
 rt a[134:135],v226 offset:6144
 mf v[172:175],a[152:155],v[40:43],v[172:175]
 mf v[156:159],a[152:155],v[36:39],v[156:159]
 s_mov_b32 s63,367744
 rt a[136:137],v227 offset:0
 mf v[156:159],a[156:159],v[52:55],v[156:159]
 bl v238,s[24:27],s63 offen offset:1024 lds
 mf v[140:143],a[156:159],v[48:51],v[140:143]
 rt a[138:139],v227 offset:2048
 mf v[140:143],a[152:155],v[32:35],v[140:143]
 s_waitcnt lgkmcnt(2)
 mf v[128:131],a[128:131],a[96:99],v[128:131]
 s_mov_b32 s63,374912
 rt a[140:141],v227 offset:4096
 mf v[128:131],a[132:135],a[112:115],v[128:131]
 bl v238,s[24:27],s63 offen offset:2048 lds
 mf v[144:147],a[132:135],a[116:119],v[144:147]
 rt a[142:143],v227 offset:6144
 mf v[144:147],a[128:131],a[100:103],v[144:147]
 mf v[160:163],a[128:131],a[104:107],v[160:163]
 s_mov_b32 s63,382080
 rt a[144:145],v228 offset:0
 mf v[160:163],a[132:135],a[120:123],v[160:163]
 bl v238,s[24:27],s63 offen offset:3072 lds
 mf v[176:179],a[132:135],a[124:127],v[176:179]
 rt a[146:147],v228 offset:2048
 mf v[176:179],a[128:131],a[108:111],v[176:179]
 s_waitcnt lgkmcnt(2)
 s_add_u32 m0,s62,69632
 mf v[180:183],a[136:139],a[108:111],v[180:183]
 s_mov_b32 s63,491648
 rt a[148:149],v228 offset:4096
 mf v[180:183],a[140:143],a[124:127],v[180:183]
 bl v238,s[24:27],s63 offen offset:0 lds
 mf v[164:167],a[140:143],a[120:123],v[164:167]
 rt a[150:151],v228 offset:6144
 mf v[164:167],a[136:139],a[104:107],v[164:167]
 mf v[148:151],a[136:139],a[100:103],v[148:151]
 s_mov_b32 s63,498816
 rt a[152:153],v229 offset:0
 mf v[148:151],a[140:143],a[116:119],v[148:151]
 bl v238,s[24:27],s63 offen offset:1024 lds
 mf v[132:135],a[140:143],a[112:115],v[132:135]
 rt a[154:155],v229 offset:2048
 mf v[132:135],a[136:139],a[96:99],v[132:135]
 s_waitcnt lgkmcnt(2)
 mf v[136:139],a[144:147],a[96:99],v[136:139]
 s_mov_b32 s63,505984
 rt a[156:157],v229 offset:4096
 mf v[136:139],a[148:151],a[112:115],v[136:139]
 bl v238,s[24:27],s63 offen offset:2048 lds
 mf v[152:155],a[148:151],a[116:119],v[152:155]
 rt a[158:159],v229 offset:6144
 mf v[152:155],a[144:147],a[100:103],v[152:155]
 mf v[168:171],a[144:147],a[104:107],v[168:171]
 s_mov_b32 s63,513152
 s_waitcnt vmcnt(7)
 rt a[128:129],v226 offset:32768
 mf v[168:171],a[148:151],a[120:123],v[168:171]
 bl v238,s[24:27],s63 offen offset:3072 lds
 mf v[184:187],a[148:151],a[124:127],v[184:187]
 rt a[130:131],v226 offset:34816
 mf v[184:187],a[144:147],a[108:111],v[184:187]
 s_waitcnt lgkmcnt(2)
 mf v[188:191],a[152:155],a[108:111],v[188:191]
 s_add_u32 s64,s68,4194304
 rt a[132:133],v226 offset:36864
 mf v[188:191],a[156:159],a[124:127],v[188:191]
 buffer_store_dwordx4 v[64:67],v218,s[16:19],s64 offen offset:0 sc1
 mf v[172:175],a[156:159],a[120:123],v[172:175]
 rt a[134:135],v226 offset:38912
 mf v[172:175],a[152:155],a[104:107],v[172:175]
 mf v[156:159],a[152:155],a[100:103],v[156:159]
 rt a[136:137],v227 offset:32768
 mf v[156:159],a[156:159],a[116:119],v[156:159]
 mf v[140:143],a[156:159],a[112:115],v[140:143]
 rt a[138:139],v227 offset:34816
 mf v[140:143],a[152:155],a[96:99],v[140:143]
 s_waitcnt lgkmcnt(2)
 mf v[128:131],a[128:131],a[0:3],v[128:131]
 s_add_u32 s64,s68,4198400
 rt a[140:141],v227 offset:36864
 mf v[128:131],a[132:135],a[16:19],v[128:131]
 buffer_store_dwordx4 v[72:75],v218,s[16:19],s64 offen offset:0 sc1
 mf v[144:147],a[132:135],a[20:23],v[144:147]
 rt a[142:143],v227 offset:38912
 mf v[144:147],a[128:131],a[4:7],v[144:147]
 mf v[160:163],a[128:131],a[8:11],v[160:163]
 rt a[144:145],v228 offset:32768
 mf v[160:163],a[132:135],a[24:27],v[160:163]
 mf v[176:179],a[132:135],a[28:31],v[176:179]
 rt a[146:147],v228 offset:34816
 mf v[176:179],a[128:131],a[12:15],v[176:179]
 s_waitcnt lgkmcnt(2)
 mf v[180:183],a[136:139],a[12:15],v[180:183]
 s_add_u32 s64,s68,4196352
 rt a[148:149],v228 offset:36864
 mf v[180:183],a[140:143],a[28:31],v[180:183]
 buffer_store_dwordx4 v[80:83],v218,s[16:19],s64 offen offset:0 sc1
 mf v[164:167],a[140:143],a[24:27],v[164:167]
 rt a[150:151],v228 offset:38912
 mf v[164:167],a[136:139],a[8:11],v[164:167]
 mf v[148:151],a[136:139],a[4:7],v[148:151]
 rt a[152:153],v229 offset:32768
 mf v[148:151],a[140:143],a[20:23],v[148:151]
 mf v[132:135],a[140:143],a[16:19],v[132:135]
 rt a[154:155],v229 offset:34816
 mf v[132:135],a[136:139],a[0:3],v[132:135]
 s_waitcnt lgkmcnt(2)
 mf v[136:139],a[144:147],a[0:3],v[136:139]
 s_add_u32 s64,s68,4200448
 rt a[156:157],v229 offset:36864
 mf v[136:139],a[148:151],a[16:19],v[136:139]
 buffer_store_dwordx4 v[88:91],v218,s[16:19],s64 offen offset:0 sc1
 mf v[152:155],a[148:151],a[20:23],v[152:155]
 rt a[158:159],v229 offset:38912
 mf v[152:155],a[144:147],a[4:7],v[152:155]
 mf v[168:171],a[144:147],a[8:11],v[168:171]
 s_waitcnt vmcnt(4)
 rt a[128:129],v230 offset:0
 mf v[168:171],a[148:151],a[24:27],v[168:171]
 mf v[184:187],a[148:151],a[28:31],v[184:187]
 rt a[130:131],v230 offset:2048
 mf v[184:187],a[144:147],a[12:15],v[184:187]
 s_waitcnt lgkmcnt(2)
 mf v[188:191],a[152:155],a[12:15],v[188:191]
 s_add_u32 s64,s68,4259840
 rt a[132:133],v230 offset:4096
 mf v[188:191],a[156:159],a[28:31],v[188:191]
 buffer_store_dwordx4 v[96:99],v219,s[16:19],s64 offen offset:0 sc1
 mf v[172:175],a[156:159],a[24:27],v[172:175]
 rt a[134:135],v230 offset:6144
 mf v[172:175],a[152:155],a[8:11],v[172:175]
 mf v[156:159],a[152:155],a[4:7],v[156:159]
 rt a[136:137],v231 offset:0
 mf v[156:159],a[156:159],a[20:23],v[156:159]
 mf v[140:143],a[156:159],a[16:19],v[140:143]
 rt a[138:139],v231 offset:2048
 mf v[140:143],a[152:155],a[0:3],v[140:143]
 s_waitcnt lgkmcnt(2)
 mf v[128:131],a[128:131],a[32:35],v[128:131]
 s_add_u32 s64,s68,4263936
 rt a[140:141],v231 offset:4096
 mf v[128:131],a[132:135],a[48:51],v[128:131]
 buffer_store_dwordx4 v[104:107],v219,s[16:19],s64 offen offset:0 sc1
 mf v[144:147],a[132:135],a[52:55],v[144:147]
 rt a[142:143],v231 offset:6144
 mf v[144:147],a[128:131],a[36:39],v[144:147]
 mf v[160:163],a[128:131],a[40:43],v[160:163]
 rt a[144:145],v232 offset:0
 mf v[160:163],a[132:135],a[56:59],v[160:163]
 mf v[176:179],a[132:135],a[60:63],v[176:179]
 rt a[146:147],v232 offset:2048
 mf v[176:179],a[128:131],a[44:47],v[176:179]
 s_waitcnt lgkmcnt(2)
 mf v[180:183],a[136:139],a[44:47],v[180:183]
 s_add_u32 s64,s68,4261888
 rt a[148:149],v232 offset:4096
 mf v[180:183],a[140:143],a[60:63],v[180:183]
 buffer_store_dwordx4 v[112:115],v219,s[16:19],s64 offen offset:0 sc1
 mf v[164:167],a[140:143],a[56:59],v[164:167]
 rt a[150:151],v232 offset:6144
 mf v[164:167],a[136:139],a[40:43],v[164:167]
 mf v[148:151],a[136:139],a[36:39],v[148:151]
 rt a[152:153],v233 offset:0
 mf v[148:151],a[140:143],a[52:55],v[148:151]
 mf v[132:135],a[140:143],a[48:51],v[132:135]
 rt a[154:155],v233 offset:2048
 mf v[132:135],a[136:139],a[32:35],v[132:135]
 s_waitcnt lgkmcnt(2)
 mf v[136:139],a[144:147],a[32:35],v[136:139]
 s_add_u32 s64,s68,4265984
 rt a[156:157],v233 offset:4096
 mf v[136:139],a[148:151],a[48:51],v[136:139]
 buffer_store_dwordx4 v[120:123],v219,s[16:19],s64 offen offset:0 sc1
 mf v[152:155],a[148:151],a[52:55],v[152:155]
 rt a[158:159],v233 offset:6144
 mf v[152:155],a[144:147],a[36:39],v[152:155]
 mf v[168:171],a[144:147],a[40:43],v[168:171]
 mf v[168:171],a[148:151],a[56:59],v[168:171]
 mf v[184:187],a[148:151],a[60:63],v[184:187]
 mf v[184:187],a[144:147],a[44:47],v[184:187]
 s_waitcnt lgkmcnt(0)
 mf v[188:191],a[152:155],a[44:47],v[188:191]
 mf v[188:191],a[156:159],a[60:63],v[188:191]
 mf v[172:175],a[156:159],a[56:59],v[172:175]
 mf v[172:175],a[152:155],a[40:43],v[172:175]
 mf v[156:159],a[152:155],a[36:39],v[156:159]
 mf v[156:159],a[156:159],a[52:55],v[156:159]
 mf v[140:143],a[156:159],a[48:51],v[140:143]
 mf v[140:143],a[152:155],a[32:35],v[140:143]
 pk v128,v128,v129
 pk v129,v130,v131
 pk v130,v132,v133
 pk v131,v134,v135
 s_add_u32 s64,s68,4194304
 buffer_store_dwordx4 v[128:131],v218,s[16:19],s64 offen offset:1024 sc1
 pk v136,v136,v137
 pk v137,v138,v139
 pk v138,v140,v141
 pk v139,v142,v143
 s_add_u32 s64,s68,4198400
 buffer_store_dwordx4 v[136:139],v218,s[16:19],s64 offen offset:1024 sc1
 pk v144,v144,v145
 pk v145,v146,v147
 pk v146,v148,v149
 pk v147,v150,v151
 s_add_u32 s64,s68,4196352
 buffer_store_dwordx4 v[144:147],v218,s[16:19],s64 offen offset:1024 sc1
 pk v152,v152,v153
 pk v153,v154,v155
 pk v154,v156,v157
 pk v155,v158,v159
 s_add_u32 s64,s68,4200448
 buffer_store_dwordx4 v[152:155],v218,s[16:19],s64 offen offset:1024 sc1
 v_mov_b32 v240,1
 s_add_u32 s64,s70,2048
 s_waitcnt vmcnt(4)
 s_mov_b64 exec,3
 buffer_store_dword v240,v251,s[16:19],s64 offen sc1
 s_mov_b64 exec,-1
 pk v160,v160,v161
 pk v161,v162,v163
 pk v162,v164,v165
 pk v163,v166,v167
 s_add_u32 s64,s68,4259840
 buffer_store_dwordx4 v[160:163],v219,s[16:19],s64 offen offset:1024 sc1
 pk v168,v168,v169
 pk v169,v170,v171
 pk v170,v172,v173
 pk v171,v174,v175
 s_add_u32 s64,s68,4263936
 buffer_store_dwordx4 v[168:171],v219,s[16:19],s64 offen offset:1024 sc1
 pk v176,v176,v177
 pk v177,v178,v179
 pk v178,v180,v181
 pk v179,v182,v183
 s_add_u32 s64,s68,4261888
 buffer_store_dwordx4 v[176:179],v219,s[16:19],s64 offen offset:1024 sc1
 pk v184,v184,v185
 pk v185,v186,v187
 pk v186,v188,v189
 pk v187,v190,v191
 s_add_u32 s64,s68,4265984
 buffer_store_dwordx4 v[184:187],v219,s[16:19],s64 offen offset:1024 sc1
 v_add_u32 v216,s62,v255
 s_cmp_eq_u32 s3,0
 s_cbranch_scc1 L_away0
 ds_write_b128 v216,v[64:67] offset:0
 ds_write_b128 v216,v[72:75] offset:4096
 ds_write_b128 v216,v[80:83] offset:2048
 ds_write_b128 v216,v[88:91] offset:6144
 ds_write_b128 v216,v[128:131] offset:1024
 ds_write_b128 v216,v[136:139] offset:5120
 ds_write_b128 v216,v[144:147] offset:3072
 ds_write_b128 v216,v[152:155] offset:7168
L_away0:
 s_cmp_eq_u32 s101,0
 s_cbranch_scc1 L_away1
 ds_write_b128 v216,v[96:99] offset:0
 ds_write_b128 v216,v[104:107] offset:4096
 ds_write_b128 v216,v[112:115] offset:2048
 ds_write_b128 v216,v[120:123] offset:6144
 ds_write_b128 v216,v[160:163] offset:1024
 ds_write_b128 v216,v[168:171] offset:5120
 ds_write_b128 v216,v[176:179] offset:3072
 ds_write_b128 v216,v[184:187] offset:7168
L_away1:
 s_lshr_b32 s55,s52,1
 s_lshl_b32 s56,s55,13
 s_lshl_b32 s59,s54,11
 s_add_u32 s56,s56,s59
 s_add_u32 s56,s56,65536
 v_add_u32 v216,s56,v255
 s_waitcnt lgkmcnt(0)
 s_barrier
 rq v[192:195],v216 offset:0
 rq v[196:199],v216 offset:1024
 v_accvgpr_read_b32 v96,a244
 v_accvgpr_read_b32 v97,a245
 v_accvgpr_read_b32 v98,a246
 v_accvgpr_read_b32 v99,a247
 v_accvgpr_read_b32 v100,a248
 v_accvgpr_read_b32 v101,a249
 v_accvgpr_read_b32 v102,a250
 v_accvgpr_read_b32 v103,a251
 v_lshlrev_b32 v64,16,v96
 v_and_b32 v65,0xffff0000,v96
 v_lshlrev_b32 v66,16,v97
 v_and_b32 v67,0xffff0000,v97
 v_lshlrev_b32 v68,16,v98
 v_and_b32 v69,0xffff0000,v98
 v_lshlrev_b32 v70,16,v99
 v_and_b32 v71,0xffff0000,v99
 v_lshlrev_b32 v72,16,v100
 v_and_b32 v73,0xffff0000,v100
 v_lshlrev_b32 v74,16,v101
 v_and_b32 v75,0xffff0000,v101
 v_lshlrev_b32 v76,16,v102
 v_and_b32 v77,0xffff0000,v102
 v_lshlrev_b32 v78,16,v103
 v_and_b32 v79,0xffff0000,v103
 v_fma_f32 v64,v64,v252,v253
 v_fma_f32 v65,v65,v252,v253
 v_fma_f32 v66,v66,v252,v253
 v_fma_f32 v67,v67,v252,v253
 v_fma_f32 v68,v68,v252,v253
 v_fma_f32 v69,v69,v252,v253
 v_fma_f32 v70,v70,v252,v253
 v_fma_f32 v71,v71,v252,v253
 v_fma_f32 v72,v72,v252,v253
 v_fma_f32 v73,v73,v252,v253
 v_fma_f32 v74,v74,v252,v253
 v_fma_f32 v75,v75,v252,v253
 v_fma_f32 v76,v76,v252,v253
 v_fma_f32 v77,v77,v252,v253
 v_fma_f32 v78,v78,v252,v253
 v_fma_f32 v79,v79,v252,v253
 s_waitcnt lgkmcnt(0)
 v_dot2_f32_bf16 v88,v196,s75,0
 v_dot2_f32_bf16 v89,v196,s76,0
 v_dot2_f32_bf16 v90,v197,s75,0
 v_dot2_f32_bf16 v91,v197,s76,0
 v_dot2_f32_bf16 v92,v198,s75,0
 v_dot2_f32_bf16 v93,v198,s76,0
 v_dot2_f32_bf16 v94,v199,s75,0
 v_dot2_f32_bf16 v95,v199,s76,0
 v_dot2_f32_bf16 v80,v192,s75,0
 v_dot2_f32_bf16 v81,v192,s76,0
 v_dot2_f32_bf16 v82,v193,s75,0
 v_dot2_f32_bf16 v83,v193,s76,0
 v_dot2_f32_bf16 v84,v194,s75,0
 v_dot2_f32_bf16 v85,v194,s76,0
 v_dot2_f32_bf16 v86,v195,s75,0
 v_dot2_f32_bf16 v87,v195,s76,0
 v_accvgpr_read_b32 v96,a160
 v_accvgpr_read_b32 v97,a161
 v_accvgpr_read_b32 v98,a162
 v_accvgpr_read_b32 v99,a163
 buffer_load_dword v241,v242,s[16:19],s81 offen sc1
 v_accvgpr_read_b32 v100,a164
 v_accvgpr_read_b32 v101,a165
 v_accvgpr_read_b32 v102,a166
 v_accvgpr_read_b32 v103,a167
 v_dot2_f32_bf16 v64,v96,s75,v64
 v_dot2_f32_bf16 v65,v96,s76,v65
 v_dot2_f32_bf16 v66,v97,s75,v66
 v_dot2_f32_bf16 v67,v97,s76,v67
 v_dot2_f32_bf16 v68,v98,s75,v68
 v_dot2_f32_bf16 v69,v98,s76,v69
 v_dot2_f32_bf16 v70,v99,s75,v70
 v_dot2_f32_bf16 v71,v99,s76,v71
 v_accvgpr_read_b32 v96,a168
 v_accvgpr_read_b32 v97,a169
 v_accvgpr_read_b32 v98,a170
 v_accvgpr_read_b32 v99,a171
 v_dot2_f32_bf16 v72,v100,s75,v72
 v_dot2_f32_bf16 v73,v100,s76,v73
 v_dot2_f32_bf16 v74,v101,s75,v74
 v_dot2_f32_bf16 v75,v101,s76,v75
 v_dot2_f32_bf16 v76,v102,s75,v76
 v_dot2_f32_bf16 v77,v102,s76,v77
 v_dot2_f32_bf16 v78,v103,s75,v78
 v_dot2_f32_bf16 v79,v103,s76,v79
 v_accvgpr_read_b32 v100,a172
 v_accvgpr_read_b32 v101,a173
 v_accvgpr_read_b32 v102,a174
 v_accvgpr_read_b32 v103,a175
 v_dot2_f32_bf16 v64,v96,s75,v64
 v_dot2_f32_bf16 v65,v96,s76,v65
 v_dot2_f32_bf16 v66,v97,s75,v66
 v_dot2_f32_bf16 v67,v97,s76,v67
 v_dot2_f32_bf16 v68,v98,s75,v68
 v_dot2_f32_bf16 v69,v98,s76,v69
 v_dot2_f32_bf16 v70,v99,s75,v70
 v_dot2_f32_bf16 v71,v99,s76,v71
 v_accvgpr_read_b32 v96,a176
 v_accvgpr_read_b32 v97,a177
 v_accvgpr_read_b32 v98,a178
 v_accvgpr_read_b32 v99,a179
 v_dot2_f32_bf16 v72,v100,s75,v72
 v_dot2_f32_bf16 v73,v100,s76,v73
 v_dot2_f32_bf16 v74,v101,s75,v74
 v_dot2_f32_bf16 v75,v101,s76,v75
 v_dot2_f32_bf16 v76,v102,s75,v76
 v_dot2_f32_bf16 v77,v102,s76,v77
 v_dot2_f32_bf16 v78,v103,s75,v78
 v_dot2_f32_bf16 v79,v103,s76,v79
 v_accvgpr_read_b32 v100,a180
 v_accvgpr_read_b32 v101,a181
 v_accvgpr_read_b32 v102,a182
 v_accvgpr_read_b32 v103,a183
 v_dot2_f32_bf16 v64,v96,s75,v64
 v_dot2_f32_bf16 v65,v96,s76,v65
 v_dot2_f32_bf16 v66,v97,s75,v66
 v_dot2_f32_bf16 v67,v97,s76,v67
 v_dot2_f32_bf16 v68,v98,s75,v68
 v_dot2_f32_bf16 v69,v98,s76,v69
 v_dot2_f32_bf16 v70,v99,s75,v70
 v_dot2_f32_bf16 v71,v99,s76,v71
 v_accvgpr_read_b32 v96,a184
 v_accvgpr_read_b32 v97,a185
 v_accvgpr_read_b32 v98,a186
 v_accvgpr_read_b32 v99,a187
 v_dot2_f32_bf16 v72,v100,s75,v72
 v_dot2_f32_bf16 v73,v100,s76,v73
 v_dot2_f32_bf16 v74,v101,s75,v74
 v_dot2_f32_bf16 v75,v101,s76,v75
 v_dot2_f32_bf16 v76,v102,s75,v76
 v_dot2_f32_bf16 v77,v102,s76,v77
 v_dot2_f32_bf16 v78,v103,s75,v78
 v_dot2_f32_bf16 v79,v103,s76,v79
 v_accvgpr_read_b32 v100,a188
 v_accvgpr_read_b32 v101,a189
 v_accvgpr_read_b32 v102,a190
 v_accvgpr_read_b32 v103,a191
 v_dot2_f32_bf16 v64,v96,s75,v64
 v_dot2_f32_bf16 v65,v96,s76,v65
 v_dot2_f32_bf16 v66,v97,s75,v66
 v_dot2_f32_bf16 v67,v97,s76,v67
 v_mov_b32 v240,1
 s_add_u32 s64,s70,3072
 s_waitcnt vmcnt(1)
 s_mov_b64 exec,3
 buffer_store_dword v240,v251,s[16:19],s64 offen sc1
 s_mov_b64 exec,-1
 s_waitcnt vmcnt(1)
 v_cmp_gt_u32 vcc,1,v241
 s_nop 1
 s_cbranch_vccnz L_slow_s0
L_back_s0:
 s_xor_b32 s64,s65,8192
 bl v[4:7],v255,s[16:19],s64 offen offset:0 sc1
 s_xor_b32 s64,s65,16384
 bl v[8:11],v255,s[16:19],s64 offen offset:0 sc1
 s_xor_b32 s64,s65,24576
 bl v[12:15],v255,s[16:19],s64 offen offset:0 sc1
 s_xor_b32 s64,s65,32768
 bl v[16:19],v255,s[16:19],s64 offen offset:0 sc1
 s_xor_b32 s64,s65,40960
 bl v[20:23],v255,s[16:19],s64 offen offset:0 sc1
 s_xor_b32 s64,s65,49152
 bl v[24:27],v255,s[16:19],s64 offen offset:0 sc1
 s_xor_b32 s64,s65,57344
 bl v[28:31],v255,s[16:19],s64 offen offset:0 sc1
 buffer_load_dword v241,v242,s[16:19],s84 offen sc1
 v_dot2_f32_bf16 v68,v98,s75,v68
 v_dot2_f32_bf16 v69,v98,s76,v69
 v_dot2_f32_bf16 v70,v99,s75,v70
 v_dot2_f32_bf16 v71,v99,s76,v71
 v_accvgpr_read_b32 v96,a212
 v_accvgpr_read_b32 v97,a213
 v_accvgpr_read_b32 v98,a214
 v_accvgpr_read_b32 v99,a215
 v_dot2_f32_bf16 v72,v100,s75,v72
 v_dot2_f32_bf16 v73,v100,s76,v73
 v_dot2_f32_bf16 v74,v101,s75,v74
 v_dot2_f32_bf16 v75,v101,s76,v75
 v_dot2_f32_bf16 v76,v102,s75,v76
 v_dot2_f32_bf16 v77,v102,s76,v77
 v_dot2_f32_bf16 v78,v103,s75,v78
 v_dot2_f32_bf16 v79,v103,s76,v79
 v_accvgpr_read_b32 v100,a216
 v_accvgpr_read_b32 v101,a217
 v_accvgpr_read_b32 v102,a218
 v_accvgpr_read_b32 v103,a219
 v_dot2_f32_bf16 v64,v96,s75,v64
 v_dot2_f32_bf16 v65,v96,s76,v65
 v_dot2_f32_bf16 v66,v97,s75,v66
 v_dot2_f32_bf16 v67,v97,s76,v67
 v_dot2_f32_bf16 v68,v98,s75,v68
 v_dot2_f32_bf16 v69,v98,s76,v69
 v_dot2_f32_bf16 v70,v99,s75,v70
 v_dot2_f32_bf16 v71,v99,s76,v71
 v_accvgpr_read_b32 v96,a220
 v_accvgpr_read_b32 v97,a221
 v_accvgpr_read_b32 v98,a222
 v_accvgpr_read_b32 v99,a223
 v_dot2_f32_bf16 v72,v100,s75,v72
 v_dot2_f32_bf16 v73,v100,s76,v73
 v_dot2_f32_bf16 v74,v101,s75,v74
 v_dot2_f32_bf16 v75,v101,s76,v75
 v_dot2_f32_bf16 v76,v102,s75,v76
 v_dot2_f32_bf16 v77,v102,s76,v77
 v_dot2_f32_bf16 v78,v103,s75,v78
L_pad_pg29:
 s_cbranch_execz L_hop7
 v_dot2_f32_bf16 v79,v103,s76,v79
 v_accvgpr_read_b32 v100,a224
 v_accvgpr_read_b32 v101,a225
 v_accvgpr_read_b32 v102,a226
 v_accvgpr_read_b32 v103,a227
 v_dot2_f32_bf16 v64,v96,s75,v64
 v_dot2_f32_bf16 v65,v96,s76,v65
 v_dot2_f32_bf16 v66,v97,s75,v66
 v_dot2_f32_bf16 v67,v97,s76,v67
 v_dot2_f32_bf16 v68,v98,s75,v68
 v_dot2_f32_bf16 v69,v98,s76,v69
 v_dot2_f32_bf16 v70,v99,s75,v70
 v_dot2_f32_bf16 v71,v99,s76,v71
 v_accvgpr_read_b32 v96,a228
 v_accvgpr_read_b32 v97,a229
 v_accvgpr_read_b32 v98,a230
 v_accvgpr_read_b32 v99,a231
 v_dot2_f32_bf16 v72,v100,s75,v72
 v_dot2_f32_bf16 v73,v100,s76,v73
 v_dot2_f32_bf16 v74,v101,s75,v74
 v_dot2_f32_bf16 v75,v101,s76,v75
 v_dot2_f32_bf16 v76,v102,s75,v76
 v_dot2_f32_bf16 v77,v102,s76,v77
 v_dot2_f32_bf16 v78,v103,s75,v78
 v_dot2_f32_bf16 v79,v103,s76,v79
 v_accvgpr_read_b32 v100,a232
 v_accvgpr_read_b32 v101,a233
 v_accvgpr_read_b32 v102,a234
 v_accvgpr_read_b32 v103,a235
 v_dot2_f32_bf16 v64,v96,s75,v64
 v_dot2_f32_bf16 v65,v96,s76,v65
 v_dot2_f32_bf16 v66,v97,s75,v66
 v_dot2_f32_bf16 v67,v97,s76,v67
 v_dot2_f32_bf16 v68,v98,s75,v68
 v_dot2_f32_bf16 v69,v98,s76,v69
 v_dot2_f32_bf16 v70,v99,s75,v70
 v_dot2_f32_bf16 v71,v99,s76,v71
 v_accvgpr_read_b32 v96,a236
 v_accvgpr_read_b32 v97,a237
 v_accvgpr_read_b32 v98,a238
 v_accvgpr_read_b32 v99,a239
 v_dot2_f32_bf16 v72,v100,s75,v72
 v_dot2_f32_bf16 v73,v100,s76,v73
 v_dot2_f32_bf16 v74,v101,s75,v74
 v_dot2_f32_bf16 v75,v101,s76,v75
 v_dot2_f32_bf16 v76,v102,s75,v76
 v_dot2_f32_bf16 v77,v102,s76,v77
 v_dot2_f32_bf16 v78,v103,s75,v78
 v_dot2_f32_bf16 v79,v103,s76,v79
 v_accvgpr_read_b32 v100,a240
 v_accvgpr_read_b32 v101,a241
 v_accvgpr_read_b32 v102,a242
 v_accvgpr_read_b32 v103,a243
 v_dot2_f32_bf16 v64,v96,s75,v64
 v_dot2_f32_bf16 v65,v96,s76,v65
 v_dot2_f32_bf16 v66,v97,s75,v66
 v_dot2_f32_bf16 v67,v97,s76,v67
 v_dot2_f32_bf16 v68,v98,s75,v68
 v_dot2_f32_bf16 v69,v98,s76,v69
 v_dot2_f32_bf16 v70,v99,s75,v70
 v_dot2_f32_bf16 v71,v99,s76,v71
 v_dot2_f32_bf16 v72,v100,s75,v72
 v_dot2_f32_bf16 v73,v100,s76,v73
 v_dot2_f32_bf16 v74,v101,s75,v74
 v_dot2_f32_bf16 v75,v101,s76,v75
 v_dot2_f32_bf16 v76,v102,s75,v76
 v_dot2_f32_bf16 v77,v102,s76,v77
 v_dot2_f32_bf16 v78,v103,s75,v78
 v_dot2_f32_bf16 v79,v103,s76,v79
 v_mul_f32 v96,s80,v64
 v_mul_f32 v97,s80,v65
 v_mul_f32 v98,s80,v66
 v_mul_f32 v99,s80,v67
 v_mul_f32 v100,s80,v68
 v_mul_f32 v101,s80,v69
 v_mul_f32 v102,s80,v70
 v_mul_f32 v103,s80,v71
 v_mul_f32 v104,s80,v72
 v_mul_f32 v105,s80,v73
 v_mul_f32 v106,s80,v74
 v_mul_f32 v107,s80,v75
 v_mul_f32 v108,s80,v76
 v_mul_f32 v109,s80,v77
 v_mul_f32 v110,s80,v78
 v_mul_f32 v111,s80,v79
 v_exp_f32 v96,v96
 v_exp_f32 v97,v97
 v_exp_f32 v98,v98
 v_exp_f32 v99,v99
 v_exp_f32 v100,v100
 v_exp_f32 v101,v101
 v_exp_f32 v102,v102
 v_exp_f32 v103,v103
 v_exp_f32 v104,v104
 v_exp_f32 v105,v105
 v_exp_f32 v106,v106
 v_exp_f32 v107,v107
 v_exp_f32 v108,v108
 v_exp_f32 v109,v109
 v_exp_f32 v110,v110
 v_exp_f32 v111,v111
 s_mov_b32 s55,0x3eeff558
 v_fma_f32 v96,v96,s55,s55
 v_fma_f32 v97,v97,s55,s55
 v_fma_f32 v98,v98,s55,s55
 v_fma_f32 v99,v99,s55,s55
 v_fma_f32 v100,v100,s55,s55
 v_fma_f32 v101,v101,s55,s55
 v_fma_f32 v102,v102,s55,s55
 v_fma_f32 v103,v103,s55,s55
 v_fma_f32 v104,v104,s55,s55
 v_fma_f32 v105,v105,s55,s55
 v_fma_f32 v106,v106,s55,s55
 v_fma_f32 v107,v107,s55,s55
 v_fma_f32 v108,v108,s55,s55
 v_fma_f32 v109,v109,s55,s55
 v_fma_f32 v110,v110,s55,s55
 v_fma_f32 v111,v111,s55,s55
 v_rcp_f32 v96,v96
 v_rcp_f32 v97,v97
 v_rcp_f32 v98,v98
 v_rcp_f32 v99,v99
 v_rcp_f32 v100,v100
 v_rcp_f32 v101,v101
 v_rcp_f32 v102,v102
 v_rcp_f32 v103,v103
 v_rcp_f32 v104,v104
 v_rcp_f32 v105,v105
 v_rcp_f32 v106,v106
 v_rcp_f32 v107,v107
 v_rcp_f32 v108,v108
 v_rcp_f32 v109,v109
 v_rcp_f32 v110,v110
 v_rcp_f32 v111,v111
 v_pk_mul_f32 v[96:97],v[96:97],v[64:65]
 v_pk_mul_f32 v[98:99],v[98:99],v[66:67]
 v_pk_mul_f32 v[100:101],v[100:101],v[68:69]
 v_pk_mul_f32 v[102:103],v[102:103],v[70:71]
 v_pk_mul_f32 v[104:105],v[104:105],v[72:73]
 v_pk_mul_f32 v[106:107],v[106:107],v[74:75]
 v_pk_mul_f32 v[108:109],v[108:109],v[76:77]
 v_pk_mul_f32 v[110:111],v[110:111],v[78:79]
 v_lshlrev_b32 v112,16,v244
 v_and_b32 v113,0xffff0000,v244
 v_lshlrev_b32 v114,16,v245
 v_and_b32 v115,0xffff0000,v245
 v_lshlrev_b32 v116,16,v246
 v_and_b32 v117,0xffff0000,v246
 v_lshlrev_b32 v118,16,v247
 v_and_b32 v119,0xffff0000,v247
 v_lshlrev_b32 v120,16,v248
 v_and_b32 v121,0xffff0000,v248
 v_lshlrev_b32 v122,16,v249
 v_and_b32 v123,0xffff0000,v249
 v_lshlrev_b32 v124,16,v236
 v_and_b32 v125,0xffff0000,v236
 v_lshlrev_b32 v126,16,v237
 v_and_b32 v127,0xffff0000,v237
 v_bfe_u32 v200,v254,4,4
 v_lshlrev_b32 v200,10,v200
 v_bfe_u32 v201,v255,8,2
 v_lshl_add_u32 v200,v201,4,v200
 s_waitcnt vmcnt(0)
 v_cmp_gt_u32 vcc,1,v241
 s_nop 1
 s_cbranch_vccnz L_slow_s1
L_back_s1:
 s_xor_b32 s64,s65,8192
 bl v[36:39],v255,s[16:19],s64 offen offset:1024 sc1
 s_xor_b32 s64,s65,16384
 bl v[40:43],v255,s[16:19],s64 offen offset:1024 sc1
 s_xor_b32 s64,s65,24576
 bl v[44:47],v255,s[16:19],s64 offen offset:1024 sc1
 s_xor_b32 s64,s65,32768
 bl v[48:51],v255,s[16:19],s64 offen offset:1024 sc1
 s_xor_b32 s64,s65,40960
 bl v[52:55],v255,s[16:19],s64 offen offset:1024 sc1
 s_xor_b32 s64,s65,49152
 bl v[56:59],v255,s[16:19],s64 offen offset:1024 sc1
 s_xor_b32 s64,s65,57344
 bl v[60:63],v255,s[16:19],s64 offen offset:1024 sc1
 v_dot2_f32_bf16 v80,v4,s75,v80
 v_dot2_f32_bf16 v81,v4,s76,v81
 v_dot2_f32_bf16 v82,v5,s75,v82
 v_dot2_f32_bf16 v83,v5,s76,v83
 v_dot2_f32_bf16 v84,v6,s75,v84
 v_dot2_f32_bf16 v85,v6,s76,v85
 v_dot2_f32_bf16 v86,v7,s75,v86
 v_dot2_f32_bf16 v87,v7,s76,v87
 v_dot2_f32_bf16 v80,v8,s75,v80
 v_dot2_f32_bf16 v81,v8,s76,v81
 v_dot2_f32_bf16 v82,v9,s75,v82
 v_dot2_f32_bf16 v83,v9,s76,v83
 v_dot2_f32_bf16 v84,v10,s75,v84
 v_dot2_f32_bf16 v85,v10,s76,v85
 v_dot2_f32_bf16 v86,v11,s75,v86
 v_dot2_f32_bf16 v87,v11,s76,v87
 v_dot2_f32_bf16 v80,v12,s75,v80
 v_dot2_f32_bf16 v81,v12,s76,v81
 v_dot2_f32_bf16 v82,v13,s75,v82
 v_dot2_f32_bf16 v83,v13,s76,v83
 v_dot2_f32_bf16 v84,v14,s75,v84
 v_dot2_f32_bf16 v85,v14,s76,v85
 v_dot2_f32_bf16 v86,v15,s75,v86
 v_dot2_f32_bf16 v87,v15,s76,v87
 v_dot2_f32_bf16 v80,v16,s75,v80
 v_dot2_f32_bf16 v81,v16,s76,v81
 v_dot2_f32_bf16 v82,v17,s75,v82
 v_dot2_f32_bf16 v83,v17,s76,v83
 v_dot2_f32_bf16 v84,v18,s75,v84
 v_dot2_f32_bf16 v85,v18,s76,v85
 v_dot2_f32_bf16 v86,v19,s75,v86
 v_dot2_f32_bf16 v87,v19,s76,v87
 v_dot2_f32_bf16 v80,v20,s75,v80
 v_dot2_f32_bf16 v81,v20,s76,v81
 v_dot2_f32_bf16 v82,v21,s75,v82
 v_dot2_f32_bf16 v83,v21,s76,v83
 v_dot2_f32_bf16 v84,v22,s75,v84
 v_dot2_f32_bf16 v85,v22,s76,v85
 v_dot2_f32_bf16 v86,v23,s75,v86
 v_dot2_f32_bf16 v87,v23,s76,v87
 v_dot2_f32_bf16 v80,v24,s75,v80
 v_dot2_f32_bf16 v81,v24,s76,v81
 v_dot2_f32_bf16 v82,v25,s75,v82
 v_dot2_f32_bf16 v83,v25,s76,v83
 v_dot2_f32_bf16 v84,v26,s75,v84
 v_dot2_f32_bf16 v85,v26,s76,v85
 v_dot2_f32_bf16 v86,v27,s75,v86
 v_dot2_f32_bf16 v87,v27,s76,v87
 v_dot2_f32_bf16 v80,v28,s75,v80
 v_dot2_f32_bf16 v81,v28,s76,v81
 v_dot2_f32_bf16 v82,v29,s75,v82
 v_dot2_f32_bf16 v83,v29,s76,v83
 v_dot2_f32_bf16 v84,v30,s75,v84
 v_dot2_f32_bf16 v85,v30,s76,v85
 v_dot2_f32_bf16 v86,v31,s75,v86
 v_dot2_f32_bf16 v87,v31,s76,v87
 v_pk_fma_f32 v[96:97],v[96:97],v[80:81],v[112:113]
 v_pk_fma_f32 v[98:99],v[98:99],v[82:83],v[114:115]
 v_pk_fma_f32 v[100:101],v[100:101],v[84:85],v[116:117]
 v_pk_fma_f32 v[102:103],v[102:103],v[86:87],v[118:119]
 pk v204,v96,v97
 pk v205,v98,v99
 pk v206,v100,v101
 pk v207,v102,v103
 s_nop 0
 v_permlane32_swap_b32 v204,v206
 v_permlane32_swap_b32 v205,v207
 s_nop 0
 v_permlane16_swap_b32 v204,v206
 v_permlane16_swap_b32 v205,v207
 buffer_store_dwordx4 v[204:207],v200,s[44:47],s87 offen offset:0
 s_waitcnt vmcnt(7)
 v_dot2_f32_bf16 v88,v36,s75,v88
 v_dot2_f32_bf16 v89,v36,s76,v89
 v_dot2_f32_bf16 v90,v37,s75,v90
 v_dot2_f32_bf16 v91,v37,s76,v91
 v_dot2_f32_bf16 v92,v38,s75,v92
 v_dot2_f32_bf16 v93,v38,s76,v93
 v_dot2_f32_bf16 v94,v39,s75,v94
 v_dot2_f32_bf16 v95,v39,s76,v95
 s_waitcnt vmcnt(6)
 v_dot2_f32_bf16 v88,v40,s75,v88
 v_dot2_f32_bf16 v89,v40,s76,v89
 v_dot2_f32_bf16 v90,v41,s75,v90
 v_dot2_f32_bf16 v91,v41,s76,v91
 v_dot2_f32_bf16 v92,v42,s75,v92
 v_dot2_f32_bf16 v93,v42,s76,v93
 v_dot2_f32_bf16 v94,v43,s75,v94
 v_dot2_f32_bf16 v95,v43,s76,v95
 s_waitcnt vmcnt(5)
 v_dot2_f32_bf16 v88,v44,s75,v88
 v_dot2_f32_bf16 v89,v44,s76,v89
 v_dot2_f32_bf16 v90,v45,s75,v90
 v_dot2_f32_bf16 v91,v45,s76,v91
 v_dot2_f32_bf16 v92,v46,s75,v92
 v_dot2_f32_bf16 v93,v46,s76,v93
 v_dot2_f32_bf16 v94,v47,s75,v94
 v_dot2_f32_bf16 v95,v47,s76,v95
 s_waitcnt vmcnt(4)
 v_dot2_f32_bf16 v88,v48,s75,v88
 v_dot2_f32_bf16 v89,v48,s76,v89
 v_dot2_f32_bf16 v90,v49,s75,v90
 v_dot2_f32_bf16 v91,v49,s76,v91
 v_dot2_f32_bf16 v92,v50,s75,v92
 v_dot2_f32_bf16 v93,v50,s76,v93
 v_dot2_f32_bf16 v94,v51,s75,v94
 v_dot2_f32_bf16 v95,v51,s76,v95
 s_waitcnt vmcnt(3)
 v_dot2_f32_bf16 v88,v52,s75,v88
 v_dot2_f32_bf16 v89,v52,s76,v89
 v_dot2_f32_bf16 v90,v53,s75,v90
 v_dot2_f32_bf16 v91,v53,s76,v91
 v_dot2_f32_bf16 v92,v54,s75,v92
 v_dot2_f32_bf16 v93,v54,s76,v93
 v_dot2_f32_bf16 v94,v55,s75,v94
 v_dot2_f32_bf16 v95,v55,s76,v95
 s_waitcnt vmcnt(2)
 v_dot2_f32_bf16 v88,v56,s75,v88
 v_dot2_f32_bf16 v89,v56,s76,v89
 v_dot2_f32_bf16 v90,v57,s75,v90
 v_dot2_f32_bf16 v91,v57,s76,v91
 v_dot2_f32_bf16 v92,v58,s75,v92
 v_dot2_f32_bf16 v93,v58,s76,v93
 v_dot2_f32_bf16 v94,v59,s75,v94
 v_dot2_f32_bf16 v95,v59,s76,v95
 s_waitcnt vmcnt(1)
 v_dot2_f32_bf16 v88,v60,s75,v88
 v_dot2_f32_bf16 v89,v60,s76,v89
 v_dot2_f32_bf16 v90,v61,s75,v90
 v_dot2_f32_bf16 v91,v61,s76,v91
 v_dot2_f32_bf16 v92,v62,s75,v92
 v_dot2_f32_bf16 v93,v62,s76,v93
 v_dot2_f32_bf16 v94,v63,s75,v94
 v_dot2_f32_bf16 v95,v63,s76,v95
 v_pk_fma_f32 v[104:105],v[104:105],v[88:89],v[120:121]
 v_pk_fma_f32 v[106:107],v[106:107],v[90:91],v[122:123]
 v_pk_fma_f32 v[108:109],v[108:109],v[92:93],v[124:125]
 v_pk_fma_f32 v[110:111],v[110:111],v[94:95],v[126:127]
 pk v208,v104,v105
 pk v209,v106,v107
 pk v210,v108,v109
 pk v211,v110,v111
 s_nop 0
 v_permlane32_swap_b32 v208,v210
 v_permlane32_swap_b32 v209,v211
 s_nop 0
 v_permlane16_swap_b32 v208,v210
 v_permlane16_swap_b32 v209,v211
 buffer_store_dwordx4 v[208:211],v200,s[44:47],s87 offen offset:128
 s_endpgm
L_side:
L_slow_h:
 s_sleep 1
 buffer_load_dword v241,v242,s[48:51],0 offen sc1
 s_add_u32 s66,s66,1
 s_waitcnt vmcnt(0)
 v_cmp_gt_u32 vcc,8,v241
 s_cmp_gt_u32 s66,0x200000
 s_cbranch_scc1 L_back_h
 s_cbranch_vccnz L_slow_h
 s_branch L_back_h
L_slow_x1:
 s_sleep 1
 buffer_load_dword v241,v242,s[16:19],s71 offen sc1
 s_add_u32 s66,s66,1
 s_waitcnt vmcnt(0)
 v_cmp_gt_u32 vcc,1,v241
 s_cmp_gt_u32 s66,0x200000
 s_cbranch_scc1 L_back_x1
 s_cbranch_vccnz L_slow_x1
 s_branch L_back_x1
L_slow_st:
 s_sleep 1
 buffer_load_dwordx2 v[226:227],v242,s[16:19],s74 offen offset:0 sc1
 buffer_load_dwordx2 v[228:229],v242,s[16:19],s74 offen offset:128 sc1
 buffer_load_dwordx2 v[230:231],v242,s[16:19],s86 offen offset:0 sc1
 buffer_load_dwordx2 v[232:233],v242,s[16:19],s86 offen offset:128 sc1
 s_add_u32 s66,s66,1
 s_waitcnt vmcnt(0)
 v_max3_u32 v234,v226,v227,v228
 v_max3_u32 v234,v234,v229,v230
 v_max3_u32 v234,v234,v231,v232
 v_max_u32 v234,v234,v233
 v_cmp_eq_u32 vcc,-1,v234
 s_cmp_gt_u32 s66,0x200000
 s_cbranch_scc1 L_back_st
 s_cbranch_vccnz L_slow_st
 s_branch L_back_st
L_slow_ph:
 s_sleep 1
 buffer_load_dword v241,v242,s[16:19],s72 offen sc1
 s_add_u32 s66,s66,1
 s_waitcnt vmcnt(0)
 v_cmp_gt_u32 vcc,1,v241
 s_cmp_gt_u32 s66,0x200000
 s_cbranch_scc1 L_back_ph
 s_cbranch_vccnz L_slow_ph
 s_branch L_back_ph
L_slow_s0:
 s_sleep 1
 buffer_load_dword v241,v242,s[16:19],s81 offen sc1
 s_add_u32 s66,s66,1
 s_waitcnt vmcnt(0)
 v_cmp_gt_u32 vcc,1,v241
 s_cmp_gt_u32 s66,0x200000
 s_cbranch_scc1 L_back_s0
 s_cbranch_vccnz L_slow_s0
 s_branch L_back_s0
L_slow_s1:
 s_sleep 1
 buffer_load_dword v241,v242,s[16:19],s84 offen sc1
 s_add_u32 s66,s66,1
 s_waitcnt vmcnt(0)
 v_cmp_gt_u32 vcc,1,v241
 s_cmp_gt_u32 s66,0x200000
 s_cbranch_scc1 L_back_s1
 s_cbranch_vccnz L_slow_s1
 s_branch L_back_s1
L_redo:
 s_mov_b32 s100,0
 v_add_u32 v208,49152,v208
 v_add_u32 v209,49152,v209
 v_add_u32 v210,49152,v210
 v_add_u32 v211,49152,v211
 v_mov_b32 v192,0xff800000
 v_mov_b32 v196,0xff800000
 v_mov_b32 v200,0xff800000
 v_mov_b32 v204,0xff800000
 s_mov_b32 s65,0
L_rmax:
 s_waitcnt vmcnt(0) lgkmcnt(0)
 s_barrier
 s_add_u32 m0,s61,98304
 s_mov_b32 s63,s65
 bl v220,s[8:11],s63 offen offset:0 lds
 bl v221,s[8:11],s63 offen offset:1024 lds
 bl v222,s[8:11],s63 offen offset:2048 lds
 bl v223,s[8:11],s63 offen offset:3072 lds
 s_waitcnt vmcnt(0) lgkmcnt(0)
 s_barrier
 rq a[128:131],v208 offset:49152
 rq a[132:135],v209 offset:49152
 rq a[136:139],v210 offset:49152
 rq a[140:143],v211 offset:49152
 rq a[144:147],v208 offset:53248
 rq a[148:151],v209 offset:53248
 rq a[152:155],v210 offset:53248
 rq a[156:159],v211 offset:53248
 s_waitcnt lgkmcnt(4)
 mf v[64:67],a[128:131],v[128:131],0
 mf v[64:67],a[132:135],v[132:135],v[64:67]
 mf v[64:67],a[136:139],v[136:139],v[64:67]
 mf v[64:67],a[140:143],v[140:143],v[64:67]
 mf v[80:83],a[140:143],v[156:159],0
 mf v[80:83],a[136:139],v[152:155],v[80:83]
 mf v[80:83],a[132:135],v[148:151],v[80:83]
 mf v[80:83],a[128:131],v[144:147],v[80:83]
 mf v[96:99],a[128:131],v[160:163],0
 mf v[96:99],a[132:135],v[164:167],v[96:99]
 mf v[96:99],a[136:139],v[168:171],v[96:99]
 mf v[96:99],a[140:143],v[172:175],v[96:99]
 mf v[112:115],a[140:143],v[188:191],0
 mf v[112:115],a[136:139],v[184:187],v[112:115]
 mf v[112:115],a[132:135],v[180:183],v[112:115]
 mf v[112:115],a[128:131],v[176:179],v[112:115]
 s_waitcnt lgkmcnt(0)
 mf v[116:119],a[144:147],v[176:179],0
 mf v[116:119],a[148:151],v[180:183],v[116:119]
 mf v[116:119],a[152:155],v[184:187],v[116:119]
 mf v[116:119],a[156:159],v[188:191],v[116:119]
 mf v[100:103],a[156:159],v[172:175],0
 mf v[100:103],a[152:155],v[168:171],v[100:103]
 mf v[100:103],a[148:151],v[164:167],v[100:103]
 mf v[100:103],a[144:147],v[160:163],v[100:103]
 mf v[84:87],a[144:147],v[144:147],0
 mf v[84:87],a[148:151],v[148:151],v[84:87]
 mf v[84:87],a[152:155],v[152:155],v[84:87]
 mf v[84:87],a[156:159],v[156:159],v[84:87]
 mf v[68:71],a[156:159],v[140:143],0
 mf v[68:71],a[152:155],v[136:139],v[68:71]
 mf v[68:71],a[148:151],v[132:135],v[68:71]
 mf v[68:71],a[144:147],v[128:131],v[68:71]
 rq a[128:131],v208 offset:57344
 rq a[132:135],v209 offset:57344
 rq a[136:139],v210 offset:57344
 rq a[140:143],v211 offset:57344
 rq a[144:147],v208 offset:61440
 rq a[148:151],v209 offset:61440
 rq a[152:155],v210 offset:61440
 rq a[156:159],v211 offset:61440
 s_waitcnt lgkmcnt(4)
 mf v[72:75],a[128:131],v[128:131],0
 mf v[72:75],a[132:135],v[132:135],v[72:75]
 mf v[72:75],a[136:139],v[136:139],v[72:75]
 mf v[72:75],a[140:143],v[140:143],v[72:75]
 mf v[88:91],a[140:143],v[156:159],0
 mf v[88:91],a[136:139],v[152:155],v[88:91]
 mf v[88:91],a[132:135],v[148:151],v[88:91]
 mf v[88:91],a[128:131],v[144:147],v[88:91]
 mf v[104:107],a[128:131],v[160:163],0
 mf v[104:107],a[132:135],v[164:167],v[104:107]
 mf v[104:107],a[136:139],v[168:171],v[104:107]
 mf v[104:107],a[140:143],v[172:175],v[104:107]
 mf v[120:123],a[140:143],v[188:191],0
 mf v[120:123],a[136:139],v[184:187],v[120:123]
 mf v[120:123],a[132:135],v[180:183],v[120:123]
 mf v[120:123],a[128:131],v[176:179],v[120:123]
 s_waitcnt lgkmcnt(0)
 mf v[124:127],a[144:147],v[176:179],0
 mf v[124:127],a[148:151],v[180:183],v[124:127]
 mf v[124:127],a[152:155],v[184:187],v[124:127]
 mf v[124:127],a[156:159],v[188:191],v[124:127]
 mf v[108:111],a[156:159],v[172:175],0
 mf v[108:111],a[152:155],v[168:171],v[108:111]
 mf v[108:111],a[148:151],v[164:167],v[108:111]
 mf v[108:111],a[144:147],v[160:163],v[108:111]
 mf v[92:95],a[144:147],v[144:147],0
 mf v[92:95],a[148:151],v[148:151],v[92:95]
 mf v[92:95],a[152:155],v[152:155],v[92:95]
 mf v[92:95],a[156:159],v[156:159],v[92:95]
 mf v[76:79],a[156:159],v[140:143],0
 mf v[76:79],a[152:155],v[136:139],v[76:79]
 mf v[76:79],a[148:151],v[132:135],v[76:79]
 mf v[76:79],a[144:147],v[128:131],v[76:79]
 v_max3_f32 v192,v192,v64,v65
 v_max3_f32 v192,v192,v66,v67
 v_max3_f32 v192,v192,v68,v69
 v_max3_f32 v192,v192,v70,v71
 v_max3_f32 v192,v192,v72,v73
 v_max3_f32 v192,v192,v74,v75
 s_nop 1
 v_max3_f32 v192,v192,v76,v77
 v_max3_f32 v192,v192,v78,v79
 v_max3_f32 v196,v196,v80,v81
 v_max3_f32 v196,v196,v82,v83
 v_max3_f32 v196,v196,v84,v85
 v_max3_f32 v196,v196,v86,v87
 v_max3_f32 v196,v196,v88,v89
 v_max3_f32 v196,v196,v90,v91
 v_max3_f32 v196,v196,v92,v93
 v_max3_f32 v196,v196,v94,v95
 v_max3_f32 v200,v200,v96,v97
 v_max3_f32 v200,v200,v98,v99
 v_max3_f32 v200,v200,v100,v101
 v_max3_f32 v200,v200,v102,v103
 v_max3_f32 v200,v200,v104,v105
 v_max3_f32 v200,v200,v106,v107
 v_max3_f32 v200,v200,v108,v109
 v_max3_f32 v200,v200,v110,v111
 v_max3_f32 v204,v204,v112,v113
 v_max3_f32 v204,v204,v114,v115
 v_max3_f32 v204,v204,v116,v117
 v_max3_f32 v204,v204,v118,v119
 v_max3_f32 v204,v204,v120,v121
 v_max3_f32 v204,v204,v122,v123
 v_max3_f32 v204,v204,v124,v125
 v_max3_f32 v204,v204,v126,v127
 s_add_u32 s65,s65,16384
 s_cmp_lt_u32 s65,0x80000
 s_cbranch_scc1 L_rmax
 v_mov_b32 v193,v192
 v_mov_b32 v197,v196
 v_mov_b32 v201,v200
 v_mov_b32 v205,v204
 v_permlane32_swap_b32 v192,v193
 v_permlane32_swap_b32 v196,v197
 v_permlane32_swap_b32 v200,v201
 v_permlane32_swap_b32 v204,v205
 v_max_f32 v192,v192,v193
 v_max_f32 v196,v196,v197
 v_max_f32 v200,v200,v201
 v_max_f32 v204,v204,v205
 v_mov_b32 v193,v192
 v_mov_b32 v197,v196
 v_mov_b32 v201,v200
 v_mov_b32 v205,v204
 v_permlane16_swap_b32 v192,v193
 v_permlane16_swap_b32 v196,v197
 v_permlane16_swap_b32 v200,v201
 v_permlane16_swap_b32 v204,v205
 v_max_f32 v192,v192,v193
 v_max_f32 v196,v196,v197
 v_max_f32 v200,v200,v201
 v_max_f32 v204,v204,v205
 v_sub_f32 v193,0,v192
 v_sub_f32 v194,0,v192
 v_sub_f32 v195,0,v192
 v_sub_f32 v192,0,v192
 v_sub_f32 v197,0,v196
 v_sub_f32 v198,0,v196
 v_sub_f32 v199,0,v196
 v_sub_f32 v196,0,v196
 v_sub_f32 v201,0,v200
 v_sub_f32 v202,0,v200
 v_sub_f32 v203,0,v200
 v_sub_f32 v200,0,v200
 v_sub_f32 v205,0,v204
 v_sub_f32 v206,0,v204
 v_sub_f32 v207,0,v204
 v_sub_f32 v204,0,v204
 v_accvgpr_write_b32 a0,0
 v_accvgpr_write_b32 a1,0
 v_accvgpr_write_b32 a2,0
 v_accvgpr_write_b32 a3,0
 v_accvgpr_write_b32 a4,0
 v_accvgpr_write_b32 a5,0
 v_accvgpr_write_b32 a6,0
 v_accvgpr_write_b32 a7,0
 v_accvgpr_write_b32 a8,0
 v_accvgpr_write_b32 a9,0
 v_accvgpr_write_b32 a10,0
 v_accvgpr_write_b32 a11,0
 v_accvgpr_write_b32 a12,0
 v_accvgpr_write_b32 a13,0
 v_accvgpr_write_b32 a14,0
 v_accvgpr_write_b32 a15,0
 v_accvgpr_write_b32 a16,0
 v_accvgpr_write_b32 a17,0
 v_accvgpr_write_b32 a18,0
 v_accvgpr_write_b32 a19,0
 v_accvgpr_write_b32 a20,0
 v_accvgpr_write_b32 a21,0
 v_accvgpr_write_b32 a22,0
 v_accvgpr_write_b32 a23,0
 v_accvgpr_write_b32 a24,0
 v_accvgpr_write_b32 a25,0
 v_accvgpr_write_b32 a26,0
 v_accvgpr_write_b32 a27,0
 v_accvgpr_write_b32 a28,0
 v_accvgpr_write_b32 a29,0
 v_accvgpr_write_b32 a30,0
 v_accvgpr_write_b32 a31,0
 v_accvgpr_write_b32 a32,0
 v_accvgpr_write_b32 a33,0
 v_accvgpr_write_b32 a34,0
 v_accvgpr_write_b32 a35,0
 v_accvgpr_write_b32 a36,0
 v_accvgpr_write_b32 a37,0
 v_accvgpr_write_b32 a38,0
 v_accvgpr_write_b32 a39,0
 v_accvgpr_write_b32 a40,0
 v_accvgpr_write_b32 a41,0
 v_accvgpr_write_b32 a42,0
 v_accvgpr_write_b32 a43,0
 v_accvgpr_write_b32 a44,0
 v_accvgpr_write_b32 a45,0
 v_accvgpr_write_b32 a46,0
 v_accvgpr_write_b32 a47,0
 v_accvgpr_write_b32 a48,0
 v_accvgpr_write_b32 a49,0
 v_accvgpr_write_b32 a50,0
 v_accvgpr_write_b32 a51,0
 v_accvgpr_write_b32 a52,0
 v_accvgpr_write_b32 a53,0
 v_accvgpr_write_b32 a54,0
 v_accvgpr_write_b32 a55,0
 v_accvgpr_write_b32 a56,0
 v_accvgpr_write_b32 a57,0
 v_accvgpr_write_b32 a58,0
 v_accvgpr_write_b32 a59,0
 v_accvgpr_write_b32 a60,0
 v_accvgpr_write_b32 a61,0
 v_accvgpr_write_b32 a62,0
 v_accvgpr_write_b32 a63,0
 v_accvgpr_write_b32 a64,0
 v_accvgpr_write_b32 a65,0
 v_accvgpr_write_b32 a66,0
 v_accvgpr_write_b32 a67,0
 v_accvgpr_write_b32 a68,0
 v_accvgpr_write_b32 a69,0
 v_accvgpr_write_b32 a70,0
 v_accvgpr_write_b32 a71,0
 v_accvgpr_write_b32 a72,0
 v_accvgpr_write_b32 a73,0
 v_accvgpr_write_b32 a74,0
 v_accvgpr_write_b32 a75,0
 v_accvgpr_write_b32 a76,0
 v_accvgpr_write_b32 a77,0
 v_accvgpr_write_b32 a78,0
 v_accvgpr_write_b32 a79,0
 v_accvgpr_write_b32 a80,0
 v_accvgpr_write_b32 a81,0
 v_accvgpr_write_b32 a82,0
 v_accvgpr_write_b32 a83,0
 v_accvgpr_write_b32 a84,0
 v_accvgpr_write_b32 a85,0
 v_accvgpr_write_b32 a86,0
 v_accvgpr_write_b32 a87,0
 v_accvgpr_write_b32 a88,0
 v_accvgpr_write_b32 a89,0
 v_accvgpr_write_b32 a90,0
 v_accvgpr_write_b32 a91,0
 v_accvgpr_write_b32 a92,0
 v_accvgpr_write_b32 a93,0
 v_accvgpr_write_b32 a94,0
 v_accvgpr_write_b32 a95,0
 v_accvgpr_write_b32 a96,0
 v_accvgpr_write_b32 a97,0
 v_accvgpr_write_b32 a98,0
 v_accvgpr_write_b32 a99,0
 v_accvgpr_write_b32 a100,0
 v_accvgpr_write_b32 a101,0
 v_accvgpr_write_b32 a102,0
 v_accvgpr_write_b32 a103,0
 v_accvgpr_write_b32 a104,0
 v_accvgpr_write_b32 a105,0
 v_accvgpr_write_b32 a106,0
 v_accvgpr_write_b32 a107,0
 v_accvgpr_write_b32 a108,0
 v_accvgpr_write_b32 a109,0
 v_accvgpr_write_b32 a110,0
 v_accvgpr_write_b32 a111,0
 v_accvgpr_write_b32 a112,0
 v_accvgpr_write_b32 a113,0
 v_accvgpr_write_b32 a114,0
 v_accvgpr_write_b32 a115,0
 v_accvgpr_write_b32 a116,0
 v_accvgpr_write_b32 a117,0
 v_accvgpr_write_b32 a118,0
 v_accvgpr_write_b32 a119,0
 v_accvgpr_write_b32 a120,0
 v_accvgpr_write_b32 a121,0
 v_accvgpr_write_b32 a122,0
 v_accvgpr_write_b32 a123,0
 v_accvgpr_write_b32 a124,0
 v_accvgpr_write_b32 a125,0
 v_accvgpr_write_b32 a126,0
 v_accvgpr_write_b32 a127,0
 v_accvgpr_write_b32 a192,0
 v_accvgpr_write_b32 a193,0
 v_accvgpr_write_b32 a194,0
 v_accvgpr_write_b32 a195,0
 v_accvgpr_write_b32 a196,0
 v_accvgpr_write_b32 a197,0
 v_accvgpr_write_b32 a198,0
 v_accvgpr_write_b32 a199,0
 v_accvgpr_write_b32 a200,0
 v_accvgpr_write_b32 a201,0
 v_accvgpr_write_b32 a202,0
 v_accvgpr_write_b32 a203,0
 v_accvgpr_write_b32 a204,0
 v_accvgpr_write_b32 a205,0
 v_accvgpr_write_b32 a206,0
 v_accvgpr_write_b32 a207,0
 s_mov_b32 s65,0
L_rpv:
 s_waitcnt vmcnt(0) lgkmcnt(0)
 s_barrier
 s_add_u32 m0,s61,98304
 s_mov_b32 s63,s65
 bl v220,s[8:11],s63 offen offset:0 lds
 bl v221,s[8:11],s63 offen offset:1024 lds
 bl v222,s[8:11],s63 offen offset:2048 lds
 bl v223,s[8:11],s63 offen offset:3072 lds
 s_add_u32 m0,s61,114688
 s_mov_b32 s63,s65
 bl v224,s[12:15],s63 offen offset:0 lds
 bl v225,s[12:15],s63 offen offset:1024 lds
 bl v224,s[12:15],s63 offen offset:2048 lds
 bl v225,s[12:15],s63 offen offset:3072 lds
 s_waitcnt vmcnt(0) lgkmcnt(0)
 s_barrier
 rq a[128:131],v208 offset:49152
 rq a[132:135],v209 offset:49152
 rq a[136:139],v210 offset:49152
 rq a[140:143],v211 offset:49152
 rq a[144:147],v208 offset:53248
 rq a[148:151],v209 offset:53248
 rq a[152:155],v210 offset:53248
 rq a[156:159],v211 offset:53248
 s_waitcnt lgkmcnt(4)
 mf v[64:67],a[128:131],v[128:131],v[192:195]
 mf v[64:67],a[132:135],v[132:135],v[64:67]
 mf v[64:67],a[136:139],v[136:139],v[64:67]
 mf v[64:67],a[140:143],v[140:143],v[64:67]
 mf v[80:83],a[140:143],v[156:159],v[196:199]
 mf v[80:83],a[136:139],v[152:155],v[80:83]
 mf v[80:83],a[132:135],v[148:151],v[80:83]
 mf v[80:83],a[128:131],v[144:147],v[80:83]
 mf v[96:99],a[128:131],v[160:163],v[200:203]
 mf v[96:99],a[132:135],v[164:167],v[96:99]
 mf v[96:99],a[136:139],v[168:171],v[96:99]
 mf v[96:99],a[140:143],v[172:175],v[96:99]
 mf v[112:115],a[140:143],v[188:191],v[204:207]
 mf v[112:115],a[136:139],v[184:187],v[112:115]
 mf v[112:115],a[132:135],v[180:183],v[112:115]
 mf v[112:115],a[128:131],v[176:179],v[112:115]
 s_waitcnt lgkmcnt(0)
 mf v[116:119],a[144:147],v[176:179],v[204:207]
 mf v[116:119],a[148:151],v[180:183],v[116:119]
 mf v[116:119],a[152:155],v[184:187],v[116:119]
 mf v[116:119],a[156:159],v[188:191],v[116:119]
 mf v[100:103],a[156:159],v[172:175],v[200:203]
 mf v[100:103],a[152:155],v[168:171],v[100:103]
 mf v[100:103],a[148:151],v[164:167],v[100:103]
 mf v[100:103],a[144:147],v[160:163],v[100:103]
 mf v[84:87],a[144:147],v[144:147],v[196:199]
 mf v[84:87],a[148:151],v[148:151],v[84:87]
 mf v[84:87],a[152:155],v[152:155],v[84:87]
 mf v[84:87],a[156:159],v[156:159],v[84:87]
 mf v[68:71],a[156:159],v[140:143],v[192:195]
 mf v[68:71],a[152:155],v[136:139],v[68:71]
 mf v[68:71],a[148:151],v[132:135],v[68:71]
 mf v[68:71],a[144:147],v[128:131],v[68:71]
 rq a[128:131],v208 offset:57344
 rq a[132:135],v209 offset:57344
 rq a[136:139],v210 offset:57344
 rq a[140:143],v211 offset:57344
 rq a[144:147],v208 offset:61440
 rq a[148:151],v209 offset:61440
 rq a[152:155],v210 offset:61440
 rq a[156:159],v211 offset:61440
 s_waitcnt lgkmcnt(4)
 mf v[72:75],a[128:131],v[128:131],v[192:195]
 mf v[72:75],a[132:135],v[132:135],v[72:75]
 mf v[72:75],a[136:139],v[136:139],v[72:75]
 mf v[72:75],a[140:143],v[140:143],v[72:75]
 mf v[88:91],a[140:143],v[156:159],v[196:199]
 mf v[88:91],a[136:139],v[152:155],v[88:91]
 mf v[88:91],a[132:135],v[148:151],v[88:91]
 mf v[88:91],a[128:131],v[144:147],v[88:91]
 mf v[104:107],a[128:131],v[160:163],v[200:203]
 mf v[104:107],a[132:135],v[164:167],v[104:107]
 mf v[104:107],a[136:139],v[168:171],v[104:107]
 mf v[104:107],a[140:143],v[172:175],v[104:107]
 mf v[120:123],a[140:143],v[188:191],v[204:207]
 mf v[120:123],a[136:139],v[184:187],v[120:123]
 mf v[120:123],a[132:135],v[180:183],v[120:123]
 mf v[120:123],a[128:131],v[176:179],v[120:123]
 s_waitcnt lgkmcnt(0)
 mf v[124:127],a[144:147],v[176:179],v[204:207]
 mf v[124:127],a[148:151],v[180:183],v[124:127]
 mf v[124:127],a[152:155],v[184:187],v[124:127]
 mf v[124:127],a[156:159],v[188:191],v[124:127]
 mf v[108:111],a[156:159],v[172:175],v[200:203]
 mf v[108:111],a[152:155],v[168:171],v[108:111]
 mf v[108:111],a[148:151],v[164:167],v[108:111]
 mf v[108:111],a[144:147],v[160:163],v[108:111]
 mf v[92:95],a[144:147],v[144:147],v[196:199]
 mf v[92:95],a[148:151],v[148:151],v[92:95]
 mf v[92:95],a[152:155],v[152:155],v[92:95]
 mf v[92:95],a[156:159],v[156:159],v[92:95]
 mf v[76:79],a[156:159],v[140:143],v[192:195]
 mf v[76:79],a[152:155],v[136:139],v[76:79]
 mf v[76:79],a[148:151],v[132:135],v[76:79]
 mf v[76:79],a[144:147],v[128:131],v[76:79]
 v_exp_f32 v64,v64
 v_exp_f32 v65,v65
 v_exp_f32 v66,v66
 v_exp_f32 v67,v67
 v_exp_f32 v68,v68
 v_exp_f32 v69,v69
 v_exp_f32 v70,v70
 v_exp_f32 v71,v71
 v_exp_f32 v80,v80
 v_exp_f32 v81,v81
 v_exp_f32 v82,v82
 v_exp_f32 v83,v83
 v_exp_f32 v84,v84
 v_exp_f32 v85,v85
 v_exp_f32 v86,v86
 v_exp_f32 v87,v87
 v_exp_f32 v96,v96
 v_exp_f32 v97,v97
 v_exp_f32 v98,v98
 v_exp_f32 v99,v99
 v_exp_f32 v100,v100
 v_exp_f32 v101,v101
 v_exp_f32 v102,v102
 v_exp_f32 v103,v103
 v_exp_f32 v112,v112
 v_exp_f32 v113,v113
 v_exp_f32 v114,v114
 v_exp_f32 v115,v115
 v_exp_f32 v116,v116
 v_exp_f32 v117,v117
 v_exp_f32 v118,v118
 v_exp_f32 v119,v119
 pk v64,v64,v65
 pk v65,v66,v67
 pk v66,v68,v69
 pk v67,v70,v71
 pk v80,v80,v81
 pk v81,v82,v83
 pk v82,v84,v85
 pk v83,v86,v87
 pk v96,v96,v97
 pk v97,v98,v99
 pk v98,v100,v101
 pk v99,v102,v103
 pk v112,v112,v113
 pk v113,v114,v115
 pk v114,v116,v117
 pk v115,v118,v119
 v_exp_f32 v72,v72
 v_exp_f32 v73,v73
 v_exp_f32 v74,v74
 v_exp_f32 v75,v75
 v_exp_f32 v76,v76
 v_exp_f32 v77,v77
 v_exp_f32 v78,v78
 v_exp_f32 v79,v79
 v_exp_f32 v88,v88
 v_exp_f32 v89,v89
 v_exp_f32 v90,v90
 v_exp_f32 v91,v91
 v_exp_f32 v92,v92
 v_exp_f32 v93,v93
 v_exp_f32 v94,v94
 v_exp_f32 v95,v95
 v_exp_f32 v104,v104
 v_exp_f32 v105,v105
 v_exp_f32 v106,v106
 v_exp_f32 v107,v107
 v_exp_f32 v108,v108
 v_exp_f32 v109,v109
 v_exp_f32 v110,v110
 v_exp_f32 v111,v111
 v_exp_f32 v120,v120
 v_exp_f32 v121,v121
 v_exp_f32 v122,v122
 v_exp_f32 v123,v123
 v_exp_f32 v124,v124
 v_exp_f32 v125,v125
 v_exp_f32 v126,v126
 v_exp_f32 v127,v127
 pk v68,v72,v73
 pk v69,v74,v75
 pk v70,v76,v77
 pk v71,v78,v79
 pk v84,v88,v89
 pk v85,v90,v91
 pk v86,v92,v93
 pk v87,v94,v95
 pk v100,v104,v105
 pk v101,v106,v107
 pk v102,v108,v109
 pk v103,v110,v111
 pk v116,v120,v121
 pk v117,v122,v123
 pk v118,v124,v125
 pk v119,v126,v127
 rt a[128:129],v212 offset:49152
 rt a[130:131],v212 offset:53248
 rt a[132:133],v212 offset:57344
 rt a[134:135],v212 offset:61440
 rt a[136:137],v213 offset:49152
 rt a[138:139],v213 offset:53248
 rt a[140:141],v213 offset:57344
 rt a[142:143],v213 offset:61440
 rt a[144:145],v214 offset:49152
 rt a[146:147],v214 offset:53248
 rt a[148:149],v214 offset:57344
 rt a[150:151],v214 offset:61440
 rt a[152:153],v215 offset:49152
 rt a[154:155],v215 offset:53248
 rt a[156:157],v215 offset:57344
 rt a[158:159],v215 offset:61440
 s_waitcnt lgkmcnt(12)
 mf a[0:3],v[64:67],a[128:131],a[0:3]
 mf a[0:3],v[68:71],a[132:135],a[0:3]
 mf a[4:7],v[84:87],a[132:135],a[4:7]
 mf a[4:7],v[80:83],a[128:131],a[4:7]
 mf a[8:11],v[96:99],a[128:131],a[8:11]
 mf a[8:11],v[100:103],a[132:135],a[8:11]
 mf a[12:15],v[116:119],a[132:135],a[12:15]
 mf a[12:15],v[112:115],a[128:131],a[12:15]
 s_waitcnt lgkmcnt(8)
 mf a[28:31],v[112:115],a[136:139],a[28:31]
 mf a[28:31],v[116:119],a[140:143],a[28:31]
 mf a[24:27],v[100:103],a[140:143],a[24:27]
 mf a[24:27],v[96:99],a[136:139],a[24:27]
 mf a[20:23],v[80:83],a[136:139],a[20:23]
 mf a[20:23],v[84:87],a[140:143],a[20:23]
 mf a[16:19],v[68:71],a[140:143],a[16:19]
 mf a[16:19],v[64:67],a[136:139],a[16:19]
 s_waitcnt lgkmcnt(4)
 mf a[32:35],v[64:67],a[144:147],a[32:35]
 mf a[32:35],v[68:71],a[148:151],a[32:35]
 mf a[36:39],v[84:87],a[148:151],a[36:39]
 mf a[36:39],v[80:83],a[144:147],a[36:39]
 mf a[40:43],v[96:99],a[144:147],a[40:43]
 mf a[40:43],v[100:103],a[148:151],a[40:43]
 mf a[44:47],v[116:119],a[148:151],a[44:47]
 mf a[44:47],v[112:115],a[144:147],a[44:47]
 s_waitcnt lgkmcnt(0)
 mf a[60:63],v[112:115],a[152:155],a[60:63]
 mf a[60:63],v[116:119],a[156:159],a[60:63]
 mf a[56:59],v[100:103],a[156:159],a[56:59]
 mf a[56:59],v[96:99],a[152:155],a[56:59]
 mf a[52:55],v[80:83],a[152:155],a[52:55]
 mf a[52:55],v[84:87],a[156:159],a[52:55]
 mf a[48:51],v[68:71],a[156:159],a[48:51]
 mf a[48:51],v[64:67],a[152:155],a[48:51]
 rt a[128:129],v216 offset:49152
 rt a[130:131],v216 offset:53248
 rt a[132:133],v216 offset:57344
 rt a[134:135],v216 offset:61440
 rt a[136:137],v217 offset:49152
 rt a[138:139],v217 offset:53248
 rt a[140:141],v217 offset:57344
 rt a[142:143],v217 offset:61440
 rt a[144:145],v218 offset:49152
 rt a[146:147],v218 offset:53248
 rt a[148:149],v218 offset:57344
 rt a[150:151],v218 offset:61440
 rt a[152:153],v219 offset:49152
 rt a[154:155],v219 offset:53248
 rt a[156:157],v219 offset:57344
 rt a[158:159],v219 offset:61440
 s_waitcnt lgkmcnt(12)
 mf a[64:67],v[64:67],a[128:131],a[64:67]
 mf a[64:67],v[68:71],a[132:135],a[64:67]
 mf a[68:71],v[84:87],a[132:135],a[68:71]
 mf a[68:71],v[80:83],a[128:131],a[68:71]
 mf a[72:75],v[96:99],a[128:131],a[72:75]
 mf a[72:75],v[100:103],a[132:135],a[72:75]
 mf a[76:79],v[116:119],a[132:135],a[76:79]
 mf a[76:79],v[112:115],a[128:131],a[76:79]
 s_waitcnt lgkmcnt(8)
 mf a[92:95],v[112:115],a[136:139],a[92:95]
 mf a[92:95],v[116:119],a[140:143],a[92:95]
 mf a[88:91],v[100:103],a[140:143],a[88:91]
 mf a[88:91],v[96:99],a[136:139],a[88:91]
 mf a[84:87],v[80:83],a[136:139],a[84:87]
 mf a[84:87],v[84:87],a[140:143],a[84:87]
 mf a[80:83],v[68:71],a[140:143],a[80:83]
 mf a[80:83],v[64:67],a[136:139],a[80:83]
 s_waitcnt lgkmcnt(4)
 mf a[96:99],v[64:67],a[144:147],a[96:99]
 mf a[96:99],v[68:71],a[148:151],a[96:99]
 mf a[100:103],v[84:87],a[148:151],a[100:103]
 mf a[100:103],v[80:83],a[144:147],a[100:103]
 mf a[104:107],v[96:99],a[144:147],a[104:107]
 mf a[104:107],v[100:103],a[148:151],a[104:107]
 mf a[108:111],v[116:119],a[148:151],a[108:111]
 mf a[108:111],v[112:115],a[144:147],a[108:111]
 s_waitcnt lgkmcnt(0)
 mf a[124:127],v[112:115],a[152:155],a[124:127]
 mf a[124:127],v[116:119],a[156:159],a[124:127]
 mf a[120:123],v[100:103],a[156:159],a[120:123]
 mf a[120:123],v[96:99],a[152:155],a[120:123]
 mf a[116:119],v[80:83],a[152:155],a[116:119]
 mf a[116:119],v[84:87],a[156:159],a[116:119]
 mf a[112:115],v[68:71],a[156:159],a[112:115]
 mf a[112:115],v[64:67],a[152:155],a[112:115]
 v_smfmac_f32_16x16x64_bf16 a[192:195],a[208:211],v[64:71],v250
 v_smfmac_f32_16x16x64_bf16 a[196:199],a[208:211],v[80:87],v250
 v_smfmac_f32_16x16x64_bf16 a[200:203],a[208:211],v[96:103],v250
 v_smfmac_f32_16x16x64_bf16 a[204:207],a[208:211],v[112:119],v250
 s_add_u32 s65,s65,16384
 s_cmp_lt_u32 s65,0x80000
 s_cbranch_scc1 L_rpv
 s_nop 5
 v_accvgpr_read_b32 v40,a192
 v_accvgpr_read_b32 v41,a193
 v_accvgpr_read_b32 v42,a196
 v_accvgpr_read_b32 v43,a197
 v_accvgpr_read_b32 v44,a200
 v_accvgpr_read_b32 v45,a201
 v_accvgpr_read_b32 v46,a204
 v_accvgpr_read_b32 v47,a205
 v_add_f32 v40,v40,v41
 v_add_f32 v42,v42,v43
 v_add_f32 v44,v44,v45
 v_add_f32 v46,v46,v47
 v_bfe_u32 v48,v255,8,2
 v_lshlrev_b32 v48,4,v48
 v_rcp_f32 v40,v40
 v_rcp_f32 v42,v42
 v_rcp_f32 v44,v44
 v_rcp_f32 v46,v46
 ds_bpermute_b32 v192,v48,v40 offset:0
 ds_bpermute_b32 v193,v48,v40 offset:4
 ds_bpermute_b32 v194,v48,v40 offset:8
 ds_bpermute_b32 v195,v48,v40 offset:12
 ds_bpermute_b32 v196,v48,v42 offset:0
 ds_bpermute_b32 v197,v48,v42 offset:4
 ds_bpermute_b32 v198,v48,v42 offset:8
 ds_bpermute_b32 v199,v48,v42 offset:12
 ds_bpermute_b32 v200,v48,v44 offset:0
 ds_bpermute_b32 v201,v48,v44 offset:4
 ds_bpermute_b32 v202,v48,v44 offset:8
 ds_bpermute_b32 v203,v48,v44 offset:12
 ds_bpermute_b32 v204,v48,v46 offset:0
 ds_bpermute_b32 v205,v48,v46 offset:4
 ds_bpermute_b32 v206,v48,v46 offset:8
 ds_bpermute_b32 v207,v48,v46 offset:12
 s_waitcnt lgkmcnt(0)
 s_branch L_att_done
.p2align 12
L_odd:
L_pad_odd0:
 s_cbranch_execz L_hop4
 s_waitcnt lgkmcnt(2)
 mf v[0:3],a[128:131],a[160:163],0
 s_mul_i32 s55,s54,57216
 rt a[140:141],v231 offset:4096
 rt a[142:143],v231 offset:6144
 v_add_u32 v243,s55,v243
 mf v[0:3],a[132:135],a[176:179],v[0:3]
 s_barrier
 rt a[144:145],v232 offset:0
 rt a[146:147],v232 offset:2048
 mf v[12:15],a[132:135],a[180:183],0
 s_add_u32 m0,s88,0
 s_mov_b32 s63,1376256
 rt a[148:149],v232 offset:4096
 rt a[150:151],v232 offset:6144
 mf v[12:15],a[128:131],a[164:167],v[12:15]
 bl v243,s[36:39],s63 offen offset:0 lds
 mf v[24:27],a[128:131],a[168:171],0
 s_mov_b32 s63,1403904
 rq a[212:215],v255 offset:40960
 mf v[24:27],a[132:135],a[184:187],v[24:27]
 bl v243,s[36:39],s63 offen offset:1024 lds
 mf v[36:39],a[132:135],a[188:191],0
 s_add_u32 m0,s88,8192
 s_mov_b32 s63,1376384
 rq a[228:231],v255 offset:45056
 mf v[36:39],a[128:131],a[172:175],v[36:39]
 s_waitcnt lgkmcnt(6)
 rq a[216:219],v255 offset:41984
 bl v243,s[36:39],s63 offen offset:0 lds
 mf v[40:43],a[136:139],a[172:175],0
 s_mov_b32 s63,1404032
 rq a[232:235],v255 offset:46080
 mf v[40:43],a[140:143],a[188:191],v[40:43]
 rq a[220:223],v255 offset:43008
 bl v243,s[36:39],s63 offen offset:1024 lds
 mf v[28:31],a[140:143],a[184:187],0
 s_add_u32 m0,s88,16384
 s_mov_b32 s63,1376512
 rq a[236:239],v255 offset:47104
 mf v[28:31],a[136:139],a[168:171],v[28:31]
 rq a[224:227],v255 offset:44032
 bl v243,s[36:39],s63 offen offset:0 lds
 mf v[16:19],a[136:139],a[164:167],0
 s_waitcnt lgkmcnt(7)
 s_waitcnt vmcnt(5)
 rq a[240:243],v255 offset:48128
 mf v[16:19],a[140:143],a[180:183],v[16:19]
 s_barrier
 s_mov_b32 s63,1404160
 mf v[4:7],a[140:143],a[176:179],0
 bl v243,s[36:39],s63 offen offset:1024 lds
 mf v[4:7],a[136:139],a[160:163],v[4:7]
 s_add_u32 m0,s88,65536
 rt a[128:129],v226 offset:32768
 rt a[130:131],v226 offset:34816
 mf v[8:11],a[144:147],a[160:163],0
 s_mov_b32 s63,1605632
 rt a[132:133],v226 offset:36864
 rt a[134:135],v226 offset:38912
 mf v[8:11],a[148:151],a[176:179],v[8:11]
 bl v243,s[36:39],s63 offen offset:0 lds
 mf v[20:23],a[148:151],a[180:183],0
 rt a[152:153],v228 offset:32768
 rt a[154:155],v228 offset:34816
 mf v[20:23],a[144:147],a[164:167],v[20:23]
 s_mov_b32 s63,1633280
 rt a[156:157],v228 offset:36864
 rt a[158:159],v228 offset:38912
 mf v[32:35],a[144:147],a[168:171],0
 bl v243,s[36:39],s63 offen offset:1024 lds
 mf v[32:35],a[148:151],a[184:187],v[32:35]
 s_add_u32 m0,s88,73728
 rt a[136:137],v227 offset:32768
 rt a[138:139],v227 offset:34816
 mf v[44:47],a[148:151],a[188:191],0
 s_mov_b32 s63,1605760
 rt a[140:141],v227 offset:36864
 rt a[142:143],v227 offset:38912
 mf v[44:47],a[144:147],a[172:175],v[44:47]
 s_waitcnt lgkmcnt(8)
 bl v243,s[36:39],s63 offen offset:0 lds
 mf v[0:3],a[128:131],a[212:215],v[0:3]
 rq a[160:163],v255 offset:49152
 mf v[0:3],a[132:135],a[228:231],v[0:3]
 s_mov_b32 s63,1633408
 rq a[176:179],v255 offset:53248
 mf v[12:15],a[132:135],a[232:235],v[12:15]
 bl v243,s[36:39],s63 offen offset:1024 lds
 mf v[12:15],a[128:131],a[216:219],v[12:15]
 s_add_u32 m0,s88,81920
 mf v[24:27],a[128:131],a[220:223],v[24:27]
 s_mov_b32 s63,1605888
 rq a[164:167],v255 offset:50176
 mf v[24:27],a[132:135],a[236:239],v[24:27]
 bl v243,s[36:39],s63 offen offset:0 lds
 mf v[36:39],a[132:135],a[240:243],v[36:39]
 rq a[180:183],v255 offset:54272
 mf v[36:39],a[128:131],a[224:227],v[36:39]
 s_waitcnt lgkmcnt(4)
 mf v[40:43],a[136:139],a[224:227],v[40:43]
 rq a[168:171],v255 offset:51200
 mf v[40:43],a[140:143],a[240:243],v[40:43]
 rq a[184:187],v255 offset:55296
 mf v[28:31],a[140:143],a[236:239],v[28:31]
 mf v[28:31],a[136:139],a[220:223],v[28:31]
 rq a[172:175],v255 offset:52224
 mf v[16:19],a[136:139],a[216:219],v[16:19]
 s_waitcnt vmcnt(5)
 rq a[188:191],v255 offset:56320
 mf v[16:19],a[140:143],a[232:235],v[16:19]
 s_barrier
 s_mov_b32 s63,1633536
 mf v[4:7],a[140:143],a[228:231],v[4:7]
 bl v243,s[36:39],s63 offen offset:1024 lds
 mf v[4:7],a[136:139],a[212:215],v[4:7]
 s_add_u32 m0,s88,32768
 rt a[128:129],v226 offset:0
 rt a[130:131],v226 offset:2048
 mf v[8:11],a[152:155],a[212:215],v[8:11]
 s_mov_b32 s63,0
 rt a[132:133],v226 offset:4096
 rt a[134:135],v226 offset:6144
 mf v[8:11],a[156:159],a[228:231],v[8:11]
 bl v243,s[36:39],s63 offen offset:0 lds
 mf v[20:23],a[156:159],a[232:235],v[20:23]
 rt a[144:145],v228 offset:0
 rt a[146:147],v228 offset:2048
 mf v[20:23],a[152:155],a[216:219],v[20:23]
 s_mov_b32 s63,27648
 rt a[148:149],v228 offset:4096
 rt a[150:151],v228 offset:6144
 mf v[32:35],a[152:155],a[220:223],v[32:35]
 bl v243,s[36:39],s63 offen offset:1024 lds
 mf v[32:35],a[156:159],a[236:239],v[32:35]
 s_add_u32 m0,s88,40960
 rt a[136:137],v227 offset:0
 rt a[138:139],v227 offset:2048
 mf v[44:47],a[156:159],a[240:243],v[44:47]
 s_mov_b32 s63,128
 rt a[140:141],v227 offset:4096
 rt a[142:143],v227 offset:6144
 mf v[44:47],a[152:155],a[224:227],v[44:47]
 s_waitcnt lgkmcnt(8)
 bl v243,s[36:39],s63 offen offset:0 lds
 mf v[0:3],a[128:131],a[160:163],v[0:3]
 rq a[212:215],v255 offset:57344
 mf v[0:3],a[132:135],a[176:179],v[0:3]
 s_mov_b32 s63,27776
 rq a[228:231],v255 offset:61440
 mf v[12:15],a[132:135],a[180:183],v[12:15]
 bl v243,s[36:39],s63 offen offset:1024 lds
 mf v[12:15],a[128:131],a[164:167],v[12:15]
 s_add_u32 m0,s88,49152
 mf v[24:27],a[128:131],a[168:171],v[24:27]
 s_mov_b32 s63,256
 rq a[216:219],v255 offset:58368
 mf v[24:27],a[132:135],a[184:187],v[24:27]
 bl v243,s[36:39],s63 offen offset:0 lds
 mf v[36:39],a[132:135],a[188:191],v[36:39]
 rq a[232:235],v255 offset:62464
 mf v[36:39],a[128:131],a[172:175],v[36:39]
 s_waitcnt lgkmcnt(4)
 mf v[40:43],a[136:139],a[172:175],v[40:43]
 rq a[220:223],v255 offset:59392
 mf v[40:43],a[140:143],a[188:191],v[40:43]
 rq a[236:239],v255 offset:63488
 mf v[28:31],a[140:143],a[184:187],v[28:31]
 mf v[28:31],a[136:139],a[168:171],v[28:31]
 rq a[224:227],v255 offset:60416
 mf v[16:19],a[136:139],a[164:167],v[16:19]
 s_waitcnt vmcnt(5)
 rq a[240:243],v255 offset:64512
 mf v[16:19],a[140:143],a[180:183],v[16:19]
 s_barrier
 s_mov_b32 s63,27904
 mf v[4:7],a[140:143],a[176:179],v[4:7]
 bl v243,s[36:39],s63 offen offset:1024 lds
 mf v[4:7],a[136:139],a[160:163],v[4:7]
 s_add_u32 m0,s88,0
 rt a[128:129],v230 offset:0
 rt a[130:131],v230 offset:2048
 mf v[8:11],a[144:147],a[160:163],v[8:11]
 s_mov_b32 s63,229376
 rt a[132:133],v230 offset:4096
 rt a[134:135],v230 offset:6144
 mf v[8:11],a[148:151],a[176:179],v[8:11]
 bl v243,s[36:39],s63 offen offset:0 lds
 mf v[20:23],a[148:151],a[180:183],v[20:23]
 rt a[152:153],v232 offset:0
 rt a[154:155],v232 offset:2048
 mf v[20:23],a[144:147],a[164:167],v[20:23]
 s_mov_b32 s63,257024
 rt a[156:157],v232 offset:4096
 rt a[158:159],v232 offset:6144
 mf v[32:35],a[144:147],a[168:171],v[32:35]
 bl v243,s[36:39],s63 offen offset:1024 lds
 mf v[32:35],a[148:151],a[184:187],v[32:35]
 s_add_u32 m0,s88,8192
 rt a[136:137],v231 offset:0
 rt a[138:139],v231 offset:2048
 mf v[44:47],a[148:151],a[188:191],v[44:47]
 s_mov_b32 s63,229504
 rt a[140:141],v231 offset:4096
 rt a[142:143],v231 offset:6144
 mf v[44:47],a[144:147],a[172:175],v[44:47]
 s_waitcnt lgkmcnt(8)
 bl v243,s[36:39],s63 offen offset:0 lds
 mf v[0:3],a[128:131],a[212:215],v[0:3]
 rq a[160:163],v255 offset:0
 mf v[0:3],a[132:135],a[228:231],v[0:3]
 s_mov_b32 s63,257152
 rq a[176:179],v255 offset:4096
 mf v[12:15],a[132:135],a[232:235],v[12:15]
 bl v243,s[36:39],s63 offen offset:1024 lds
 mf v[12:15],a[128:131],a[216:219],v[12:15]
 s_add_u32 m0,s88,16384
 mf v[24:27],a[128:131],a[220:223],v[24:27]
 s_mov_b32 s63,229632
 rq a[164:167],v255 offset:1024
 mf v[24:27],a[132:135],a[236:239],v[24:27]
 bl v243,s[36:39],s63 offen offset:0 lds
 mf v[36:39],a[132:135],a[240:243],v[36:39]
 rq a[180:183],v255 offset:5120
 mf v[36:39],a[128:131],a[224:227],v[36:39]
 s_waitcnt lgkmcnt(4)
 mf v[40:43],a[136:139],a[224:227],v[40:43]
 rq a[168:171],v255 offset:2048
 mf v[40:43],a[140:143],a[240:243],v[40:43]
 rq a[184:187],v255 offset:6144
 mf v[28:31],a[140:143],a[236:239],v[28:31]
 mf v[28:31],a[136:139],a[220:223],v[28:31]
 rq a[172:175],v255 offset:3072
 mf v[16:19],a[136:139],a[216:219],v[16:19]
 s_waitcnt vmcnt(5)
 rq a[188:191],v255 offset:7168
 mf v[16:19],a[140:143],a[232:235],v[16:19]
 s_barrier
 s_mov_b32 s63,257280
 mf v[4:7],a[140:143],a[228:231],v[4:7]
 bl v243,s[36:39],s63 offen offset:1024 lds
 mf v[4:7],a[136:139],a[212:215],v[4:7]
 s_add_u32 m0,s88,65536
 rt a[128:129],v226 offset:32768
 rt a[130:131],v226 offset:34816
 mf v[8:11],a[152:155],a[212:215],v[8:11]
 s_mov_b32 s63,458752
 rt a[132:133],v226 offset:36864
 rt a[134:135],v226 offset:38912
 mf v[8:11],a[156:159],a[228:231],v[8:11]
 bl v243,s[36:39],s63 offen offset:0 lds
 mf v[20:23],a[156:159],a[232:235],v[20:23]
 rt a[144:145],v228 offset:32768
 rt a[146:147],v228 offset:34816
 mf v[20:23],a[152:155],a[216:219],v[20:23]
 s_mov_b32 s63,486400
 rt a[148:149],v228 offset:36864
 rt a[150:151],v228 offset:38912
 mf v[32:35],a[152:155],a[220:223],v[32:35]
 bl v243,s[36:39],s63 offen offset:1024 lds
 mf v[32:35],a[156:159],a[236:239],v[32:35]
 s_add_u32 m0,s88,73728
 rt a[136:137],v227 offset:32768
 rt a[138:139],v227 offset:34816
 mf v[44:47],a[156:159],a[240:243],v[44:47]
 s_mov_b32 s63,458880
 rt a[140:141],v227 offset:36864
 rt a[142:143],v227 offset:38912
 mf v[44:47],a[152:155],a[224:227],v[44:47]
 s_waitcnt lgkmcnt(8)
 bl v243,s[36:39],s63 offen offset:0 lds
 mf v[0:3],a[128:131],a[160:163],v[0:3]
 rq a[212:215],v255 offset:8192
 mf v[0:3],a[132:135],a[176:179],v[0:3]
 s_mov_b32 s63,486528
 rq a[228:231],v255 offset:12288
 mf v[12:15],a[132:135],a[180:183],v[12:15]
 s_lshl2_add_u32 s55,s83,s85
 bl v243,s[36:39],s63 offen offset:1024 lds
 mf v[12:15],a[128:131],a[164:167],v[12:15]
 s_add_u32 m0,s88,81920
 mf v[24:27],a[128:131],a[168:171],v[24:27]
 s_mov_b32 s63,459008
 rq a[216:219],v255 offset:9216
 mf v[24:27],a[132:135],a[184:187],v[24:27]
 bl v243,s[36:39],s63 offen offset:0 lds
 mf v[36:39],a[132:135],a[188:191],v[36:39]
 s_lshl_b32 s55,s55,10
 rq a[232:235],v255 offset:13312
 v_add_u32 v235,s55,v255
 mf v[36:39],a[128:131],a[172:175],v[36:39]
 s_waitcnt lgkmcnt(4)
 mf v[40:43],a[136:139],a[172:175],v[40:43]
 rq a[220:223],v255 offset:10240
 mf v[40:43],a[140:143],a[188:191],v[40:43]
 rq a[236:239],v255 offset:14336
 mf v[28:31],a[140:143],a[184:187],v[28:31]
 mf v[28:31],a[136:139],a[168:171],v[28:31]
 rq a[224:227],v255 offset:11264
 mf v[16:19],a[136:139],a[164:167],v[16:19]
 s_waitcnt vmcnt(5)
 rq a[240:243],v255 offset:15360
 mf v[16:19],a[140:143],a[180:183],v[16:19]
 s_barrier
 s_mov_b32 s63,486656
 mf v[4:7],a[140:143],a[176:179],v[4:7]
 bl v243,s[36:39],s63 offen offset:1024 lds
 mf v[4:7],a[136:139],a[160:163],v[4:7]
 s_add_u32 m0,s88,32768
 rt a[128:129],v226 offset:0
 rt a[130:131],v226 offset:2048
 mf v[8:11],a[144:147],a[160:163],v[8:11]
 s_mov_b32 s63,688128
 rt a[132:133],v226 offset:4096
 rt a[134:135],v226 offset:6144
 mf v[8:11],a[148:151],a[176:179],v[8:11]
 bl v243,s[36:39],s63 offen offset:0 lds
 mf v[20:23],a[148:151],a[180:183],v[20:23]
 rt a[152:153],v228 offset:0
 rt a[154:155],v228 offset:2048
 mf v[20:23],a[144:147],a[164:167],v[20:23]
 s_mov_b32 s63,715776
 rt a[156:157],v228 offset:4096
 rt a[158:159],v228 offset:6144
 mf v[32:35],a[144:147],a[168:171],v[32:35]
 bl v243,s[36:39],s63 offen offset:1024 lds
 mf v[32:35],a[148:151],a[184:187],v[32:35]
 s_add_u32 m0,s88,40960
 rt a[136:137],v227 offset:0
 rt a[138:139],v227 offset:2048
 mf v[44:47],a[148:151],a[188:191],v[44:47]
 s_mov_b32 s63,688256
 rt a[140:141],v227 offset:4096
 rt a[142:143],v227 offset:6144
 mf v[44:47],a[144:147],a[172:175],v[44:47]
 s_waitcnt lgkmcnt(8)
 bl v243,s[36:39],s63 offen offset:0 lds
 mf v[0:3],a[128:131],a[212:215],v[0:3]
 rq a[160:163],v255 offset:16384
 mf v[0:3],a[132:135],a[228:231],v[0:3]
 s_mov_b32 s63,715904
 rq a[176:179],v255 offset:20480
 mf v[12:15],a[132:135],a[232:235],v[12:15]
 bl v243,s[36:39],s63 offen offset:1024 lds
 mf v[12:15],a[128:131],a[216:219],v[12:15]
 s_add_u32 m0,s88,49152
 mf v[24:27],a[128:131],a[220:223],v[24:27]
 s_mov_b32 s63,688384
 rq a[164:167],v255 offset:17408
 mf v[24:27],a[132:135],a[236:239],v[24:27]
 bl v243,s[36:39],s63 offen offset:0 lds
 mf v[36:39],a[132:135],a[240:243],v[36:39]
 rq a[180:183],v255 offset:21504
 mf v[36:39],a[128:131],a[224:227],v[36:39]
 s_waitcnt lgkmcnt(4)
 mf v[40:43],a[136:139],a[224:227],v[40:43]
 rq a[168:171],v255 offset:18432
 mf v[40:43],a[140:143],a[240:243],v[40:43]
 rq a[184:187],v255 offset:22528
 mf v[28:31],a[140:143],a[236:239],v[28:31]
 mf v[28:31],a[136:139],a[220:223],v[28:31]
 rq a[172:175],v255 offset:19456
 mf v[16:19],a[136:139],a[216:219],v[16:19]
 s_waitcnt vmcnt(5)
 rq a[188:191],v255 offset:23552
 mf v[16:19],a[140:143],a[232:235],v[16:19]
 s_barrier
 s_mov_b32 s63,716032
 mf v[4:7],a[140:143],a[228:231],v[4:7]
 bl v243,s[36:39],s63 offen offset:1024 lds
 mf v[4:7],a[136:139],a[212:215],v[4:7]
 s_add_u32 m0,s62,0
 s_mov_b32 s63,0
 rt a[128:129],v230 offset:0
 rt a[130:131],v230 offset:2048
 mf v[8:11],a[152:155],a[212:215],v[8:11]
 rt a[132:133],v230 offset:4096
 rt a[134:135],v230 offset:6144
 bl v239,s[40:43],s63 offen offset:0 lds
 mf v[8:11],a[156:159],a[228:231],v[8:11]
 s_mov_b32 s63,7168
 mf v[20:23],a[156:159],a[232:235],v[20:23]
 rt a[144:145],v232 offset:0
 rt a[146:147],v232 offset:2048
 bl v239,s[40:43],s63 offen offset:1024 lds
 mf v[20:23],a[152:155],a[216:219],v[20:23]
 s_mov_b32 s63,14336
 rt a[148:149],v232 offset:4096
 rt a[150:151],v232 offset:6144
 mf v[32:35],a[152:155],a[220:223],v[32:35]
 bl v239,s[40:43],s63 offen offset:2048 lds
 mf v[32:35],a[156:159],a[236:239],v[32:35]
 rt a[136:137],v231 offset:0
 rt a[138:139],v231 offset:2048
 mf v[44:47],a[156:159],a[240:243],v[44:47]
 s_mov_b32 s63,21504
 rt a[140:141],v231 offset:4096
 rt a[142:143],v231 offset:6144
 mf v[44:47],a[152:155],a[224:227],v[44:47]
 s_waitcnt lgkmcnt(8)
 bl v239,s[40:43],s63 offen offset:3072 lds
 mf v[0:3],a[128:131],a[160:163],v[0:3]
 s_add_u32 m0,s62,4096
 rq a[212:215],v255 offset:24576
 mf v[0:3],a[132:135],a[176:179],v[0:3]
 s_mov_b32 s63,32768
 rq a[228:231],v255 offset:28672
 mf v[12:15],a[132:135],a[180:183],v[12:15]
 bl v239,s[40:43],s63 offen offset:0 lds
 mf v[12:15],a[128:131],a[164:167],v[12:15]
 mf v[24:27],a[128:131],a[168:171],v[24:27]
 s_mov_b32 s63,39936
 rq a[216:219],v255 offset:25600
 mf v[24:27],a[132:135],a[184:187],v[24:27]
 bl v239,s[40:43],s63 offen offset:1024 lds
 mf v[36:39],a[132:135],a[188:191],v[36:39]
 rq a[232:235],v255 offset:29696
 mf v[36:39],a[128:131],a[172:175],v[36:39]
 s_waitcnt lgkmcnt(4)
 mf v[40:43],a[136:139],a[172:175],v[40:43]
 rq a[220:223],v255 offset:26624
 mf v[40:43],a[140:143],a[188:191],v[40:43]
 rq a[236:239],v255 offset:30720
 mf v[28:31],a[140:143],a[184:187],v[28:31]
 mf v[28:31],a[136:139],a[168:171],v[28:31]
 rq a[224:227],v255 offset:27648
 mf v[16:19],a[136:139],a[164:167],v[16:19]
 s_waitcnt vmcnt(6)
 rq a[240:243],v255 offset:31744
 mf v[16:19],a[140:143],a[180:183],v[16:19]
 s_barrier
 s_mov_b32 s63,47104
 mf v[4:7],a[140:143],a[176:179],v[4:7]
 bl v239,s[40:43],s63 offen offset:2048 lds
 mf v[4:7],a[136:139],a[160:163],v[4:7]
 s_mov_b32 s63,54272
 rt a[128:129],v226 offset:32768
 rt a[130:131],v226 offset:34816
 mf v[8:11],a[144:147],a[160:163],v[8:11]
 rt a[132:133],v226 offset:36864
 rt a[134:135],v226 offset:38912
 bl v239,s[40:43],s63 offen offset:3072 lds
 mf v[8:11],a[148:151],a[176:179],v[8:11]
 s_add_u32 m0,s62,65536
 s_mov_b32 s63,128
 mf v[20:23],a[148:151],a[180:183],v[20:23]
 rt a[152:153],v228 offset:32768
 rt a[154:155],v228 offset:34816
 bl v239,s[40:43],s63 offen offset:0 lds
 mf v[20:23],a[144:147],a[164:167],v[20:23]
 s_mov_b32 s63,7296
 rt a[156:157],v228 offset:36864
 rt a[158:159],v228 offset:38912
 mf v[32:35],a[144:147],a[168:171],v[32:35]
 bl v239,s[40:43],s63 offen offset:1024 lds
 mf v[32:35],a[148:151],a[184:187],v[32:35]
 rt a[136:137],v227 offset:32768
 rt a[138:139],v227 offset:34816
 mf v[44:47],a[148:151],a[188:191],v[44:47]
 s_mov_b32 s63,14464
 rt a[140:141],v227 offset:36864
 rt a[142:143],v227 offset:38912
 mf v[44:47],a[144:147],a[172:175],v[44:47]
 s_waitcnt lgkmcnt(8)
 bl v239,s[40:43],s63 offen offset:2048 lds
 mf v[0:3],a[128:131],a[212:215],v[0:3]
 mf v[0:3],a[132:135],a[228:231],v[0:3]
 s_mov_b32 s63,21632
 mf v[12:15],a[132:135],a[232:235],v[12:15]
 bl v239,s[40:43],s63 offen offset:3072 lds
 mf v[12:15],a[128:131],a[216:219],v[12:15]
 s_add_u32 m0,s62,69632
 rq a[244:247],v235
 mf v[24:27],a[128:131],a[220:223],v[24:27]
 s_mov_b32 s63,32896
 mf v[24:27],a[132:135],a[236:239],v[24:27]
 bl v239,s[40:43],s63 offen offset:0 lds
 mf v[36:39],a[132:135],a[240:243],v[36:39]
 mf v[36:39],a[128:131],a[224:227],v[36:39]
 s_waitcnt lgkmcnt(1)
 rq a[248:251],v235 offset:8192
 mf v[40:43],a[136:139],a[224:227],v[40:43]
 mf v[40:43],a[140:143],a[240:243],v[40:43]
 mf v[28:31],a[140:143],a[236:239],v[28:31]
 mf v[28:31],a[136:139],a[220:223],v[28:31]
 mf v[16:19],a[136:139],a[216:219],v[16:19]
 s_mul_i32 s55,s54,3
 s_lshr_b32 s56,s55,1
 mf v[16:19],a[140:143],a[232:235],v[16:19]
 s_barrier
 s_mov_b32 s63,40064
 s_lshl_b32 s56,s56,12
 mf v[4:7],a[140:143],a[228:231],v[4:7]
 s_and_b32 s57,s55,1
 bl v239,s[40:43],s63 offen offset:1024 lds
 mf v[4:7],a[136:139],a[212:215],v[4:7]
 s_mov_b32 s63,47232
 s_lshl3_add_u32 s56,s57,s56
 v_add_u32 v234,s56,v255
 mf v[8:11],a[152:155],a[212:215],v[8:11]
 s_add_u32 s55,s55,1
 bl v239,s[40:43],s63 offen offset:2048 lds
 mf v[8:11],a[156:159],a[228:231],v[8:11]
 s_mov_b32 s63,54400
 s_lshr_b32 s56,s55,1
 s_lshl_b32 s56,s56,12
 mf v[20:23],a[156:159],a[232:235],v[20:23]
 s_and_b32 s57,s55,1
 bl v239,s[40:43],s63 offen offset:3072 lds
 mf v[20:23],a[152:155],a[216:219],v[20:23]
 s_mov_b64 exec,0
 s_cmp_eq_u32 s54,0
 s_cbranch_scc1 L_pad_odd1
 s_cmp_eq_u32 s54,1
 s_cbranch_scc1 L_pad_odd2
L_hop8:
 s_mov_b64 exec,-1
 s_add_u32 m0,s62,32768
 s_mov_b32 s63,65536
 s_lshl3_add_u32 s56,s57,s56
 mf v[32:35],a[152:155],a[220:223],v[32:35]
 bl v239,s[40:43],s63 offen offset:0 lds
 mf v[32:35],a[156:159],a[236:239],v[32:35]
 s_mov_b32 s63,72704
 v_add_u32 v235,s56,v255
 s_add_u32 s55,s55,1
 mf v[44:47],a[156:159],a[240:243],v[44:47]
 s_lshr_b32 s56,s55,1
 bl v239,s[40:43],s63 offen offset:1024 lds
 mf v[44:47],a[152:155],a[224:227],v[44:47]
 s_lshl_b32 s56,s56,12
 s_and_b32 s57,s55,1
 s_lshl3_add_u32 s56,s57,s56
 v_add_u32 v241,s56,v255
 s_add_u32 s55,s55,1
 s_sub_u32 s55,s62,131072
 v_add_u32 v226,s55,v244
 v_add_u32 v230,0x10000,v226
 v_add_u32 v227,s55,v245
 v_add_u32 v231,0x10000,v227
 v_add_u32 v228,s55,v246
 v_add_u32 v232,0x10000,v228
 v_add_u32 v229,s55,v247
 v_add_u32 v233,0x10000,v229
 s_waitcnt lgkmcnt(0)
 s_barrier
 s_mov_b32 s63,79872
 bl v239,s[40:43],s63 offen offset:2048 lds
 v_mov_b32 v236,s78
 v_pk_fma_f32 v[64:65],v[0:1],v[0:1],v[236:237] op_sel_hi:[1,1,0]
 v_pk_fma_f32 v[66:67],v[2:3],v[2:3],v[236:237] op_sel_hi:[1,1,0]
 v_pk_fma_f32 v[68:69],v[4:5],v[4:5],v[236:237] op_sel_hi:[1,1,0]
 v_pk_fma_f32 v[70:71],v[6:7],v[6:7],v[236:237] op_sel_hi:[1,1,0]
 v_pk_fma_f32 v[72:73],v[8:9],v[8:9],v[236:237] op_sel_hi:[1,1,0]
 v_pk_fma_f32 v[74:75],v[10:11],v[10:11],v[236:237] op_sel_hi:[1,1,0]
 v_pk_mul_f32 v[64:65],v[64:65],v[0:1] neg_lo:[0,1] neg_hi:[0,1]
L_pad_odd1:
 s_cbranch_execz L_hop8
 v_pk_mul_f32 v[66:67],v[66:67],v[2:3] neg_lo:[0,1] neg_hi:[0,1]
 v_pk_mul_f32 v[68:69],v[68:69],v[4:5] neg_lo:[0,1] neg_hi:[0,1]
 v_pk_mul_f32 v[70:71],v[70:71],v[6:7] neg_lo:[0,1] neg_hi:[0,1]
 v_pk_mul_f32 v[72:73],v[72:73],v[8:9] neg_lo:[0,1] neg_hi:[0,1]
 v_pk_mul_f32 v[74:75],v[74:75],v[10:11] neg_lo:[0,1] neg_hi:[0,1]
 v_exp_f32 v64,v64
 v_exp_f32 v65,v65
 v_exp_f32 v66,v66
 s_mov_b32 s63,87040
 bl v239,s[40:43],s63 offen offset:3072 lds
 v_exp_f32 v67,v67
 v_exp_f32 v68,v68
 v_exp_f32 v69,v69
 v_exp_f32 v70,v70
 v_exp_f32 v71,v71
 v_exp_f32 v72,v72
 v_exp_f32 v73,v73
 v_exp_f32 v74,v74
 v_exp_f32 v75,v75
 v_pk_add_f32 v[64:65],v[64:65],1.0 op_sel_hi:[1,0]
 v_pk_add_f32 v[66:67],v[66:67],1.0 op_sel_hi:[1,0]
 v_pk_add_f32 v[68:69],v[68:69],1.0 op_sel_hi:[1,0]
 v_pk_add_f32 v[70:71],v[70:71],1.0 op_sel_hi:[1,0]
 v_pk_add_f32 v[72:73],v[72:73],1.0 op_sel_hi:[1,0]
 v_pk_add_f32 v[74:75],v[74:75],1.0 op_sel_hi:[1,0]
 v_rcp_f32 v64,v64
 s_add_u32 m0,s62,36864
 s_mov_b32 s63,98304
 bl v239,s[40:43],s63 offen offset:0 lds
 v_rcp_f32 v65,v65
 v_rcp_f32 v66,v66
 v_rcp_f32 v67,v67
 v_rcp_f32 v68,v68
 v_rcp_f32 v69,v69
 v_rcp_f32 v70,v70
 v_rcp_f32 v71,v71
 v_rcp_f32 v72,v72
 v_rcp_f32 v73,v73
 v_rcp_f32 v74,v74
 v_rcp_f32 v75,v75
 v_pk_mul_f32 v[64:65],v[64:65],v[0:1]
 v_pk_mul_f32 v[66:67],v[66:67],v[2:3]
 v_pk_mul_f32 v[68:69],v[68:69],v[4:5]
 v_pk_mul_f32 v[70:71],v[70:71],v[6:7]
 v_pk_mul_f32 v[72:73],v[72:73],v[8:9]
 s_mov_b32 s63,105472
 bl v239,s[40:43],s63 offen offset:1024 lds
 v_pk_mul_f32 v[74:75],v[74:75],v[10:11]
 pk v0,v64,v65
 pk v1,v66,v67
 pk v2,v68,v69
 pk v3,v70,v71
 pk v4,v72,v73
 pk v5,v74,v75
 ds_write_b64 v234,v[0:1] offset:0
 ds_write_b64 v235,v[2:3] offset:0
 ds_write_b64 v241,v[4:5] offset:0
 v_pk_fma_f32 v[76:77],v[12:13],v[12:13],v[236:237] op_sel_hi:[1,1,0]
 v_pk_fma_f32 v[78:79],v[14:15],v[14:15],v[236:237] op_sel_hi:[1,1,0]
 v_pk_fma_f32 v[80:81],v[16:17],v[16:17],v[236:237] op_sel_hi:[1,1,0]
 v_pk_fma_f32 v[82:83],v[18:19],v[18:19],v[236:237] op_sel_hi:[1,1,0]
 v_pk_fma_f32 v[84:85],v[20:21],v[20:21],v[236:237] op_sel_hi:[1,1,0]
 v_pk_fma_f32 v[86:87],v[22:23],v[22:23],v[236:237] op_sel_hi:[1,1,0]
 s_mov_b32 s63,112640
 bl v239,s[40:43],s63 offen offset:2048 lds
 v_pk_mul_f32 v[76:77],v[76:77],v[12:13] neg_lo:[0,1] neg_hi:[0,1]
 v_pk_mul_f32 v[78:79],v[78:79],v[14:15] neg_lo:[0,1] neg_hi:[0,1]
 v_pk_mul_f32 v[80:81],v[80:81],v[16:17] neg_lo:[0,1] neg_hi:[0,1]
 v_pk_mul_f32 v[82:83],v[82:83],v[18:19] neg_lo:[0,1] neg_hi:[0,1]
 v_pk_mul_f32 v[84:85],v[84:85],v[20:21] neg_lo:[0,1] neg_hi:[0,1]
 v_pk_mul_f32 v[86:87],v[86:87],v[22:23] neg_lo:[0,1] neg_hi:[0,1]
 v_exp_f32 v76,v76
 v_exp_f32 v77,v77
 v_exp_f32 v78,v78
 v_exp_f32 v79,v79
 v_exp_f32 v80,v80
 v_exp_f32 v81,v81
 v_exp_f32 v82,v82
 v_exp_f32 v83,v83
 v_exp_f32 v84,v84
 v_exp_f32 v85,v85
 s_mov_b32 s63,119808
 bl v239,s[40:43],s63 offen offset:3072 lds
 v_exp_f32 v86,v86
 v_exp_f32 v87,v87
 v_pk_add_f32 v[76:77],v[76:77],1.0 op_sel_hi:[1,0]
 v_pk_add_f32 v[78:79],v[78:79],1.0 op_sel_hi:[1,0]
 v_pk_add_f32 v[80:81],v[80:81],1.0 op_sel_hi:[1,0]
 v_pk_add_f32 v[82:83],v[82:83],1.0 op_sel_hi:[1,0]
 v_pk_add_f32 v[84:85],v[84:85],1.0 op_sel_hi:[1,0]
 v_pk_add_f32 v[86:87],v[86:87],1.0 op_sel_hi:[1,0]
 v_rcp_f32 v76,v76
 v_rcp_f32 v77,v77
 v_rcp_f32 v78,v78
 v_rcp_f32 v79,v79
 v_rcp_f32 v80,v80
 v_rcp_f32 v81,v81
 v_rcp_f32 v82,v82
 v_rcp_f32 v83,v83
 v_rcp_f32 v84,v84
 v_rcp_f32 v85,v85
 v_rcp_f32 v86,v86
 v_rcp_f32 v87,v87
 v_pk_mul_f32 v[76:77],v[76:77],v[12:13]
 v_pk_mul_f32 v[78:79],v[78:79],v[14:15]
 v_pk_mul_f32 v[80:81],v[80:81],v[16:17]
 v_pk_mul_f32 v[82:83],v[82:83],v[18:19]
 v_pk_mul_f32 v[84:85],v[84:85],v[20:21]
 v_pk_mul_f32 v[86:87],v[86:87],v[22:23]
 pk v12,v76,v77
 pk v13,v78,v79
 pk v14,v80,v81
 pk v15,v82,v83
 pk v16,v84,v85
 pk v17,v86,v87
 ds_write_b64 v234,v[12:13] offset:1024
 ds_write_b64 v235,v[14:15] offset:1024
 ds_write_b64 v241,v[16:17] offset:1024
 v_pk_fma_f32 v[88:89],v[24:25],v[24:25],v[236:237] op_sel_hi:[1,1,0]
 v_pk_fma_f32 v[90:91],v[26:27],v[26:27],v[236:237] op_sel_hi:[1,1,0]
 v_pk_fma_f32 v[92:93],v[28:29],v[28:29],v[236:237] op_sel_hi:[1,1,0]
 v_pk_fma_f32 v[94:95],v[30:31],v[30:31],v[236:237] op_sel_hi:[1,1,0]
 v_pk_fma_f32 v[96:97],v[32:33],v[32:33],v[236:237] op_sel_hi:[1,1,0]
 v_pk_fma_f32 v[98:99],v[34:35],v[34:35],v[236:237] op_sel_hi:[1,1,0]
 v_pk_mul_f32 v[88:89],v[88:89],v[24:25] neg_lo:[0,1] neg_hi:[0,1]
 v_pk_mul_f32 v[90:91],v[90:91],v[26:27] neg_lo:[0,1] neg_hi:[0,1]
 v_pk_mul_f32 v[92:93],v[92:93],v[28:29] neg_lo:[0,1] neg_hi:[0,1]
 v_pk_mul_f32 v[94:95],v[94:95],v[30:31] neg_lo:[0,1] neg_hi:[0,1]
 v_pk_mul_f32 v[96:97],v[96:97],v[32:33] neg_lo:[0,1] neg_hi:[0,1]
 v_pk_mul_f32 v[98:99],v[98:99],v[34:35] neg_lo:[0,1] neg_hi:[0,1]
 v_exp_f32 v88,v88
 v_exp_f32 v89,v89
 v_exp_f32 v90,v90
 v_exp_f32 v91,v91
 v_exp_f32 v92,v92
 v_exp_f32 v93,v93
 v_exp_f32 v94,v94
 v_exp_f32 v95,v95
 v_exp_f32 v96,v96
 v_exp_f32 v97,v97
 v_exp_f32 v98,v98
 v_exp_f32 v99,v99
 v_pk_add_f32 v[88:89],v[88:89],1.0 op_sel_hi:[1,0]
 v_pk_add_f32 v[90:91],v[90:91],1.0 op_sel_hi:[1,0]
 v_pk_add_f32 v[92:93],v[92:93],1.0 op_sel_hi:[1,0]
 v_pk_add_f32 v[94:95],v[94:95],1.0 op_sel_hi:[1,0]
 v_pk_add_f32 v[96:97],v[96:97],1.0 op_sel_hi:[1,0]
 v_pk_add_f32 v[98:99],v[98:99],1.0 op_sel_hi:[1,0]
 v_rcp_f32 v88,v88
 v_rcp_f32 v89,v89
 v_rcp_f32 v90,v90
 v_rcp_f32 v91,v91
 v_rcp_f32 v92,v92
 v_rcp_f32 v93,v93
 v_rcp_f32 v94,v94
 v_rcp_f32 v95,v95
 v_rcp_f32 v96,v96
 v_rcp_f32 v97,v97
 v_rcp_f32 v98,v98
 v_rcp_f32 v99,v99
 v_pk_mul_f32 v[88:89],v[88:89],v[24:25]
 v_pk_mul_f32 v[90:91],v[90:91],v[26:27]
 v_pk_mul_f32 v[92:93],v[92:93],v[28:29]
 v_pk_mul_f32 v[94:95],v[94:95],v[30:31]
 v_pk_mul_f32 v[96:97],v[96:97],v[32:33]
 v_pk_mul_f32 v[98:99],v[98:99],v[34:35]
 pk v24,v88,v89
 pk v25,v90,v91
 pk v26,v92,v93
 pk v27,v94,v95
 pk v28,v96,v97
 pk v29,v98,v99
 ds_write_b64 v234,v[24:25] offset:2048
 ds_write_b64 v235,v[26:27] offset:2048
 ds_write_b64 v241,v[28:29] offset:2048
 v_pk_fma_f32 v[100:101],v[36:37],v[36:37],v[236:237] op_sel_hi:[1,1,0]
 v_pk_fma_f32 v[102:103],v[38:39],v[38:39],v[236:237] op_sel_hi:[1,1,0]
 v_pk_fma_f32 v[104:105],v[40:41],v[40:41],v[236:237] op_sel_hi:[1,1,0]
 v_pk_fma_f32 v[106:107],v[42:43],v[42:43],v[236:237] op_sel_hi:[1,1,0]
 v_pk_fma_f32 v[108:109],v[44:45],v[44:45],v[236:237] op_sel_hi:[1,1,0]
 v_pk_fma_f32 v[110:111],v[46:47],v[46:47],v[236:237] op_sel_hi:[1,1,0]
 v_pk_mul_f32 v[100:101],v[100:101],v[36:37] neg_lo:[0,1] neg_hi:[0,1]
 v_pk_mul_f32 v[102:103],v[102:103],v[38:39] neg_lo:[0,1] neg_hi:[0,1]
 v_pk_mul_f32 v[104:105],v[104:105],v[40:41] neg_lo:[0,1] neg_hi:[0,1]
 v_pk_mul_f32 v[106:107],v[106:107],v[42:43] neg_lo:[0,1] neg_hi:[0,1]
 v_pk_mul_f32 v[108:109],v[108:109],v[44:45] neg_lo:[0,1] neg_hi:[0,1]
 v_pk_mul_f32 v[110:111],v[110:111],v[46:47] neg_lo:[0,1] neg_hi:[0,1]
 v_exp_f32 v100,v100
 v_exp_f32 v101,v101
 v_exp_f32 v102,v102
 v_exp_f32 v103,v103
 v_exp_f32 v104,v104
 v_exp_f32 v105,v105
 v_exp_f32 v106,v106
 v_exp_f32 v107,v107
 v_exp_f32 v108,v108
 v_exp_f32 v109,v109
 v_exp_f32 v110,v110
 v_exp_f32 v111,v111
 v_pk_add_f32 v[100:101],v[100:101],1.0 op_sel_hi:[1,0]
 v_pk_add_f32 v[102:103],v[102:103],1.0 op_sel_hi:[1,0]
 v_pk_add_f32 v[104:105],v[104:105],1.0 op_sel_hi:[1,0]
 v_pk_add_f32 v[106:107],v[106:107],1.0 op_sel_hi:[1,0]
 v_pk_add_f32 v[108:109],v[108:109],1.0 op_sel_hi:[1,0]
 v_pk_add_f32 v[110:111],v[110:111],1.0 op_sel_hi:[1,0]
 v_rcp_f32 v100,v100
 v_rcp_f32 v101,v101
 v_rcp_f32 v102,v102
 v_rcp_f32 v103,v103
 v_rcp_f32 v104,v104
 v_rcp_f32 v105,v105
 v_rcp_f32 v106,v106
 v_rcp_f32 v107,v107
 v_rcp_f32 v108,v108
 v_rcp_f32 v109,v109
 v_rcp_f32 v110,v110
 v_rcp_f32 v111,v111
 v_pk_mul_f32 v[100:101],v[100:101],v[36:37]
 v_pk_mul_f32 v[102:103],v[102:103],v[38:39]
 v_pk_mul_f32 v[104:105],v[104:105],v[40:41]
 v_pk_mul_f32 v[106:107],v[106:107],v[42:43]
 v_pk_mul_f32 v[108:109],v[108:109],v[44:45]
 v_pk_mul_f32 v[110:111],v[110:111],v[46:47]
 pk v36,v100,v101
 pk v37,v102,v103
 pk v38,v104,v105
 pk v39,v106,v107
 pk v40,v108,v109
 pk v41,v110,v111
 ds_write_b64 v234,v[36:37] offset:3072
 ds_write_b64 v235,v[38:39] offset:3072
 ds_write_b64 v241,v[40:41] offset:3072
 s_waitcnt vmcnt(16)
 rt a[128:129],v226 offset:0
 rt a[130:131],v226 offset:2048
 rt a[132:133],v226 offset:4096
 rt a[134:135],v226 offset:6144
 s_waitcnt lgkmcnt(4)
 s_barrier
 rq a[212:215],v255 offset:0
 rq a[228:231],v255 offset:4096
 rq a[216:219],v255 offset:1024
 rq a[232:235],v255 offset:5120
 rq a[220:223],v255 offset:2048
 rq a[236:239],v255 offset:6144
 rq a[224:227],v255 offset:3072
 rq a[240:243],v255 offset:7168
 rt a[136:137],v227 offset:0
 rt a[138:139],v227 offset:2048
 s_waitcnt lgkmcnt(8)
 mf v[0:3],a[128:131],a[212:215],0
 rt a[140:141],v227 offset:4096
 mf v[0:3],a[132:135],a[228:231],v[0:3]
 s_waitcnt lgkmcnt(7)
 mf v[16:19],a[132:135],a[232:235],0
 rt a[142:143],v227 offset:6144
 mf v[16:19],a[128:131],a[216:219],v[16:19]
 s_waitcnt lgkmcnt(6)
 rq a[160:163],v255 offset:8192
 mf v[32:35],a[128:131],a[220:223],0
 rt a[144:145],v228 offset:0
 mf v[32:35],a[132:135],a[236:239],v[32:35]
 s_waitcnt lgkmcnt(6)
 mf v[48:51],a[132:135],a[240:243],0
 rt a[146:147],v228 offset:2048
 mf v[48:51],a[128:131],a[224:227],v[48:51]
 s_waitcnt lgkmcnt(3)
 rq a[176:179],v255 offset:12288
 mf v[52:55],a[136:139],a[224:227],0
 rt a[148:149],v228 offset:4096
 mf v[52:55],a[140:143],a[240:243],v[52:55]
 mf v[36:39],a[140:143],a[236:239],0
 rt a[150:151],v228 offset:6144
 mf v[36:39],a[136:139],a[220:223],v[36:39]
 mf v[20:23],a[136:139],a[216:219],0
 rt a[152:153],v229 offset:0
 mf v[20:23],a[140:143],a[232:235],v[20:23]
 mf v[4:7],a[140:143],a[228:231],0
 rt a[154:155],v229 offset:2048
 mf v[4:7],a[136:139],a[212:215],v[4:7]
 s_waitcnt lgkmcnt(2)
 rq a[164:167],v255 offset:9216
 mf v[8:11],a[144:147],a[212:215],0
 rt a[156:157],v229 offset:4096
 mf v[8:11],a[148:151],a[228:231],v[8:11]
 mf v[24:27],a[148:151],a[232:235],0
 rt a[158:159],v229 offset:6144
 mf v[24:27],a[144:147],a[216:219],v[24:27]
 mf v[40:43],a[144:147],a[220:223],0
 s_waitcnt vmcnt(8)
 rt a[128:129],v230 offset:0
 mf v[40:43],a[148:151],a[236:239],v[40:43]
 mf v[56:59],a[148:151],a[240:243],0
 rt a[130:131],v230 offset:2048
 mf v[56:59],a[144:147],a[224:227],v[56:59]
 s_waitcnt lgkmcnt(2)
 s_add_u32 m0,s62,0
 rq a[180:183],v255 offset:13312
 mf v[60:63],a[152:155],a[224:227],0
 s_mov_b32 s63,65664
 rt a[132:133],v230 offset:4096
 mf v[60:63],a[156:159],a[240:243],v[60:63]
 bl v239,s[40:43],s63 offen offset:0 lds
 mf v[44:47],a[156:159],a[236:239],0
 rt a[134:135],v230 offset:6144
 mf v[44:47],a[152:155],a[220:223],v[44:47]
 mf v[28:31],a[152:155],a[216:219],0
 s_mov_b32 s63,72832
 rt a[136:137],v231 offset:0
 mf v[28:31],a[156:159],a[232:235],v[28:31]
 bl v239,s[40:43],s63 offen offset:1024 lds
 mf v[12:15],a[156:159],a[228:231],0
 rt a[138:139],v231 offset:2048
 mf v[12:15],a[152:155],a[212:215],v[12:15]
 s_waitcnt lgkmcnt(2)
 rq a[168:171],v255 offset:10240
 mf v[64:67],a[128:131],a[212:215],0
 s_mov_b32 s63,80000
 rt a[140:141],v231 offset:4096
 mf v[64:67],a[132:135],a[228:231],v[64:67]
 bl v239,s[40:43],s63 offen offset:2048 lds
 mf v[80:83],a[132:135],a[232:235],0
 rt a[142:143],v231 offset:6144
 mf v[80:83],a[128:131],a[216:219],v[80:83]
 rq a[184:187],v255 offset:14336
 mf v[96:99],a[128:131],a[220:223],0
 s_mov_b32 s63,87168
 rt a[144:145],v232 offset:0
 mf v[96:99],a[132:135],a[236:239],v[96:99]
 bl v239,s[40:43],s63 offen offset:3072 lds
 mf v[112:115],a[132:135],a[240:243],0
 rt a[146:147],v232 offset:2048
 mf v[112:115],a[128:131],a[224:227],v[112:115]
 s_waitcnt lgkmcnt(3)
 s_add_u32 m0,s62,4096
 mf v[116:119],a[136:139],a[224:227],0
 s_mov_b32 s63,98432
 rt a[148:149],v232 offset:4096
 mf v[116:119],a[140:143],a[240:243],v[116:119]
 bl v239,s[40:43],s63 offen offset:0 lds
 mf v[100:103],a[140:143],a[236:239],0
 rt a[150:151],v232 offset:6144
 mf v[100:103],a[136:139],a[220:223],v[100:103]
 rq a[172:175],v255 offset:11264
 mf v[84:87],a[136:139],a[216:219],0
 s_mov_b32 s63,105600
 rt a[152:153],v233 offset:0
 mf v[84:87],a[140:143],a[232:235],v[84:87]
 bl v239,s[40:43],s63 offen offset:1024 lds
 mf v[68:71],a[140:143],a[228:231],0
 rt a[154:155],v233 offset:2048
 mf v[68:71],a[136:139],a[212:215],v[68:71]
 s_waitcnt lgkmcnt(3)
 mf v[72:75],a[144:147],a[212:215],0
 s_mov_b32 s63,112768
 rt a[156:157],v233 offset:4096
 mf v[72:75],a[148:151],a[228:231],v[72:75]
 bl v239,s[40:43],s63 offen offset:2048 lds
 mf v[88:91],a[148:151],a[232:235],0
 rt a[158:159],v233 offset:6144
 mf v[88:91],a[144:147],a[216:219],v[88:91]
 rq a[188:191],v255 offset:15360
 mf v[104:107],a[144:147],a[220:223],0
 s_mov_b32 s63,119936
 s_waitcnt vmcnt(7)
 rt a[128:129],v226 offset:32768
 mf v[104:107],a[148:151],a[236:239],v[104:107]
 bl v239,s[40:43],s63 offen offset:3072 lds
 mf v[120:123],a[148:151],a[240:243],0
 rt a[130:131],v226 offset:34816
 mf v[120:123],a[144:147],a[224:227],v[120:123]
 s_waitcnt lgkmcnt(3)
 s_add_u32 m0,s62,65536
 mf v[124:127],a[152:155],a[224:227],0
 s_mov_b32 s63,131072
 rt a[132:133],v226 offset:36864
 mf v[124:127],a[156:159],a[240:243],v[124:127]
 bl v239,s[40:43],s63 offen offset:0 lds
 mf v[108:111],a[156:159],a[236:239],0
 rt a[134:135],v226 offset:38912
 mf v[108:111],a[152:155],a[220:223],v[108:111]
 mf v[92:95],a[152:155],a[216:219],0
 s_mov_b32 s63,138240
 rt a[136:137],v227 offset:32768
 mf v[92:95],a[156:159],a[232:235],v[92:95]
 bl v239,s[40:43],s63 offen offset:1024 lds
 mf v[76:79],a[156:159],a[228:231],0
 rt a[138:139],v227 offset:34816
 mf v[76:79],a[152:155],a[212:215],v[76:79]
 s_waitcnt lgkmcnt(2)
 mf v[0:3],a[128:131],a[160:163],v[0:3]
 s_mov_b32 s63,145408
 rt a[140:141],v227 offset:36864
 mf v[0:3],a[132:135],a[176:179],v[0:3]
 bl v239,s[40:43],s63 offen offset:2048 lds
 mf v[16:19],a[132:135],a[180:183],v[16:19]
 rt a[142:143],v227 offset:38912
 mf v[16:19],a[128:131],a[164:167],v[16:19]
 rq a[212:215],v255 offset:16384
 mf v[32:35],a[128:131],a[168:171],v[32:35]
 s_mov_b32 s63,152576
 rt a[144:145],v228 offset:32768
 mf v[32:35],a[132:135],a[184:187],v[32:35]
 bl v239,s[40:43],s63 offen offset:3072 lds
 mf v[48:51],a[132:135],a[188:191],v[48:51]
 rt a[146:147],v228 offset:34816
 mf v[48:51],a[128:131],a[172:175],v[48:51]
 s_waitcnt lgkmcnt(3)
 s_add_u32 m0,s62,69632
 rq a[228:231],v255 offset:20480
 mf v[52:55],a[136:139],a[172:175],v[52:55]
 s_mov_b32 s63,163840
 rt a[148:149],v228 offset:36864
 mf v[52:55],a[140:143],a[188:191],v[52:55]
 bl v239,s[40:43],s63 offen offset:0 lds
 mf v[36:39],a[140:143],a[184:187],v[36:39]
 rt a[150:151],v228 offset:38912
 mf v[36:39],a[136:139],a[168:171],v[36:39]
 mf v[20:23],a[136:139],a[164:167],v[20:23]
 s_mov_b32 s63,171008
 rt a[152:153],v229 offset:32768
 mf v[20:23],a[140:143],a[180:183],v[20:23]
 bl v239,s[40:43],s63 offen offset:1024 lds
 mf v[4:7],a[140:143],a[176:179],v[4:7]
 rt a[154:155],v229 offset:34816
 mf v[4:7],a[136:139],a[160:163],v[4:7]
 s_waitcnt lgkmcnt(2)
 rq a[216:219],v255 offset:17408
 mf v[8:11],a[144:147],a[160:163],v[8:11]
 s_mov_b32 s63,178176
 rt a[156:157],v229 offset:36864
 mf v[8:11],a[148:151],a[176:179],v[8:11]
 bl v239,s[40:43],s63 offen offset:2048 lds
 mf v[24:27],a[148:151],a[180:183],v[24:27]
 rt a[158:159],v229 offset:38912
 mf v[24:27],a[144:147],a[164:167],v[24:27]
 mf v[40:43],a[144:147],a[168:171],v[40:43]
 s_mov_b32 s63,185344
 s_waitcnt vmcnt(7)
 rt a[128:129],v226 offset:0
 mf v[40:43],a[148:151],a[184:187],v[40:43]
 bl v239,s[40:43],s63 offen offset:3072 lds
 mf v[56:59],a[148:151],a[188:191],v[56:59]
 rt a[130:131],v226 offset:2048
 mf v[56:59],a[144:147],a[172:175],v[56:59]
 s_waitcnt lgkmcnt(2)
 s_add_u32 m0,s62,32768
 rq a[232:235],v255 offset:21504
 mf v[60:63],a[152:155],a[172:175],v[60:63]
 s_mov_b32 s63,131200
 rt a[132:133],v226 offset:4096
 mf v[60:63],a[156:159],a[188:191],v[60:63]
 bl v239,s[40:43],s63 offen offset:0 lds
 mf v[44:47],a[156:159],a[184:187],v[44:47]
 rt a[134:135],v226 offset:6144
 mf v[44:47],a[152:155],a[168:171],v[44:47]
 mf v[28:31],a[152:155],a[164:167],v[28:31]
 s_mov_b32 s63,138368
 rt a[136:137],v227 offset:0
 mf v[28:31],a[156:159],a[180:183],v[28:31]
 bl v239,s[40:43],s63 offen offset:1024 lds
 mf v[12:15],a[156:159],a[176:179],v[12:15]
 rt a[138:139],v227 offset:2048
 mf v[12:15],a[152:155],a[160:163],v[12:15]
 s_waitcnt lgkmcnt(2)
 rq a[220:223],v255 offset:18432
 mf v[64:67],a[128:131],a[160:163],v[64:67]
 s_mov_b32 s63,145536
 rt a[140:141],v227 offset:4096
 mf v[64:67],a[132:135],a[176:179],v[64:67]
 bl v239,s[40:43],s63 offen offset:2048 lds
 mf v[80:83],a[132:135],a[180:183],v[80:83]
 rt a[142:143],v227 offset:6144
 mf v[80:83],a[128:131],a[164:167],v[80:83]
 rq a[236:239],v255 offset:22528
 mf v[96:99],a[128:131],a[168:171],v[96:99]
 s_mov_b32 s63,152704
 rt a[144:145],v228 offset:0
 mf v[96:99],a[132:135],a[184:187],v[96:99]
 bl v239,s[40:43],s63 offen offset:3072 lds
 mf v[112:115],a[132:135],a[188:191],v[112:115]
 rt a[146:147],v228 offset:2048
 mf v[112:115],a[128:131],a[172:175],v[112:115]
 s_waitcnt lgkmcnt(3)
 s_add_u32 m0,s62,36864
 mf v[116:119],a[136:139],a[172:175],v[116:119]
 s_mov_b32 s63,163968
 rt a[148:149],v228 offset:4096
 mf v[116:119],a[140:143],a[188:191],v[116:119]
 bl v239,s[40:43],s63 offen offset:0 lds
 mf v[100:103],a[140:143],a[184:187],v[100:103]
 rt a[150:151],v228 offset:6144
 mf v[100:103],a[136:139],a[168:171],v[100:103]
 rq a[224:227],v255 offset:19456
 mf v[84:87],a[136:139],a[164:167],v[84:87]
 s_mov_b32 s63,171136
 rt a[152:153],v229 offset:0
 mf v[84:87],a[140:143],a[180:183],v[84:87]
 bl v239,s[40:43],s63 offen offset:1024 lds
 mf v[68:71],a[140:143],a[176:179],v[68:71]
 rt a[154:155],v229 offset:2048
 mf v[68:71],a[136:139],a[160:163],v[68:71]
 s_waitcnt lgkmcnt(3)
 mf v[72:75],a[144:147],a[160:163],v[72:75]
 s_mov_b32 s63,178304
 rt a[156:157],v229 offset:4096
 mf v[72:75],a[148:151],a[176:179],v[72:75]
 bl v239,s[40:43],s63 offen offset:2048 lds
 mf v[88:91],a[148:151],a[180:183],v[88:91]
 rt a[158:159],v229 offset:6144
 mf v[88:91],a[144:147],a[164:167],v[88:91]
 rq a[240:243],v255 offset:23552
 mf v[104:107],a[144:147],a[168:171],v[104:107]
 s_mov_b32 s63,185472
 s_waitcnt vmcnt(7)
 rt a[128:129],v230 offset:0
 mf v[104:107],a[148:151],a[184:187],v[104:107]
 bl v239,s[40:43],s63 offen offset:3072 lds
 mf v[120:123],a[148:151],a[188:191],v[120:123]
 rt a[130:131],v230 offset:2048
 mf v[120:123],a[144:147],a[172:175],v[120:123]
 s_waitcnt lgkmcnt(3)
 s_add_u32 m0,s61,32768
 mf v[124:127],a[152:155],a[172:175],v[124:127]
 s_mov_b32 s63,360448
 rt a[132:133],v230 offset:4096
 mf v[124:127],a[156:159],a[188:191],v[124:127]
 bl v220,s[8:11],s63 offen offset:0 lds
 mf v[108:111],a[156:159],a[184:187],v[108:111]
 rt a[134:135],v230 offset:6144
 mf v[108:111],a[152:155],a[168:171],v[108:111]
 mf v[92:95],a[152:155],a[164:167],v[92:95]
 rt a[136:137],v231 offset:0
 mf v[92:95],a[156:159],a[180:183],v[92:95]
 bl v221,s[8:11],s63 offen offset:1024 lds
 mf v[76:79],a[156:159],a[176:179],v[76:79]
 rt a[138:139],v231 offset:2048
 mf v[76:79],a[152:155],a[160:163],v[76:79]
 s_waitcnt lgkmcnt(2)
 mf v[0:3],a[128:131],a[212:215],v[0:3]
 rt a[140:141],v231 offset:4096
 mf v[0:3],a[132:135],a[228:231],v[0:3]
 bl v222,s[8:11],s63 offen offset:2048 lds
 mf v[16:19],a[132:135],a[232:235],v[16:19]
 rt a[142:143],v231 offset:6144
 mf v[16:19],a[128:131],a[216:219],v[16:19]
 mf v[32:35],a[128:131],a[220:223],v[32:35]
 rt a[144:145],v232 offset:0
 mf v[32:35],a[132:135],a[236:239],v[32:35]
 bl v223,s[8:11],s63 offen offset:3072 lds
 mf v[48:51],a[132:135],a[240:243],v[48:51]
 rt a[146:147],v232 offset:2048
 mf v[48:51],a[128:131],a[224:227],v[48:51]
 s_waitcnt lgkmcnt(2)
 s_add_u32 m0,s61,49152
 mf v[52:55],a[136:139],a[224:227],v[52:55]
 s_mov_b32 s63,376832
 rt a[148:149],v232 offset:4096
 mf v[52:55],a[140:143],a[240:243],v[52:55]
 bl v220,s[8:11],s63 offen offset:0 lds
 mf v[36:39],a[140:143],a[236:239],v[36:39]
 rt a[150:151],v232 offset:6144
 mf v[36:39],a[136:139],a[220:223],v[36:39]
 mf v[20:23],a[136:139],a[216:219],v[20:23]
 rt a[152:153],v233 offset:0
 mf v[20:23],a[140:143],a[232:235],v[20:23]
 bl v221,s[8:11],s63 offen offset:1024 lds
 mf v[4:7],a[140:143],a[228:231],v[4:7]
L_pad_odd2:
 s_cbranch_execz L_hop8
 rt a[154:155],v233 offset:2048
 mf v[4:7],a[136:139],a[212:215],v[4:7]
 s_waitcnt lgkmcnt(2)
 mf v[8:11],a[144:147],a[212:215],v[8:11]
 rt a[156:157],v233 offset:4096
 mf v[8:11],a[148:151],a[228:231],v[8:11]
 bl v222,s[8:11],s63 offen offset:2048 lds
 mf v[24:27],a[148:151],a[232:235],v[24:27]
 rt a[158:159],v233 offset:6144
 mf v[24:27],a[144:147],a[216:219],v[24:27]
 mf v[40:43],a[144:147],a[220:223],v[40:43]
 s_waitcnt vmcnt(7)
 rt a[128:129],v226 offset:32768
 pk v0,v0,v1
 mf v[40:43],a[148:151],a[236:239],v[40:43]
 bl v223,s[8:11],s63 offen offset:3072 lds
 mf v[56:59],a[148:151],a[240:243],v[56:59]
 rt a[130:131],v226 offset:34816
 pk v1,v2,v3
 mf v[56:59],a[144:147],a[224:227],v[56:59]
 s_waitcnt lgkmcnt(2)
 pk v2,v4,v5
 pk v3,v6,v7
 mf v[60:63],a[152:155],a[224:227],v[60:63]
 rt a[132:133],v226 offset:36864
 v_accvgpr_write_b32 a160,v0
 mf v[60:63],a[156:159],a[240:243],v[60:63]
 v_accvgpr_write_b32 a161,v1
 v_accvgpr_write_b32 a162,v2
 mf v[44:47],a[156:159],a[236:239],v[44:47]
 rt a[134:135],v226 offset:38912
 v_accvgpr_write_b32 a163,v3
 mf v[44:47],a[152:155],a[220:223],v[44:47]
 pk v16,v16,v17
 pk v17,v18,v19
 mf v[28:31],a[152:155],a[216:219],v[28:31]
 rt a[136:137],v227 offset:32768
 pk v18,v20,v21
 mf v[28:31],a[156:159],a[232:235],v[28:31]
 pk v19,v22,v23
 v_accvgpr_write_b32 a168,v16
 mf v[12:15],a[156:159],a[228:231],v[12:15]
 rt a[138:139],v227 offset:34816
 v_accvgpr_write_b32 a169,v17
 mf v[12:15],a[152:155],a[212:215],v[12:15]
 s_waitcnt lgkmcnt(2)
 v_accvgpr_write_b32 a170,v18
 v_accvgpr_write_b32 a171,v19
 mf v[64:67],a[128:131],a[212:215],v[64:67]
 rt a[140:141],v227 offset:36864
 pk v32,v32,v33
 mf v[64:67],a[132:135],a[228:231],v[64:67]
 pk v33,v34,v35
 pk v34,v36,v37
 mf v[80:83],a[132:135],a[232:235],v[80:83]
 rt a[142:143],v227 offset:38912
 pk v35,v38,v39
 mf v[80:83],a[128:131],a[216:219],v[80:83]
 v_accvgpr_write_b32 a176,v32
 v_accvgpr_write_b32 a177,v33
 mf v[96:99],a[128:131],a[220:223],v[96:99]
 rt a[144:145],v228 offset:32768
 v_accvgpr_write_b32 a178,v34
 mf v[96:99],a[132:135],a[236:239],v[96:99]
 v_accvgpr_write_b32 a179,v35
 pk v48,v48,v49
 mf v[112:115],a[132:135],a[240:243],v[112:115]
 rt a[146:147],v228 offset:34816
 pk v49,v50,v51
 mf v[112:115],a[128:131],a[224:227],v[112:115]
 s_waitcnt lgkmcnt(2)
 pk v50,v52,v53
 pk v51,v54,v55
 mf v[116:119],a[136:139],a[224:227],v[116:119]
 rt a[148:149],v228 offset:36864
 v_accvgpr_write_b32 a184,v48
 mf v[116:119],a[140:143],a[240:243],v[116:119]
 v_accvgpr_write_b32 a185,v49
 v_accvgpr_write_b32 a186,v50
 mf v[100:103],a[140:143],a[236:239],v[100:103]
 rt a[150:151],v228 offset:38912
 v_accvgpr_write_b32 a187,v51
 mf v[100:103],a[136:139],a[220:223],v[100:103]
 pk v8,v8,v9
 pk v9,v10,v11
 mf v[84:87],a[136:139],a[216:219],v[84:87]
 rt a[152:153],v229 offset:32768
 pk v10,v12,v13
 mf v[84:87],a[140:143],a[232:235],v[84:87]
 pk v11,v14,v15
 v_accvgpr_write_b32 a164,v8
 mf v[68:71],a[140:143],a[228:231],v[68:71]
 rt a[154:155],v229 offset:34816
 v_accvgpr_write_b32 a165,v9
 mf v[68:71],a[136:139],a[212:215],v[68:71]
 s_waitcnt lgkmcnt(2)
 v_accvgpr_write_b32 a166,v10
 v_accvgpr_write_b32 a167,v11
 mf v[72:75],a[144:147],a[212:215],v[72:75]
 rt a[156:157],v229 offset:36864
 pk v24,v24,v25
 mf v[72:75],a[148:151],a[228:231],v[72:75]
 pk v25,v26,v27
 pk v26,v28,v29
 mf v[88:91],a[148:151],a[232:235],v[88:91]
 rt a[158:159],v229 offset:38912
 pk v27,v30,v31
 mf v[88:91],a[144:147],a[216:219],v[88:91]
 v_accvgpr_write_b32 a172,v24
 v_accvgpr_write_b32 a173,v25
 mf v[104:107],a[144:147],a[220:223],v[104:107]
 v_accvgpr_write_b32 a174,v26
 v_accvgpr_write_b32 a175,v27
 mf v[104:107],a[148:151],a[236:239],v[104:107]
 pk v40,v40,v41
 pk v41,v42,v43
 mf v[120:123],a[148:151],a[240:243],v[120:123]
 pk v42,v44,v45
 pk v43,v46,v47
 mf v[120:123],a[144:147],a[224:227],v[120:123]
 s_waitcnt lgkmcnt(0)
 v_accvgpr_write_b32 a180,v40
 v_accvgpr_write_b32 a181,v41
 mf v[124:127],a[152:155],a[224:227],v[124:127]
 v_accvgpr_write_b32 a182,v42
 v_accvgpr_write_b32 a183,v43
 mf v[124:127],a[156:159],a[240:243],v[124:127]
 pk v56,v56,v57
 pk v57,v58,v59
 mf v[108:111],a[156:159],a[236:239],v[108:111]
 pk v58,v60,v61
 pk v59,v62,v63
 mf v[108:111],a[152:155],a[220:223],v[108:111]
 v_accvgpr_write_b32 a188,v56
 v_accvgpr_write_b32 a189,v57
 mf v[92:95],a[152:155],a[216:219],v[92:95]
 v_accvgpr_write_b32 a190,v58
 v_accvgpr_write_b32 a191,v59
 mf v[92:95],a[156:159],a[232:235],v[92:95]
 mf v[76:79],a[156:159],a[228:231],v[76:79]
 mf v[76:79],a[152:155],a[212:215],v[76:79]
 s_waitcnt vmcnt(0)
 s_barrier
 rq a[128:131],v208 offset:32768
 rq a[132:135],v209 offset:32768
 rq a[136:139],v210 offset:32768
 rq a[140:143],v211 offset:32768
 rq a[144:147],v208 offset:36864
 rq a[148:151],v209 offset:36864
 rq a[152:155],v210 offset:36864
 rq a[156:159],v211 offset:36864
 s_branch L_join
L_end:
 s_endpgm
.section .rodata,"a"
.p2align 6
.amdhsa_kernel recurrent_scan__gqa_block_cached__mixer_s_mlp__prompt_kernel
  .amdhsa_next_free_vgpr 512
  .amdhsa_next_free_sgpr 102
  .amdhsa_accum_offset 256
  .amdhsa_group_segment_fixed_size 0
  .amdhsa_kernarg_size 104
  .amdhsa_user_sgpr_count 2
  .amdhsa_user_sgpr_kernarg_segment_ptr 1
  .amdhsa_system_sgpr_workgroup_id_x 1
  .amdhsa_float_denorm_mode_32 3
.end_amdhsa_kernel
```
